```python
import torch

def _softmax(x, axis=-1):
    return torch.softmax(x, dim=axis)

def _gelu(x):
    return torch.nn.functional.gelu(x, approximate='tanh')

def _silu(x):
    return torch.nn.functional.silu(x)

def _sigmoid(x):
    return torch.sigmoid(x)

def _layernorm(x, axis=-1, eps=1e-05):
    m = x.mean(dim=axis, keepdim=True)
    v = x.var(dim=axis, keepdim=True, unbiased=False)
    return (x - m) / torch.sqrt(v + eps)

def _scatter_add(tgt, idx, src, axis=0):
    return tgt.clone().index_add_(axis, idx, src)

def _segment_sum(src, seg, n):
    out = torch.zeros((n,) + src.shape[1:], dtype=src.dtype)
    return out.index_add_(0, seg, src)

def _pad(x, pw):
    flat = tuple((v for pair in reversed(pw) for v in pair))
    return torch.nn.functional.pad(x, flat)
kernel_name = 'sequential_preLN__memory_aug_recurrent_mem_tr__dense_activation_gelu__prompt'

def setup_inputs():

    _w = lambda a: (lambda t: t.to(torch.bfloat16) if t.is_floating_point() else t)(torch.as_tensor(a))

    def _A_setup():
        B, S, Dm = (1, 2048, 576)
        H, Dh = (32, 128)
        M, seg = (8, 32)
        seg = min(seg, S)
        S = S // seg * seg
        return {'x': _w((lambda *s: torch.randn(*s, dtype=torch.bfloat16) * 0.05)(B, S, Dm)), 'mem0': _w((lambda *s: torch.randn(*s, dtype=torch.bfloat16) * 0.2)(B, M, Dm)), 'Wq': _w((lambda *s: torch.randn(*s, dtype=torch.bfloat16) * 1.6)(Dm, H, Dh) * Dm ** (-0.5)), 'Wk': _w((lambda *s: torch.randn(*s, dtype=torch.bfloat16) * 1.6)(Dm, H, Dh) * Dm ** (-0.5)), 'Wv': _w((lambda *s: torch.randn(*s, dtype=torch.bfloat16) * 0.2)(Dm, H, Dh) * Dm ** (-0.5)), 'Wo': _w((lambda *s: torch.randn(*s, dtype=torch.bfloat16) * 0.2)(H, Dh, Dm) * (H * Dh) ** (-0.5)), 'seg_len': seg}
    _A_in = _A_setup()

    def _B_setup():
        B, S, D, F = (1, 2048, 576, 4608)
        return {'x': _w((lambda *s: torch.randn(*s, dtype=torch.bfloat16) * 0.05)(B, S, D)), 'w1': _w((lambda *s: torch.randn(*s, dtype=torch.bfloat16) * 0.4)(D, F) * D ** (-0.5)), 'b1': _w((lambda *s: torch.randn(*s, dtype=torch.bfloat16) * 12.8)(F) * 0.01), 'w2': _w((lambda *s: torch.randn(*s, dtype=torch.bfloat16) * 0.2)(F, D) * F ** (-0.5)), 'b2': _w((lambda *s: torch.randn(*s, dtype=torch.bfloat16) * 3.2)(D) * 0.01)}
    _B_in = _B_setup()
    return {'A_x': _A_in['x'], 'A_mem0': _A_in['mem0'], 'A_Wq': _A_in['Wq'], 'A_Wk': _A_in['Wk'], 'A_Wv': _A_in['Wv'], 'A_Wo': _A_in['Wo'], 'A_seg_len': _A_in['seg_len'], 'B_x': _B_in['x'], 'B_w1': _B_in['w1'], 'B_b1': _B_in['b1'], 'B_w2': _B_in['w2'], 'B_b2': _B_in['b2']}

def reference(A_x, A_mem0, A_Wq, A_Wk, A_Wv, A_Wo, A_seg_len, B_x, B_w1, B_b1, B_w2, B_b2):

    def _A_ref(x, mem0, Wq, Wk, Wv, Wo, seg_len):
        B, S, Dm = x.shape
        H, Dh = (Wq.shape[1], Wq.shape[2])
        M = mem0.shape[1]
        scale = Dh ** (-0.5)
        n_seg = S // seg_len
        L = M + seg_len
        idx = torch.arange(L)
        mask = (idx[:, None] < M) | (idx[:, None] >= idx[None, :])
        mem = mem0
        outs = []
        for s in range(n_seg):
            xs = x[:, s * seg_len:(s + 1) * seg_len, :].clone()
            h = torch.concatenate([mem, xs], axis=1)
            q = torch.einsum('btd,dhe->bhte', h, Wq)
            k = torch.einsum('btd,dhe->bhte', h, Wk)
            v = torch.einsum('btd,dhe->bhte', h, Wv)
            scores = torch.einsum('bhqe,bhke->bhqk', q, k) * scale
            scores = torch.where(mask[None, None], scores, -1000000000.0)
            p = _softmax(scores, axis=-1)
            o = torch.einsum('bhqk,bhke->bhqe', p, v)
            o = torch.einsum('bhte,hed->btd', o, Wo)
            mem = o[:, :M, :].clone()
            outs.append(o[:, M:, :])
        return torch.concatenate(outs, axis=1)

    def _B_ref(x, w1, b1, w2, b2):
        h = torch.einsum('bsd,df->bsf', x, w1) + b1
        h = _gelu(h)
        return torch.einsum('bsf,fd->bsd', h, w2) + b2
    x = A_x
    h = x + _A_ref(_layernorm(x, axis=-1), A_mem0, A_Wq, A_Wk, A_Wv, A_Wo, A_seg_len)
    h2 = h + _B_ref(_layernorm(h, axis=-1), B_w1, B_b1, B_w2, B_b2)
    return h2
```

```asm
; @launch grid=(256,1,1) block=(256,1,1) lds=163840
.amdgcn_target "amdgcn-amd-amdhsa--gfx950"
.text
.globl sequential_preLN__memory_aug_recurrent_mem_tr__dense_activation_gelu__prompt_kernel
.p2align 8
.type sequential_preLN__memory_aug_recurrent_mem_tr__dense_activation_gelu__prompt_kernel,@function
sequential_preLN__memory_aug_recurrent_mem_tr__dense_activation_gelu__prompt_kernel:
    s_cmp_ge_u32 s2, 256
    s_cbranch_scc1 L_abort
    s_load_dwordx4 s[4:7], s[0:1], 104
    v_lshrrev_b32 v20, 6, v0
    s_getreg_b32 s67, hwreg(HW_REG_XCC_ID)
    v_readfirstlane_b32 s17, v20
    s_and_b32 s67, s67, 7
    s_waitcnt lgkmcnt(0)
    s_mov_b32 s8, s6
    s_and_b32 s9, s7, 0xffff
    s_mov_b32 s10, 268435456
    s_mov_b32 s11, 0x00020000
    s_mov_b32 s12, s4
    s_and_b32 s13, s5, 0xffff
    s_mov_b32 s14, 256
    s_mov_b32 s15, 0x00020000
    s_cmp_lg_u32 s17, 0
    s_cbranch_scc1 L_claimed
    s_mov_b64 exec, 1
    s_mov_b32 s31, s67
    s_mov_b32 s32, 0
L_claim:
    v_mov_b32 v20, 1
    s_lshl_b32 s30, s31, 2
    buffer_atomic_add v20, off, s[12:15], s30 sc0 sc1
    s_waitcnt vmcnt(0)
    v_readfirstlane_b32 s30, v20
    s_nop 0
    s_cmp_lt_u32 s30, 32
    s_nop 2
    s_cbranch_scc1 L_claim_ok
    s_add_u32 s31, s31, 1
    s_and_b32 s31, s31, 7
    s_add_u32 s32, s32, 1
    s_cmp_lt_u32 s32, 8
    s_cbranch_scc1 L_claim
    s_mov_b32 s31, 8
L_claim_ok:
    s_lshl_b32 s31, s31, 5
    s_add_u32 s31, s31, s30
    v_mov_b32 v20, s31
    v_mov_b32 v21, 23552
    ds_write_b32 v21, v20
    s_cmp_ge_u32 s31, 32
    s_cbranch_scc1 L_noreg
    s_lshl_b32 s30, s67, 2
    s_add_u32 s30, s30, 164
    v_mov_b32 v20, 1
    buffer_atomic_add v20, off, s[12:15], s30 sc1
    s_nop 0
L_noreg:
    s_mov_b64 exec, -1
    s_waitcnt lgkmcnt(0)
L_claimed:
    s_barrier
    v_mov_b32 v21, 23552
    ds_read_b32 v20, v21
    s_waitcnt lgkmcnt(0)
    v_readfirstlane_b32 s66, v20
    s_nop 0
    s_cmp_lt_u32 s66, 32
    s_nop 2
    s_cbranch_scc1 L_role_r
    s_cmp_ge_u32 s66, 256
    s_cbranch_scc1 L_abort
    s_sub_u32 s64, s66, 32
    s_barrier
    s_and_b32 s20, s64, 31
    s_lshr_b32 s21, s64, 5
    s_lshl_b32 s21, s21, 2
    s_add_u32 s21, s21, s17
    s_mul_i32 s22, s21, 57
    s_lshr_b32 s22, s22, 9
    s_min_u32 s30, s22, 2
    s_lshl_b32 s30, s30, 3
    s_add_u32 s30, s30, 16
    s_load_dwordx2 s[36:37], s[0:1], s30
    s_load_dwordx4 s[40:43], s[0:1], 0
    v_and_b32 v1, 63, v0
    v_lshlrev_b32 v2, 4, v1
    v_lshlrev_b32 v3, 3, v1
    s_lshl_b32 s35, s64, 2
    s_add_u32 s35, s35, s17
    s_waitcnt lgkmcnt(0)
    s_branch L_p0_b
    s_cmp_ge_u32 s21, 27
    s_cbranch_scc1 L_p0_noimg
    v_mov_b32 v4, 0
    v_bfe_u32 v8, v1, 0, 1
    v_lshl_add_u32 v4, v8, 4, v4
    v_bfe_u32 v8, v1, 1, 1
    v_lshl_add_u32 v4, v8, 17, v4
    v_bfe_u32 v8, v1, 2, 1
    v_lshl_add_u32 v4, v8, 14, v4
    v_bfe_u32 v8, v1, 3, 1
    v_lshl_add_u32 v4, v8, 13, v4
    v_bfe_u32 v8, v1, 4, 1
    v_lshl_add_u32 v4, v8, 15, v4
    v_bfe_u32 v8, v1, 5, 1
    v_lshl_add_u32 v4, v8, 18, v4
    v_mov_b32 v5, 1048576
    v_bfe_u32 v8, v1, 0, 1
    v_lshl_add_u32 v5, v8, 4, v5
    v_bfe_u32 v8, v1, 1, 1
    v_lshl_add_u32 v5, v8, 13, v5
    v_bfe_u32 v8, v1, 2, 1
    v_lshl_add_u32 v5, v8, 16, v5
    v_bfe_u32 v8, v1, 3, 1
    v_lshl_add_u32 v5, v8, 15, v5
    v_bfe_u32 v8, v1, 4, 1
    s_mov_b32 s30, 1179648
    v_mad_u32_u24 v5, v8, s30, v5
    v_bfe_u32 v8, v1, 5, 1
    v_lshl_add_u32 v5, v8, 14, v5
    s_lshl_b32 s26, s17, 14
    v_add_u32 v7, s26, v3
    s_mul_i32 s30, s22, 9
    s_sub_u32 s23, s21, s30
    s_lshl_b32 s23, s23, 3
    s_waitcnt lgkmcnt(0)
    s_mov_b32 s48, s36
    s_and_b32 s49, s37, 0xffff
    s_mov_b32 s50, 4718592
    s_mov_b32 s51, 0x00020000
    s_add_u32 s31, s23, 0
    s_mul_i32 s32, s31, 57
    s_lshr_b32 s32, s32, 10
    s_mul_i32 s33, s32, 18
    s_sub_u32 s31, s31, s33
    s_lshl_b32 s33, s20, 2
    s_add_u32 s33, s33, s32
    s_mul_i32 s56, s33, 147456
    s_mul_i32 s33, s22, 18
    s_add_u32 s33, s33, s31
    s_lshl_b32 s33, s33, 11
    s_add_u32 s56, s56, s33
    s_add_u32 s56, s56, 134217728
    s_lshl_b32 s25, s20, 8
    s_lshl_b32 s32, s32, 6
    s_add_u32 s25, s25, s32
    s_and_b32 s32, s31, 1
    s_lshl_b32 s32, s32, 5
    s_add_u32 s25, s25, s32
    s_lshr_b32 s32, s31, 2
    s_mul_i32 s28, s32, 1179648
    s_bfe_u32 s32, s31, 65537
    s_lshl_b32 s32, s32, 19
    s_add_u32 s28, s28, s32
    s_cmp_ge_u32 s31, 16
    s_cselect_b32 s28, 0, s28
    s_mov_b32 s34, 65536
    s_cselect_b32 s34, 2359296, s34
    s_cselect_b64 vcc, -1, 0
    v_cndmask_b32 v6, v4, v5, vcc
    s_add_u32 s28, s28, s25
    s_add_u32 m0, s26, 0
    s_nop 0
    buffer_load_dwordx4 v6, s[48:51], s28 offen lds
    s_add_u32 s28, s28, s34
    s_add_u32 m0, s26, 1024
    s_nop 0
    buffer_load_dwordx4 v6, s[48:51], s28 offen lds
    s_add_u32 s31, s23, 1
    s_mul_i32 s32, s31, 57
    s_lshr_b32 s32, s32, 10
    s_mul_i32 s33, s32, 18
    s_sub_u32 s31, s31, s33
    s_lshl_b32 s33, s20, 2
    s_add_u32 s33, s33, s32
    s_mul_i32 s57, s33, 147456
    s_mul_i32 s33, s22, 18
    s_add_u32 s33, s33, s31
    s_lshl_b32 s33, s33, 11
    s_add_u32 s57, s57, s33
    s_add_u32 s57, s57, 134217728
    s_lshl_b32 s25, s20, 8
    s_lshl_b32 s32, s32, 6
    s_add_u32 s25, s25, s32
    s_and_b32 s32, s31, 1
    s_lshl_b32 s32, s32, 5
    s_add_u32 s25, s25, s32
    s_lshr_b32 s32, s31, 2
    s_mul_i32 s28, s32, 1179648
    s_bfe_u32 s32, s31, 65537
    s_lshl_b32 s32, s32, 19
    s_add_u32 s28, s28, s32
    s_cmp_ge_u32 s31, 16
    s_cselect_b32 s28, 0, s28
    s_mov_b32 s34, 65536
    s_cselect_b32 s34, 2359296, s34
    s_cselect_b64 vcc, -1, 0
    v_cndmask_b32 v6, v4, v5, vcc
    s_add_u32 s28, s28, s25
    s_add_u32 m0, s26, 2048
    s_nop 0
    buffer_load_dwordx4 v6, s[48:51], s28 offen lds
    s_add_u32 s28, s28, s34
    s_add_u32 m0, s26, 3072
    s_nop 0
    buffer_load_dwordx4 v6, s[48:51], s28 offen lds
    s_add_u32 s31, s23, 2
    s_mul_i32 s32, s31, 57
    s_lshr_b32 s32, s32, 10
    s_mul_i32 s33, s32, 18
    s_sub_u32 s31, s31, s33
    s_lshl_b32 s33, s20, 2
    s_add_u32 s33, s33, s32
    s_mul_i32 s58, s33, 147456
    s_mul_i32 s33, s22, 18
    s_add_u32 s33, s33, s31
    s_lshl_b32 s33, s33, 11
    s_add_u32 s58, s58, s33
    s_add_u32 s58, s58, 134217728
    s_lshl_b32 s25, s20, 8
    s_lshl_b32 s32, s32, 6
    s_add_u32 s25, s25, s32
    s_and_b32 s32, s31, 1
    s_lshl_b32 s32, s32, 5
    s_add_u32 s25, s25, s32
    s_lshr_b32 s32, s31, 2
    s_mul_i32 s28, s32, 1179648
    s_bfe_u32 s32, s31, 65537
    s_lshl_b32 s32, s32, 19
    s_add_u32 s28, s28, s32
    s_cmp_ge_u32 s31, 16
    s_cselect_b32 s28, 0, s28
    s_mov_b32 s34, 65536
    s_cselect_b32 s34, 2359296, s34
    s_cselect_b64 vcc, -1, 0
    v_cndmask_b32 v6, v4, v5, vcc
    s_add_u32 s28, s28, s25
    s_add_u32 m0, s26, 4096
    s_nop 0
    buffer_load_dwordx4 v6, s[48:51], s28 offen lds
    s_add_u32 s28, s28, s34
    s_add_u32 m0, s26, 5120
    s_nop 0
    buffer_load_dwordx4 v6, s[48:51], s28 offen lds
    s_add_u32 s31, s23, 3
    s_mul_i32 s32, s31, 57
    s_lshr_b32 s32, s32, 10
    s_mul_i32 s33, s32, 18
    s_sub_u32 s31, s31, s33
    s_lshl_b32 s33, s20, 2
    s_add_u32 s33, s33, s32
    s_mul_i32 s59, s33, 147456
    s_mul_i32 s33, s22, 18
    s_add_u32 s33, s33, s31
    s_lshl_b32 s33, s33, 11
    s_add_u32 s59, s59, s33
    s_add_u32 s59, s59, 134217728
    s_lshl_b32 s25, s20, 8
    s_lshl_b32 s32, s32, 6
    s_add_u32 s25, s25, s32
    s_and_b32 s32, s31, 1
    s_lshl_b32 s32, s32, 5
    s_add_u32 s25, s25, s32
    s_lshr_b32 s32, s31, 2
    s_mul_i32 s28, s32, 1179648
    s_bfe_u32 s32, s31, 65537
    s_lshl_b32 s32, s32, 19
    s_add_u32 s28, s28, s32
    s_cmp_ge_u32 s31, 16
    s_cselect_b32 s28, 0, s28
    s_mov_b32 s34, 65536
    s_cselect_b32 s34, 2359296, s34
    s_cselect_b64 vcc, -1, 0
    v_cndmask_b32 v6, v4, v5, vcc
    s_add_u32 s28, s28, s25
    s_add_u32 m0, s26, 6144
    s_nop 0
    buffer_load_dwordx4 v6, s[48:51], s28 offen lds
    s_add_u32 s28, s28, s34
    s_add_u32 m0, s26, 7168
    s_nop 0
    buffer_load_dwordx4 v6, s[48:51], s28 offen lds
    s_add_u32 s31, s23, 4
    s_mul_i32 s32, s31, 57
    s_lshr_b32 s32, s32, 10
    s_mul_i32 s33, s32, 18
    s_sub_u32 s31, s31, s33
    s_lshl_b32 s33, s20, 2
    s_add_u32 s33, s33, s32
    s_mul_i32 s60, s33, 147456
    s_mul_i32 s33, s22, 18
    s_add_u32 s33, s33, s31
    s_lshl_b32 s33, s33, 11
    s_add_u32 s60, s60, s33
    s_add_u32 s60, s60, 134217728
    s_lshl_b32 s25, s20, 8
    s_lshl_b32 s32, s32, 6
    s_add_u32 s25, s25, s32
    s_and_b32 s32, s31, 1
    s_lshl_b32 s32, s32, 5
    s_add_u32 s25, s25, s32
    s_lshr_b32 s32, s31, 2
    s_mul_i32 s28, s32, 1179648
    s_bfe_u32 s32, s31, 65537
    s_lshl_b32 s32, s32, 19
    s_add_u32 s28, s28, s32
    s_cmp_ge_u32 s31, 16
    s_cselect_b32 s28, 0, s28
    s_mov_b32 s34, 65536
    s_cselect_b32 s34, 2359296, s34
    s_cselect_b64 vcc, -1, 0
    v_cndmask_b32 v6, v4, v5, vcc
    s_add_u32 s28, s28, s25
    s_add_u32 m0, s26, 8192
    s_nop 0
    buffer_load_dwordx4 v6, s[48:51], s28 offen lds
    s_add_u32 s28, s28, s34
    s_add_u32 m0, s26, 9216
    s_nop 0
    buffer_load_dwordx4 v6, s[48:51], s28 offen lds
    s_add_u32 s31, s23, 5
    s_mul_i32 s32, s31, 57
    s_lshr_b32 s32, s32, 10
    s_mul_i32 s33, s32, 18
    s_sub_u32 s31, s31, s33
    s_lshl_b32 s33, s20, 2
    s_add_u32 s33, s33, s32
    s_mul_i32 s61, s33, 147456
    s_mul_i32 s33, s22, 18
    s_add_u32 s33, s33, s31
    s_lshl_b32 s33, s33, 11
    s_add_u32 s61, s61, s33
    s_add_u32 s61, s61, 134217728
    s_lshl_b32 s25, s20, 8
    s_lshl_b32 s32, s32, 6
    s_add_u32 s25, s25, s32
    s_and_b32 s32, s31, 1
    s_lshl_b32 s32, s32, 5
    s_add_u32 s25, s25, s32
    s_lshr_b32 s32, s31, 2
    s_mul_i32 s28, s32, 1179648
    s_bfe_u32 s32, s31, 65537
    s_lshl_b32 s32, s32, 19
    s_add_u32 s28, s28, s32
    s_cmp_ge_u32 s31, 16
    s_cselect_b32 s28, 0, s28
    s_mov_b32 s34, 65536
    s_cselect_b32 s34, 2359296, s34
    s_cselect_b64 vcc, -1, 0
    v_cndmask_b32 v6, v4, v5, vcc
    s_add_u32 s28, s28, s25
    s_add_u32 m0, s26, 10240
    s_nop 0
    buffer_load_dwordx4 v6, s[48:51], s28 offen lds
    s_add_u32 s28, s28, s34
    s_add_u32 m0, s26, 11264
    s_nop 0
    buffer_load_dwordx4 v6, s[48:51], s28 offen lds
    s_add_u32 s31, s23, 6
    s_mul_i32 s32, s31, 57
    s_lshr_b32 s32, s32, 10
    s_mul_i32 s33, s32, 18
    s_sub_u32 s31, s31, s33
    s_lshl_b32 s33, s20, 2
    s_add_u32 s33, s33, s32
    s_mul_i32 s62, s33, 147456
    s_mul_i32 s33, s22, 18
    s_add_u32 s33, s33, s31
    s_lshl_b32 s33, s33, 11
    s_add_u32 s62, s62, s33
    s_add_u32 s62, s62, 134217728
    s_lshl_b32 s25, s20, 8
    s_lshl_b32 s32, s32, 6
    s_add_u32 s25, s25, s32
    s_and_b32 s32, s31, 1
    s_lshl_b32 s32, s32, 5
    s_add_u32 s25, s25, s32
    s_lshr_b32 s32, s31, 2
    s_mul_i32 s28, s32, 1179648
    s_bfe_u32 s32, s31, 65537
    s_lshl_b32 s32, s32, 19
    s_add_u32 s28, s28, s32
    s_cmp_ge_u32 s31, 16
    s_cselect_b32 s28, 0, s28
    s_mov_b32 s34, 65536
    s_cselect_b32 s34, 2359296, s34
    s_cselect_b64 vcc, -1, 0
    v_cndmask_b32 v6, v4, v5, vcc
    s_add_u32 s28, s28, s25
    s_add_u32 m0, s26, 12288
    s_nop 0
    buffer_load_dwordx4 v6, s[48:51], s28 offen lds
    s_add_u32 s28, s28, s34
    s_add_u32 m0, s26, 13312
    s_nop 0
    buffer_load_dwordx4 v6, s[48:51], s28 offen lds
    s_add_u32 s31, s23, 7
    s_mul_i32 s32, s31, 57
    s_lshr_b32 s32, s32, 10
    s_mul_i32 s33, s32, 18
    s_sub_u32 s31, s31, s33
    s_lshl_b32 s33, s20, 2
    s_add_u32 s33, s33, s32
    s_mul_i32 s63, s33, 147456
    s_mul_i32 s33, s22, 18
    s_add_u32 s33, s33, s31
    s_lshl_b32 s33, s33, 11
    s_add_u32 s63, s63, s33
    s_add_u32 s63, s63, 134217728
    s_lshl_b32 s25, s20, 8
    s_lshl_b32 s32, s32, 6
    s_add_u32 s25, s25, s32
    s_and_b32 s32, s31, 1
    s_lshl_b32 s32, s32, 5
    s_add_u32 s25, s25, s32
    s_lshr_b32 s32, s31, 2
    s_mul_i32 s28, s32, 1179648
    s_bfe_u32 s32, s31, 65537
    s_lshl_b32 s32, s32, 19
    s_add_u32 s28, s28, s32
    s_cmp_ge_u32 s31, 16
    s_cselect_b32 s28, 0, s28
    s_mov_b32 s34, 65536
    s_cselect_b32 s34, 2359296, s34
    s_cselect_b64 vcc, -1, 0
    v_cndmask_b32 v6, v4, v5, vcc
    s_add_u32 s28, s28, s25
    s_add_u32 m0, s26, 14336
    s_nop 0
    buffer_load_dwordx4 v6, s[48:51], s28 offen lds
    s_add_u32 s28, s28, s34
    s_add_u32 m0, s26, 15360
    s_nop 0
    buffer_load_dwordx4 v6, s[48:51], s28 offen lds
    s_waitcnt vmcnt(14)
    ds_read_b64_tr_b16 v[16:17], v7 offset:0
    ds_read_b64_tr_b16 v[18:19], v7 offset:512
    ds_read_b64_tr_b16 v[20:21], v7 offset:1024
    ds_read_b64_tr_b16 v[22:23], v7 offset:1536
    s_waitcnt lgkmcnt(0)
    buffer_store_dwordx4 v[16:19], v2, s[8:11], s56 offen offset:0 sc1
    buffer_store_dwordx4 v[20:23], v2, s[8:11], s56 offen offset:1024 sc1
    s_waitcnt vmcnt(14)
    ds_read_b64_tr_b16 v[24:25], v7 offset:2048
    ds_read_b64_tr_b16 v[26:27], v7 offset:2560
    ds_read_b64_tr_b16 v[28:29], v7 offset:3072
    ds_read_b64_tr_b16 v[30:31], v7 offset:3584
    s_waitcnt lgkmcnt(0)
    buffer_store_dwordx4 v[24:27], v2, s[8:11], s57 offen offset:0 sc1
    buffer_store_dwordx4 v[28:31], v2, s[8:11], s57 offen offset:1024 sc1
    s_waitcnt vmcnt(14)
    ds_read_b64_tr_b16 v[32:33], v7 offset:4096
    ds_read_b64_tr_b16 v[34:35], v7 offset:4608
    ds_read_b64_tr_b16 v[36:37], v7 offset:5120
    ds_read_b64_tr_b16 v[38:39], v7 offset:5632
    s_waitcnt lgkmcnt(0)
    buffer_store_dwordx4 v[32:35], v2, s[8:11], s58 offen offset:0 sc1
    buffer_store_dwordx4 v[36:39], v2, s[8:11], s58 offen offset:1024 sc1
    s_waitcnt vmcnt(14)
    ds_read_b64_tr_b16 v[40:41], v7 offset:6144
    ds_read_b64_tr_b16 v[42:43], v7 offset:6656
    ds_read_b64_tr_b16 v[44:45], v7 offset:7168
    ds_read_b64_tr_b16 v[46:47], v7 offset:7680
    s_waitcnt lgkmcnt(0)
    buffer_store_dwordx4 v[40:43], v2, s[8:11], s59 offen offset:0 sc1
    buffer_store_dwordx4 v[44:47], v2, s[8:11], s59 offen offset:1024 sc1
    s_waitcnt vmcnt(14)
    ds_read_b64_tr_b16 v[48:49], v7 offset:8192
    ds_read_b64_tr_b16 v[50:51], v7 offset:8704
    ds_read_b64_tr_b16 v[52:53], v7 offset:9216
    ds_read_b64_tr_b16 v[54:55], v7 offset:9728
    s_waitcnt lgkmcnt(0)
    buffer_store_dwordx4 v[48:51], v2, s[8:11], s60 offen offset:0 sc1
    buffer_store_dwordx4 v[52:55], v2, s[8:11], s60 offen offset:1024 sc1
    s_waitcnt vmcnt(14)
    ds_read_b64_tr_b16 v[56:57], v7 offset:10240
    ds_read_b64_tr_b16 v[58:59], v7 offset:10752
    ds_read_b64_tr_b16 v[60:61], v7 offset:11264
    ds_read_b64_tr_b16 v[62:63], v7 offset:11776
    s_waitcnt lgkmcnt(0)
    buffer_store_dwordx4 v[56:59], v2, s[8:11], s61 offen offset:0 sc1
    buffer_store_dwordx4 v[60:63], v2, s[8:11], s61 offen offset:1024 sc1
    s_waitcnt vmcnt(14)
    ds_read_b64_tr_b16 v[64:65], v7 offset:12288
    ds_read_b64_tr_b16 v[66:67], v7 offset:12800
    ds_read_b64_tr_b16 v[68:69], v7 offset:13312
    ds_read_b64_tr_b16 v[70:71], v7 offset:13824
    s_waitcnt lgkmcnt(0)
    buffer_store_dwordx4 v[64:67], v2, s[8:11], s62 offen offset:0 sc1
    buffer_store_dwordx4 v[68:71], v2, s[8:11], s62 offen offset:1024 sc1
    s_waitcnt vmcnt(14)
    ds_read_b64_tr_b16 v[72:73], v7 offset:14336
    ds_read_b64_tr_b16 v[74:75], v7 offset:14848
    ds_read_b64_tr_b16 v[76:77], v7 offset:15360
    ds_read_b64_tr_b16 v[78:79], v7 offset:15872
    s_waitcnt lgkmcnt(0)
    buffer_store_dwordx4 v[72:75], v2, s[8:11], s63 offen offset:0 sc1
    buffer_store_dwordx4 v[76:79], v2, s[8:11], s63 offen offset:1024 sc1
    s_nop 1
L_p0_noimg:
    s_waitcnt vmcnt(0) lgkmcnt(0)
    s_barrier
    s_lshl_b32 s30, s20, 2
    s_add_u32 s30, s30, 32
    s_cmp_lg_u32 s17, 0
    s_cbranch_scc1 L_p0_b
    s_mov_b64 exec, 1
    v_mov_b32 v8, 1
    buffer_atomic_add v8, off, s[12:15], s30 sc1
    s_mov_b64 exec, -1
L_p0_b:
    s_cmp_ge_u32 s35, 128
    s_cbranch_scc1 L_p0_fill
    s_mov_b32 s48, s40
    s_and_b32 s49, s41, 0xffff
    s_mov_b32 s50, 2359296
    s_mov_b32 s51, 0x00020000
    v_and_b32 v4, 15, v1
    v_lshrrev_b32 v5, 4, v1
    v_mul_u32_u24 v4, 1152, v4
    v_lshl_add_u32 v4, v5, 4, v4
    s_mul_i32 s24, s35, 18432
    buffer_load_dwordx4 v[8:11], v4, s[48:51], s24 offen offset:0
    buffer_load_dwordx4 v[12:15], v4, s[48:51], s24 offen offset:64
    buffer_load_dwordx4 v[16:19], v4, s[48:51], s24 offen offset:128
    buffer_load_dwordx4 v[20:23], v4, s[48:51], s24 offen offset:192
    buffer_load_dwordx4 v[24:27], v4, s[48:51], s24 offen offset:256
    buffer_load_dwordx4 v[28:31], v4, s[48:51], s24 offen offset:320
    buffer_load_dwordx4 v[32:35], v4, s[48:51], s24 offen offset:384
    buffer_load_dwordx4 v[36:39], v4, s[48:51], s24 offen offset:448
    buffer_load_dwordx4 v[40:43], v4, s[48:51], s24 offen offset:512
    buffer_load_dwordx4 v[44:47], v4, s[48:51], s24 offen offset:576
    buffer_load_dwordx4 v[48:51], v4, s[48:51], s24 offen offset:640
    buffer_load_dwordx4 v[52:55], v4, s[48:51], s24 offen offset:704
    buffer_load_dwordx4 v[56:59], v4, s[48:51], s24 offen offset:768
    buffer_load_dwordx4 v[60:63], v4, s[48:51], s24 offen offset:832
    buffer_load_dwordx4 v[64:67], v4, s[48:51], s24 offen offset:896
    buffer_load_dwordx4 v[68:71], v4, s[48:51], s24 offen offset:960
    buffer_load_dwordx4 v[72:75], v4, s[48:51], s24 offen offset:1024
    buffer_load_dwordx4 v[76:79], v4, s[48:51], s24 offen offset:1088
    s_mov_b32 s25, 0xffff0000
    v_mov_b32 v224, 0
    v_mov_b32 v225, 0
    v_mov_b32 v226, 0
    v_mov_b32 v227, 0
    s_waitcnt vmcnt(17)
    v_lshlrev_b32 v80, 16, v8
    v_and_b32 v81, s25, v8
    v_lshlrev_b32 v82, 16, v9
    v_and_b32 v83, s25, v9
    v_lshlrev_b32 v84, 16, v10
    v_and_b32 v85, s25, v10
    v_lshlrev_b32 v86, 16, v11
    v_and_b32 v87, s25, v11
    v_pk_add_f32 v[224:225], v[224:225], v[80:81]
    v_pk_add_f32 v[226:227], v[226:227], v[82:83]
    v_pk_add_f32 v[224:225], v[224:225], v[84:85]
    v_pk_add_f32 v[226:227], v[226:227], v[86:87]
    s_waitcnt vmcnt(16)
    v_lshlrev_b32 v88, 16, v12
    v_and_b32 v89, s25, v12
    v_lshlrev_b32 v90, 16, v13
    v_and_b32 v91, s25, v13
    v_lshlrev_b32 v92, 16, v14
    v_and_b32 v93, s25, v14
    v_lshlrev_b32 v94, 16, v15
    v_and_b32 v95, s25, v15
    v_pk_add_f32 v[224:225], v[224:225], v[88:89]
    v_pk_add_f32 v[226:227], v[226:227], v[90:91]
    v_pk_add_f32 v[224:225], v[224:225], v[92:93]
    v_pk_add_f32 v[226:227], v[226:227], v[94:95]
    s_waitcnt vmcnt(15)
    v_lshlrev_b32 v96, 16, v16
    v_and_b32 v97, s25, v16
    v_lshlrev_b32 v98, 16, v17
    v_and_b32 v99, s25, v17
    v_lshlrev_b32 v100, 16, v18
    v_and_b32 v101, s25, v18
    v_lshlrev_b32 v102, 16, v19
    v_and_b32 v103, s25, v19
    v_pk_add_f32 v[224:225], v[224:225], v[96:97]
    v_pk_add_f32 v[226:227], v[226:227], v[98:99]
    v_pk_add_f32 v[224:225], v[224:225], v[100:101]
    v_pk_add_f32 v[226:227], v[226:227], v[102:103]
    s_waitcnt vmcnt(14)
    v_lshlrev_b32 v104, 16, v20
    v_and_b32 v105, s25, v20
    v_lshlrev_b32 v106, 16, v21
    v_and_b32 v107, s25, v21
    v_lshlrev_b32 v108, 16, v22
    v_and_b32 v109, s25, v22
    v_lshlrev_b32 v110, 16, v23
    v_and_b32 v111, s25, v23
    v_pk_add_f32 v[224:225], v[224:225], v[104:105]
    v_pk_add_f32 v[226:227], v[226:227], v[106:107]
    v_pk_add_f32 v[224:225], v[224:225], v[108:109]
    v_pk_add_f32 v[226:227], v[226:227], v[110:111]
    s_waitcnt vmcnt(13)
    v_lshlrev_b32 v112, 16, v24
    v_and_b32 v113, s25, v24
    v_lshlrev_b32 v114, 16, v25
    v_and_b32 v115, s25, v25
    v_lshlrev_b32 v116, 16, v26
    v_and_b32 v117, s25, v26
    v_lshlrev_b32 v118, 16, v27
    v_and_b32 v119, s25, v27
    v_pk_add_f32 v[224:225], v[224:225], v[112:113]
    v_pk_add_f32 v[226:227], v[226:227], v[114:115]
    v_pk_add_f32 v[224:225], v[224:225], v[116:117]
    v_pk_add_f32 v[226:227], v[226:227], v[118:119]
    s_waitcnt vmcnt(12)
    v_lshlrev_b32 v120, 16, v28
    v_and_b32 v121, s25, v28
    v_lshlrev_b32 v122, 16, v29
    v_and_b32 v123, s25, v29
    v_lshlrev_b32 v124, 16, v30
    v_and_b32 v125, s25, v30
    v_lshlrev_b32 v126, 16, v31
    v_and_b32 v127, s25, v31
    v_pk_add_f32 v[224:225], v[224:225], v[120:121]
    v_pk_add_f32 v[226:227], v[226:227], v[122:123]
    v_pk_add_f32 v[224:225], v[224:225], v[124:125]
    v_pk_add_f32 v[226:227], v[226:227], v[126:127]
    s_waitcnt vmcnt(11)
    v_lshlrev_b32 v128, 16, v32
    v_and_b32 v129, s25, v32
    v_lshlrev_b32 v130, 16, v33
    v_and_b32 v131, s25, v33
    v_lshlrev_b32 v132, 16, v34
    v_and_b32 v133, s25, v34
    v_lshlrev_b32 v134, 16, v35
    v_and_b32 v135, s25, v35
    v_pk_add_f32 v[224:225], v[224:225], v[128:129]
    v_pk_add_f32 v[226:227], v[226:227], v[130:131]
    v_pk_add_f32 v[224:225], v[224:225], v[132:133]
    v_pk_add_f32 v[226:227], v[226:227], v[134:135]
    s_waitcnt vmcnt(10)
    v_lshlrev_b32 v136, 16, v36
    v_and_b32 v137, s25, v36
    v_lshlrev_b32 v138, 16, v37
    v_and_b32 v139, s25, v37
    v_lshlrev_b32 v140, 16, v38
    v_and_b32 v141, s25, v38
    v_lshlrev_b32 v142, 16, v39
    v_and_b32 v143, s25, v39
    v_pk_add_f32 v[224:225], v[224:225], v[136:137]
    v_pk_add_f32 v[226:227], v[226:227], v[138:139]
    v_pk_add_f32 v[224:225], v[224:225], v[140:141]
    v_pk_add_f32 v[226:227], v[226:227], v[142:143]
    s_waitcnt vmcnt(9)
    v_lshlrev_b32 v144, 16, v40
    v_and_b32 v145, s25, v40
    v_lshlrev_b32 v146, 16, v41
    v_and_b32 v147, s25, v41
    v_lshlrev_b32 v148, 16, v42
    v_and_b32 v149, s25, v42
    v_lshlrev_b32 v150, 16, v43
    v_and_b32 v151, s25, v43
    v_pk_add_f32 v[224:225], v[224:225], v[144:145]
    v_pk_add_f32 v[226:227], v[226:227], v[146:147]
    v_pk_add_f32 v[224:225], v[224:225], v[148:149]
    v_pk_add_f32 v[226:227], v[226:227], v[150:151]
    s_waitcnt vmcnt(8)
    v_lshlrev_b32 v152, 16, v44
    v_and_b32 v153, s25, v44
    v_lshlrev_b32 v154, 16, v45
    v_and_b32 v155, s25, v45
    v_lshlrev_b32 v156, 16, v46
    v_and_b32 v157, s25, v46
    v_lshlrev_b32 v158, 16, v47
    v_and_b32 v159, s25, v47
    v_pk_add_f32 v[224:225], v[224:225], v[152:153]
    v_pk_add_f32 v[226:227], v[226:227], v[154:155]
    v_pk_add_f32 v[224:225], v[224:225], v[156:157]
    v_pk_add_f32 v[226:227], v[226:227], v[158:159]
    s_waitcnt vmcnt(7)
    v_lshlrev_b32 v160, 16, v48
    v_and_b32 v161, s25, v48
    v_lshlrev_b32 v162, 16, v49
    v_and_b32 v163, s25, v49
    v_lshlrev_b32 v164, 16, v50
    v_and_b32 v165, s25, v50
    v_lshlrev_b32 v166, 16, v51
    v_and_b32 v167, s25, v51
    v_pk_add_f32 v[224:225], v[224:225], v[160:161]
    v_pk_add_f32 v[226:227], v[226:227], v[162:163]
    v_pk_add_f32 v[224:225], v[224:225], v[164:165]
    v_pk_add_f32 v[226:227], v[226:227], v[166:167]
    s_waitcnt vmcnt(6)
    v_lshlrev_b32 v168, 16, v52
    v_and_b32 v169, s25, v52
    v_lshlrev_b32 v170, 16, v53
    v_and_b32 v171, s25, v53
    v_lshlrev_b32 v172, 16, v54
    v_and_b32 v173, s25, v54
    v_lshlrev_b32 v174, 16, v55
    v_and_b32 v175, s25, v55
    v_pk_add_f32 v[224:225], v[224:225], v[168:169]
    v_pk_add_f32 v[226:227], v[226:227], v[170:171]
    v_pk_add_f32 v[224:225], v[224:225], v[172:173]
    v_pk_add_f32 v[226:227], v[226:227], v[174:175]
    s_waitcnt vmcnt(5)
    v_lshlrev_b32 v176, 16, v56
    v_and_b32 v177, s25, v56
    v_lshlrev_b32 v178, 16, v57
    v_and_b32 v179, s25, v57
    v_lshlrev_b32 v180, 16, v58
    v_and_b32 v181, s25, v58
    v_lshlrev_b32 v182, 16, v59
    v_and_b32 v183, s25, v59
    v_pk_add_f32 v[224:225], v[224:225], v[176:177]
    v_pk_add_f32 v[226:227], v[226:227], v[178:179]
    v_pk_add_f32 v[224:225], v[224:225], v[180:181]
    v_pk_add_f32 v[226:227], v[226:227], v[182:183]
    s_waitcnt vmcnt(4)
    v_lshlrev_b32 v184, 16, v60
    v_and_b32 v185, s25, v60
    v_lshlrev_b32 v186, 16, v61
    v_and_b32 v187, s25, v61
    v_lshlrev_b32 v188, 16, v62
    v_and_b32 v189, s25, v62
    v_lshlrev_b32 v190, 16, v63
    v_and_b32 v191, s25, v63
    v_pk_add_f32 v[224:225], v[224:225], v[184:185]
    v_pk_add_f32 v[226:227], v[226:227], v[186:187]
    v_pk_add_f32 v[224:225], v[224:225], v[188:189]
    v_pk_add_f32 v[226:227], v[226:227], v[190:191]
    s_waitcnt vmcnt(3)
    v_lshlrev_b32 v192, 16, v64
    v_and_b32 v193, s25, v64
    v_lshlrev_b32 v194, 16, v65
    v_and_b32 v195, s25, v65
    v_lshlrev_b32 v196, 16, v66
    v_and_b32 v197, s25, v66
    v_lshlrev_b32 v198, 16, v67
    v_and_b32 v199, s25, v67
    v_pk_add_f32 v[224:225], v[224:225], v[192:193]
    v_pk_add_f32 v[226:227], v[226:227], v[194:195]
    v_pk_add_f32 v[224:225], v[224:225], v[196:197]
    v_pk_add_f32 v[226:227], v[226:227], v[198:199]
    s_waitcnt vmcnt(2)
    v_lshlrev_b32 v200, 16, v68
    v_and_b32 v201, s25, v68
    v_lshlrev_b32 v202, 16, v69
    v_and_b32 v203, s25, v69
    v_lshlrev_b32 v204, 16, v70
    v_and_b32 v205, s25, v70
    v_lshlrev_b32 v206, 16, v71
    v_and_b32 v207, s25, v71
    v_pk_add_f32 v[224:225], v[224:225], v[200:201]
    v_pk_add_f32 v[226:227], v[226:227], v[202:203]
    v_pk_add_f32 v[224:225], v[224:225], v[204:205]
    v_pk_add_f32 v[226:227], v[226:227], v[206:207]
    s_waitcnt vmcnt(1)
    v_lshlrev_b32 v208, 16, v72
    v_and_b32 v209, s25, v72
    v_lshlrev_b32 v210, 16, v73
    v_and_b32 v211, s25, v73
    v_lshlrev_b32 v212, 16, v74
    v_and_b32 v213, s25, v74
    v_lshlrev_b32 v214, 16, v75
    v_and_b32 v215, s25, v75
    v_pk_add_f32 v[224:225], v[224:225], v[208:209]
    v_pk_add_f32 v[226:227], v[226:227], v[210:211]
    v_pk_add_f32 v[224:225], v[224:225], v[212:213]
    v_pk_add_f32 v[226:227], v[226:227], v[214:215]
    s_waitcnt vmcnt(0)
    v_lshlrev_b32 v216, 16, v76
    v_and_b32 v217, s25, v76
    v_lshlrev_b32 v218, 16, v77
    v_and_b32 v219, s25, v77
    v_lshlrev_b32 v220, 16, v78
    v_and_b32 v221, s25, v78
    v_lshlrev_b32 v222, 16, v79
    v_and_b32 v223, s25, v79
    v_pk_add_f32 v[224:225], v[224:225], v[216:217]
    v_pk_add_f32 v[226:227], v[226:227], v[218:219]
    v_pk_add_f32 v[224:225], v[224:225], v[220:221]
    v_pk_add_f32 v[226:227], v[226:227], v[222:223]
    v_pk_add_f32 v[224:225], v[224:225], v[226:227]
    v_add_f32 v224, v224, v225
    v_mov_b32 v225, v224
    s_nop 1
    v_permlane16_swap_b32 v224, v225
    v_add_f32 v224, v224, v225
    v_mov_b32 v225, v224
    s_nop 1
    v_permlane32_swap_b32 v224, v225
    v_add_f32 v224, v224, v225
    v_mul_f32 v224, 0xbae38e39, v224
    v_mov_b32 v225, v224
    v_mov_b32 v228, 0
    v_mov_b32 v229, 0
    v_mov_b32 v230, 0
    v_mov_b32 v231, 0
    v_pk_add_f32 v[80:81], v[80:81], v[224:225]
    v_pk_fma_f32 v[228:229], v[80:81], v[80:81], v[228:229]
    v_pk_add_f32 v[82:83], v[82:83], v[224:225]
    v_pk_fma_f32 v[230:231], v[82:83], v[82:83], v[230:231]
    v_pk_add_f32 v[84:85], v[84:85], v[224:225]
    v_pk_fma_f32 v[228:229], v[84:85], v[84:85], v[228:229]
    v_pk_add_f32 v[86:87], v[86:87], v[224:225]
    v_pk_fma_f32 v[230:231], v[86:87], v[86:87], v[230:231]
    v_pk_add_f32 v[88:89], v[88:89], v[224:225]
    v_pk_fma_f32 v[228:229], v[88:89], v[88:89], v[228:229]
    v_pk_add_f32 v[90:91], v[90:91], v[224:225]
    v_pk_fma_f32 v[230:231], v[90:91], v[90:91], v[230:231]
    v_pk_add_f32 v[92:93], v[92:93], v[224:225]
    v_pk_fma_f32 v[228:229], v[92:93], v[92:93], v[228:229]
    v_pk_add_f32 v[94:95], v[94:95], v[224:225]
    v_pk_fma_f32 v[230:231], v[94:95], v[94:95], v[230:231]
    v_pk_add_f32 v[96:97], v[96:97], v[224:225]
    v_pk_fma_f32 v[228:229], v[96:97], v[96:97], v[228:229]
    v_pk_add_f32 v[98:99], v[98:99], v[224:225]
    v_pk_fma_f32 v[230:231], v[98:99], v[98:99], v[230:231]
    v_pk_add_f32 v[100:101], v[100:101], v[224:225]
    v_pk_fma_f32 v[228:229], v[100:101], v[100:101], v[228:229]
    v_pk_add_f32 v[102:103], v[102:103], v[224:225]
    v_pk_fma_f32 v[230:231], v[102:103], v[102:103], v[230:231]
    v_pk_add_f32 v[104:105], v[104:105], v[224:225]
    v_pk_fma_f32 v[228:229], v[104:105], v[104:105], v[228:229]
    v_pk_add_f32 v[106:107], v[106:107], v[224:225]
    v_pk_fma_f32 v[230:231], v[106:107], v[106:107], v[230:231]
    v_pk_add_f32 v[108:109], v[108:109], v[224:225]
    v_pk_fma_f32 v[228:229], v[108:109], v[108:109], v[228:229]
    v_pk_add_f32 v[110:111], v[110:111], v[224:225]
    v_pk_fma_f32 v[230:231], v[110:111], v[110:111], v[230:231]
    v_pk_add_f32 v[112:113], v[112:113], v[224:225]
    v_pk_fma_f32 v[228:229], v[112:113], v[112:113], v[228:229]
    v_pk_add_f32 v[114:115], v[114:115], v[224:225]
    v_pk_fma_f32 v[230:231], v[114:115], v[114:115], v[230:231]
    v_pk_add_f32 v[116:117], v[116:117], v[224:225]
    v_pk_fma_f32 v[228:229], v[116:117], v[116:117], v[228:229]
    v_pk_add_f32 v[118:119], v[118:119], v[224:225]
    v_pk_fma_f32 v[230:231], v[118:119], v[118:119], v[230:231]
    v_pk_add_f32 v[120:121], v[120:121], v[224:225]
    v_pk_fma_f32 v[228:229], v[120:121], v[120:121], v[228:229]
    v_pk_add_f32 v[122:123], v[122:123], v[224:225]
    v_pk_fma_f32 v[230:231], v[122:123], v[122:123], v[230:231]
    v_pk_add_f32 v[124:125], v[124:125], v[224:225]
    v_pk_fma_f32 v[228:229], v[124:125], v[124:125], v[228:229]
    v_pk_add_f32 v[126:127], v[126:127], v[224:225]
    v_pk_fma_f32 v[230:231], v[126:127], v[126:127], v[230:231]
    v_pk_add_f32 v[128:129], v[128:129], v[224:225]
    v_pk_fma_f32 v[228:229], v[128:129], v[128:129], v[228:229]
    v_pk_add_f32 v[130:131], v[130:131], v[224:225]
    v_pk_fma_f32 v[230:231], v[130:131], v[130:131], v[230:231]
    v_pk_add_f32 v[132:133], v[132:133], v[224:225]
    v_pk_fma_f32 v[228:229], v[132:133], v[132:133], v[228:229]
    v_pk_add_f32 v[134:135], v[134:135], v[224:225]
    v_pk_fma_f32 v[230:231], v[134:135], v[134:135], v[230:231]
    v_pk_add_f32 v[136:137], v[136:137], v[224:225]
    v_pk_fma_f32 v[228:229], v[136:137], v[136:137], v[228:229]
    v_pk_add_f32 v[138:139], v[138:139], v[224:225]
    v_pk_fma_f32 v[230:231], v[138:139], v[138:139], v[230:231]
    v_pk_add_f32 v[140:141], v[140:141], v[224:225]
    v_pk_fma_f32 v[228:229], v[140:141], v[140:141], v[228:229]
    v_pk_add_f32 v[142:143], v[142:143], v[224:225]
    v_pk_fma_f32 v[230:231], v[142:143], v[142:143], v[230:231]
    v_pk_add_f32 v[144:145], v[144:145], v[224:225]
    v_pk_fma_f32 v[228:229], v[144:145], v[144:145], v[228:229]
    v_pk_add_f32 v[146:147], v[146:147], v[224:225]
    v_pk_fma_f32 v[230:231], v[146:147], v[146:147], v[230:231]
    v_pk_add_f32 v[148:149], v[148:149], v[224:225]
    v_pk_fma_f32 v[228:229], v[148:149], v[148:149], v[228:229]
    v_pk_add_f32 v[150:151], v[150:151], v[224:225]
    v_pk_fma_f32 v[230:231], v[150:151], v[150:151], v[230:231]
    v_pk_add_f32 v[152:153], v[152:153], v[224:225]
    v_pk_fma_f32 v[228:229], v[152:153], v[152:153], v[228:229]
    v_pk_add_f32 v[154:155], v[154:155], v[224:225]
    v_pk_fma_f32 v[230:231], v[154:155], v[154:155], v[230:231]
    v_pk_add_f32 v[156:157], v[156:157], v[224:225]
    v_pk_fma_f32 v[228:229], v[156:157], v[156:157], v[228:229]
    v_pk_add_f32 v[158:159], v[158:159], v[224:225]
    v_pk_fma_f32 v[230:231], v[158:159], v[158:159], v[230:231]
    v_pk_add_f32 v[160:161], v[160:161], v[224:225]
    v_pk_fma_f32 v[228:229], v[160:161], v[160:161], v[228:229]
    v_pk_add_f32 v[162:163], v[162:163], v[224:225]
    v_pk_fma_f32 v[230:231], v[162:163], v[162:163], v[230:231]
    v_pk_add_f32 v[164:165], v[164:165], v[224:225]
    v_pk_fma_f32 v[228:229], v[164:165], v[164:165], v[228:229]
    v_pk_add_f32 v[166:167], v[166:167], v[224:225]
    v_pk_fma_f32 v[230:231], v[166:167], v[166:167], v[230:231]
    v_pk_add_f32 v[168:169], v[168:169], v[224:225]
    v_pk_fma_f32 v[228:229], v[168:169], v[168:169], v[228:229]
    v_pk_add_f32 v[170:171], v[170:171], v[224:225]
    v_pk_fma_f32 v[230:231], v[170:171], v[170:171], v[230:231]
    v_pk_add_f32 v[172:173], v[172:173], v[224:225]
    v_pk_fma_f32 v[228:229], v[172:173], v[172:173], v[228:229]
    v_pk_add_f32 v[174:175], v[174:175], v[224:225]
    v_pk_fma_f32 v[230:231], v[174:175], v[174:175], v[230:231]
    v_pk_add_f32 v[176:177], v[176:177], v[224:225]
    v_pk_fma_f32 v[228:229], v[176:177], v[176:177], v[228:229]
    v_pk_add_f32 v[178:179], v[178:179], v[224:225]
    v_pk_fma_f32 v[230:231], v[178:179], v[178:179], v[230:231]
    v_pk_add_f32 v[180:181], v[180:181], v[224:225]
    v_pk_fma_f32 v[228:229], v[180:181], v[180:181], v[228:229]
    v_pk_add_f32 v[182:183], v[182:183], v[224:225]
    v_pk_fma_f32 v[230:231], v[182:183], v[182:183], v[230:231]
    v_pk_add_f32 v[184:185], v[184:185], v[224:225]
    v_pk_fma_f32 v[228:229], v[184:185], v[184:185], v[228:229]
    v_pk_add_f32 v[186:187], v[186:187], v[224:225]
    v_pk_fma_f32 v[230:231], v[186:187], v[186:187], v[230:231]
    v_pk_add_f32 v[188:189], v[188:189], v[224:225]
    v_pk_fma_f32 v[228:229], v[188:189], v[188:189], v[228:229]
    v_pk_add_f32 v[190:191], v[190:191], v[224:225]
    v_pk_fma_f32 v[230:231], v[190:191], v[190:191], v[230:231]
    v_pk_add_f32 v[192:193], v[192:193], v[224:225]
    v_pk_fma_f32 v[228:229], v[192:193], v[192:193], v[228:229]
    v_pk_add_f32 v[194:195], v[194:195], v[224:225]
    v_pk_fma_f32 v[230:231], v[194:195], v[194:195], v[230:231]
    v_pk_add_f32 v[196:197], v[196:197], v[224:225]
    v_pk_fma_f32 v[228:229], v[196:197], v[196:197], v[228:229]
    v_pk_add_f32 v[198:199], v[198:199], v[224:225]
    v_pk_fma_f32 v[230:231], v[198:199], v[198:199], v[230:231]
    v_pk_add_f32 v[200:201], v[200:201], v[224:225]
    v_pk_fma_f32 v[228:229], v[200:201], v[200:201], v[228:229]
    v_pk_add_f32 v[202:203], v[202:203], v[224:225]
    v_pk_fma_f32 v[230:231], v[202:203], v[202:203], v[230:231]
    v_pk_add_f32 v[204:205], v[204:205], v[224:225]
    v_pk_fma_f32 v[228:229], v[204:205], v[204:205], v[228:229]
    v_pk_add_f32 v[206:207], v[206:207], v[224:225]
    v_pk_fma_f32 v[230:231], v[206:207], v[206:207], v[230:231]
    v_pk_add_f32 v[208:209], v[208:209], v[224:225]
    v_pk_fma_f32 v[228:229], v[208:209], v[208:209], v[228:229]
    v_pk_add_f32 v[210:211], v[210:211], v[224:225]
    v_pk_fma_f32 v[230:231], v[210:211], v[210:211], v[230:231]
    v_pk_add_f32 v[212:213], v[212:213], v[224:225]
    v_pk_fma_f32 v[228:229], v[212:213], v[212:213], v[228:229]
    v_pk_add_f32 v[214:215], v[214:215], v[224:225]
    v_pk_fma_f32 v[230:231], v[214:215], v[214:215], v[230:231]
    v_pk_add_f32 v[216:217], v[216:217], v[224:225]
    v_pk_fma_f32 v[228:229], v[216:217], v[216:217], v[228:229]
    v_pk_add_f32 v[218:219], v[218:219], v[224:225]
    v_pk_fma_f32 v[230:231], v[218:219], v[218:219], v[230:231]
    v_pk_add_f32 v[220:221], v[220:221], v[224:225]
    v_pk_fma_f32 v[228:229], v[220:221], v[220:221], v[228:229]
    v_pk_add_f32 v[222:223], v[222:223], v[224:225]
    v_pk_fma_f32 v[230:231], v[222:223], v[222:223], v[230:231]
    v_pk_add_f32 v[228:229], v[228:229], v[230:231]
    v_add_f32 v228, v228, v229
    v_mov_b32 v229, v228
    s_nop 1
    v_permlane16_swap_b32 v228, v229
    v_add_f32 v228, v228, v229
    v_mov_b32 v229, v228
    s_nop 1
    v_permlane32_swap_b32 v228, v229
    v_add_f32 v228, v228, v229
    v_mov_b32 v229, 0x3727c5ac
    v_fmac_f32 v229, 0x3ae38e39, v228
    v_rsq_f32 v228, v229
    s_nop 0
    v_mov_b32 v229, v228
    s_add_u32 s24, s24, 0
    v_pk_mul_f32 v[80:81], v[80:81], v[228:229]
    v_pk_mul_f32 v[82:83], v[82:83], v[228:229]
    v_pk_mul_f32 v[84:85], v[84:85], v[228:229]
    v_pk_mul_f32 v[86:87], v[86:87], v[228:229]
    v_cvt_pk_bf16_f32 v8, v80, v81
    v_cvt_pk_bf16_f32 v9, v82, v83
    v_cvt_pk_bf16_f32 v10, v84, v85
    v_cvt_pk_bf16_f32 v11, v86, v87
    buffer_store_dwordx4 v[8:11], v2, s[8:11], s24 offen offset:0 sc1
    v_pk_mul_f32 v[88:89], v[88:89], v[228:229]
    v_pk_mul_f32 v[90:91], v[90:91], v[228:229]
    v_pk_mul_f32 v[92:93], v[92:93], v[228:229]
    v_pk_mul_f32 v[94:95], v[94:95], v[228:229]
    v_cvt_pk_bf16_f32 v12, v88, v89
    v_cvt_pk_bf16_f32 v13, v90, v91
    v_cvt_pk_bf16_f32 v14, v92, v93
    v_cvt_pk_bf16_f32 v15, v94, v95
    buffer_store_dwordx4 v[12:15], v2, s[8:11], s24 offen offset:1024 sc1
    v_pk_mul_f32 v[96:97], v[96:97], v[228:229]
    v_pk_mul_f32 v[98:99], v[98:99], v[228:229]
    v_pk_mul_f32 v[100:101], v[100:101], v[228:229]
    v_pk_mul_f32 v[102:103], v[102:103], v[228:229]
    v_cvt_pk_bf16_f32 v16, v96, v97
    v_cvt_pk_bf16_f32 v17, v98, v99
    v_cvt_pk_bf16_f32 v18, v100, v101
    v_cvt_pk_bf16_f32 v19, v102, v103
    buffer_store_dwordx4 v[16:19], v2, s[8:11], s24 offen offset:2048 sc1
    v_pk_mul_f32 v[104:105], v[104:105], v[228:229]
    v_pk_mul_f32 v[106:107], v[106:107], v[228:229]
    v_pk_mul_f32 v[108:109], v[108:109], v[228:229]
    v_pk_mul_f32 v[110:111], v[110:111], v[228:229]
    v_cvt_pk_bf16_f32 v20, v104, v105
    v_cvt_pk_bf16_f32 v21, v106, v107
    v_cvt_pk_bf16_f32 v22, v108, v109
    v_cvt_pk_bf16_f32 v23, v110, v111
    buffer_store_dwordx4 v[20:23], v2, s[8:11], s24 offen offset:3072 sc1
    s_add_u32 s24, s24, 4096
    v_pk_mul_f32 v[112:113], v[112:113], v[228:229]
    v_pk_mul_f32 v[114:115], v[114:115], v[228:229]
    v_pk_mul_f32 v[116:117], v[116:117], v[228:229]
    v_pk_mul_f32 v[118:119], v[118:119], v[228:229]
    v_cvt_pk_bf16_f32 v24, v112, v113
    v_cvt_pk_bf16_f32 v25, v114, v115
    v_cvt_pk_bf16_f32 v26, v116, v117
    v_cvt_pk_bf16_f32 v27, v118, v119
    buffer_store_dwordx4 v[24:27], v2, s[8:11], s24 offen offset:0 sc1
    v_pk_mul_f32 v[120:121], v[120:121], v[228:229]
    v_pk_mul_f32 v[122:123], v[122:123], v[228:229]
    v_pk_mul_f32 v[124:125], v[124:125], v[228:229]
    v_pk_mul_f32 v[126:127], v[126:127], v[228:229]
    v_cvt_pk_bf16_f32 v28, v120, v121
    v_cvt_pk_bf16_f32 v29, v122, v123
    v_cvt_pk_bf16_f32 v30, v124, v125
    v_cvt_pk_bf16_f32 v31, v126, v127
    buffer_store_dwordx4 v[28:31], v2, s[8:11], s24 offen offset:1024 sc1
    v_pk_mul_f32 v[128:129], v[128:129], v[228:229]
    v_pk_mul_f32 v[130:131], v[130:131], v[228:229]
    v_pk_mul_f32 v[132:133], v[132:133], v[228:229]
    v_pk_mul_f32 v[134:135], v[134:135], v[228:229]
    v_cvt_pk_bf16_f32 v32, v128, v129
    v_cvt_pk_bf16_f32 v33, v130, v131
    v_cvt_pk_bf16_f32 v34, v132, v133
    v_cvt_pk_bf16_f32 v35, v134, v135
    buffer_store_dwordx4 v[32:35], v2, s[8:11], s24 offen offset:2048 sc1
    v_pk_mul_f32 v[136:137], v[136:137], v[228:229]
    v_pk_mul_f32 v[138:139], v[138:139], v[228:229]
    v_pk_mul_f32 v[140:141], v[140:141], v[228:229]
    v_pk_mul_f32 v[142:143], v[142:143], v[228:229]
    v_cvt_pk_bf16_f32 v36, v136, v137
    v_cvt_pk_bf16_f32 v37, v138, v139
    v_cvt_pk_bf16_f32 v38, v140, v141
    v_cvt_pk_bf16_f32 v39, v142, v143
    buffer_store_dwordx4 v[36:39], v2, s[8:11], s24 offen offset:3072 sc1
    s_add_u32 s24, s24, 4096
    v_pk_mul_f32 v[144:145], v[144:145], v[228:229]
    v_pk_mul_f32 v[146:147], v[146:147], v[228:229]
    v_pk_mul_f32 v[148:149], v[148:149], v[228:229]
    v_pk_mul_f32 v[150:151], v[150:151], v[228:229]
    v_cvt_pk_bf16_f32 v40, v144, v145
    v_cvt_pk_bf16_f32 v41, v146, v147
    v_cvt_pk_bf16_f32 v42, v148, v149
    v_cvt_pk_bf16_f32 v43, v150, v151
    buffer_store_dwordx4 v[40:43], v2, s[8:11], s24 offen offset:0 sc1
    v_pk_mul_f32 v[152:153], v[152:153], v[228:229]
    v_pk_mul_f32 v[154:155], v[154:155], v[228:229]
    v_pk_mul_f32 v[156:157], v[156:157], v[228:229]
    v_pk_mul_f32 v[158:159], v[158:159], v[228:229]
    v_cvt_pk_bf16_f32 v44, v152, v153
    v_cvt_pk_bf16_f32 v45, v154, v155
    v_cvt_pk_bf16_f32 v46, v156, v157
    v_cvt_pk_bf16_f32 v47, v158, v159
    buffer_store_dwordx4 v[44:47], v2, s[8:11], s24 offen offset:1024 sc1
    v_pk_mul_f32 v[160:161], v[160:161], v[228:229]
    v_pk_mul_f32 v[162:163], v[162:163], v[228:229]
    v_pk_mul_f32 v[164:165], v[164:165], v[228:229]
    v_pk_mul_f32 v[166:167], v[166:167], v[228:229]
    v_cvt_pk_bf16_f32 v48, v160, v161
    v_cvt_pk_bf16_f32 v49, v162, v163
    v_cvt_pk_bf16_f32 v50, v164, v165
    v_cvt_pk_bf16_f32 v51, v166, v167
    buffer_store_dwordx4 v[48:51], v2, s[8:11], s24 offen offset:2048 sc1
    v_pk_mul_f32 v[168:169], v[168:169], v[228:229]
    v_pk_mul_f32 v[170:171], v[170:171], v[228:229]
    v_pk_mul_f32 v[172:173], v[172:173], v[228:229]
    v_pk_mul_f32 v[174:175], v[174:175], v[228:229]
    v_cvt_pk_bf16_f32 v52, v168, v169
    v_cvt_pk_bf16_f32 v53, v170, v171
    v_cvt_pk_bf16_f32 v54, v172, v173
    v_cvt_pk_bf16_f32 v55, v174, v175
    buffer_store_dwordx4 v[52:55], v2, s[8:11], s24 offen offset:3072 sc1
    s_add_u32 s24, s24, 4096
    v_pk_mul_f32 v[176:177], v[176:177], v[228:229]
    v_pk_mul_f32 v[178:179], v[178:179], v[228:229]
    v_pk_mul_f32 v[180:181], v[180:181], v[228:229]
    v_pk_mul_f32 v[182:183], v[182:183], v[228:229]
    v_cvt_pk_bf16_f32 v56, v176, v177
    v_cvt_pk_bf16_f32 v57, v178, v179
    v_cvt_pk_bf16_f32 v58, v180, v181
    v_cvt_pk_bf16_f32 v59, v182, v183
    buffer_store_dwordx4 v[56:59], v2, s[8:11], s24 offen offset:0 sc1
    v_pk_mul_f32 v[184:185], v[184:185], v[228:229]
    v_pk_mul_f32 v[186:187], v[186:187], v[228:229]
    v_pk_mul_f32 v[188:189], v[188:189], v[228:229]
    v_pk_mul_f32 v[190:191], v[190:191], v[228:229]
    v_cvt_pk_bf16_f32 v60, v184, v185
    v_cvt_pk_bf16_f32 v61, v186, v187
    v_cvt_pk_bf16_f32 v62, v188, v189
    v_cvt_pk_bf16_f32 v63, v190, v191
    buffer_store_dwordx4 v[60:63], v2, s[8:11], s24 offen offset:1024 sc1
    v_pk_mul_f32 v[192:193], v[192:193], v[228:229]
    v_pk_mul_f32 v[194:195], v[194:195], v[228:229]
    v_pk_mul_f32 v[196:197], v[196:197], v[228:229]
    v_pk_mul_f32 v[198:199], v[198:199], v[228:229]
    v_cvt_pk_bf16_f32 v64, v192, v193
    v_cvt_pk_bf16_f32 v65, v194, v195
    v_cvt_pk_bf16_f32 v66, v196, v197
    v_cvt_pk_bf16_f32 v67, v198, v199
    buffer_store_dwordx4 v[64:67], v2, s[8:11], s24 offen offset:2048 sc1
    v_pk_mul_f32 v[200:201], v[200:201], v[228:229]
    v_pk_mul_f32 v[202:203], v[202:203], v[228:229]
    v_pk_mul_f32 v[204:205], v[204:205], v[228:229]
    v_pk_mul_f32 v[206:207], v[206:207], v[228:229]
    v_cvt_pk_bf16_f32 v68, v200, v201
    v_cvt_pk_bf16_f32 v69, v202, v203
    v_cvt_pk_bf16_f32 v70, v204, v205
    v_cvt_pk_bf16_f32 v71, v206, v207
    buffer_store_dwordx4 v[68:71], v2, s[8:11], s24 offen offset:3072 sc1
    s_add_u32 s24, s24, 4096
    v_pk_mul_f32 v[208:209], v[208:209], v[228:229]
    v_pk_mul_f32 v[210:211], v[210:211], v[228:229]
    v_pk_mul_f32 v[212:213], v[212:213], v[228:229]
    v_pk_mul_f32 v[214:215], v[214:215], v[228:229]
    v_cvt_pk_bf16_f32 v72, v208, v209
    v_cvt_pk_bf16_f32 v73, v210, v211
    v_cvt_pk_bf16_f32 v74, v212, v213
    v_cvt_pk_bf16_f32 v75, v214, v215
    buffer_store_dwordx4 v[72:75], v2, s[8:11], s24 offen offset:0 sc1
    v_pk_mul_f32 v[216:217], v[216:217], v[228:229]
    v_pk_mul_f32 v[218:219], v[218:219], v[228:229]
    v_pk_mul_f32 v[220:221], v[220:221], v[228:229]
    v_pk_mul_f32 v[222:223], v[222:223], v[228:229]
    v_cvt_pk_bf16_f32 v76, v216, v217
    v_cvt_pk_bf16_f32 v77, v218, v219
    v_cvt_pk_bf16_f32 v78, v220, v221
    v_cvt_pk_bf16_f32 v79, v222, v223
    buffer_store_dwordx4 v[76:79], v2, s[8:11], s24 offen offset:1024 sc1
    s_nop 1
    s_branch L_p0_done
L_p0_fill:
    s_sub_u32 s35, s35, 128
    v_mov_b32 v8, -1
    v_mov_b32 v9, -1
    v_mov_b32 v10, -1
    v_mov_b32 v11, -1
    v_mov_b32 v12, 0
    v_mov_b32 v13, 0
    v_mov_b32 v14, 0
    v_mov_b32 v15, 0
    s_lshl_b32 s31, s35, 10
    s_add_u32 s32, s31, 117440512
    s_add_u32 s33, s31, 117657600
    s_cmp_ge_u32 s35, 300
    s_cselect_b32 s32, s33, s32
    s_add_u32 s33, s31, 117883904
    s_cmp_ge_u32 s35, 600
    s_cselect_b32 s32, s33, s32
    s_add_u32 s33, s31, 53902336
    s_cmp_ge_u32 s35, 618
    s_cselect_b32 s32, s33, s32
    buffer_store_dwordx4 v[8:11], v2, s[8:11], s32 offen sc1
    s_add_u32 s23, s35, 768
    s_cmp_ge_u32 s23, 1185
    s_cbranch_scc1 L_p0_z
    s_lshl_b32 s31, s23, 10
    s_add_u32 s32, s31, 117440512
    s_add_u32 s33, s31, 117657600
    s_cmp_ge_u32 s23, 300
    s_cselect_b32 s32, s33, s32
    s_add_u32 s33, s31, 117883904
    s_cmp_ge_u32 s23, 600
    s_cselect_b32 s32, s33, s32
    s_add_u32 s33, s31, 53902336
    s_cmp_ge_u32 s23, 618
    s_cselect_b32 s32, s33, s32
    buffer_store_dwordx4 v[8:11], v2, s[8:11], s32 offen sc1
    s_nop 1
    s_branch L_p0_m
L_p0_z:
    s_sub_u32 s23, s23, 1185
    s_cmp_ge_u32 s23, 200
    s_cbranch_scc1 L_p0_done
    s_lshl_b32 s23, s23, 10
    s_add_u32 s23, s23, 119537664
    buffer_store_dwordx4 v[12:15], v2, s[8:11], s23 offen sc1
    s_nop 1
    s_branch L_p0_done
L_p0_m:
    s_cmp_ge_u32 s35, 9
    s_cbranch_scc1 L_p0_done
    s_mov_b32 s48, s42
    s_and_b32 s49, s43, 0xffff
    s_mov_b32 s50, 9216
    s_mov_b32 s51, 0x00020000
    v_and_b32 v16, 15, v1
    v_lshrrev_b32 v17, 4, v1
    v_lshrrev_b32 v4, 2, v16
    v_lshlrev_b32 v4, 1, v4
    v_and_b32 v5, 1, v16
    v_add_u32 v4, v4, v5
    v_mul_u32_u24 v4, 1152, v4
    v_bfe_u32 v5, v16, 1, 1
    s_cmp_eq_u32 s35, 8
    s_nop 0
    s_cbranch_scc1 L_p0_mc
    v_lshlrev_b32 v6, 3, v17
    v_lshl_add_u32 v6, v5, 2, v6
    v_add_u32 v4, v4, v6
    s_lshr_b32 s27, s35, 1
    s_mul_i32 s27, s27, 288
    s_and_b32 s28, s35, 1
    s_lshl_b32 s28, s28, 7
    s_add_u32 s27, s27, s28
    buffer_load_ushort v16, v4, s[48:51], s27 offen offset:0
    buffer_load_ushort v17, v4, s[48:51], s27 offen offset:32
    buffer_load_ushort v18, v4, s[48:51], s27 offen offset:64
    buffer_load_ushort v19, v4, s[48:51], s27 offen offset:96
    buffer_load_ushort v20, v4, s[48:51], s27 offen offset:2
    buffer_load_ushort v21, v4, s[48:51], s27 offen offset:34
    buffer_load_ushort v22, v4, s[48:51], s27 offen offset:66
    buffer_load_ushort v23, v4, s[48:51], s27 offen offset:98
    s_branch L_p0_mp
L_p0_mc:
    v_mul_u32_u24 v6, 288, v17
    v_lshl_add_u32 v6, v5, 4, v6
    v_add_u32 v4, v4, v6
    buffer_load_ushort v16, v4, s[48:51], 0 offen offset:256
    buffer_load_ushort v17, v4, s[48:51], 0 offen offset:258
    buffer_load_ushort v18, v4, s[48:51], 0 offen offset:260
    buffer_load_ushort v19, v4, s[48:51], 0 offen offset:262
    buffer_load_ushort v20, v4, s[48:51], 0 offen offset:264
    buffer_load_ushort v21, v4, s[48:51], 0 offen offset:266
    buffer_load_ushort v22, v4, s[48:51], 0 offen offset:268
    buffer_load_ushort v23, v4, s[48:51], 0 offen offset:270
L_p0_mp:
    s_waitcnt vmcnt(0)
    v_lshl_or_b32 v24, v17, 16, v16
    v_min_u32 v24, -2, v24
    v_lshl_or_b32 v25, v19, 16, v18
    v_min_u32 v25, -2, v25
    v_lshl_or_b32 v26, v21, 16, v20
    v_min_u32 v26, -2, v26
    v_lshl_or_b32 v27, v23, 16, v22
    v_min_u32 v27, -2, v27
    s_lshl_b32 s27, s35, 10
    s_add_u32 s28, s27, 118489088
    buffer_store_dwordx4 v[24:27], v2, s[8:11], s28 offen sc1
    s_add_u32 s28, s27, 54525952
    buffer_store_dwordx4 v[24:27], v2, s[8:11], s28 offen sc1
    s_nop 1
L_p0_done:
    s_waitcnt vmcnt(0)
    s_barrier
    s_mov_b32 s30, 160
    s_cmp_lg_u32 s17, 0
    s_cbranch_scc1 L_p0_e
    s_mov_b64 exec, 1
    v_mov_b32 v8, 1
    buffer_atomic_add v8, off, s[12:15], s30 sc1
    s_mov_b64 exec, -1
L_p0_e:
    s_sub_u32 s64, s66, 32
    s_cmp_lt_u32 s66, 96
    s_cbranch_scc1 L_warm
    s_cmp_lt_u32 s66, 160
    s_cbranch_scc1 L_nowarm
    s_sub_u32 s64, s66, 96
L_warm:
    s_mul_i32 s31, s64, 32768
    v_lshlrev_b32 v32, 4, v0
    s_load_dwordx2 s[36:37], s[0:1], 24
    s_waitcnt lgkmcnt(0)
    s_mov_b32 s40, s36
    s_and_b32 s41, s37, 0xffff
    s_mov_b32 s42, 4718592
    s_mov_b32 s43, 0x00020000
    s_mov_b32 s32, s31
    buffer_load_dwordx4 v[36:39], v32, s[40:43], s32 offen
    s_add_u32 s32, s32, 4096
    buffer_load_dwordx4 v[40:43], v32, s[40:43], s32 offen
    s_add_u32 s32, s32, 4096
    buffer_load_dwordx4 v[44:47], v32, s[40:43], s32 offen
    s_add_u32 s32, s32, 4096
    buffer_load_dwordx4 v[48:51], v32, s[40:43], s32 offen
    s_add_u32 s32, s32, 4096
    buffer_load_dwordx4 v[52:55], v32, s[40:43], s32 offen
    s_add_u32 s32, s32, 4096
    buffer_load_dwordx4 v[56:59], v32, s[40:43], s32 offen
    s_add_u32 s32, s32, 4096
    buffer_load_dwordx4 v[60:63], v32, s[40:43], s32 offen
    s_add_u32 s32, s32, 4096
    buffer_load_dwordx4 v[64:67], v32, s[40:43], s32 offen
    s_add_u32 s32, s32, 4096
    s_load_dwordx2 s[36:37], s[0:1], 32
    s_waitcnt lgkmcnt(0)
    s_mov_b32 s40, s36
    s_and_b32 s41, s37, 0xffff
    s_mov_b32 s42, 4718592
    s_mov_b32 s43, 0x00020000
    s_mov_b32 s32, s31
    buffer_load_dwordx4 v[68:71], v32, s[40:43], s32 offen
    s_add_u32 s32, s32, 4096
    buffer_load_dwordx4 v[72:75], v32, s[40:43], s32 offen
    s_add_u32 s32, s32, 4096
    buffer_load_dwordx4 v[76:79], v32, s[40:43], s32 offen
    s_add_u32 s32, s32, 4096
    buffer_load_dwordx4 v[80:83], v32, s[40:43], s32 offen
    s_add_u32 s32, s32, 4096
    buffer_load_dwordx4 v[84:87], v32, s[40:43], s32 offen
    s_add_u32 s32, s32, 4096
    buffer_load_dwordx4 v[88:91], v32, s[40:43], s32 offen
    s_add_u32 s32, s32, 4096
    buffer_load_dwordx4 v[92:95], v32, s[40:43], s32 offen
    s_add_u32 s32, s32, 4096
    buffer_load_dwordx4 v[96:99], v32, s[40:43], s32 offen
    s_add_u32 s32, s32, 4096
    s_load_dwordx2 s[36:37], s[0:1], 16
    s_waitcnt lgkmcnt(0)
    s_mov_b32 s40, s36
    s_and_b32 s41, s37, 0xffff
    s_mov_b32 s42, 4718592
    s_mov_b32 s43, 0x00020000
    s_mov_b32 s32, s31
    buffer_load_dwordx4 v[100:103], v32, s[40:43], s32 offen
    s_add_u32 s32, s32, 4096
    buffer_load_dwordx4 v[104:107], v32, s[40:43], s32 offen
    s_add_u32 s32, s32, 4096
    buffer_load_dwordx4 v[108:111], v32, s[40:43], s32 offen
    s_add_u32 s32, s32, 4096
    buffer_load_dwordx4 v[112:115], v32, s[40:43], s32 offen
    s_add_u32 s32, s32, 4096
    buffer_load_dwordx4 v[116:119], v32, s[40:43], s32 offen
    s_add_u32 s32, s32, 4096
    buffer_load_dwordx4 v[120:123], v32, s[40:43], s32 offen
    s_add_u32 s32, s32, 4096
    buffer_load_dwordx4 v[124:127], v32, s[40:43], s32 offen
    s_add_u32 s32, s32, 4096
    buffer_load_dwordx4 v[128:131], v32, s[40:43], s32 offen
    s_add_u32 s32, s32, 4096
    s_load_dwordx2 s[36:37], s[0:1], 40
    s_waitcnt lgkmcnt(0)
    s_mov_b32 s40, s36
    s_and_b32 s41, s37, 0xffff
    s_mov_b32 s42, 4718592
    s_mov_b32 s43, 0x00020000
    s_mov_b32 s32, s31
    buffer_load_dwordx4 v[132:135], v32, s[40:43], s32 offen
    s_add_u32 s32, s32, 4096
    buffer_load_dwordx4 v[136:139], v32, s[40:43], s32 offen
    s_add_u32 s32, s32, 4096
    buffer_load_dwordx4 v[140:143], v32, s[40:43], s32 offen
    s_add_u32 s32, s32, 4096
    buffer_load_dwordx4 v[144:147], v32, s[40:43], s32 offen
    s_add_u32 s32, s32, 4096
    buffer_load_dwordx4 v[148:151], v32, s[40:43], s32 offen
    s_add_u32 s32, s32, 4096
    buffer_load_dwordx4 v[152:155], v32, s[40:43], s32 offen
    s_add_u32 s32, s32, 4096
    buffer_load_dwordx4 v[156:159], v32, s[40:43], s32 offen
    s_add_u32 s32, s32, 4096
    buffer_load_dwordx4 v[160:163], v32, s[40:43], s32 offen
    s_add_u32 s32, s32, 4096
    s_waitcnt vmcnt(0)
L_nowarm:
    s_cmp_lt_u32 s66, 64
    s_cbranch_scc1 L_role_s2
    s_sub_u32 s64, s66, 64
    s_barrier
    s_cmp_ge_u32 s64, 96
    s_cselect_b32 s20, 1, 0
    s_mul_i32 s30, s20, 96
    s_sub_u32 s21, s64, s30
    s_lshr_b32 s22, s21, 5
    s_and_b32 s23, s21, 31
    s_lshl_b32 s30, s22, 3
    s_add_u32 s30, s30, 16
    s_load_dwordx2 s[36:37], s[0:1], s30
    v_and_b32 v1, 63, v0
    v_lshlrev_b32 v2, 4, v1
    v_mov_b32 v5, 1
    v_mov_b32 v3, 0
    v_bfe_u32 v7, v1, 0, 1
    v_lshl_add_u32 v3, v7, 4, v3
    v_bfe_u32 v7, v1, 1, 1
    v_lshl_add_u32 v3, v7, 5, v3
    v_bfe_u32 v7, v1, 2, 1
    v_lshl_add_u32 v3, v7, 13, v3
    v_bfe_u32 v7, v1, 3, 1
    v_lshl_add_u32 v3, v7, 14, v3
    v_bfe_u32 v7, v1, 4, 1
    v_lshl_add_u32 v3, v7, 16, v3
    v_bfe_u32 v7, v1, 5, 1
    v_lshl_add_u32 v3, v7, 17, v3
    s_lshl_b32 s28, s17, 15
    s_add_u32 s28, s28, 32768
    v_mov_b32 v8, 0
    v_bfe_u32 v7, v1, 0, 1
    v_lshl_add_u32 v8, v7, 3, v8
    v_bfe_u32 v7, v1, 1, 1
    v_lshl_add_u32 v8, v7, 4, v8
    v_bfe_u32 v7, v1, 2, 1
    v_lshl_add_u32 v8, v7, 6, v8
    v_bfe_u32 v7, v1, 3, 1
    v_lshl_add_u32 v8, v7, 7, v8
    v_bfe_u32 v7, v1, 4, 1
    v_lshl_add_u32 v8, v7, 8, v8
    v_bfe_u32 v7, v1, 5, 1
    v_lshl_add_u32 v8, v7, 9, v8
    s_cmp_eq_u32 s22, 2
    s_cselect_b32 s35, 1, 0
    s_cselect_b64 vcc, -1, 0
    v_cndmask_b32 v4, v2, v8, vcc
    v_add_u32 v4, s28, v4
    s_lshl_b32 s34, s23, 8
    s_lshl_b32 s30, s17, 6
    s_add_u32 s34, s34, s30
    s_mul_i32 s39, s17, 9216
    s_mul_i32 s25, s20, 1179648
    s_add_u32 s25, s25, s39
    s_lshl_b32 s26, s22, 24
    s_add_u32 s26, s26, 4194304
    s_lshl_b32 s30, s20, 23
    s_add_u32 s26, s26, s30
    s_lshl_b32 s30, s23, 13
    s_add_u32 s26, s26, s30
    s_lshl_b32 s30, s17, 11
    s_add_u32 s26, s26, s30
    s_lshl_b32 s27, s21, 3
    s_lshl_b32 s30, s20, 15
    s_add_u32 s27, s27, s30
    s_add_u32 s27, s27, 119668736
    s_mov_b32 s38, 120061952
    s_cmp_eq_u32 s17, 0
    s_cselect_b32 s40, 1, 0
    s_mov_b32 s41, 0
    v_mov_b32 v60, 1
    v_mov_b32 v61, 1
    s_waitcnt lgkmcnt(0)
    s_mov_b32 s48, s36
    s_and_b32 s49, s37, 0xffff
    s_mov_b32 s50, 4718592
    s_mov_b32 s51, 0x00020000
    s_cmp_eq_u32 s35, 1
    s_cbranch_scc1 L_s1_ldv
    s_add_u32 m0, s28, 0
    s_add_u32 s33, s34, 0
    buffer_load_dwordx4 v3, s[48:51], s33 offen lds
    s_add_u32 m0, s28, 1024
    s_add_u32 s33, s34, 32768
    buffer_load_dwordx4 v3, s[48:51], s33 offen lds
    s_add_u32 m0, s28, 2048
    s_add_u32 s33, s34, 262144
    buffer_load_dwordx4 v3, s[48:51], s33 offen lds
    s_add_u32 m0, s28, 3072
    s_add_u32 s33, s34, 294912
    buffer_load_dwordx4 v3, s[48:51], s33 offen lds
    s_add_u32 m0, s28, 4096
    s_add_u32 s33, s34, 524288
    buffer_load_dwordx4 v3, s[48:51], s33 offen lds
    s_add_u32 m0, s28, 5120
    s_add_u32 s33, s34, 557056
    buffer_load_dwordx4 v3, s[48:51], s33 offen lds
    s_add_u32 m0, s28, 6144
    s_add_u32 s33, s34, 786432
    buffer_load_dwordx4 v3, s[48:51], s33 offen lds
    s_add_u32 m0, s28, 7168
    s_add_u32 s33, s34, 819200
    buffer_load_dwordx4 v3, s[48:51], s33 offen lds
    s_add_u32 m0, s28, 8192
    s_add_u32 s33, s34, 1048576
    buffer_load_dwordx4 v3, s[48:51], s33 offen lds
    s_add_u32 m0, s28, 9216
    s_add_u32 s33, s34, 1081344
    buffer_load_dwordx4 v3, s[48:51], s33 offen lds
    s_add_u32 m0, s28, 10240
    s_add_u32 s33, s34, 1310720
    buffer_load_dwordx4 v3, s[48:51], s33 offen lds
    s_add_u32 m0, s28, 11264
    s_add_u32 s33, s34, 1343488
    buffer_load_dwordx4 v3, s[48:51], s33 offen lds
    s_add_u32 m0, s28, 12288
    s_add_u32 s33, s34, 1572864
    buffer_load_dwordx4 v3, s[48:51], s33 offen lds
    s_add_u32 m0, s28, 13312
    s_add_u32 s33, s34, 1605632
    buffer_load_dwordx4 v3, s[48:51], s33 offen lds
    s_add_u32 m0, s28, 14336
    s_add_u32 s33, s34, 1835008
    buffer_load_dwordx4 v3, s[48:51], s33 offen lds
    s_add_u32 m0, s28, 15360
    s_add_u32 s33, s34, 1867776
    buffer_load_dwordx4 v3, s[48:51], s33 offen lds
    s_add_u32 m0, s28, 16384
    s_add_u32 s33, s34, 2097152
    buffer_load_dwordx4 v3, s[48:51], s33 offen lds
    s_add_u32 m0, s28, 17408
    s_add_u32 s33, s34, 2129920
    buffer_load_dwordx4 v3, s[48:51], s33 offen lds
    s_add_u32 m0, s28, 18432
    s_add_u32 s33, s34, 2359296
    buffer_load_dwordx4 v3, s[48:51], s33 offen lds
    s_add_u32 m0, s28, 19456
    s_add_u32 s33, s34, 2392064
    buffer_load_dwordx4 v3, s[48:51], s33 offen lds
    s_add_u32 m0, s28, 20480
    s_add_u32 s33, s34, 2621440
    buffer_load_dwordx4 v3, s[48:51], s33 offen lds
    s_add_u32 m0, s28, 21504
    s_add_u32 s33, s34, 2654208
    buffer_load_dwordx4 v3, s[48:51], s33 offen lds
    s_add_u32 m0, s28, 22528
    s_add_u32 s33, s34, 2883584
    buffer_load_dwordx4 v3, s[48:51], s33 offen lds
    s_add_u32 m0, s28, 23552
    s_add_u32 s33, s34, 2916352
    buffer_load_dwordx4 v3, s[48:51], s33 offen lds
    s_waitcnt vmcnt(22)
    ds_read_b64_tr_b16 a[0:1], v4 offset:0
    ds_read_b64_tr_b16 a[2:3], v4 offset:1024
    ds_read_b64_tr_b16 a[4:5], v4 offset:8
    ds_read_b64_tr_b16 a[6:7], v4 offset:1032
    s_waitcnt lgkmcnt(0)
    s_add_u32 m0, s28, 0
    s_add_u32 s33, s34, 3145728
    buffer_load_dwordx4 v3, s[48:51], s33 offen lds
    s_add_u32 m0, s28, 1024
    s_add_u32 s33, s34, 3178496
    buffer_load_dwordx4 v3, s[48:51], s33 offen lds
    s_waitcnt vmcnt(22)
    ds_read_b64_tr_b16 a[8:9], v4 offset:2048
    ds_read_b64_tr_b16 a[10:11], v4 offset:3072
    ds_read_b64_tr_b16 a[12:13], v4 offset:2056
    ds_read_b64_tr_b16 a[14:15], v4 offset:3080
    s_waitcnt lgkmcnt(0)
    s_add_u32 m0, s28, 2048
    s_add_u32 s33, s34, 3407872
    buffer_load_dwordx4 v3, s[48:51], s33 offen lds
    s_add_u32 m0, s28, 3072
    s_add_u32 s33, s34, 3440640
    buffer_load_dwordx4 v3, s[48:51], s33 offen lds
    s_waitcnt vmcnt(22)
    ds_read_b64_tr_b16 a[16:17], v4 offset:4096
    ds_read_b64_tr_b16 a[18:19], v4 offset:5120
    ds_read_b64_tr_b16 a[20:21], v4 offset:4104
    ds_read_b64_tr_b16 a[22:23], v4 offset:5128
    s_waitcnt lgkmcnt(0)
    s_add_u32 m0, s28, 4096
    s_add_u32 s33, s34, 3670016
    buffer_load_dwordx4 v3, s[48:51], s33 offen lds
    s_add_u32 m0, s28, 5120
    s_add_u32 s33, s34, 3702784
    buffer_load_dwordx4 v3, s[48:51], s33 offen lds
    s_waitcnt vmcnt(22)
    ds_read_b64_tr_b16 a[24:25], v4 offset:6144
    ds_read_b64_tr_b16 a[26:27], v4 offset:7168
    ds_read_b64_tr_b16 a[28:29], v4 offset:6152
    ds_read_b64_tr_b16 a[30:31], v4 offset:7176
    s_waitcnt lgkmcnt(0)
    s_add_u32 m0, s28, 6144
    s_add_u32 s33, s34, 3932160
    buffer_load_dwordx4 v3, s[48:51], s33 offen lds
    s_add_u32 m0, s28, 7168
    s_add_u32 s33, s34, 3964928
    buffer_load_dwordx4 v3, s[48:51], s33 offen lds
    s_waitcnt vmcnt(22)
    ds_read_b64_tr_b16 a[32:33], v4 offset:8192
    ds_read_b64_tr_b16 a[34:35], v4 offset:9216
    ds_read_b64_tr_b16 a[36:37], v4 offset:8200
    ds_read_b64_tr_b16 a[38:39], v4 offset:9224
    s_waitcnt lgkmcnt(0)
    s_add_u32 m0, s28, 8192
    s_add_u32 s33, s34, 4194304
    buffer_load_dwordx4 v3, s[48:51], s33 offen lds
    s_add_u32 m0, s28, 9216
    s_add_u32 s33, s34, 4227072
    buffer_load_dwordx4 v3, s[48:51], s33 offen lds
    s_waitcnt vmcnt(22)
    ds_read_b64_tr_b16 a[40:41], v4 offset:10240
    ds_read_b64_tr_b16 a[42:43], v4 offset:11264
    ds_read_b64_tr_b16 a[44:45], v4 offset:10248
    ds_read_b64_tr_b16 a[46:47], v4 offset:11272
    s_waitcnt lgkmcnt(0)
    s_add_u32 m0, s28, 10240
    s_add_u32 s33, s34, 4456448
    buffer_load_dwordx4 v3, s[48:51], s33 offen lds
    s_add_u32 m0, s28, 11264
    s_add_u32 s33, s34, 4489216
    buffer_load_dwordx4 v3, s[48:51], s33 offen lds
    s_waitcnt vmcnt(22)
    ds_read_b64_tr_b16 a[48:49], v4 offset:12288
    ds_read_b64_tr_b16 a[50:51], v4 offset:13312
    ds_read_b64_tr_b16 a[52:53], v4 offset:12296
    ds_read_b64_tr_b16 a[54:55], v4 offset:13320
    s_waitcnt vmcnt(20)
    ds_read_b64_tr_b16 a[56:57], v4 offset:14336
    ds_read_b64_tr_b16 a[58:59], v4 offset:15360
    ds_read_b64_tr_b16 a[60:61], v4 offset:14344
    ds_read_b64_tr_b16 a[62:63], v4 offset:15368
    s_waitcnt vmcnt(18)
    ds_read_b64_tr_b16 a[64:65], v4 offset:16384
    ds_read_b64_tr_b16 a[66:67], v4 offset:17408
    ds_read_b64_tr_b16 a[68:69], v4 offset:16392
    ds_read_b64_tr_b16 a[70:71], v4 offset:17416
    s_waitcnt vmcnt(16)
    ds_read_b64_tr_b16 a[72:73], v4 offset:18432
    ds_read_b64_tr_b16 a[74:75], v4 offset:19456
    ds_read_b64_tr_b16 a[76:77], v4 offset:18440
    ds_read_b64_tr_b16 a[78:79], v4 offset:19464
    s_waitcnt vmcnt(14)
    ds_read_b64_tr_b16 a[80:81], v4 offset:20480
    ds_read_b64_tr_b16 a[82:83], v4 offset:21504
    ds_read_b64_tr_b16 a[84:85], v4 offset:20488
    ds_read_b64_tr_b16 a[86:87], v4 offset:21512
    s_waitcnt vmcnt(12)
    ds_read_b64_tr_b16 a[88:89], v4 offset:22528
    ds_read_b64_tr_b16 a[90:91], v4 offset:23552
    ds_read_b64_tr_b16 a[92:93], v4 offset:22536
    ds_read_b64_tr_b16 a[94:95], v4 offset:23560
    s_waitcnt vmcnt(10)
    ds_read_b64_tr_b16 a[96:97], v4 offset:0
    ds_read_b64_tr_b16 a[98:99], v4 offset:1024
    ds_read_b64_tr_b16 a[100:101], v4 offset:8
    ds_read_b64_tr_b16 a[102:103], v4 offset:1032
    s_waitcnt vmcnt(8)
    ds_read_b64_tr_b16 a[104:105], v4 offset:2048
    ds_read_b64_tr_b16 a[106:107], v4 offset:3072
    ds_read_b64_tr_b16 a[108:109], v4 offset:2056
    ds_read_b64_tr_b16 a[110:111], v4 offset:3080
    s_waitcnt vmcnt(6)
    ds_read_b64_tr_b16 a[112:113], v4 offset:4096
    ds_read_b64_tr_b16 a[114:115], v4 offset:5120
    ds_read_b64_tr_b16 a[116:117], v4 offset:4104
    ds_read_b64_tr_b16 a[118:119], v4 offset:5128
    s_waitcnt vmcnt(4)
    ds_read_b64_tr_b16 a[120:121], v4 offset:6144
    ds_read_b64_tr_b16 a[122:123], v4 offset:7168
    ds_read_b64_tr_b16 a[124:125], v4 offset:6152
    ds_read_b64_tr_b16 a[126:127], v4 offset:7176
    s_waitcnt vmcnt(2)
    ds_read_b64_tr_b16 a[128:129], v4 offset:8192
    ds_read_b64_tr_b16 a[130:131], v4 offset:9216
    ds_read_b64_tr_b16 a[132:133], v4 offset:8200
    ds_read_b64_tr_b16 a[134:135], v4 offset:9224
    s_waitcnt vmcnt(0)
    ds_read_b64_tr_b16 a[136:137], v4 offset:10240
    ds_read_b64_tr_b16 a[138:139], v4 offset:11264
    ds_read_b64_tr_b16 a[140:141], v4 offset:10248
    ds_read_b64_tr_b16 a[142:143], v4 offset:11272
    s_waitcnt lgkmcnt(0)
    s_branch L_s1_ld_done
L_s1_ldv:
    s_add_u32 m0, s28, 0
    s_add_u32 s33, s34, 0
    buffer_load_dwordx4 v3, s[48:51], s33 offen lds
    s_add_u32 m0, s28, 1024
    s_add_u32 s33, s34, 32768
    buffer_load_dwordx4 v3, s[48:51], s33 offen lds
    s_add_u32 m0, s28, 2048
    s_add_u32 s33, s34, 262144
    buffer_load_dwordx4 v3, s[48:51], s33 offen lds
    s_add_u32 m0, s28, 3072
    s_add_u32 s33, s34, 294912
    buffer_load_dwordx4 v3, s[48:51], s33 offen lds
    s_add_u32 m0, s28, 4096
    s_add_u32 s33, s34, 524288
    buffer_load_dwordx4 v3, s[48:51], s33 offen lds
    s_add_u32 m0, s28, 5120
    s_add_u32 s33, s34, 557056
    buffer_load_dwordx4 v3, s[48:51], s33 offen lds
    s_add_u32 m0, s28, 6144
    s_add_u32 s33, s34, 786432
    buffer_load_dwordx4 v3, s[48:51], s33 offen lds
    s_add_u32 m0, s28, 7168
    s_add_u32 s33, s34, 819200
    buffer_load_dwordx4 v3, s[48:51], s33 offen lds
    s_add_u32 m0, s28, 8192
    s_add_u32 s33, s34, 1048576
    buffer_load_dwordx4 v3, s[48:51], s33 offen lds
    s_add_u32 m0, s28, 9216
    s_add_u32 s33, s34, 1081344
    buffer_load_dwordx4 v3, s[48:51], s33 offen lds
    s_add_u32 m0, s28, 10240
    s_add_u32 s33, s34, 1310720
    buffer_load_dwordx4 v3, s[48:51], s33 offen lds
    s_add_u32 m0, s28, 11264
    s_add_u32 s33, s34, 1343488
    buffer_load_dwordx4 v3, s[48:51], s33 offen lds
    s_add_u32 m0, s28, 12288
    s_add_u32 s33, s34, 1572864
    buffer_load_dwordx4 v3, s[48:51], s33 offen lds
    s_add_u32 m0, s28, 13312
    s_add_u32 s33, s34, 1605632
    buffer_load_dwordx4 v3, s[48:51], s33 offen lds
    s_add_u32 m0, s28, 14336
    s_add_u32 s33, s34, 1835008
    buffer_load_dwordx4 v3, s[48:51], s33 offen lds
    s_add_u32 m0, s28, 15360
    s_add_u32 s33, s34, 1867776
    buffer_load_dwordx4 v3, s[48:51], s33 offen lds
    s_add_u32 m0, s28, 16384
    s_add_u32 s33, s34, 2097152
    buffer_load_dwordx4 v3, s[48:51], s33 offen lds
    s_add_u32 m0, s28, 17408
    s_add_u32 s33, s34, 2129920
    buffer_load_dwordx4 v3, s[48:51], s33 offen lds
    s_add_u32 m0, s28, 18432
    s_add_u32 s33, s34, 2359296
    buffer_load_dwordx4 v3, s[48:51], s33 offen lds
    s_add_u32 m0, s28, 19456
    s_add_u32 s33, s34, 2392064
    buffer_load_dwordx4 v3, s[48:51], s33 offen lds
    s_add_u32 m0, s28, 20480
    s_add_u32 s33, s34, 2621440
    buffer_load_dwordx4 v3, s[48:51], s33 offen lds
    s_add_u32 m0, s28, 21504
    s_add_u32 s33, s34, 2654208
    buffer_load_dwordx4 v3, s[48:51], s33 offen lds
    s_add_u32 m0, s28, 22528
    s_add_u32 s33, s34, 2883584
    buffer_load_dwordx4 v3, s[48:51], s33 offen lds
    s_add_u32 m0, s28, 23552
    s_add_u32 s33, s34, 2916352
    buffer_load_dwordx4 v3, s[48:51], s33 offen lds
    s_waitcnt vmcnt(22)
    ds_read_b64_tr_b16 a[0:1], v4 offset:0
    ds_read_b64_tr_b16 a[2:3], v4 offset:1024
    ds_read_b64_tr_b16 a[4:5], v4 offset:32
    ds_read_b64_tr_b16 a[6:7], v4 offset:1056
    s_waitcnt lgkmcnt(0)
    s_add_u32 m0, s28, 0
    s_add_u32 s33, s34, 3145728
    buffer_load_dwordx4 v3, s[48:51], s33 offen lds
    s_add_u32 m0, s28, 1024
    s_add_u32 s33, s34, 3178496
    buffer_load_dwordx4 v3, s[48:51], s33 offen lds
    s_waitcnt vmcnt(22)
    ds_read_b64_tr_b16 a[8:9], v4 offset:2048
    ds_read_b64_tr_b16 a[10:11], v4 offset:3072
    ds_read_b64_tr_b16 a[12:13], v4 offset:2080
    ds_read_b64_tr_b16 a[14:15], v4 offset:3104
    s_waitcnt lgkmcnt(0)
    s_add_u32 m0, s28, 2048
    s_add_u32 s33, s34, 3407872
    buffer_load_dwordx4 v3, s[48:51], s33 offen lds
    s_add_u32 m0, s28, 3072
    s_add_u32 s33, s34, 3440640
    buffer_load_dwordx4 v3, s[48:51], s33 offen lds
    s_waitcnt vmcnt(22)
    ds_read_b64_tr_b16 a[16:17], v4 offset:4096
    ds_read_b64_tr_b16 a[18:19], v4 offset:5120
    ds_read_b64_tr_b16 a[20:21], v4 offset:4128
    ds_read_b64_tr_b16 a[22:23], v4 offset:5152
    s_waitcnt lgkmcnt(0)
    s_add_u32 m0, s28, 4096
    s_add_u32 s33, s34, 3670016
    buffer_load_dwordx4 v3, s[48:51], s33 offen lds
    s_add_u32 m0, s28, 5120
    s_add_u32 s33, s34, 3702784
    buffer_load_dwordx4 v3, s[48:51], s33 offen lds
    s_waitcnt vmcnt(22)
    ds_read_b64_tr_b16 a[24:25], v4 offset:6144
    ds_read_b64_tr_b16 a[26:27], v4 offset:7168
    ds_read_b64_tr_b16 a[28:29], v4 offset:6176
    ds_read_b64_tr_b16 a[30:31], v4 offset:7200
    s_waitcnt lgkmcnt(0)
    s_add_u32 m0, s28, 6144
    s_add_u32 s33, s34, 3932160
    buffer_load_dwordx4 v3, s[48:51], s33 offen lds
    s_add_u32 m0, s28, 7168
    s_add_u32 s33, s34, 3964928
    buffer_load_dwordx4 v3, s[48:51], s33 offen lds
    s_waitcnt vmcnt(22)
    ds_read_b64_tr_b16 a[32:33], v4 offset:8192
    ds_read_b64_tr_b16 a[34:35], v4 offset:9216
    ds_read_b64_tr_b16 a[36:37], v4 offset:8224
    ds_read_b64_tr_b16 a[38:39], v4 offset:9248
    s_waitcnt lgkmcnt(0)
    s_add_u32 m0, s28, 8192
    s_add_u32 s33, s34, 4194304
    buffer_load_dwordx4 v3, s[48:51], s33 offen lds
    s_add_u32 m0, s28, 9216
    s_add_u32 s33, s34, 4227072
    buffer_load_dwordx4 v3, s[48:51], s33 offen lds
    s_waitcnt vmcnt(22)
    ds_read_b64_tr_b16 a[40:41], v4 offset:10240
    ds_read_b64_tr_b16 a[42:43], v4 offset:11264
    ds_read_b64_tr_b16 a[44:45], v4 offset:10272
    ds_read_b64_tr_b16 a[46:47], v4 offset:11296
    s_waitcnt lgkmcnt(0)
    s_add_u32 m0, s28, 10240
    s_add_u32 s33, s34, 4456448
    buffer_load_dwordx4 v3, s[48:51], s33 offen lds
    s_add_u32 m0, s28, 11264
    s_add_u32 s33, s34, 4489216
    buffer_load_dwordx4 v3, s[48:51], s33 offen lds
    s_waitcnt vmcnt(22)
    ds_read_b64_tr_b16 a[48:49], v4 offset:12288
    ds_read_b64_tr_b16 a[50:51], v4 offset:13312
    ds_read_b64_tr_b16 a[52:53], v4 offset:12320
    ds_read_b64_tr_b16 a[54:55], v4 offset:13344
    s_waitcnt vmcnt(20)
    ds_read_b64_tr_b16 a[56:57], v4 offset:14336
    ds_read_b64_tr_b16 a[58:59], v4 offset:15360
    ds_read_b64_tr_b16 a[60:61], v4 offset:14368
    ds_read_b64_tr_b16 a[62:63], v4 offset:15392
    s_waitcnt vmcnt(18)
    ds_read_b64_tr_b16 a[64:65], v4 offset:16384
    ds_read_b64_tr_b16 a[66:67], v4 offset:17408
    ds_read_b64_tr_b16 a[68:69], v4 offset:16416
    ds_read_b64_tr_b16 a[70:71], v4 offset:17440
    s_waitcnt vmcnt(16)
    ds_read_b64_tr_b16 a[72:73], v4 offset:18432
    ds_read_b64_tr_b16 a[74:75], v4 offset:19456
    ds_read_b64_tr_b16 a[76:77], v4 offset:18464
    ds_read_b64_tr_b16 a[78:79], v4 offset:19488
    s_waitcnt vmcnt(14)
    ds_read_b64_tr_b16 a[80:81], v4 offset:20480
    ds_read_b64_tr_b16 a[82:83], v4 offset:21504
    ds_read_b64_tr_b16 a[84:85], v4 offset:20512
    ds_read_b64_tr_b16 a[86:87], v4 offset:21536
    s_waitcnt vmcnt(12)
    ds_read_b64_tr_b16 a[88:89], v4 offset:22528
    ds_read_b64_tr_b16 a[90:91], v4 offset:23552
    ds_read_b64_tr_b16 a[92:93], v4 offset:22560
    ds_read_b64_tr_b16 a[94:95], v4 offset:23584
    s_waitcnt vmcnt(10)
    ds_read_b64_tr_b16 a[96:97], v4 offset:0
    ds_read_b64_tr_b16 a[98:99], v4 offset:1024
    ds_read_b64_tr_b16 a[100:101], v4 offset:32
    ds_read_b64_tr_b16 a[102:103], v4 offset:1056
    s_waitcnt vmcnt(8)
    ds_read_b64_tr_b16 a[104:105], v4 offset:2048
    ds_read_b64_tr_b16 a[106:107], v4 offset:3072
    ds_read_b64_tr_b16 a[108:109], v4 offset:2080
    ds_read_b64_tr_b16 a[110:111], v4 offset:3104
    s_waitcnt vmcnt(6)
    ds_read_b64_tr_b16 a[112:113], v4 offset:4096
    ds_read_b64_tr_b16 a[114:115], v4 offset:5120
    ds_read_b64_tr_b16 a[116:117], v4 offset:4128
    ds_read_b64_tr_b16 a[118:119], v4 offset:5152
    s_waitcnt vmcnt(4)
    ds_read_b64_tr_b16 a[120:121], v4 offset:6144
    ds_read_b64_tr_b16 a[122:123], v4 offset:7168
    ds_read_b64_tr_b16 a[124:125], v4 offset:6176
    ds_read_b64_tr_b16 a[126:127], v4 offset:7200
    s_waitcnt vmcnt(2)
    ds_read_b64_tr_b16 a[128:129], v4 offset:8192
    ds_read_b64_tr_b16 a[130:131], v4 offset:9216
    ds_read_b64_tr_b16 a[132:133], v4 offset:8224
    ds_read_b64_tr_b16 a[134:135], v4 offset:9248
    s_waitcnt vmcnt(0)
    ds_read_b64_tr_b16 a[136:137], v4 offset:10240
    ds_read_b64_tr_b16 a[138:139], v4 offset:11264
    ds_read_b64_tr_b16 a[140:141], v4 offset:10272
    ds_read_b64_tr_b16 a[142:143], v4 offset:11296
    s_waitcnt lgkmcnt(0)
L_s1_ld_done:
    v_add_u32 v6, 126976, v2
    s_mov_b32 s31, 160
    s_cmp_lg_u32 s17, 0
    s_cbranch_scc1 L_s1_init_go
    s_mov_b32 s29, 0
L_s1_init_p:
    buffer_load_dword v7, off, s[12:15], s31 sc1
    s_add_u32 s29, s29, 1
    s_cmp_ge_u32 s29, 4194304
    s_cbranch_scc1 L_abort
    s_waitcnt vmcnt(0)
    v_cmp_eq_u32 vcc, 0xe0, v7
    s_cbranch_vccnz L_s1_init_go
    s_sleep 8
    s_branch L_s1_init_p
L_s1_init_go:
    s_barrier
    s_cmp_eq_u32 s20, 0
    s_cbranch_scc1 L_s1_nothr0
    s_mov_b32 s31, 196
    s_cmp_lg_u32 s17, 0
    s_cbranch_scc1 L_s1_rw0_go
    s_mov_b32 s29, 0
L_s1_rw0_p:
    buffer_load_dword v7, off, s[12:15], s31 sc1
    s_add_u32 s29, s29, 1
    s_cmp_ge_u32 s29, 4194304
    s_cbranch_scc1 L_abort
    s_waitcnt vmcnt(0)
    v_cmp_eq_u32 vcc, 32, v7
    s_cbranch_vccnz L_s1_rw0_go
    s_sleep 8
    s_branch L_s1_rw0_p
L_s1_rw0_go:
    s_barrier
L_s1_nothr0:
    s_add_u32 m0, s39, 0
    s_add_u32 s30, s25, 0
    buffer_load_dwordx4 v2, s[8:11], s30 offen offset:0 lds
    buffer_load_dwordx4 v2, s[8:11], s30 offen offset:1024 lds
    buffer_load_dwordx4 v2, s[8:11], s30 offen offset:2048 lds
    buffer_load_dwordx4 v2, s[8:11], s30 offen offset:3072 lds
    s_add_u32 m0, s39, 4096
    s_add_u32 s30, s25, 4096
    buffer_load_dwordx4 v2, s[8:11], s30 offen offset:0 lds
    buffer_load_dwordx4 v2, s[8:11], s30 offen offset:1024 lds
    buffer_load_dwordx4 v2, s[8:11], s30 offen offset:2048 lds
    buffer_load_dwordx4 v2, s[8:11], s30 offen offset:3072 lds
    s_add_u32 m0, s39, 8192
    s_add_u32 s30, s25, 8192
    buffer_load_dwordx4 v2, s[8:11], s30 offen offset:0 lds
    s_mov_b32 s24, 0
    s_waitcnt vmcnt(0)
    s_cmp_eq_u32 s35, 1
    s_cbranch_scc1 L_s1v_go0
    s_branch L_s1q_go0
L_s1q_top0:
    s_cmp_eq_u32 s24, 6
    s_cbranch_scc0 L_s1q_nothr
    s_mov_b32 s31, 196
    s_cmp_lg_u32 s17, 0
    s_cbranch_scc1 L_s1q_rw_go
    s_mov_b32 s29, 0
L_s1q_rw_p:
    buffer_load_dword v7, off, s[12:15], s31 sc1
    s_add_u32 s29, s29, 1
    s_cmp_ge_u32 s29, 4194304
    s_cbranch_scc1 L_abort
    s_waitcnt vmcnt(0)
    v_cmp_eq_u32 vcc, 32, v7
    s_cbranch_vccnz L_s1q_rw_go
    s_sleep 8
    s_branch L_s1q_rw_p
L_s1q_rw_go:
    s_barrier
L_s1q_nothr:
    s_waitcnt vmcnt(2)
L_s1q_go0:
    s_barrier
    s_mov_b64 exec, s[40:41]
    buffer_store_dwordx2 v[60:61], off, s[8:11], s38 sc1
    s_mov_b64 exec, -1
    s_add_u32 s25, s25, 36864
    s_add_u32 m0, s39, 126976
    s_add_u32 s30, s25, 0
    buffer_load_dwordx4 v2, s[8:11], s30 offen offset:0 lds
    buffer_load_dwordx4 v2, s[8:11], s30 offen offset:1024 lds
    buffer_load_dwordx4 v2, s[8:11], s30 offen offset:2048 lds
    buffer_load_dwordx4 v2, s[8:11], s30 offen offset:3072 lds
    s_add_u32 m0, s39, 131072
    s_add_u32 s30, s25, 4096
    buffer_load_dwordx4 v2, s[8:11], s30 offen offset:0 lds
    buffer_load_dwordx4 v2, s[8:11], s30 offen offset:1024 lds
    buffer_load_dwordx4 v2, s[8:11], s30 offen offset:2048 lds
    buffer_load_dwordx4 v2, s[8:11], s30 offen offset:3072 lds
    s_add_u32 m0, s39, 135168
    s_add_u32 s30, s25, 8192
    buffer_load_dwordx4 v2, s[8:11], s30 offen offset:0 lds
    ds_read_b128 v[8:11], v2 offset:0
    ds_read_b128 v[12:15], v2 offset:18432
    ds_read_b128 v[16:19], v2 offset:1024
    ds_read_b128 v[20:23], v2 offset:19456
    s_waitcnt lgkmcnt(2)
    v_mfma_f32_16x16x32_bf16 v[32:35], a[0:3], v[8:11], 0
    v_mfma_f32_16x16x32_bf16 v[40:43], a[0:3], v[12:15], 0
    ds_read_b128 v[24:27], v2 offset:2048
    ds_read_b128 v[28:31], v2 offset:20480
    v_mfma_f32_16x16x32_bf16 v[36:39], a[4:7], v[8:11], 0
    v_mfma_f32_16x16x32_bf16 v[44:47], a[4:7], v[12:15], 0
    s_waitcnt lgkmcnt(2)
    v_mfma_f32_16x16x32_bf16 v[32:35], a[8:11], v[16:19], v[32:35]
    v_mfma_f32_16x16x32_bf16 v[40:43], a[8:11], v[20:23], v[40:43]
    ds_read_b128 v[8:11], v2 offset:3072
    ds_read_b128 v[12:15], v2 offset:21504
    v_mfma_f32_16x16x32_bf16 v[36:39], a[12:15], v[16:19], v[36:39]
    v_mfma_f32_16x16x32_bf16 v[44:47], a[12:15], v[20:23], v[44:47]
    s_waitcnt lgkmcnt(2)
    v_mfma_f32_16x16x32_bf16 v[32:35], a[16:19], v[24:27], v[32:35]
    v_mfma_f32_16x16x32_bf16 v[40:43], a[16:19], v[28:31], v[40:43]
    ds_read_b128 v[16:19], v2 offset:4096
    ds_read_b128 v[20:23], v2 offset:22528
    v_mfma_f32_16x16x32_bf16 v[36:39], a[20:23], v[24:27], v[36:39]
    v_mfma_f32_16x16x32_bf16 v[44:47], a[20:23], v[28:31], v[44:47]
    s_waitcnt lgkmcnt(2)
    v_mfma_f32_16x16x32_bf16 v[32:35], a[24:27], v[8:11], v[32:35]
    v_mfma_f32_16x16x32_bf16 v[40:43], a[24:27], v[12:15], v[40:43]
    ds_read_b128 v[24:27], v2 offset:5120
    ds_read_b128 v[28:31], v2 offset:23552
    v_mfma_f32_16x16x32_bf16 v[36:39], a[28:31], v[8:11], v[36:39]
    v_mfma_f32_16x16x32_bf16 v[44:47], a[28:31], v[12:15], v[44:47]
    s_waitcnt lgkmcnt(2)
    v_mfma_f32_16x16x32_bf16 v[32:35], a[32:35], v[16:19], v[32:35]
    v_mfma_f32_16x16x32_bf16 v[40:43], a[32:35], v[20:23], v[40:43]
    ds_read_b128 v[8:11], v2 offset:6144
    ds_read_b128 v[12:15], v2 offset:24576
    v_mfma_f32_16x16x32_bf16 v[36:39], a[36:39], v[16:19], v[36:39]
    v_mfma_f32_16x16x32_bf16 v[44:47], a[36:39], v[20:23], v[44:47]
    s_waitcnt lgkmcnt(2)
    v_mfma_f32_16x16x32_bf16 v[32:35], a[40:43], v[24:27], v[32:35]
    v_mfma_f32_16x16x32_bf16 v[40:43], a[40:43], v[28:31], v[40:43]
    ds_read_b128 v[16:19], v2 offset:7168
    ds_read_b128 v[20:23], v2 offset:25600
    v_mfma_f32_16x16x32_bf16 v[36:39], a[44:47], v[24:27], v[36:39]
    v_mfma_f32_16x16x32_bf16 v[44:47], a[44:47], v[28:31], v[44:47]
    s_waitcnt lgkmcnt(2)
    v_mfma_f32_16x16x32_bf16 v[32:35], a[48:51], v[8:11], v[32:35]
    v_mfma_f32_16x16x32_bf16 v[40:43], a[48:51], v[12:15], v[40:43]
    ds_read_b128 v[24:27], v2 offset:8192
    ds_read_b128 v[28:31], v2 offset:26624
    v_mfma_f32_16x16x32_bf16 v[36:39], a[52:55], v[8:11], v[36:39]
    v_mfma_f32_16x16x32_bf16 v[44:47], a[52:55], v[12:15], v[44:47]
    s_waitcnt lgkmcnt(2)
    v_mfma_f32_16x16x32_bf16 v[32:35], a[56:59], v[16:19], v[32:35]
    v_mfma_f32_16x16x32_bf16 v[40:43], a[56:59], v[20:23], v[40:43]
    ds_read_b128 v[8:11], v2 offset:9216
    ds_read_b128 v[12:15], v2 offset:27648
    v_mfma_f32_16x16x32_bf16 v[36:39], a[60:63], v[16:19], v[36:39]
    v_mfma_f32_16x16x32_bf16 v[44:47], a[60:63], v[20:23], v[44:47]
    s_waitcnt lgkmcnt(2)
    v_mfma_f32_16x16x32_bf16 v[32:35], a[64:67], v[24:27], v[32:35]
    v_mfma_f32_16x16x32_bf16 v[40:43], a[64:67], v[28:31], v[40:43]
    ds_read_b128 v[16:19], v2 offset:10240
    ds_read_b128 v[20:23], v2 offset:28672
    v_mfma_f32_16x16x32_bf16 v[36:39], a[68:71], v[24:27], v[36:39]
    v_mfma_f32_16x16x32_bf16 v[44:47], a[68:71], v[28:31], v[44:47]
    s_waitcnt lgkmcnt(2)
    v_mfma_f32_16x16x32_bf16 v[32:35], a[72:75], v[8:11], v[32:35]
    v_mfma_f32_16x16x32_bf16 v[40:43], a[72:75], v[12:15], v[40:43]
    ds_read_b128 v[24:27], v2 offset:11264
    ds_read_b128 v[28:31], v2 offset:29696
    v_mfma_f32_16x16x32_bf16 v[36:39], a[76:79], v[8:11], v[36:39]
    v_mfma_f32_16x16x32_bf16 v[44:47], a[76:79], v[12:15], v[44:47]
    s_waitcnt lgkmcnt(2)
    v_mfma_f32_16x16x32_bf16 v[32:35], a[80:83], v[16:19], v[32:35]
    v_mfma_f32_16x16x32_bf16 v[40:43], a[80:83], v[20:23], v[40:43]
    ds_read_b128 v[8:11], v2 offset:12288
    ds_read_b128 v[12:15], v2 offset:30720
    v_mfma_f32_16x16x32_bf16 v[36:39], a[84:87], v[16:19], v[36:39]
    v_mfma_f32_16x16x32_bf16 v[44:47], a[84:87], v[20:23], v[44:47]
    s_waitcnt lgkmcnt(2)
    v_mfma_f32_16x16x32_bf16 v[32:35], a[88:91], v[24:27], v[32:35]
    v_mfma_f32_16x16x32_bf16 v[40:43], a[88:91], v[28:31], v[40:43]
    ds_read_b128 v[16:19], v2 offset:13312
    ds_read_b128 v[20:23], v2 offset:31744
    v_mfma_f32_16x16x32_bf16 v[36:39], a[92:95], v[24:27], v[36:39]
    v_mfma_f32_16x16x32_bf16 v[44:47], a[92:95], v[28:31], v[44:47]
    s_waitcnt lgkmcnt(2)
    v_mfma_f32_16x16x32_bf16 v[32:35], a[96:99], v[8:11], v[32:35]
    v_mfma_f32_16x16x32_bf16 v[40:43], a[96:99], v[12:15], v[40:43]
    ds_read_b128 v[24:27], v2 offset:14336
    ds_read_b128 v[28:31], v2 offset:32768
    v_mfma_f32_16x16x32_bf16 v[36:39], a[100:103], v[8:11], v[36:39]
    v_mfma_f32_16x16x32_bf16 v[44:47], a[100:103], v[12:15], v[44:47]
    s_waitcnt lgkmcnt(2)
    v_mfma_f32_16x16x32_bf16 v[32:35], a[104:107], v[16:19], v[32:35]
    v_mfma_f32_16x16x32_bf16 v[40:43], a[104:107], v[20:23], v[40:43]
    ds_read_b128 v[8:11], v2 offset:15360
    ds_read_b128 v[12:15], v2 offset:33792
    v_mfma_f32_16x16x32_bf16 v[36:39], a[108:111], v[16:19], v[36:39]
    v_mfma_f32_16x16x32_bf16 v[44:47], a[108:111], v[20:23], v[44:47]
    s_waitcnt lgkmcnt(2)
    v_mfma_f32_16x16x32_bf16 v[32:35], a[112:115], v[24:27], v[32:35]
    v_mfma_f32_16x16x32_bf16 v[40:43], a[112:115], v[28:31], v[40:43]
    ds_read_b128 v[16:19], v2 offset:16384
    ds_read_b128 v[20:23], v2 offset:34816
    v_mfma_f32_16x16x32_bf16 v[36:39], a[116:119], v[24:27], v[36:39]
    v_mfma_f32_16x16x32_bf16 v[44:47], a[116:119], v[28:31], v[44:47]
    s_waitcnt lgkmcnt(2)
    v_mfma_f32_16x16x32_bf16 v[32:35], a[120:123], v[8:11], v[32:35]
    v_mfma_f32_16x16x32_bf16 v[40:43], a[120:123], v[12:15], v[40:43]
    ds_read_b128 v[24:27], v2 offset:17408
    ds_read_b128 v[28:31], v2 offset:35840
    v_mfma_f32_16x16x32_bf16 v[36:39], a[124:127], v[8:11], v[36:39]
    v_mfma_f32_16x16x32_bf16 v[44:47], a[124:127], v[12:15], v[44:47]
    s_waitcnt lgkmcnt(2)
    v_mfma_f32_16x16x32_bf16 v[32:35], a[128:131], v[16:19], v[32:35]
    v_mfma_f32_16x16x32_bf16 v[40:43], a[128:131], v[20:23], v[40:43]
    v_mfma_f32_16x16x32_bf16 v[36:39], a[132:135], v[16:19], v[36:39]
    v_mfma_f32_16x16x32_bf16 v[44:47], a[132:135], v[20:23], v[44:47]
    s_waitcnt lgkmcnt(0)
    v_mfma_f32_16x16x32_bf16 v[32:35], a[136:139], v[24:27], v[32:35]
    v_mfma_f32_16x16x32_bf16 v[40:43], a[136:139], v[28:31], v[40:43]
    v_mfma_f32_16x16x32_bf16 v[36:39], a[140:143], v[24:27], v[36:39]
    v_mfma_f32_16x16x32_bf16 v[44:47], a[140:143], v[28:31], v[44:47]
    s_sub_u32 s38, s27, 1024
    s_cmp_eq_u32 s24, 0
    s_cselect_b32 s38, 120061952, s38
    s_add_u32 s27, s27, 1024
    s_add_u32 s24, s24, 1
    v_cvt_pk_bf16_f32 v48, v32, v33
    v_cvt_pk_bf16_f32 v49, v34, v35
    v_cvt_pk_bf16_f32 v50, v36, v37
    v_cvt_pk_bf16_f32 v51, v38, v39
    buffer_store_dwordx4 v[48:51], v2, s[8:11], s26 offen offset:0 sc1
    v_cvt_pk_bf16_f32 v52, v40, v41
    v_cvt_pk_bf16_f32 v53, v42, v43
    v_cvt_pk_bf16_f32 v54, v44, v45
    v_cvt_pk_bf16_f32 v55, v46, v47
    buffer_store_dwordx4 v[52:55], v2, s[8:11], s26 offen offset:1024 sc1
    s_add_u32 s26, s26, 262144
    s_cmp_gt_u32 s24, 3
    s_cbranch_scc1 L_s1q_late0
    s_waitcnt vmcnt(0)
    s_barrier
    s_sub_u32 s31, s27, 1024
    s_mov_b64 exec, s[40:41]
    buffer_store_dwordx2 v[60:61], off, s[8:11], s31 sc1
    s_mov_b64 exec, -1
L_s1q_late0:
L_s1q_top1:
    s_waitcnt vmcnt(2)
L_s1q_go1:
    s_barrier
    s_mov_b64 exec, s[40:41]
    buffer_store_dwordx2 v[60:61], off, s[8:11], s38 sc1
    s_mov_b64 exec, -1
    s_add_u32 s25, s25, 36864
    s_add_u32 m0, s39, 0
    s_add_u32 s30, s25, 0
    buffer_load_dwordx4 v2, s[8:11], s30 offen offset:0 lds
    buffer_load_dwordx4 v2, s[8:11], s30 offen offset:1024 lds
    buffer_load_dwordx4 v2, s[8:11], s30 offen offset:2048 lds
    buffer_load_dwordx4 v2, s[8:11], s30 offen offset:3072 lds
    s_add_u32 m0, s39, 4096
    s_add_u32 s30, s25, 4096
    buffer_load_dwordx4 v2, s[8:11], s30 offen offset:0 lds
    buffer_load_dwordx4 v2, s[8:11], s30 offen offset:1024 lds
    buffer_load_dwordx4 v2, s[8:11], s30 offen offset:2048 lds
    buffer_load_dwordx4 v2, s[8:11], s30 offen offset:3072 lds
    s_add_u32 m0, s39, 8192
    s_add_u32 s30, s25, 8192
    buffer_load_dwordx4 v2, s[8:11], s30 offen offset:0 lds
    ds_read_b128 v[8:11], v6 offset:0
    ds_read_b128 v[12:15], v6 offset:18432
    ds_read_b128 v[16:19], v6 offset:1024
    ds_read_b128 v[20:23], v6 offset:19456
    s_waitcnt lgkmcnt(2)
    v_mfma_f32_16x16x32_bf16 v[32:35], a[0:3], v[8:11], 0
    v_mfma_f32_16x16x32_bf16 v[40:43], a[0:3], v[12:15], 0
    ds_read_b128 v[24:27], v6 offset:2048
    ds_read_b128 v[28:31], v6 offset:20480
    v_mfma_f32_16x16x32_bf16 v[36:39], a[4:7], v[8:11], 0
    v_mfma_f32_16x16x32_bf16 v[44:47], a[4:7], v[12:15], 0
    s_waitcnt lgkmcnt(2)
    v_mfma_f32_16x16x32_bf16 v[32:35], a[8:11], v[16:19], v[32:35]
    v_mfma_f32_16x16x32_bf16 v[40:43], a[8:11], v[20:23], v[40:43]
    ds_read_b128 v[8:11], v6 offset:3072
    ds_read_b128 v[12:15], v6 offset:21504
    v_mfma_f32_16x16x32_bf16 v[36:39], a[12:15], v[16:19], v[36:39]
    v_mfma_f32_16x16x32_bf16 v[44:47], a[12:15], v[20:23], v[44:47]
    s_waitcnt lgkmcnt(2)
    v_mfma_f32_16x16x32_bf16 v[32:35], a[16:19], v[24:27], v[32:35]
    v_mfma_f32_16x16x32_bf16 v[40:43], a[16:19], v[28:31], v[40:43]
    ds_read_b128 v[16:19], v6 offset:4096
    ds_read_b128 v[20:23], v6 offset:22528
    v_mfma_f32_16x16x32_bf16 v[36:39], a[20:23], v[24:27], v[36:39]
    v_mfma_f32_16x16x32_bf16 v[44:47], a[20:23], v[28:31], v[44:47]
    s_waitcnt lgkmcnt(2)
    v_mfma_f32_16x16x32_bf16 v[32:35], a[24:27], v[8:11], v[32:35]
    v_mfma_f32_16x16x32_bf16 v[40:43], a[24:27], v[12:15], v[40:43]
    ds_read_b128 v[24:27], v6 offset:5120
    ds_read_b128 v[28:31], v6 offset:23552
    v_mfma_f32_16x16x32_bf16 v[36:39], a[28:31], v[8:11], v[36:39]
    v_mfma_f32_16x16x32_bf16 v[44:47], a[28:31], v[12:15], v[44:47]
    s_waitcnt lgkmcnt(2)
    v_mfma_f32_16x16x32_bf16 v[32:35], a[32:35], v[16:19], v[32:35]
    v_mfma_f32_16x16x32_bf16 v[40:43], a[32:35], v[20:23], v[40:43]
    ds_read_b128 v[8:11], v6 offset:6144
    ds_read_b128 v[12:15], v6 offset:24576
    v_mfma_f32_16x16x32_bf16 v[36:39], a[36:39], v[16:19], v[36:39]
    v_mfma_f32_16x16x32_bf16 v[44:47], a[36:39], v[20:23], v[44:47]
    s_waitcnt lgkmcnt(2)
    v_mfma_f32_16x16x32_bf16 v[32:35], a[40:43], v[24:27], v[32:35]
    v_mfma_f32_16x16x32_bf16 v[40:43], a[40:43], v[28:31], v[40:43]
    ds_read_b128 v[16:19], v6 offset:7168
    ds_read_b128 v[20:23], v6 offset:25600
    v_mfma_f32_16x16x32_bf16 v[36:39], a[44:47], v[24:27], v[36:39]
    v_mfma_f32_16x16x32_bf16 v[44:47], a[44:47], v[28:31], v[44:47]
    s_waitcnt lgkmcnt(2)
    v_mfma_f32_16x16x32_bf16 v[32:35], a[48:51], v[8:11], v[32:35]
    v_mfma_f32_16x16x32_bf16 v[40:43], a[48:51], v[12:15], v[40:43]
    ds_read_b128 v[24:27], v6 offset:8192
    ds_read_b128 v[28:31], v6 offset:26624
    v_mfma_f32_16x16x32_bf16 v[36:39], a[52:55], v[8:11], v[36:39]
    v_mfma_f32_16x16x32_bf16 v[44:47], a[52:55], v[12:15], v[44:47]
    s_waitcnt lgkmcnt(2)
    v_mfma_f32_16x16x32_bf16 v[32:35], a[56:59], v[16:19], v[32:35]
    v_mfma_f32_16x16x32_bf16 v[40:43], a[56:59], v[20:23], v[40:43]
    ds_read_b128 v[8:11], v6 offset:9216
    ds_read_b128 v[12:15], v6 offset:27648
    v_mfma_f32_16x16x32_bf16 v[36:39], a[60:63], v[16:19], v[36:39]
    v_mfma_f32_16x16x32_bf16 v[44:47], a[60:63], v[20:23], v[44:47]
    s_waitcnt lgkmcnt(2)
    v_mfma_f32_16x16x32_bf16 v[32:35], a[64:67], v[24:27], v[32:35]
    v_mfma_f32_16x16x32_bf16 v[40:43], a[64:67], v[28:31], v[40:43]
    ds_read_b128 v[16:19], v6 offset:10240
    ds_read_b128 v[20:23], v6 offset:28672
    v_mfma_f32_16x16x32_bf16 v[36:39], a[68:71], v[24:27], v[36:39]
    v_mfma_f32_16x16x32_bf16 v[44:47], a[68:71], v[28:31], v[44:47]
    s_waitcnt lgkmcnt(2)
    v_mfma_f32_16x16x32_bf16 v[32:35], a[72:75], v[8:11], v[32:35]
    v_mfma_f32_16x16x32_bf16 v[40:43], a[72:75], v[12:15], v[40:43]
    ds_read_b128 v[24:27], v6 offset:11264
    ds_read_b128 v[28:31], v6 offset:29696
    v_mfma_f32_16x16x32_bf16 v[36:39], a[76:79], v[8:11], v[36:39]
    v_mfma_f32_16x16x32_bf16 v[44:47], a[76:79], v[12:15], v[44:47]
    s_waitcnt lgkmcnt(2)
    v_mfma_f32_16x16x32_bf16 v[32:35], a[80:83], v[16:19], v[32:35]
    v_mfma_f32_16x16x32_bf16 v[40:43], a[80:83], v[20:23], v[40:43]
    ds_read_b128 v[8:11], v6 offset:12288
    ds_read_b128 v[12:15], v6 offset:30720
    v_mfma_f32_16x16x32_bf16 v[36:39], a[84:87], v[16:19], v[36:39]
    v_mfma_f32_16x16x32_bf16 v[44:47], a[84:87], v[20:23], v[44:47]
    s_waitcnt lgkmcnt(2)
    v_mfma_f32_16x16x32_bf16 v[32:35], a[88:91], v[24:27], v[32:35]
    v_mfma_f32_16x16x32_bf16 v[40:43], a[88:91], v[28:31], v[40:43]
    ds_read_b128 v[16:19], v6 offset:13312
    ds_read_b128 v[20:23], v6 offset:31744
    v_mfma_f32_16x16x32_bf16 v[36:39], a[92:95], v[24:27], v[36:39]
    v_mfma_f32_16x16x32_bf16 v[44:47], a[92:95], v[28:31], v[44:47]
    s_waitcnt lgkmcnt(2)
    v_mfma_f32_16x16x32_bf16 v[32:35], a[96:99], v[8:11], v[32:35]
    v_mfma_f32_16x16x32_bf16 v[40:43], a[96:99], v[12:15], v[40:43]
    ds_read_b128 v[24:27], v6 offset:14336
    ds_read_b128 v[28:31], v6 offset:32768
    v_mfma_f32_16x16x32_bf16 v[36:39], a[100:103], v[8:11], v[36:39]
    v_mfma_f32_16x16x32_bf16 v[44:47], a[100:103], v[12:15], v[44:47]
    s_waitcnt lgkmcnt(2)
    v_mfma_f32_16x16x32_bf16 v[32:35], a[104:107], v[16:19], v[32:35]
    v_mfma_f32_16x16x32_bf16 v[40:43], a[104:107], v[20:23], v[40:43]
    ds_read_b128 v[8:11], v6 offset:15360
    ds_read_b128 v[12:15], v6 offset:33792
    v_mfma_f32_16x16x32_bf16 v[36:39], a[108:111], v[16:19], v[36:39]
    v_mfma_f32_16x16x32_bf16 v[44:47], a[108:111], v[20:23], v[44:47]
    s_waitcnt lgkmcnt(2)
    v_mfma_f32_16x16x32_bf16 v[32:35], a[112:115], v[24:27], v[32:35]
    v_mfma_f32_16x16x32_bf16 v[40:43], a[112:115], v[28:31], v[40:43]
    ds_read_b128 v[16:19], v6 offset:16384
    ds_read_b128 v[20:23], v6 offset:34816
    v_mfma_f32_16x16x32_bf16 v[36:39], a[116:119], v[24:27], v[36:39]
    v_mfma_f32_16x16x32_bf16 v[44:47], a[116:119], v[28:31], v[44:47]
    s_waitcnt lgkmcnt(2)
    v_mfma_f32_16x16x32_bf16 v[32:35], a[120:123], v[8:11], v[32:35]
    v_mfma_f32_16x16x32_bf16 v[40:43], a[120:123], v[12:15], v[40:43]
    ds_read_b128 v[24:27], v6 offset:17408
    ds_read_b128 v[28:31], v6 offset:35840
    v_mfma_f32_16x16x32_bf16 v[36:39], a[124:127], v[8:11], v[36:39]
    v_mfma_f32_16x16x32_bf16 v[44:47], a[124:127], v[12:15], v[44:47]
    s_waitcnt lgkmcnt(2)
    v_mfma_f32_16x16x32_bf16 v[32:35], a[128:131], v[16:19], v[32:35]
    v_mfma_f32_16x16x32_bf16 v[40:43], a[128:131], v[20:23], v[40:43]
    v_mfma_f32_16x16x32_bf16 v[36:39], a[132:135], v[16:19], v[36:39]
    v_mfma_f32_16x16x32_bf16 v[44:47], a[132:135], v[20:23], v[44:47]
    s_waitcnt lgkmcnt(0)
    v_mfma_f32_16x16x32_bf16 v[32:35], a[136:139], v[24:27], v[32:35]
    v_mfma_f32_16x16x32_bf16 v[40:43], a[136:139], v[28:31], v[40:43]
    v_mfma_f32_16x16x32_bf16 v[36:39], a[140:143], v[24:27], v[36:39]
    v_mfma_f32_16x16x32_bf16 v[44:47], a[140:143], v[28:31], v[44:47]
    s_sub_u32 s38, s27, 1024
    s_cmp_eq_u32 s24, 0
    s_cselect_b32 s38, 120061952, s38
    s_add_u32 s27, s27, 1024
    s_add_u32 s24, s24, 1
    v_cvt_pk_bf16_f32 v48, v32, v33
    v_cvt_pk_bf16_f32 v49, v34, v35
    v_cvt_pk_bf16_f32 v50, v36, v37
    v_cvt_pk_bf16_f32 v51, v38, v39
    buffer_store_dwordx4 v[48:51], v2, s[8:11], s26 offen offset:0 sc1
    v_cvt_pk_bf16_f32 v52, v40, v41
    v_cvt_pk_bf16_f32 v53, v42, v43
    v_cvt_pk_bf16_f32 v54, v44, v45
    v_cvt_pk_bf16_f32 v55, v46, v47
    buffer_store_dwordx4 v[52:55], v2, s[8:11], s26 offen offset:1024 sc1
    s_add_u32 s26, s26, 262144
    s_cmp_gt_u32 s24, 3
    s_cbranch_scc1 L_s1q_late1
    s_waitcnt vmcnt(0)
    s_barrier
    s_sub_u32 s31, s27, 1024
    s_mov_b64 exec, s[40:41]
    buffer_store_dwordx2 v[60:61], off, s[8:11], s31 sc1
    s_mov_b64 exec, -1
L_s1q_late1:
    s_cmp_lt_u32 s24, 32
    s_cbranch_scc1 L_s1q_top0
    s_branch L_s1_end
L_s1v_top0:
    s_cmp_eq_u32 s24, 6
    s_cbranch_scc0 L_s1v_nothr
    s_mov_b32 s31, 196
    s_cmp_lg_u32 s17, 0
    s_cbranch_scc1 L_s1v_rw_go
    s_mov_b32 s29, 0
L_s1v_rw_p:
    buffer_load_dword v7, off, s[12:15], s31 sc1
    s_add_u32 s29, s29, 1
    s_cmp_ge_u32 s29, 4194304
    s_cbranch_scc1 L_abort
    s_waitcnt vmcnt(0)
    v_cmp_eq_u32 vcc, 32, v7
    s_cbranch_vccnz L_s1v_rw_go
    s_sleep 8
    s_branch L_s1v_rw_p
L_s1v_rw_go:
    s_barrier
L_s1v_nothr:
    s_waitcnt vmcnt(2)
L_s1v_go0:
    s_barrier
    s_mov_b64 exec, s[40:41]
    buffer_store_dwordx2 v[60:61], off, s[8:11], s38 sc1
    s_mov_b64 exec, -1
    s_add_u32 s25, s25, 36864
    s_add_u32 m0, s39, 126976
    s_add_u32 s30, s25, 0
    buffer_load_dwordx4 v2, s[8:11], s30 offen offset:0 lds
    buffer_load_dwordx4 v2, s[8:11], s30 offen offset:1024 lds
    buffer_load_dwordx4 v2, s[8:11], s30 offen offset:2048 lds
    buffer_load_dwordx4 v2, s[8:11], s30 offen offset:3072 lds
    s_add_u32 m0, s39, 131072
    s_add_u32 s30, s25, 4096
    buffer_load_dwordx4 v2, s[8:11], s30 offen offset:0 lds
    buffer_load_dwordx4 v2, s[8:11], s30 offen offset:1024 lds
    buffer_load_dwordx4 v2, s[8:11], s30 offen offset:2048 lds
    buffer_load_dwordx4 v2, s[8:11], s30 offen offset:3072 lds
    s_add_u32 m0, s39, 135168
    s_add_u32 s30, s25, 8192
    buffer_load_dwordx4 v2, s[8:11], s30 offen offset:0 lds
    ds_read_b128 v[8:11], v2 offset:0
    ds_read_b128 v[12:15], v2 offset:18432
    ds_read_b128 v[16:19], v2 offset:1024
    ds_read_b128 v[20:23], v2 offset:19456
    s_waitcnt lgkmcnt(2)
    v_mfma_f32_16x16x32_bf16 v[32:35], v[8:11], a[0:3], 0
    v_mfma_f32_16x16x32_bf16 v[36:39], v[12:15], a[0:3], 0
    ds_read_b128 v[24:27], v2 offset:2048
    ds_read_b128 v[28:31], v2 offset:20480
    v_mfma_f32_16x16x32_bf16 v[40:43], v[8:11], a[4:7], 0
    v_mfma_f32_16x16x32_bf16 v[44:47], v[12:15], a[4:7], 0
    s_waitcnt lgkmcnt(2)
    v_mfma_f32_16x16x32_bf16 v[32:35], v[16:19], a[8:11], v[32:35]
    v_mfma_f32_16x16x32_bf16 v[36:39], v[20:23], a[8:11], v[36:39]
    ds_read_b128 v[8:11], v2 offset:3072
    ds_read_b128 v[12:15], v2 offset:21504
    v_mfma_f32_16x16x32_bf16 v[40:43], v[16:19], a[12:15], v[40:43]
    v_mfma_f32_16x16x32_bf16 v[44:47], v[20:23], a[12:15], v[44:47]
    s_waitcnt lgkmcnt(2)
    v_mfma_f32_16x16x32_bf16 v[32:35], v[24:27], a[16:19], v[32:35]
    v_mfma_f32_16x16x32_bf16 v[36:39], v[28:31], a[16:19], v[36:39]
    ds_read_b128 v[16:19], v2 offset:4096
    ds_read_b128 v[20:23], v2 offset:22528
    v_mfma_f32_16x16x32_bf16 v[40:43], v[24:27], a[20:23], v[40:43]
    v_mfma_f32_16x16x32_bf16 v[44:47], v[28:31], a[20:23], v[44:47]
    s_waitcnt lgkmcnt(2)
    v_mfma_f32_16x16x32_bf16 v[32:35], v[8:11], a[24:27], v[32:35]
    v_mfma_f32_16x16x32_bf16 v[36:39], v[12:15], a[24:27], v[36:39]
    ds_read_b128 v[24:27], v2 offset:5120
    ds_read_b128 v[28:31], v2 offset:23552
    v_mfma_f32_16x16x32_bf16 v[40:43], v[8:11], a[28:31], v[40:43]
    v_mfma_f32_16x16x32_bf16 v[44:47], v[12:15], a[28:31], v[44:47]
    s_waitcnt lgkmcnt(2)
    v_mfma_f32_16x16x32_bf16 v[32:35], v[16:19], a[32:35], v[32:35]
    v_mfma_f32_16x16x32_bf16 v[36:39], v[20:23], a[32:35], v[36:39]
    ds_read_b128 v[8:11], v2 offset:6144
    ds_read_b128 v[12:15], v2 offset:24576
    v_mfma_f32_16x16x32_bf16 v[40:43], v[16:19], a[36:39], v[40:43]
    v_mfma_f32_16x16x32_bf16 v[44:47], v[20:23], a[36:39], v[44:47]
    s_waitcnt lgkmcnt(2)
    v_mfma_f32_16x16x32_bf16 v[32:35], v[24:27], a[40:43], v[32:35]
    v_mfma_f32_16x16x32_bf16 v[36:39], v[28:31], a[40:43], v[36:39]
    ds_read_b128 v[16:19], v2 offset:7168
    ds_read_b128 v[20:23], v2 offset:25600
    v_mfma_f32_16x16x32_bf16 v[40:43], v[24:27], a[44:47], v[40:43]
    v_mfma_f32_16x16x32_bf16 v[44:47], v[28:31], a[44:47], v[44:47]
    s_waitcnt lgkmcnt(2)
    v_mfma_f32_16x16x32_bf16 v[32:35], v[8:11], a[48:51], v[32:35]
    v_mfma_f32_16x16x32_bf16 v[36:39], v[12:15], a[48:51], v[36:39]
    ds_read_b128 v[24:27], v2 offset:8192
    ds_read_b128 v[28:31], v2 offset:26624
    v_mfma_f32_16x16x32_bf16 v[40:43], v[8:11], a[52:55], v[40:43]
    v_mfma_f32_16x16x32_bf16 v[44:47], v[12:15], a[52:55], v[44:47]
    s_waitcnt lgkmcnt(2)
    v_mfma_f32_16x16x32_bf16 v[32:35], v[16:19], a[56:59], v[32:35]
    v_mfma_f32_16x16x32_bf16 v[36:39], v[20:23], a[56:59], v[36:39]
    ds_read_b128 v[8:11], v2 offset:9216
    ds_read_b128 v[12:15], v2 offset:27648
    v_mfma_f32_16x16x32_bf16 v[40:43], v[16:19], a[60:63], v[40:43]
    v_mfma_f32_16x16x32_bf16 v[44:47], v[20:23], a[60:63], v[44:47]
    s_waitcnt lgkmcnt(2)
    v_mfma_f32_16x16x32_bf16 v[32:35], v[24:27], a[64:67], v[32:35]
    v_mfma_f32_16x16x32_bf16 v[36:39], v[28:31], a[64:67], v[36:39]
    ds_read_b128 v[16:19], v2 offset:10240
    ds_read_b128 v[20:23], v2 offset:28672
    v_mfma_f32_16x16x32_bf16 v[40:43], v[24:27], a[68:71], v[40:43]
    v_mfma_f32_16x16x32_bf16 v[44:47], v[28:31], a[68:71], v[44:47]
    s_waitcnt lgkmcnt(2)
    v_mfma_f32_16x16x32_bf16 v[32:35], v[8:11], a[72:75], v[32:35]
    v_mfma_f32_16x16x32_bf16 v[36:39], v[12:15], a[72:75], v[36:39]
    ds_read_b128 v[24:27], v2 offset:11264
    ds_read_b128 v[28:31], v2 offset:29696
    v_mfma_f32_16x16x32_bf16 v[40:43], v[8:11], a[76:79], v[40:43]
    v_mfma_f32_16x16x32_bf16 v[44:47], v[12:15], a[76:79], v[44:47]
    s_waitcnt lgkmcnt(2)
    v_mfma_f32_16x16x32_bf16 v[32:35], v[16:19], a[80:83], v[32:35]
    v_mfma_f32_16x16x32_bf16 v[36:39], v[20:23], a[80:83], v[36:39]
    ds_read_b128 v[8:11], v2 offset:12288
    ds_read_b128 v[12:15], v2 offset:30720
    v_mfma_f32_16x16x32_bf16 v[40:43], v[16:19], a[84:87], v[40:43]
    v_mfma_f32_16x16x32_bf16 v[44:47], v[20:23], a[84:87], v[44:47]
    s_waitcnt lgkmcnt(2)
    v_mfma_f32_16x16x32_bf16 v[32:35], v[24:27], a[88:91], v[32:35]
    v_mfma_f32_16x16x32_bf16 v[36:39], v[28:31], a[88:91], v[36:39]
    ds_read_b128 v[16:19], v2 offset:13312
    ds_read_b128 v[20:23], v2 offset:31744
    v_mfma_f32_16x16x32_bf16 v[40:43], v[24:27], a[92:95], v[40:43]
    v_mfma_f32_16x16x32_bf16 v[44:47], v[28:31], a[92:95], v[44:47]
    s_waitcnt lgkmcnt(2)
    v_mfma_f32_16x16x32_bf16 v[32:35], v[8:11], a[96:99], v[32:35]
    v_mfma_f32_16x16x32_bf16 v[36:39], v[12:15], a[96:99], v[36:39]
    ds_read_b128 v[24:27], v2 offset:14336
    ds_read_b128 v[28:31], v2 offset:32768
    v_mfma_f32_16x16x32_bf16 v[40:43], v[8:11], a[100:103], v[40:43]
    v_mfma_f32_16x16x32_bf16 v[44:47], v[12:15], a[100:103], v[44:47]
    s_waitcnt lgkmcnt(2)
    v_mfma_f32_16x16x32_bf16 v[32:35], v[16:19], a[104:107], v[32:35]
    v_mfma_f32_16x16x32_bf16 v[36:39], v[20:23], a[104:107], v[36:39]
    ds_read_b128 v[8:11], v2 offset:15360
    ds_read_b128 v[12:15], v2 offset:33792
    v_mfma_f32_16x16x32_bf16 v[40:43], v[16:19], a[108:111], v[40:43]
    v_mfma_f32_16x16x32_bf16 v[44:47], v[20:23], a[108:111], v[44:47]
    s_waitcnt lgkmcnt(2)
    v_mfma_f32_16x16x32_bf16 v[32:35], v[24:27], a[112:115], v[32:35]
    v_mfma_f32_16x16x32_bf16 v[36:39], v[28:31], a[112:115], v[36:39]
    ds_read_b128 v[16:19], v2 offset:16384
    ds_read_b128 v[20:23], v2 offset:34816
    v_mfma_f32_16x16x32_bf16 v[40:43], v[24:27], a[116:119], v[40:43]
    v_mfma_f32_16x16x32_bf16 v[44:47], v[28:31], a[116:119], v[44:47]
    s_waitcnt lgkmcnt(2)
    v_mfma_f32_16x16x32_bf16 v[32:35], v[8:11], a[120:123], v[32:35]
    v_mfma_f32_16x16x32_bf16 v[36:39], v[12:15], a[120:123], v[36:39]
    ds_read_b128 v[24:27], v2 offset:17408
    ds_read_b128 v[28:31], v2 offset:35840
    v_mfma_f32_16x16x32_bf16 v[40:43], v[8:11], a[124:127], v[40:43]
    v_mfma_f32_16x16x32_bf16 v[44:47], v[12:15], a[124:127], v[44:47]
    s_waitcnt lgkmcnt(2)
    v_mfma_f32_16x16x32_bf16 v[32:35], v[16:19], a[128:131], v[32:35]
    v_mfma_f32_16x16x32_bf16 v[36:39], v[20:23], a[128:131], v[36:39]
    v_mfma_f32_16x16x32_bf16 v[40:43], v[16:19], a[132:135], v[40:43]
    v_mfma_f32_16x16x32_bf16 v[44:47], v[20:23], a[132:135], v[44:47]
    s_waitcnt lgkmcnt(0)
    v_mfma_f32_16x16x32_bf16 v[32:35], v[24:27], a[136:139], v[32:35]
    v_mfma_f32_16x16x32_bf16 v[36:39], v[28:31], a[136:139], v[36:39]
    v_mfma_f32_16x16x32_bf16 v[40:43], v[24:27], a[140:143], v[40:43]
    v_mfma_f32_16x16x32_bf16 v[44:47], v[28:31], a[140:143], v[44:47]
    s_sub_u32 s38, s27, 1024
    s_cmp_eq_u32 s24, 0
    s_cselect_b32 s38, 120061952, s38
    s_add_u32 s27, s27, 1024
    s_add_u32 s24, s24, 1
    v_cvt_pk_bf16_f32 v48, v32, v33
    v_cvt_pk_bf16_f32 v49, v34, v35
    v_cvt_pk_bf16_f32 v50, v36, v37
    v_cvt_pk_bf16_f32 v51, v38, v39
    buffer_store_dwordx4 v[48:51], v2, s[8:11], s26 offen offset:0 sc1
    v_cvt_pk_bf16_f32 v52, v40, v41
    v_cvt_pk_bf16_f32 v53, v42, v43
    v_cvt_pk_bf16_f32 v54, v44, v45
    v_cvt_pk_bf16_f32 v55, v46, v47
    buffer_store_dwordx4 v[52:55], v2, s[8:11], s26 offen offset:1024 sc1
    s_add_u32 s26, s26, 262144
    s_cmp_gt_u32 s24, 3
    s_cbranch_scc1 L_s1v_late0
    s_waitcnt vmcnt(0)
    s_barrier
    s_sub_u32 s31, s27, 1024
    s_mov_b64 exec, s[40:41]
    buffer_store_dwordx2 v[60:61], off, s[8:11], s31 sc1
    s_mov_b64 exec, -1
L_s1v_late0:
L_s1v_top1:
    s_waitcnt vmcnt(2)
L_s1v_go1:
    s_barrier
    s_mov_b64 exec, s[40:41]
    buffer_store_dwordx2 v[60:61], off, s[8:11], s38 sc1
    s_mov_b64 exec, -1
    s_add_u32 s25, s25, 36864
    s_add_u32 m0, s39, 0
    s_add_u32 s30, s25, 0
    buffer_load_dwordx4 v2, s[8:11], s30 offen offset:0 lds
    buffer_load_dwordx4 v2, s[8:11], s30 offen offset:1024 lds
    buffer_load_dwordx4 v2, s[8:11], s30 offen offset:2048 lds
    buffer_load_dwordx4 v2, s[8:11], s30 offen offset:3072 lds
    s_add_u32 m0, s39, 4096
    s_add_u32 s30, s25, 4096
    buffer_load_dwordx4 v2, s[8:11], s30 offen offset:0 lds
    buffer_load_dwordx4 v2, s[8:11], s30 offen offset:1024 lds
    buffer_load_dwordx4 v2, s[8:11], s30 offen offset:2048 lds
    buffer_load_dwordx4 v2, s[8:11], s30 offen offset:3072 lds
    s_add_u32 m0, s39, 8192
    s_add_u32 s30, s25, 8192
    buffer_load_dwordx4 v2, s[8:11], s30 offen offset:0 lds
    ds_read_b128 v[8:11], v6 offset:0
    ds_read_b128 v[12:15], v6 offset:18432
    ds_read_b128 v[16:19], v6 offset:1024
    ds_read_b128 v[20:23], v6 offset:19456
    s_waitcnt lgkmcnt(2)
    v_mfma_f32_16x16x32_bf16 v[32:35], v[8:11], a[0:3], 0
    v_mfma_f32_16x16x32_bf16 v[36:39], v[12:15], a[0:3], 0
    ds_read_b128 v[24:27], v6 offset:2048
    ds_read_b128 v[28:31], v6 offset:20480
    v_mfma_f32_16x16x32_bf16 v[40:43], v[8:11], a[4:7], 0
    v_mfma_f32_16x16x32_bf16 v[44:47], v[12:15], a[4:7], 0
    s_waitcnt lgkmcnt(2)
    v_mfma_f32_16x16x32_bf16 v[32:35], v[16:19], a[8:11], v[32:35]
    v_mfma_f32_16x16x32_bf16 v[36:39], v[20:23], a[8:11], v[36:39]
    ds_read_b128 v[8:11], v6 offset:3072
    ds_read_b128 v[12:15], v6 offset:21504
    v_mfma_f32_16x16x32_bf16 v[40:43], v[16:19], a[12:15], v[40:43]
    v_mfma_f32_16x16x32_bf16 v[44:47], v[20:23], a[12:15], v[44:47]
    s_waitcnt lgkmcnt(2)
    v_mfma_f32_16x16x32_bf16 v[32:35], v[24:27], a[16:19], v[32:35]
    v_mfma_f32_16x16x32_bf16 v[36:39], v[28:31], a[16:19], v[36:39]
    ds_read_b128 v[16:19], v6 offset:4096
    ds_read_b128 v[20:23], v6 offset:22528
    v_mfma_f32_16x16x32_bf16 v[40:43], v[24:27], a[20:23], v[40:43]
    v_mfma_f32_16x16x32_bf16 v[44:47], v[28:31], a[20:23], v[44:47]
    s_waitcnt lgkmcnt(2)
    v_mfma_f32_16x16x32_bf16 v[32:35], v[8:11], a[24:27], v[32:35]
    v_mfma_f32_16x16x32_bf16 v[36:39], v[12:15], a[24:27], v[36:39]
    ds_read_b128 v[24:27], v6 offset:5120
    ds_read_b128 v[28:31], v6 offset:23552
    v_mfma_f32_16x16x32_bf16 v[40:43], v[8:11], a[28:31], v[40:43]
    v_mfma_f32_16x16x32_bf16 v[44:47], v[12:15], a[28:31], v[44:47]
    s_waitcnt lgkmcnt(2)
    v_mfma_f32_16x16x32_bf16 v[32:35], v[16:19], a[32:35], v[32:35]
    v_mfma_f32_16x16x32_bf16 v[36:39], v[20:23], a[32:35], v[36:39]
    ds_read_b128 v[8:11], v6 offset:6144
    ds_read_b128 v[12:15], v6 offset:24576
    v_mfma_f32_16x16x32_bf16 v[40:43], v[16:19], a[36:39], v[40:43]
    v_mfma_f32_16x16x32_bf16 v[44:47], v[20:23], a[36:39], v[44:47]
    s_waitcnt lgkmcnt(2)
    v_mfma_f32_16x16x32_bf16 v[32:35], v[24:27], a[40:43], v[32:35]
    v_mfma_f32_16x16x32_bf16 v[36:39], v[28:31], a[40:43], v[36:39]
    ds_read_b128 v[16:19], v6 offset:7168
    ds_read_b128 v[20:23], v6 offset:25600
    v_mfma_f32_16x16x32_bf16 v[40:43], v[24:27], a[44:47], v[40:43]
    v_mfma_f32_16x16x32_bf16 v[44:47], v[28:31], a[44:47], v[44:47]
    s_waitcnt lgkmcnt(2)
    v_mfma_f32_16x16x32_bf16 v[32:35], v[8:11], a[48:51], v[32:35]
    v_mfma_f32_16x16x32_bf16 v[36:39], v[12:15], a[48:51], v[36:39]
    ds_read_b128 v[24:27], v6 offset:8192
    ds_read_b128 v[28:31], v6 offset:26624
    v_mfma_f32_16x16x32_bf16 v[40:43], v[8:11], a[52:55], v[40:43]
    v_mfma_f32_16x16x32_bf16 v[44:47], v[12:15], a[52:55], v[44:47]
    s_waitcnt lgkmcnt(2)
    v_mfma_f32_16x16x32_bf16 v[32:35], v[16:19], a[56:59], v[32:35]
    v_mfma_f32_16x16x32_bf16 v[36:39], v[20:23], a[56:59], v[36:39]
    ds_read_b128 v[8:11], v6 offset:9216
    ds_read_b128 v[12:15], v6 offset:27648
    v_mfma_f32_16x16x32_bf16 v[40:43], v[16:19], a[60:63], v[40:43]
    v_mfma_f32_16x16x32_bf16 v[44:47], v[20:23], a[60:63], v[44:47]
    s_waitcnt lgkmcnt(2)
    v_mfma_f32_16x16x32_bf16 v[32:35], v[24:27], a[64:67], v[32:35]
    v_mfma_f32_16x16x32_bf16 v[36:39], v[28:31], a[64:67], v[36:39]
    ds_read_b128 v[16:19], v6 offset:10240
    ds_read_b128 v[20:23], v6 offset:28672
    v_mfma_f32_16x16x32_bf16 v[40:43], v[24:27], a[68:71], v[40:43]
    v_mfma_f32_16x16x32_bf16 v[44:47], v[28:31], a[68:71], v[44:47]
    s_waitcnt lgkmcnt(2)
    v_mfma_f32_16x16x32_bf16 v[32:35], v[8:11], a[72:75], v[32:35]
    v_mfma_f32_16x16x32_bf16 v[36:39], v[12:15], a[72:75], v[36:39]
    ds_read_b128 v[24:27], v6 offset:11264
    ds_read_b128 v[28:31], v6 offset:29696
    v_mfma_f32_16x16x32_bf16 v[40:43], v[8:11], a[76:79], v[40:43]
    v_mfma_f32_16x16x32_bf16 v[44:47], v[12:15], a[76:79], v[44:47]
    s_waitcnt lgkmcnt(2)
    v_mfma_f32_16x16x32_bf16 v[32:35], v[16:19], a[80:83], v[32:35]
    v_mfma_f32_16x16x32_bf16 v[36:39], v[20:23], a[80:83], v[36:39]
    ds_read_b128 v[8:11], v6 offset:12288
    ds_read_b128 v[12:15], v6 offset:30720
    v_mfma_f32_16x16x32_bf16 v[40:43], v[16:19], a[84:87], v[40:43]
    v_mfma_f32_16x16x32_bf16 v[44:47], v[20:23], a[84:87], v[44:47]
    s_waitcnt lgkmcnt(2)
    v_mfma_f32_16x16x32_bf16 v[32:35], v[24:27], a[88:91], v[32:35]
    v_mfma_f32_16x16x32_bf16 v[36:39], v[28:31], a[88:91], v[36:39]
    ds_read_b128 v[16:19], v6 offset:13312
    ds_read_b128 v[20:23], v6 offset:31744
    v_mfma_f32_16x16x32_bf16 v[40:43], v[24:27], a[92:95], v[40:43]
    v_mfma_f32_16x16x32_bf16 v[44:47], v[28:31], a[92:95], v[44:47]
    s_waitcnt lgkmcnt(2)
    v_mfma_f32_16x16x32_bf16 v[32:35], v[8:11], a[96:99], v[32:35]
    v_mfma_f32_16x16x32_bf16 v[36:39], v[12:15], a[96:99], v[36:39]
    ds_read_b128 v[24:27], v6 offset:14336
    ds_read_b128 v[28:31], v6 offset:32768
    v_mfma_f32_16x16x32_bf16 v[40:43], v[8:11], a[100:103], v[40:43]
    v_mfma_f32_16x16x32_bf16 v[44:47], v[12:15], a[100:103], v[44:47]
    s_waitcnt lgkmcnt(2)
    v_mfma_f32_16x16x32_bf16 v[32:35], v[16:19], a[104:107], v[32:35]
    v_mfma_f32_16x16x32_bf16 v[36:39], v[20:23], a[104:107], v[36:39]
    ds_read_b128 v[8:11], v6 offset:15360
    ds_read_b128 v[12:15], v6 offset:33792
    v_mfma_f32_16x16x32_bf16 v[40:43], v[16:19], a[108:111], v[40:43]
    v_mfma_f32_16x16x32_bf16 v[44:47], v[20:23], a[108:111], v[44:47]
    s_waitcnt lgkmcnt(2)
    v_mfma_f32_16x16x32_bf16 v[32:35], v[24:27], a[112:115], v[32:35]
    v_mfma_f32_16x16x32_bf16 v[36:39], v[28:31], a[112:115], v[36:39]
    ds_read_b128 v[16:19], v6 offset:16384
    ds_read_b128 v[20:23], v6 offset:34816
    v_mfma_f32_16x16x32_bf16 v[40:43], v[24:27], a[116:119], v[40:43]
    v_mfma_f32_16x16x32_bf16 v[44:47], v[28:31], a[116:119], v[44:47]
    s_waitcnt lgkmcnt(2)
    v_mfma_f32_16x16x32_bf16 v[32:35], v[8:11], a[120:123], v[32:35]
    v_mfma_f32_16x16x32_bf16 v[36:39], v[12:15], a[120:123], v[36:39]
    ds_read_b128 v[24:27], v6 offset:17408
    ds_read_b128 v[28:31], v6 offset:35840
    v_mfma_f32_16x16x32_bf16 v[40:43], v[8:11], a[124:127], v[40:43]
    v_mfma_f32_16x16x32_bf16 v[44:47], v[12:15], a[124:127], v[44:47]
    s_waitcnt lgkmcnt(2)
    v_mfma_f32_16x16x32_bf16 v[32:35], v[16:19], a[128:131], v[32:35]
    v_mfma_f32_16x16x32_bf16 v[36:39], v[20:23], a[128:131], v[36:39]
    v_mfma_f32_16x16x32_bf16 v[40:43], v[16:19], a[132:135], v[40:43]
    v_mfma_f32_16x16x32_bf16 v[44:47], v[20:23], a[132:135], v[44:47]
    s_waitcnt lgkmcnt(0)
    v_mfma_f32_16x16x32_bf16 v[32:35], v[24:27], a[136:139], v[32:35]
    v_mfma_f32_16x16x32_bf16 v[36:39], v[28:31], a[136:139], v[36:39]
    v_mfma_f32_16x16x32_bf16 v[40:43], v[24:27], a[140:143], v[40:43]
    v_mfma_f32_16x16x32_bf16 v[44:47], v[28:31], a[140:143], v[44:47]
    s_sub_u32 s38, s27, 1024
    s_cmp_eq_u32 s24, 0
    s_cselect_b32 s38, 120061952, s38
    s_add_u32 s27, s27, 1024
    s_add_u32 s24, s24, 1
    v_cvt_pk_bf16_f32 v48, v32, v33
    v_cvt_pk_bf16_f32 v49, v34, v35
    v_cvt_pk_bf16_f32 v50, v36, v37
    v_cvt_pk_bf16_f32 v51, v38, v39
    buffer_store_dwordx4 v[48:51], v2, s[8:11], s26 offen offset:0 sc1
    v_cvt_pk_bf16_f32 v52, v40, v41
    v_cvt_pk_bf16_f32 v53, v42, v43
    v_cvt_pk_bf16_f32 v54, v44, v45
    v_cvt_pk_bf16_f32 v55, v46, v47
    buffer_store_dwordx4 v[52:55], v2, s[8:11], s26 offen offset:1024 sc1
    s_add_u32 s26, s26, 262144
    s_cmp_gt_u32 s24, 3
    s_cbranch_scc1 L_s1v_late1
    s_waitcnt vmcnt(0)
    s_barrier
    s_sub_u32 s31, s27, 1024
    s_mov_b64 exec, s[40:41]
    buffer_store_dwordx2 v[60:61], off, s[8:11], s31 sc1
    s_mov_b64 exec, -1
L_s1v_late1:
    s_cmp_lt_u32 s24, 32
    s_cbranch_scc1 L_s1v_top0
    s_branch L_s1_end
L_s1_end:
    s_waitcnt vmcnt(0)
    s_barrier
    s_mov_b64 exec, s[40:41]
    buffer_store_dwordx2 v[60:61], off, s[8:11], s38 sc1
    s_mov_b64 exec, -1
    s_sub_u32 s38, s27, 1024
    s_mov_b64 exec, s[40:41]
    buffer_store_dwordx2 v[60:61], off, s[8:11], s38 sc1
    s_mov_b64 exec, -1
    s_barrier
    s_mul_hi_u32 s65, s64, 238609295
    s_mul_i32 s30, s65, 18
    s_sub_u32 s69, s64, s30
    s_cmp_lt_u32 s65, 4
    s_cbranch_scc1 L_role_s4
    s_sub_u32 s65, s65, 4
    s_cmp_lt_u32 s65, 3
    s_cbranch_scc1 L_role_s3
    s_sub_u32 s65, s65, 3
    s_cmp_lt_u32 s65, 3
    s_cbranch_scc1 L_role_s5
    s_sub_u32 s65, s65, 3
L_abort:
    s_endpgm
L_role_s3:
    s_load_dwordx2 s[36:37], s[0:1], 40
    s_load_dwordx2 s[38:39], s[0:1], 0
    v_and_b32 v1, 63, v0
    v_lshlrev_b32 v2, 4, v1
    v_mov_b32 v5, 1
    v_mov_b32 v3, 0
    v_bfe_u32 v36, v1, 0, 1
    v_lshl_add_u32 v3, v36, 4, v3
    v_bfe_u32 v36, v1, 1, 1
    v_lshl_add_u32 v3, v36, 5, v3
    v_bfe_u32 v36, v1, 2, 1
    s_mov_b32 s30, 1152
    v_mad_u32_u24 v3, v36, s30, v3
    v_bfe_u32 v36, v1, 3, 1
    s_mov_b32 s30, 2304
    v_mad_u32_u24 v3, v36, s30, v3
    v_bfe_u32 v36, v1, 4, 1
    s_mov_b32 s30, 4608
    v_mad_u32_u24 v3, v36, s30, v3
    v_bfe_u32 v36, v1, 5, 1
    s_mov_b32 s30, 9216
    v_mad_u32_u24 v3, v36, s30, v3
    s_lshl_b32 s23, s17, 15
    v_add_u32 v4, s23, v2
    s_mul_i32 s24, s17, 1179648
    s_lshl_b32 s30, s69, 6
    s_add_u32 s24, s24, s30
    v_mov_b32 v7, 0
    v_bfe_u32 v36, v1, 0, 1
    s_mov_b32 s30, 1152
    v_mad_u32_u24 v7, v36, s30, v7
    v_bfe_u32 v36, v1, 1, 1
    s_mov_b32 s30, 2304
    v_mad_u32_u24 v7, v36, s30, v7
    v_bfe_u32 v36, v1, 2, 1
    s_mov_b32 s30, 4608
    v_mad_u32_u24 v7, v36, s30, v7
    v_bfe_u32 v36, v1, 3, 1
    s_mov_b32 s30, 9216
    v_mad_u32_u24 v7, v36, s30, v7
    v_bfe_u32 v36, v1, 4, 1
    v_lshl_add_u32 v7, v36, 4, v7
    v_bfe_u32 v36, v1, 5, 1
    v_lshl_add_u32 v7, v36, 5, v7
    s_lshl_b32 s30, s69, 6
    v_add_u32 v7, s30, v7
    s_lshl_b32 s30, s17, 11
    v_add_u32 v8, s30, v2
    v_add_u32 v8, 131072, v8
    v_add_u32 v29, 131072, v2
    v_and_b32 v6, 31, v1
    s_lshl_b32 s30, s17, 7
    v_lshlrev_b32 v6, 2, v6
    v_add_u32 v6, s30, v6
    v_and_b32 v9, 15, v1
    v_lshlrev_b32 v9, 3, v9
    s_waitcnt lgkmcnt(0)
    s_mov_b32 s48, s36
    s_and_b32 s49, s37, 0xffff
    s_mov_b32 s50, 4718592
    s_mov_b32 s51, 0x00020000
    s_mov_b32 s52, s38
    s_and_b32 s53, s39, 0xffff
    s_mov_b32 s54, 2359296
    s_mov_b32 s55, 0x00020000
    s_add_u32 m0, s23, 0
    s_add_u32 s33, s24, 0
    buffer_load_dwordx4 v3, s[48:51], s33 offen lds
    s_add_u32 m0, s23, 1024
    s_add_u32 s33, s24, 18432
    buffer_load_dwordx4 v3, s[48:51], s33 offen lds
    s_add_u32 m0, s23, 2048
    s_add_u32 s33, s24, 36864
    buffer_load_dwordx4 v3, s[48:51], s33 offen lds
    s_add_u32 m0, s23, 3072
    s_add_u32 s33, s24, 55296
    buffer_load_dwordx4 v3, s[48:51], s33 offen lds
    s_add_u32 m0, s23, 4096
    s_add_u32 s33, s24, 73728
    buffer_load_dwordx4 v3, s[48:51], s33 offen lds
    s_add_u32 m0, s23, 5120
    s_add_u32 s33, s24, 92160
    buffer_load_dwordx4 v3, s[48:51], s33 offen lds
    s_add_u32 m0, s23, 6144
    s_add_u32 s33, s24, 110592
    buffer_load_dwordx4 v3, s[48:51], s33 offen lds
    s_add_u32 m0, s23, 7168
    s_add_u32 s33, s24, 129024
    buffer_load_dwordx4 v3, s[48:51], s33 offen lds
    s_add_u32 m0, s23, 8192
    s_add_u32 s33, s24, 147456
    buffer_load_dwordx4 v3, s[48:51], s33 offen lds
    s_add_u32 m0, s23, 9216
    s_add_u32 s33, s24, 165888
    buffer_load_dwordx4 v3, s[48:51], s33 offen lds
    s_add_u32 m0, s23, 10240
    s_add_u32 s33, s24, 184320
    buffer_load_dwordx4 v3, s[48:51], s33 offen lds
    s_add_u32 m0, s23, 11264
    s_add_u32 s33, s24, 202752
    buffer_load_dwordx4 v3, s[48:51], s33 offen lds
    s_add_u32 m0, s23, 12288
    s_add_u32 s33, s24, 221184
    buffer_load_dwordx4 v3, s[48:51], s33 offen lds
    s_add_u32 m0, s23, 13312
    s_add_u32 s33, s24, 239616
    buffer_load_dwordx4 v3, s[48:51], s33 offen lds
    s_add_u32 m0, s23, 14336
    s_add_u32 s33, s24, 258048
    buffer_load_dwordx4 v3, s[48:51], s33 offen lds
    s_add_u32 m0, s23, 15360
    s_add_u32 s33, s24, 276480
    buffer_load_dwordx4 v3, s[48:51], s33 offen lds
    s_add_u32 m0, s23, 16384
    s_add_u32 s33, s24, 294912
    buffer_load_dwordx4 v3, s[48:51], s33 offen lds
    s_add_u32 m0, s23, 17408
    s_add_u32 s33, s24, 313344
    buffer_load_dwordx4 v3, s[48:51], s33 offen lds
    s_add_u32 m0, s23, 18432
    s_add_u32 s33, s24, 331776
    buffer_load_dwordx4 v3, s[48:51], s33 offen lds
    s_add_u32 m0, s23, 19456
    s_add_u32 s33, s24, 350208
    buffer_load_dwordx4 v3, s[48:51], s33 offen lds
    s_add_u32 m0, s23, 20480
    s_add_u32 s33, s24, 368640
    buffer_load_dwordx4 v3, s[48:51], s33 offen lds
    s_add_u32 m0, s23, 21504
    s_add_u32 s33, s24, 387072
    buffer_load_dwordx4 v3, s[48:51], s33 offen lds
    s_add_u32 m0, s23, 22528
    s_add_u32 s33, s24, 405504
    buffer_load_dwordx4 v3, s[48:51], s33 offen lds
    s_add_u32 m0, s23, 23552
    s_add_u32 s33, s24, 423936
    buffer_load_dwordx4 v3, s[48:51], s33 offen lds
    s_add_u32 m0, s23, 24576
    s_add_u32 s33, s24, 442368
    buffer_load_dwordx4 v3, s[48:51], s33 offen lds
    s_add_u32 m0, s23, 25600
    s_add_u32 s33, s24, 460800
    buffer_load_dwordx4 v3, s[48:51], s33 offen lds
    s_add_u32 m0, s23, 26624
    s_add_u32 s33, s24, 479232
    buffer_load_dwordx4 v3, s[48:51], s33 offen lds
    s_add_u32 m0, s23, 27648
    s_add_u32 s33, s24, 497664
    buffer_load_dwordx4 v3, s[48:51], s33 offen lds
    s_add_u32 m0, s23, 28672
    s_add_u32 s33, s24, 516096
    buffer_load_dwordx4 v3, s[48:51], s33 offen lds
    s_add_u32 m0, s23, 29696
    s_add_u32 s33, s24, 534528
    buffer_load_dwordx4 v3, s[48:51], s33 offen lds
    s_add_u32 m0, s23, 30720
    s_add_u32 s33, s24, 552960
    buffer_load_dwordx4 v3, s[48:51], s33 offen lds
    s_add_u32 m0, s23, 31744
    s_add_u32 s33, s24, 571392
    buffer_load_dwordx4 v3, s[48:51], s33 offen lds
    s_waitcnt vmcnt(30)
    ds_read_b64_tr_b16 a[0:1], v4 offset:0
    ds_read_b64_tr_b16 a[2:3], v4 offset:1024
    ds_read_b64_tr_b16 a[4:5], v4 offset:8
    ds_read_b64_tr_b16 a[6:7], v4 offset:1032
    s_waitcnt lgkmcnt(0)
    s_add_u32 m0, s23, 0
    s_add_u32 s33, s24, 589824
    buffer_load_dwordx4 v3, s[48:51], s33 offen lds
    s_add_u32 m0, s23, 1024
    s_add_u32 s33, s24, 608256
    buffer_load_dwordx4 v3, s[48:51], s33 offen lds
    s_waitcnt vmcnt(30)
    ds_read_b64_tr_b16 a[8:9], v4 offset:2048
    ds_read_b64_tr_b16 a[10:11], v4 offset:3072
    ds_read_b64_tr_b16 a[12:13], v4 offset:2056
    ds_read_b64_tr_b16 a[14:15], v4 offset:3080
    s_waitcnt lgkmcnt(0)
    s_add_u32 m0, s23, 2048
    s_add_u32 s33, s24, 626688
    buffer_load_dwordx4 v3, s[48:51], s33 offen lds
    s_add_u32 m0, s23, 3072
    s_add_u32 s33, s24, 645120
    buffer_load_dwordx4 v3, s[48:51], s33 offen lds
    s_waitcnt vmcnt(30)
    ds_read_b64_tr_b16 a[16:17], v4 offset:4096
    ds_read_b64_tr_b16 a[18:19], v4 offset:5120
    ds_read_b64_tr_b16 a[20:21], v4 offset:4104
    ds_read_b64_tr_b16 a[22:23], v4 offset:5128
    s_waitcnt lgkmcnt(0)
    s_add_u32 m0, s23, 4096
    s_add_u32 s33, s24, 663552
    buffer_load_dwordx4 v3, s[48:51], s33 offen lds
    s_add_u32 m0, s23, 5120
    s_add_u32 s33, s24, 681984
    buffer_load_dwordx4 v3, s[48:51], s33 offen lds
    s_waitcnt vmcnt(30)
    ds_read_b64_tr_b16 a[24:25], v4 offset:6144
    ds_read_b64_tr_b16 a[26:27], v4 offset:7168
    ds_read_b64_tr_b16 a[28:29], v4 offset:6152
    ds_read_b64_tr_b16 a[30:31], v4 offset:7176
    s_waitcnt lgkmcnt(0)
    s_add_u32 m0, s23, 6144
    s_add_u32 s33, s24, 700416
    buffer_load_dwordx4 v3, s[48:51], s33 offen lds
    s_add_u32 m0, s23, 7168
    s_add_u32 s33, s24, 718848
    buffer_load_dwordx4 v3, s[48:51], s33 offen lds
    s_waitcnt vmcnt(30)
    ds_read_b64_tr_b16 a[32:33], v4 offset:8192
    ds_read_b64_tr_b16 a[34:35], v4 offset:9216
    ds_read_b64_tr_b16 a[36:37], v4 offset:8200
    ds_read_b64_tr_b16 a[38:39], v4 offset:9224
    s_waitcnt lgkmcnt(0)
    s_add_u32 m0, s23, 8192
    s_add_u32 s33, s24, 737280
    buffer_load_dwordx4 v3, s[48:51], s33 offen lds
    s_add_u32 m0, s23, 9216
    s_add_u32 s33, s24, 755712
    buffer_load_dwordx4 v3, s[48:51], s33 offen lds
    s_waitcnt vmcnt(30)
    ds_read_b64_tr_b16 a[40:41], v4 offset:10240
    ds_read_b64_tr_b16 a[42:43], v4 offset:11264
    ds_read_b64_tr_b16 a[44:45], v4 offset:10248
    ds_read_b64_tr_b16 a[46:47], v4 offset:11272
    s_waitcnt lgkmcnt(0)
    s_add_u32 m0, s23, 10240
    s_add_u32 s33, s24, 774144
    buffer_load_dwordx4 v3, s[48:51], s33 offen lds
    s_add_u32 m0, s23, 11264
    s_add_u32 s33, s24, 792576
    buffer_load_dwordx4 v3, s[48:51], s33 offen lds
    s_waitcnt vmcnt(30)
    ds_read_b64_tr_b16 a[48:49], v4 offset:12288
    ds_read_b64_tr_b16 a[50:51], v4 offset:13312
    ds_read_b64_tr_b16 a[52:53], v4 offset:12296
    ds_read_b64_tr_b16 a[54:55], v4 offset:13320
    s_waitcnt lgkmcnt(0)
    s_add_u32 m0, s23, 12288
    s_add_u32 s33, s24, 811008
    buffer_load_dwordx4 v3, s[48:51], s33 offen lds
    s_add_u32 m0, s23, 13312
    s_add_u32 s33, s24, 829440
    buffer_load_dwordx4 v3, s[48:51], s33 offen lds
    s_waitcnt vmcnt(30)
    ds_read_b64_tr_b16 a[56:57], v4 offset:14336
    ds_read_b64_tr_b16 a[58:59], v4 offset:15360
    ds_read_b64_tr_b16 a[60:61], v4 offset:14344
    ds_read_b64_tr_b16 a[62:63], v4 offset:15368
    s_waitcnt lgkmcnt(0)
    s_add_u32 m0, s23, 14336
    s_add_u32 s33, s24, 847872
    buffer_load_dwordx4 v3, s[48:51], s33 offen lds
    s_add_u32 m0, s23, 15360
    s_add_u32 s33, s24, 866304
    buffer_load_dwordx4 v3, s[48:51], s33 offen lds
    s_waitcnt vmcnt(30)
    ds_read_b64_tr_b16 a[64:65], v4 offset:16384
    ds_read_b64_tr_b16 a[66:67], v4 offset:17408
    ds_read_b64_tr_b16 a[68:69], v4 offset:16392
    ds_read_b64_tr_b16 a[70:71], v4 offset:17416
    s_waitcnt lgkmcnt(0)
    s_add_u32 m0, s23, 16384
    s_add_u32 s33, s24, 884736
    buffer_load_dwordx4 v3, s[48:51], s33 offen lds
    s_add_u32 m0, s23, 17408
    s_add_u32 s33, s24, 903168
    buffer_load_dwordx4 v3, s[48:51], s33 offen lds
    s_waitcnt vmcnt(30)
    ds_read_b64_tr_b16 a[72:73], v4 offset:18432
    ds_read_b64_tr_b16 a[74:75], v4 offset:19456
    ds_read_b64_tr_b16 a[76:77], v4 offset:18440
    ds_read_b64_tr_b16 a[78:79], v4 offset:19464
    s_waitcnt lgkmcnt(0)
    s_add_u32 m0, s23, 18432
    s_add_u32 s33, s24, 921600
    buffer_load_dwordx4 v3, s[48:51], s33 offen lds
    s_add_u32 m0, s23, 19456
    s_add_u32 s33, s24, 940032
    buffer_load_dwordx4 v3, s[48:51], s33 offen lds
    s_waitcnt vmcnt(30)
    ds_read_b64_tr_b16 a[80:81], v4 offset:20480
    ds_read_b64_tr_b16 a[82:83], v4 offset:21504
    ds_read_b64_tr_b16 a[84:85], v4 offset:20488
    ds_read_b64_tr_b16 a[86:87], v4 offset:21512
    s_waitcnt lgkmcnt(0)
    s_add_u32 m0, s23, 20480
    s_add_u32 s33, s24, 958464
    buffer_load_dwordx4 v3, s[48:51], s33 offen lds
    s_add_u32 m0, s23, 21504
    s_add_u32 s33, s24, 976896
    buffer_load_dwordx4 v3, s[48:51], s33 offen lds
    s_waitcnt vmcnt(30)
    ds_read_b64_tr_b16 a[88:89], v4 offset:22528
    ds_read_b64_tr_b16 a[90:91], v4 offset:23552
    ds_read_b64_tr_b16 a[92:93], v4 offset:22536
    ds_read_b64_tr_b16 a[94:95], v4 offset:23560
    s_waitcnt lgkmcnt(0)
    s_add_u32 m0, s23, 22528
    s_add_u32 s33, s24, 995328
    buffer_load_dwordx4 v3, s[48:51], s33 offen lds
    s_add_u32 m0, s23, 23552
    s_add_u32 s33, s24, 1013760
    buffer_load_dwordx4 v3, s[48:51], s33 offen lds
    s_waitcnt vmcnt(30)
    ds_read_b64_tr_b16 a[96:97], v4 offset:24576
    ds_read_b64_tr_b16 a[98:99], v4 offset:25600
    ds_read_b64_tr_b16 a[100:101], v4 offset:24584
    ds_read_b64_tr_b16 a[102:103], v4 offset:25608
    s_waitcnt lgkmcnt(0)
    s_add_u32 m0, s23, 24576
    s_add_u32 s33, s24, 1032192
    buffer_load_dwordx4 v3, s[48:51], s33 offen lds
    s_add_u32 m0, s23, 25600
    s_add_u32 s33, s24, 1050624
    buffer_load_dwordx4 v3, s[48:51], s33 offen lds
    s_waitcnt vmcnt(30)
    ds_read_b64_tr_b16 a[104:105], v4 offset:26624
    ds_read_b64_tr_b16 a[106:107], v4 offset:27648
    ds_read_b64_tr_b16 a[108:109], v4 offset:26632
    ds_read_b64_tr_b16 a[110:111], v4 offset:27656
    s_waitcnt lgkmcnt(0)
    s_add_u32 m0, s23, 26624
    s_add_u32 s33, s24, 1069056
    buffer_load_dwordx4 v3, s[48:51], s33 offen lds
    s_add_u32 m0, s23, 27648
    s_add_u32 s33, s24, 1087488
    buffer_load_dwordx4 v3, s[48:51], s33 offen lds
    s_waitcnt vmcnt(30)
    ds_read_b64_tr_b16 a[112:113], v4 offset:28672
    ds_read_b64_tr_b16 a[114:115], v4 offset:29696
    ds_read_b64_tr_b16 a[116:117], v4 offset:28680
    ds_read_b64_tr_b16 a[118:119], v4 offset:29704
    s_waitcnt lgkmcnt(0)
    s_add_u32 m0, s23, 28672
    s_add_u32 s33, s24, 1105920
    buffer_load_dwordx4 v3, s[48:51], s33 offen lds
    s_add_u32 m0, s23, 29696
    s_add_u32 s33, s24, 1124352
    buffer_load_dwordx4 v3, s[48:51], s33 offen lds
    s_waitcnt vmcnt(30)
    ds_read_b64_tr_b16 a[120:121], v4 offset:30720
    ds_read_b64_tr_b16 a[122:123], v4 offset:31744
    ds_read_b64_tr_b16 a[124:125], v4 offset:30728
    ds_read_b64_tr_b16 a[126:127], v4 offset:31752
    s_waitcnt lgkmcnt(0)
    s_add_u32 m0, s23, 30720
    s_add_u32 s33, s24, 1142784
    buffer_load_dwordx4 v3, s[48:51], s33 offen lds
    s_add_u32 m0, s23, 31744
    s_add_u32 s33, s24, 1161216
    buffer_load_dwordx4 v3, s[48:51], s33 offen lds
    s_waitcnt vmcnt(30)
    ds_read_b64_tr_b16 a[128:129], v4 offset:0
    ds_read_b64_tr_b16 a[130:131], v4 offset:1024
    ds_read_b64_tr_b16 a[132:133], v4 offset:8
    ds_read_b64_tr_b16 a[134:135], v4 offset:1032
    s_waitcnt vmcnt(28)
    ds_read_b64_tr_b16 a[136:137], v4 offset:2048
    ds_read_b64_tr_b16 a[138:139], v4 offset:3072
    ds_read_b64_tr_b16 a[140:141], v4 offset:2056
    ds_read_b64_tr_b16 a[142:143], v4 offset:3080
    s_waitcnt vmcnt(26)
    ds_read_b64_tr_b16 a[144:145], v4 offset:4096
    ds_read_b64_tr_b16 a[146:147], v4 offset:5120
    ds_read_b64_tr_b16 a[148:149], v4 offset:4104
    ds_read_b64_tr_b16 a[150:151], v4 offset:5128
    s_waitcnt vmcnt(24)
    ds_read_b64_tr_b16 a[152:153], v4 offset:6144
    ds_read_b64_tr_b16 a[154:155], v4 offset:7168
    ds_read_b64_tr_b16 a[156:157], v4 offset:6152
    ds_read_b64_tr_b16 a[158:159], v4 offset:7176
    s_waitcnt vmcnt(22)
    ds_read_b64_tr_b16 a[160:161], v4 offset:8192
    ds_read_b64_tr_b16 a[162:163], v4 offset:9216
    ds_read_b64_tr_b16 a[164:165], v4 offset:8200
    ds_read_b64_tr_b16 a[166:167], v4 offset:9224
    s_waitcnt vmcnt(20)
    ds_read_b64_tr_b16 a[168:169], v4 offset:10240
    ds_read_b64_tr_b16 a[170:171], v4 offset:11264
    ds_read_b64_tr_b16 a[172:173], v4 offset:10248
    ds_read_b64_tr_b16 a[174:175], v4 offset:11272
    s_waitcnt vmcnt(18)
    ds_read_b64_tr_b16 a[176:177], v4 offset:12288
    ds_read_b64_tr_b16 a[178:179], v4 offset:13312
    ds_read_b64_tr_b16 a[180:181], v4 offset:12296
    ds_read_b64_tr_b16 a[182:183], v4 offset:13320
    s_waitcnt vmcnt(16)
    ds_read_b64_tr_b16 a[184:185], v4 offset:14336
    ds_read_b64_tr_b16 a[186:187], v4 offset:15360
    ds_read_b64_tr_b16 a[188:189], v4 offset:14344
    ds_read_b64_tr_b16 a[190:191], v4 offset:15368
    s_waitcnt vmcnt(14)
    ds_read_b64_tr_b16 a[192:193], v4 offset:16384
    ds_read_b64_tr_b16 a[194:195], v4 offset:17408
    ds_read_b64_tr_b16 a[196:197], v4 offset:16392
    ds_read_b64_tr_b16 a[198:199], v4 offset:17416
    s_waitcnt vmcnt(12)
    ds_read_b64_tr_b16 a[200:201], v4 offset:18432
    ds_read_b64_tr_b16 a[202:203], v4 offset:19456
    ds_read_b64_tr_b16 a[204:205], v4 offset:18440
    ds_read_b64_tr_b16 a[206:207], v4 offset:19464
    s_waitcnt vmcnt(10)
    ds_read_b64_tr_b16 a[208:209], v4 offset:20480
    ds_read_b64_tr_b16 a[210:211], v4 offset:21504
    ds_read_b64_tr_b16 a[212:213], v4 offset:20488
    ds_read_b64_tr_b16 a[214:215], v4 offset:21512
    s_waitcnt vmcnt(8)
    ds_read_b64_tr_b16 a[216:217], v4 offset:22528
    ds_read_b64_tr_b16 a[218:219], v4 offset:23552
    ds_read_b64_tr_b16 a[220:221], v4 offset:22536
    ds_read_b64_tr_b16 a[222:223], v4 offset:23560
    s_waitcnt vmcnt(6)
    ds_read_b64_tr_b16 a[224:225], v4 offset:24576
    ds_read_b64_tr_b16 a[226:227], v4 offset:25600
    ds_read_b64_tr_b16 a[228:229], v4 offset:24584
    ds_read_b64_tr_b16 a[230:231], v4 offset:25608
    s_waitcnt vmcnt(4)
    ds_read_b64_tr_b16 a[232:233], v4 offset:26624
    ds_read_b64_tr_b16 a[234:235], v4 offset:27648
    ds_read_b64_tr_b16 a[236:237], v4 offset:26632
    ds_read_b64_tr_b16 a[238:239], v4 offset:27656
    s_waitcnt vmcnt(2)
    ds_read_b64_tr_b16 a[240:241], v4 offset:28672
    ds_read_b64_tr_b16 a[242:243], v4 offset:29696
    ds_read_b64_tr_b16 a[244:245], v4 offset:28680
    ds_read_b64_tr_b16 a[246:247], v4 offset:29704
    s_waitcnt vmcnt(0)
    ds_read_b64_tr_b16 a[248:249], v4 offset:30720
    ds_read_b64_tr_b16 a[250:251], v4 offset:31744
    ds_read_b64_tr_b16 a[252:253], v4 offset:30728
    ds_read_b64_tr_b16 a[254:255], v4 offset:31752
    s_waitcnt lgkmcnt(0)
    s_mov_b32 s20, s65
    s_mov_b32 s34, 0
    s_mov_b32 s35, 0
    s_mul_i32 s21, s20, 131072
    s_mul_i32 s30, s17, 32768
    s_add_u32 s21, s21, s30
    s_add_u32 s21, s21, 71303168
L_s3_top:
    s_mul_i32 s26, s20, 18432
    s_mul_i32 s25, s20, 18432
    s_lshl_b32 s30, s69, 10
    s_add_u32 s25, s25, s30
    s_add_u32 s25, s25, 88080384
    s_cmp_eq_u32 s35, 1
    s_cbranch_scc1 L_s3_have
    s_add_u32 s22, s20, 0
    s_min_u32 s22, s22, 127
    s_lshr_b32 s22, s22, 1
    s_lshl_b32 s22, s22, 9
    s_add_u32 s22, s22, 119554048
    s_mov_b32 s29, 0
L_s3_p:
    buffer_load_dword v28, v6, s[8:11], s22 offen sc1
    s_add_u32 s29, s29, 1
    s_cmp_ge_u32 s29, 4194304
    s_cbranch_scc1 L_abort
    s_waitcnt vmcnt(0)
    v_cmp_eq_u32 vcc, 0, v28
    s_cbranch_vccz L_s3_ok
    s_sleep 2
    s_branch L_s3_p
L_s3_ok:
    s_add_u32 s22, s20, 3
    s_min_u32 s22, s22, 127
    s_lshr_b32 s22, s22, 1
    s_lshl_b32 s22, s22, 9
    s_add_u32 s22, s22, 119554048
    buffer_load_dword v28, v6, s[8:11], s22 offen sc1
    buffer_load_dwordx4 v[64:67], v2, s[8:11], s21 offen offset:0 sc1
    buffer_load_dwordx4 v[68:71], v2, s[8:11], s21 offen offset:1024 sc1
    buffer_load_dwordx4 v[72:75], v2, s[8:11], s21 offen offset:2048 sc1
    buffer_load_dwordx4 v[76:79], v2, s[8:11], s21 offen offset:3072 sc1
    s_add_u32 s21, s21, 4096
    buffer_load_dwordx4 v[80:83], v2, s[8:11], s21 offen offset:0 sc1
    buffer_load_dwordx4 v[84:87], v2, s[8:11], s21 offen offset:1024 sc1
    buffer_load_dwordx4 v[88:91], v2, s[8:11], s21 offen offset:2048 sc1
    buffer_load_dwordx4 v[92:95], v2, s[8:11], s21 offen offset:3072 sc1
    s_add_u32 s21, s21, 4096
    buffer_load_dwordx4 v[96:99], v2, s[8:11], s21 offen offset:0 sc1
    buffer_load_dwordx4 v[100:103], v2, s[8:11], s21 offen offset:1024 sc1
    buffer_load_dwordx4 v[104:107], v2, s[8:11], s21 offen offset:2048 sc1
    buffer_load_dwordx4 v[108:111], v2, s[8:11], s21 offen offset:3072 sc1
    s_add_u32 s21, s21, 4096
    buffer_load_dwordx4 v[112:115], v2, s[8:11], s21 offen offset:0 sc1
    buffer_load_dwordx4 v[116:119], v2, s[8:11], s21 offen offset:1024 sc1
    buffer_load_dwordx4 v[120:123], v2, s[8:11], s21 offen offset:2048 sc1
    buffer_load_dwordx4 v[124:127], v2, s[8:11], s21 offen offset:3072 sc1
    s_add_u32 s21, s21, 4096
    buffer_load_dwordx4 v[128:131], v2, s[8:11], s21 offen offset:0 sc1
    buffer_load_dwordx4 v[132:135], v2, s[8:11], s21 offen offset:1024 sc1
    buffer_load_dwordx4 v[136:139], v2, s[8:11], s21 offen offset:2048 sc1
    buffer_load_dwordx4 v[140:143], v2, s[8:11], s21 offen offset:3072 sc1
    s_add_u32 s21, s21, 4096
    buffer_load_dwordx4 v[144:147], v2, s[8:11], s21 offen offset:0 sc1
    buffer_load_dwordx4 v[148:151], v2, s[8:11], s21 offen offset:1024 sc1
    buffer_load_dwordx4 v[152:155], v2, s[8:11], s21 offen offset:2048 sc1
    buffer_load_dwordx4 v[156:159], v2, s[8:11], s21 offen offset:3072 sc1
    s_add_u32 s21, s21, 4096
    buffer_load_dwordx4 v[160:163], v2, s[8:11], s21 offen offset:0 sc1
    buffer_load_dwordx4 v[164:167], v2, s[8:11], s21 offen offset:1024 sc1
    buffer_load_dwordx4 v[168:171], v2, s[8:11], s21 offen offset:2048 sc1
    buffer_load_dwordx4 v[172:175], v2, s[8:11], s21 offen offset:3072 sc1
    s_add_u32 s21, s21, 4096
    buffer_load_dwordx4 v[176:179], v2, s[8:11], s21 offen offset:0 sc1
    buffer_load_dwordx4 v[180:183], v2, s[8:11], s21 offen offset:1024 sc1
    buffer_load_dwordx4 v[184:187], v2, s[8:11], s21 offen offset:2048 sc1
    buffer_load_dwordx4 v[188:191], v2, s[8:11], s21 offen offset:3072 sc1
    s_add_u32 s21, s21, 364544
L_s3_have:
    s_add_u32 s22, s20, 6
    s_min_u32 s22, s22, 127
    s_lshr_b32 s22, s22, 1
    s_lshl_b32 s22, s22, 9
    s_add_u32 s22, s22, 119554048
    s_waitcnt vmcnt(31)
    v_cmp_eq_u32 vcc, 0, v28
    s_add_u32 s30, s20, 3
    s_cmp_lt_u32 s30, 128
    s_cselect_b32 s35, 1, 0
    s_cmp_eq_u64 vcc, 0
    s_cselect_b32 s35, s35, 0
    buffer_load_dword v28, v6, s[8:11], s22 offen sc1
    buffer_load_dwordx4 v[32:35], v7, s[52:55], s26 offen
    s_cmp_eq_u32 s35, 1
    s_cbranch_scc1 L_s3_pf
    v_mfma_f32_16x16x32_bf16 v[20:23], a[0:3], v[64:67], 0
    v_mfma_f32_16x16x32_bf16 v[24:27], a[4:7], v[64:67], 0
    s_waitcnt vmcnt(32)
    v_mfma_f32_16x16x32_bf16 v[20:23], a[8:11], v[68:71], v[20:23]
    v_mfma_f32_16x16x32_bf16 v[24:27], a[12:15], v[68:71], v[24:27]
    s_waitcnt vmcnt(31)
    v_mfma_f32_16x16x32_bf16 v[20:23], a[16:19], v[72:75], v[20:23]
    v_mfma_f32_16x16x32_bf16 v[24:27], a[20:23], v[72:75], v[24:27]
    s_waitcnt vmcnt(30)
    v_mfma_f32_16x16x32_bf16 v[20:23], a[24:27], v[76:79], v[20:23]
    v_mfma_f32_16x16x32_bf16 v[24:27], a[28:31], v[76:79], v[24:27]
    s_waitcnt vmcnt(29)
    v_mfma_f32_16x16x32_bf16 v[20:23], a[32:35], v[80:83], v[20:23]
    v_mfma_f32_16x16x32_bf16 v[24:27], a[36:39], v[80:83], v[24:27]
    s_waitcnt vmcnt(28)
    v_mfma_f32_16x16x32_bf16 v[20:23], a[40:43], v[84:87], v[20:23]
    v_mfma_f32_16x16x32_bf16 v[24:27], a[44:47], v[84:87], v[24:27]
    s_waitcnt vmcnt(27)
    v_mfma_f32_16x16x32_bf16 v[20:23], a[48:51], v[88:91], v[20:23]
    v_mfma_f32_16x16x32_bf16 v[24:27], a[52:55], v[88:91], v[24:27]
    s_waitcnt vmcnt(26)
    v_mfma_f32_16x16x32_bf16 v[20:23], a[56:59], v[92:95], v[20:23]
    v_mfma_f32_16x16x32_bf16 v[24:27], a[60:63], v[92:95], v[24:27]
    s_waitcnt vmcnt(25)
    v_mfma_f32_16x16x32_bf16 v[20:23], a[64:67], v[96:99], v[20:23]
    v_mfma_f32_16x16x32_bf16 v[24:27], a[68:71], v[96:99], v[24:27]
    s_waitcnt vmcnt(24)
    v_mfma_f32_16x16x32_bf16 v[20:23], a[72:75], v[100:103], v[20:23]
    v_mfma_f32_16x16x32_bf16 v[24:27], a[76:79], v[100:103], v[24:27]
    s_waitcnt vmcnt(23)
    v_mfma_f32_16x16x32_bf16 v[20:23], a[80:83], v[104:107], v[20:23]
    v_mfma_f32_16x16x32_bf16 v[24:27], a[84:87], v[104:107], v[24:27]
    s_waitcnt vmcnt(22)
    v_mfma_f32_16x16x32_bf16 v[20:23], a[88:91], v[108:111], v[20:23]
    v_mfma_f32_16x16x32_bf16 v[24:27], a[92:95], v[108:111], v[24:27]
    s_waitcnt vmcnt(21)
    v_mfma_f32_16x16x32_bf16 v[20:23], a[96:99], v[112:115], v[20:23]
    v_mfma_f32_16x16x32_bf16 v[24:27], a[100:103], v[112:115], v[24:27]
    s_waitcnt vmcnt(20)
    v_mfma_f32_16x16x32_bf16 v[20:23], a[104:107], v[116:119], v[20:23]
    v_mfma_f32_16x16x32_bf16 v[24:27], a[108:111], v[116:119], v[24:27]
    s_waitcnt vmcnt(19)
    v_mfma_f32_16x16x32_bf16 v[20:23], a[112:115], v[120:123], v[20:23]
    v_mfma_f32_16x16x32_bf16 v[24:27], a[116:119], v[120:123], v[24:27]
    s_waitcnt vmcnt(18)
    v_mfma_f32_16x16x32_bf16 v[20:23], a[120:123], v[124:127], v[20:23]
    v_mfma_f32_16x16x32_bf16 v[24:27], a[124:127], v[124:127], v[24:27]
    s_waitcnt vmcnt(17)
    v_mfma_f32_16x16x32_bf16 v[20:23], a[128:131], v[128:131], v[20:23]
    v_mfma_f32_16x16x32_bf16 v[24:27], a[132:135], v[128:131], v[24:27]
    s_waitcnt vmcnt(16)
    v_mfma_f32_16x16x32_bf16 v[20:23], a[136:139], v[132:135], v[20:23]
    v_mfma_f32_16x16x32_bf16 v[24:27], a[140:143], v[132:135], v[24:27]
    s_waitcnt vmcnt(15)
    v_mfma_f32_16x16x32_bf16 v[20:23], a[144:147], v[136:139], v[20:23]
    v_mfma_f32_16x16x32_bf16 v[24:27], a[148:151], v[136:139], v[24:27]
    s_waitcnt vmcnt(14)
    v_mfma_f32_16x16x32_bf16 v[20:23], a[152:155], v[140:143], v[20:23]
    v_mfma_f32_16x16x32_bf16 v[24:27], a[156:159], v[140:143], v[24:27]
    s_waitcnt vmcnt(13)
    v_mfma_f32_16x16x32_bf16 v[20:23], a[160:163], v[144:147], v[20:23]
    v_mfma_f32_16x16x32_bf16 v[24:27], a[164:167], v[144:147], v[24:27]
    s_waitcnt vmcnt(12)
    v_mfma_f32_16x16x32_bf16 v[20:23], a[168:171], v[148:151], v[20:23]
    v_mfma_f32_16x16x32_bf16 v[24:27], a[172:175], v[148:151], v[24:27]
    s_waitcnt vmcnt(11)
    v_mfma_f32_16x16x32_bf16 v[20:23], a[176:179], v[152:155], v[20:23]
    v_mfma_f32_16x16x32_bf16 v[24:27], a[180:183], v[152:155], v[24:27]
    s_waitcnt vmcnt(10)
    v_mfma_f32_16x16x32_bf16 v[20:23], a[184:187], v[156:159], v[20:23]
    v_mfma_f32_16x16x32_bf16 v[24:27], a[188:191], v[156:159], v[24:27]
    s_waitcnt vmcnt(9)
    v_mfma_f32_16x16x32_bf16 v[20:23], a[192:195], v[160:163], v[20:23]
    v_mfma_f32_16x16x32_bf16 v[24:27], a[196:199], v[160:163], v[24:27]
    s_waitcnt vmcnt(8)
    v_mfma_f32_16x16x32_bf16 v[20:23], a[200:203], v[164:167], v[20:23]
    v_mfma_f32_16x16x32_bf16 v[24:27], a[204:207], v[164:167], v[24:27]
    s_waitcnt vmcnt(7)
    v_mfma_f32_16x16x32_bf16 v[20:23], a[208:211], v[168:171], v[20:23]
    v_mfma_f32_16x16x32_bf16 v[24:27], a[212:215], v[168:171], v[24:27]
    s_waitcnt vmcnt(6)
    v_mfma_f32_16x16x32_bf16 v[20:23], a[216:219], v[172:175], v[20:23]
    v_mfma_f32_16x16x32_bf16 v[24:27], a[220:223], v[172:175], v[24:27]
    s_waitcnt vmcnt(5)
    v_mfma_f32_16x16x32_bf16 v[20:23], a[224:227], v[176:179], v[20:23]
    v_mfma_f32_16x16x32_bf16 v[24:27], a[228:231], v[176:179], v[24:27]
    s_waitcnt vmcnt(4)
    v_mfma_f32_16x16x32_bf16 v[20:23], a[232:235], v[180:183], v[20:23]
    v_mfma_f32_16x16x32_bf16 v[24:27], a[236:239], v[180:183], v[24:27]
    s_waitcnt vmcnt(3)
    v_mfma_f32_16x16x32_bf16 v[20:23], a[240:243], v[184:187], v[20:23]
    v_mfma_f32_16x16x32_bf16 v[24:27], a[244:247], v[184:187], v[24:27]
    s_waitcnt vmcnt(2)
    v_mfma_f32_16x16x32_bf16 v[20:23], a[248:251], v[188:191], v[20:23]
    v_mfma_f32_16x16x32_bf16 v[24:27], a[252:255], v[188:191], v[24:27]
    s_nop 7
    s_branch L_s3_red
L_s3_pf:
    v_mfma_f32_16x16x32_bf16 v[20:23], a[0:3], v[64:67], 0
    v_mfma_f32_16x16x32_bf16 v[24:27], a[4:7], v[64:67], 0
    buffer_load_dwordx4 v[64:67], v2, s[8:11], s21 offen offset:0 sc1
    s_waitcnt vmcnt(33)
    v_mfma_f32_16x16x32_bf16 v[20:23], a[8:11], v[68:71], v[20:23]
    v_mfma_f32_16x16x32_bf16 v[24:27], a[12:15], v[68:71], v[24:27]
    buffer_load_dwordx4 v[68:71], v2, s[8:11], s21 offen offset:1024 sc1
    s_waitcnt vmcnt(33)
    v_mfma_f32_16x16x32_bf16 v[20:23], a[16:19], v[72:75], v[20:23]
    v_mfma_f32_16x16x32_bf16 v[24:27], a[20:23], v[72:75], v[24:27]
    buffer_load_dwordx4 v[72:75], v2, s[8:11], s21 offen offset:2048 sc1
    s_waitcnt vmcnt(33)
    v_mfma_f32_16x16x32_bf16 v[20:23], a[24:27], v[76:79], v[20:23]
    v_mfma_f32_16x16x32_bf16 v[24:27], a[28:31], v[76:79], v[24:27]
    buffer_load_dwordx4 v[76:79], v2, s[8:11], s21 offen offset:3072 sc1
    s_waitcnt vmcnt(33)
    v_mfma_f32_16x16x32_bf16 v[20:23], a[32:35], v[80:83], v[20:23]
    v_mfma_f32_16x16x32_bf16 v[24:27], a[36:39], v[80:83], v[24:27]
    s_add_u32 s21, s21, 4096
    buffer_load_dwordx4 v[80:83], v2, s[8:11], s21 offen offset:0 sc1
    s_waitcnt vmcnt(33)
    v_mfma_f32_16x16x32_bf16 v[20:23], a[40:43], v[84:87], v[20:23]
    v_mfma_f32_16x16x32_bf16 v[24:27], a[44:47], v[84:87], v[24:27]
    buffer_load_dwordx4 v[84:87], v2, s[8:11], s21 offen offset:1024 sc1
    s_waitcnt vmcnt(33)
    v_mfma_f32_16x16x32_bf16 v[20:23], a[48:51], v[88:91], v[20:23]
    v_mfma_f32_16x16x32_bf16 v[24:27], a[52:55], v[88:91], v[24:27]
    buffer_load_dwordx4 v[88:91], v2, s[8:11], s21 offen offset:2048 sc1
    s_waitcnt vmcnt(33)
    v_mfma_f32_16x16x32_bf16 v[20:23], a[56:59], v[92:95], v[20:23]
    v_mfma_f32_16x16x32_bf16 v[24:27], a[60:63], v[92:95], v[24:27]
    buffer_load_dwordx4 v[92:95], v2, s[8:11], s21 offen offset:3072 sc1
    s_waitcnt vmcnt(33)
    v_mfma_f32_16x16x32_bf16 v[20:23], a[64:67], v[96:99], v[20:23]
    v_mfma_f32_16x16x32_bf16 v[24:27], a[68:71], v[96:99], v[24:27]
    s_add_u32 s21, s21, 4096
    buffer_load_dwordx4 v[96:99], v2, s[8:11], s21 offen offset:0 sc1
    s_waitcnt vmcnt(33)
    v_mfma_f32_16x16x32_bf16 v[20:23], a[72:75], v[100:103], v[20:23]
    v_mfma_f32_16x16x32_bf16 v[24:27], a[76:79], v[100:103], v[24:27]
    buffer_load_dwordx4 v[100:103], v2, s[8:11], s21 offen offset:1024 sc1
    s_waitcnt vmcnt(33)
    v_mfma_f32_16x16x32_bf16 v[20:23], a[80:83], v[104:107], v[20:23]
    v_mfma_f32_16x16x32_bf16 v[24:27], a[84:87], v[104:107], v[24:27]
    buffer_load_dwordx4 v[104:107], v2, s[8:11], s21 offen offset:2048 sc1
    s_waitcnt vmcnt(33)
    v_mfma_f32_16x16x32_bf16 v[20:23], a[88:91], v[108:111], v[20:23]
    v_mfma_f32_16x16x32_bf16 v[24:27], a[92:95], v[108:111], v[24:27]
    buffer_load_dwordx4 v[108:111], v2, s[8:11], s21 offen offset:3072 sc1
    s_waitcnt vmcnt(33)
    v_mfma_f32_16x16x32_bf16 v[20:23], a[96:99], v[112:115], v[20:23]
    v_mfma_f32_16x16x32_bf16 v[24:27], a[100:103], v[112:115], v[24:27]
    s_add_u32 s21, s21, 4096
    buffer_load_dwordx4 v[112:115], v2, s[8:11], s21 offen offset:0 sc1
    s_waitcnt vmcnt(33)
    v_mfma_f32_16x16x32_bf16 v[20:23], a[104:107], v[116:119], v[20:23]
    v_mfma_f32_16x16x32_bf16 v[24:27], a[108:111], v[116:119], v[24:27]
    buffer_load_dwordx4 v[116:119], v2, s[8:11], s21 offen offset:1024 sc1
    s_waitcnt vmcnt(33)
    v_mfma_f32_16x16x32_bf16 v[20:23], a[112:115], v[120:123], v[20:23]
    v_mfma_f32_16x16x32_bf16 v[24:27], a[116:119], v[120:123], v[24:27]
    buffer_load_dwordx4 v[120:123], v2, s[8:11], s21 offen offset:2048 sc1
    s_waitcnt vmcnt(33)
    v_mfma_f32_16x16x32_bf16 v[20:23], a[120:123], v[124:127], v[20:23]
    v_mfma_f32_16x16x32_bf16 v[24:27], a[124:127], v[124:127], v[24:27]
    buffer_load_dwordx4 v[124:127], v2, s[8:11], s21 offen offset:3072 sc1
    s_waitcnt vmcnt(33)
    v_mfma_f32_16x16x32_bf16 v[20:23], a[128:131], v[128:131], v[20:23]
    v_mfma_f32_16x16x32_bf16 v[24:27], a[132:135], v[128:131], v[24:27]
    s_add_u32 s21, s21, 4096
    buffer_load_dwordx4 v[128:131], v2, s[8:11], s21 offen offset:0 sc1
    s_waitcnt vmcnt(33)
    v_mfma_f32_16x16x32_bf16 v[20:23], a[136:139], v[132:135], v[20:23]
    v_mfma_f32_16x16x32_bf16 v[24:27], a[140:143], v[132:135], v[24:27]
    buffer_load_dwordx4 v[132:135], v2, s[8:11], s21 offen offset:1024 sc1
    s_waitcnt vmcnt(33)
    v_mfma_f32_16x16x32_bf16 v[20:23], a[144:147], v[136:139], v[20:23]
    v_mfma_f32_16x16x32_bf16 v[24:27], a[148:151], v[136:139], v[24:27]
    buffer_load_dwordx4 v[136:139], v2, s[8:11], s21 offen offset:2048 sc1
    s_waitcnt vmcnt(33)
    v_mfma_f32_16x16x32_bf16 v[20:23], a[152:155], v[140:143], v[20:23]
    v_mfma_f32_16x16x32_bf16 v[24:27], a[156:159], v[140:143], v[24:27]
    buffer_load_dwordx4 v[140:143], v2, s[8:11], s21 offen offset:3072 sc1
    s_waitcnt vmcnt(33)
    v_mfma_f32_16x16x32_bf16 v[20:23], a[160:163], v[144:147], v[20:23]
    v_mfma_f32_16x16x32_bf16 v[24:27], a[164:167], v[144:147], v[24:27]
    s_add_u32 s21, s21, 4096
    buffer_load_dwordx4 v[144:147], v2, s[8:11], s21 offen offset:0 sc1
    s_waitcnt vmcnt(33)
    v_mfma_f32_16x16x32_bf16 v[20:23], a[168:171], v[148:151], v[20:23]
    v_mfma_f32_16x16x32_bf16 v[24:27], a[172:175], v[148:151], v[24:27]
    buffer_load_dwordx4 v[148:151], v2, s[8:11], s21 offen offset:1024 sc1
    s_waitcnt vmcnt(33)
    v_mfma_f32_16x16x32_bf16 v[20:23], a[176:179], v[152:155], v[20:23]
    v_mfma_f32_16x16x32_bf16 v[24:27], a[180:183], v[152:155], v[24:27]
    buffer_load_dwordx4 v[152:155], v2, s[8:11], s21 offen offset:2048 sc1
    s_waitcnt vmcnt(33)
    v_mfma_f32_16x16x32_bf16 v[20:23], a[184:187], v[156:159], v[20:23]
    v_mfma_f32_16x16x32_bf16 v[24:27], a[188:191], v[156:159], v[24:27]
    buffer_load_dwordx4 v[156:159], v2, s[8:11], s21 offen offset:3072 sc1
    s_waitcnt vmcnt(33)
    v_mfma_f32_16x16x32_bf16 v[20:23], a[192:195], v[160:163], v[20:23]
    v_mfma_f32_16x16x32_bf16 v[24:27], a[196:199], v[160:163], v[24:27]
    s_add_u32 s21, s21, 4096
    buffer_load_dwordx4 v[160:163], v2, s[8:11], s21 offen offset:0 sc1
    s_waitcnt vmcnt(33)
    v_mfma_f32_16x16x32_bf16 v[20:23], a[200:203], v[164:167], v[20:23]
    v_mfma_f32_16x16x32_bf16 v[24:27], a[204:207], v[164:167], v[24:27]
    buffer_load_dwordx4 v[164:167], v2, s[8:11], s21 offen offset:1024 sc1
    s_waitcnt vmcnt(33)
    v_mfma_f32_16x16x32_bf16 v[20:23], a[208:211], v[168:171], v[20:23]
    v_mfma_f32_16x16x32_bf16 v[24:27], a[212:215], v[168:171], v[24:27]
    buffer_load_dwordx4 v[168:171], v2, s[8:11], s21 offen offset:2048 sc1
    s_waitcnt vmcnt(33)
    v_mfma_f32_16x16x32_bf16 v[20:23], a[216:219], v[172:175], v[20:23]
    v_mfma_f32_16x16x32_bf16 v[24:27], a[220:223], v[172:175], v[24:27]
    buffer_load_dwordx4 v[172:175], v2, s[8:11], s21 offen offset:3072 sc1
    s_waitcnt vmcnt(33)
    v_mfma_f32_16x16x32_bf16 v[20:23], a[224:227], v[176:179], v[20:23]
    v_mfma_f32_16x16x32_bf16 v[24:27], a[228:231], v[176:179], v[24:27]
    s_add_u32 s21, s21, 4096
    buffer_load_dwordx4 v[176:179], v2, s[8:11], s21 offen offset:0 sc1
    s_waitcnt vmcnt(33)
    v_mfma_f32_16x16x32_bf16 v[20:23], a[232:235], v[180:183], v[20:23]
    v_mfma_f32_16x16x32_bf16 v[24:27], a[236:239], v[180:183], v[24:27]
    buffer_load_dwordx4 v[180:183], v2, s[8:11], s21 offen offset:1024 sc1
    s_waitcnt vmcnt(33)
    v_mfma_f32_16x16x32_bf16 v[20:23], a[240:243], v[184:187], v[20:23]
    v_mfma_f32_16x16x32_bf16 v[24:27], a[244:247], v[184:187], v[24:27]
    buffer_load_dwordx4 v[184:187], v2, s[8:11], s21 offen offset:2048 sc1
    s_waitcnt vmcnt(33)
    v_mfma_f32_16x16x32_bf16 v[20:23], a[248:251], v[188:191], v[20:23]
    v_mfma_f32_16x16x32_bf16 v[24:27], a[252:255], v[188:191], v[24:27]
    buffer_load_dwordx4 v[188:191], v2, s[8:11], s21 offen offset:3072 sc1
    s_add_u32 s21, s21, 364544
    s_nop 5
L_s3_red:
    v_xor_b32 v8, 0x2000, v8
    ds_write_b128 v8, v[20:23] offset:0
    ds_write_b128 v8, v[24:27] offset:1024
    s_waitcnt lgkmcnt(0)
    s_barrier
    v_xor_b32 v29, 0x2000, v29
    s_add_u32 s34, s34, 1
    s_and_b32 s30, s34, 3
    s_cmp_lg_u32 s17, s30
    s_cbranch_scc1 L_s3_next
    ds_read_b128 v[20:23], v29 offset:0
    ds_read_b128 v[24:27], v29 offset:1024
    ds_read_b128 v[36:39], v29 offset:2048
    ds_read_b128 v[40:43], v29 offset:3072
    ds_read_b128 v[44:47], v29 offset:4096
    ds_read_b128 v[48:51], v29 offset:5120
    ds_read_b128 v[52:55], v29 offset:6144
    ds_read_b128 v[56:59], v29 offset:7168
    s_cmp_eq_u32 s35, 1
    s_cbranch_scc1 L_s3_w1
    s_waitcnt vmcnt(0)
L_s3_w1:
    s_waitcnt vmcnt(32) lgkmcnt(0)
    v_add_f32 v36, v36, v44
    v_add_f32 v20, v20, v52
    v_add_f32 v37, v37, v45
    v_add_f32 v21, v21, v53
    v_add_f32 v38, v38, v46
    v_add_f32 v22, v22, v54
    v_add_f32 v39, v39, v47
    v_add_f32 v23, v23, v55
    v_add_f32 v40, v40, v48
    v_add_f32 v24, v24, v56
    v_add_f32 v41, v41, v49
    v_add_f32 v25, v25, v57
    v_add_f32 v42, v42, v50
    v_add_f32 v26, v26, v58
    v_add_f32 v43, v43, v51
    v_add_f32 v27, v27, v59
    v_lshlrev_b32 v44, 16, v32
    v_and_b32 v45, 0xffff0000, v32
    v_lshlrev_b32 v46, 16, v33
    v_and_b32 v47, 0xffff0000, v33
    v_lshlrev_b32 v48, 16, v34
    v_and_b32 v49, 0xffff0000, v34
    v_lshlrev_b32 v50, 16, v35
    v_and_b32 v51, 0xffff0000, v35
    v_add_f32 v20, v20, v36
    v_add_f32 v20, v20, v44
    v_add_f32 v21, v21, v37
    v_add_f32 v21, v21, v45
    v_add_f32 v22, v22, v38
    v_add_f32 v22, v22, v46
    v_add_f32 v23, v23, v39
    v_add_f32 v23, v23, v47
    v_add_f32 v24, v24, v40
    v_add_f32 v24, v24, v48
    v_add_f32 v25, v25, v41
    v_add_f32 v25, v25, v49
    v_add_f32 v26, v26, v42
    v_add_f32 v26, v26, v50
    v_add_f32 v27, v27, v43
    v_add_f32 v27, v27, v51
    v_cvt_pk_bf16_f32 v32, v20, v21
    v_cvt_pk_bf16_f32 v33, v22, v23
    v_cvt_pk_bf16_f32 v34, v24, v25
    v_cvt_pk_bf16_f32 v35, v26, v27
    buffer_store_dwordx4 v[32:35], v2, s[8:11], s25 offen sc1
    v_lshlrev_b32 v36, 16, v32
    v_and_b32 v37, 0xffff0000, v32
    v_lshlrev_b32 v38, 16, v33
    v_and_b32 v39, 0xffff0000, v33
    v_lshlrev_b32 v40, 16, v34
    v_and_b32 v41, 0xffff0000, v34
    v_lshlrev_b32 v42, 16, v35
    v_and_b32 v43, 0xffff0000, v35
    v_add_f32 v44, v36, v37
    v_add_f32 v44, v44, v38
    v_add_f32 v44, v44, v39
    v_add_f32 v44, v44, v40
    v_add_f32 v44, v44, v41
    v_add_f32 v44, v44, v42
    v_add_f32 v44, v44, v43
    v_mov_b32 v46, v44
    s_nop 1
    v_permlane16_swap_b32 v44, v46
    v_add_f32 v44, v44, v46
    v_mov_b32 v46, v44
    s_nop 1
    v_permlane32_swap_b32 v44, v46
    v_add_f32 v44, v44, v46
    v_mul_f32 v44, 0x3d000000, v44
    v_sub_f32 v36, v36, v44
    v_sub_f32 v37, v37, v44
    v_sub_f32 v38, v38, v44
    v_sub_f32 v39, v39, v44
    v_sub_f32 v40, v40, v44
    v_sub_f32 v41, v41, v44
    v_sub_f32 v42, v42, v44
    v_sub_f32 v43, v43, v44
    v_mul_f32 v45, v36, v36
    v_fmac_f32 v45, v37, v37
    v_fmac_f32 v45, v38, v38
    v_fmac_f32 v45, v39, v39
    v_fmac_f32 v45, v40, v40
    v_fmac_f32 v45, v41, v41
    v_fmac_f32 v45, v42, v42
    v_fmac_f32 v45, v43, v43
    v_mov_b32 v46, v45
    s_nop 1
    v_permlane16_swap_b32 v45, v46
    v_add_f32 v45, v45, v46
    v_mov_b32 v46, v45
    s_nop 1
    v_permlane32_swap_b32 v45, v46
    v_add_f32 v45, v45, v46
    s_mul_i32 s28, s20, 2304
    s_lshl_b32 s30, s69, 7
    s_add_u32 s28, s28, s30
    s_add_u32 s28, s28, 92274688
    s_lshl_b32 s27, s20, 7
    s_lshl_b32 s30, s69, 2
    s_add_u32 s27, s27, s30
    s_add_u32 s27, s27, 119586816
    s_mov_b64 exec, 0xffff
    buffer_store_dwordx2 v[44:45], v9, s[8:11], s28 offen sc1
    s_mov_b64 exec, -1
    s_waitcnt vmcnt(0)
    s_mov_b64 exec, 1
    buffer_store_dword v5, off, s[8:11], s27 sc1
    s_mov_b64 exec, -1
L_s3_next:
    s_add_u32 s20, s20, 3
    s_cmp_lt_u32 s20, 128
    s_cbranch_scc1 L_s3_top
    s_endpgm
L_role_s4:
    s_load_dwordx4 s[36:39], s[0:1], 64
    v_and_b32 v1, 63, v0
    v_lshlrev_b32 v2, 4, v1
    v_mov_b32 v5, 1
    v_mov_b32 v3, 0
    v_bfe_u32 v13, v1, 0, 1
    v_lshl_add_u32 v3, v13, 4, v3
    v_bfe_u32 v13, v1, 1, 1
    v_lshl_add_u32 v3, v13, 5, v3
    v_bfe_u32 v13, v1, 2, 1
    s_mov_b32 s30, 9216
    v_mad_u32_u24 v3, v13, s30, v3
    v_bfe_u32 v13, v1, 3, 1
    s_mov_b32 s30, 18432
    v_mad_u32_u24 v3, v13, s30, v3
    v_bfe_u32 v13, v1, 4, 1
    s_mov_b32 s30, 73728
    v_mad_u32_u24 v3, v13, s30, v3
    v_bfe_u32 v13, v1, 5, 1
    s_mov_b32 s30, 147456
    v_mad_u32_u24 v3, v13, s30, v3
    s_lshl_b32 s23, s17, 15
    v_add_u32 v4, s23, v2
    s_lshl_b32 s24, s69, 9
    s_lshl_b32 s30, s17, 7
    s_add_u32 s24, s24, s30
    v_min_u32 v6, 17, v1
    v_lshlrev_b32 v6, 2, v6
    v_mov_b32 v7, 0
    v_bfe_u32 v13, v1, 0, 1
    v_lshl_add_u32 v7, v13, 3, v7
    v_bfe_u32 v13, v1, 1, 1
    v_lshl_add_u32 v7, v13, 4, v7
    v_bfe_u32 v13, v1, 2, 1
    v_lshl_add_u32 v7, v13, 5, v7
    v_bfe_u32 v13, v1, 3, 1
    v_lshl_add_u32 v7, v13, 6, v7
    v_bfe_u32 v13, v1, 4, 1
    v_lshl_add_u32 v7, v13, 7, v7
    v_bfe_u32 v13, v1, 5, 1
    v_lshl_add_u32 v7, v13, 8, v7
    v_cmp_gt_u32 vcc, 32, v1
    s_nop 1
    v_cndmask_b32 v8, 0, 1.0, vcc
    v_add_u32 v18, 2048, v7
    v_cndmask_b32 v18, v7, v18, vcc
    s_waitcnt lgkmcnt(0)
    s_mov_b32 s48, s36
    s_and_b32 s49, s37, 0xffff
    s_mov_b32 s50, 5308416
    s_mov_b32 s51, 0x00020000
    s_mov_b32 s52, s38
    s_and_b32 s53, s39, 0xffff
    s_mov_b32 s54, 9216
    s_mov_b32 s55, 0x00020000
    v_lshrrev_b32 v13, 4, v1
    v_lshlrev_b32 v13, 4, v13
    buffer_load_dwordx4 v[96:99], v13, s[52:55], s24 offen offset:0
    buffer_load_dwordx4 v[100:103], v13, s[52:55], s24 offen offset:64
    s_waitcnt vmcnt(0)
    v_lshlrev_b32 v64, 16, v96
    v_and_b32 v65, 0xffff0000, v96
    v_lshlrev_b32 v66, 16, v97
    v_and_b32 v67, 0xffff0000, v97
    v_lshlrev_b32 v68, 16, v98
    v_and_b32 v69, 0xffff0000, v98
    v_lshlrev_b32 v70, 16, v99
    v_and_b32 v71, 0xffff0000, v99
    v_lshlrev_b32 v72, 16, v100
    v_and_b32 v73, 0xffff0000, v100
    v_lshlrev_b32 v74, 16, v101
    v_and_b32 v75, 0xffff0000, v101
    v_lshlrev_b32 v76, 16, v102
    v_and_b32 v77, 0xffff0000, v102
    v_lshlrev_b32 v78, 16, v103
    v_and_b32 v79, 0xffff0000, v103
    s_add_u32 m0, s23, 0
    s_add_u32 s33, s24, 0
    buffer_load_dwordx4 v3, s[48:51], s33 offen lds
    s_add_u32 m0, s23, 1024
    s_add_u32 s33, s24, 36864
    buffer_load_dwordx4 v3, s[48:51], s33 offen lds
    s_add_u32 m0, s23, 2048
    s_add_u32 s33, s24, 64
    buffer_load_dwordx4 v3, s[48:51], s33 offen lds
    s_add_u32 m0, s23, 3072
    s_add_u32 s33, s24, 36928
    buffer_load_dwordx4 v3, s[48:51], s33 offen lds
    s_add_u32 m0, s23, 4096
    s_add_u32 s33, s24, 294912
    buffer_load_dwordx4 v3, s[48:51], s33 offen lds
    s_add_u32 m0, s23, 5120
    s_add_u32 s33, s24, 331776
    buffer_load_dwordx4 v3, s[48:51], s33 offen lds
    s_add_u32 m0, s23, 6144
    s_add_u32 s33, s24, 294976
    buffer_load_dwordx4 v3, s[48:51], s33 offen lds
    s_add_u32 m0, s23, 7168
    s_add_u32 s33, s24, 331840
    buffer_load_dwordx4 v3, s[48:51], s33 offen lds
    s_add_u32 m0, s23, 8192
    s_add_u32 s33, s24, 589824
    buffer_load_dwordx4 v3, s[48:51], s33 offen lds
    s_add_u32 m0, s23, 9216
    s_add_u32 s33, s24, 626688
    buffer_load_dwordx4 v3, s[48:51], s33 offen lds
    s_add_u32 m0, s23, 10240
    s_add_u32 s33, s24, 589888
    buffer_load_dwordx4 v3, s[48:51], s33 offen lds
    s_add_u32 m0, s23, 11264
    s_add_u32 s33, s24, 626752
    buffer_load_dwordx4 v3, s[48:51], s33 offen lds
    s_add_u32 m0, s23, 12288
    s_add_u32 s33, s24, 884736
    buffer_load_dwordx4 v3, s[48:51], s33 offen lds
    s_add_u32 m0, s23, 13312
    s_add_u32 s33, s24, 921600
    buffer_load_dwordx4 v3, s[48:51], s33 offen lds
    s_add_u32 m0, s23, 14336
    s_add_u32 s33, s24, 884800
    buffer_load_dwordx4 v3, s[48:51], s33 offen lds
    s_add_u32 m0, s23, 15360
    s_add_u32 s33, s24, 921664
    buffer_load_dwordx4 v3, s[48:51], s33 offen lds
    s_add_u32 m0, s23, 16384
    s_add_u32 s33, s24, 1179648
    buffer_load_dwordx4 v3, s[48:51], s33 offen lds
    s_add_u32 m0, s23, 17408
    s_add_u32 s33, s24, 1216512
    buffer_load_dwordx4 v3, s[48:51], s33 offen lds
    s_add_u32 m0, s23, 18432
    s_add_u32 s33, s24, 1179712
    buffer_load_dwordx4 v3, s[48:51], s33 offen lds
    s_add_u32 m0, s23, 19456
    s_add_u32 s33, s24, 1216576
    buffer_load_dwordx4 v3, s[48:51], s33 offen lds
    s_add_u32 m0, s23, 20480
    s_add_u32 s33, s24, 1474560
    buffer_load_dwordx4 v3, s[48:51], s33 offen lds
    s_add_u32 m0, s23, 21504
    s_add_u32 s33, s24, 1511424
    buffer_load_dwordx4 v3, s[48:51], s33 offen lds
    s_add_u32 m0, s23, 22528
    s_add_u32 s33, s24, 1474624
    buffer_load_dwordx4 v3, s[48:51], s33 offen lds
    s_add_u32 m0, s23, 23552
    s_add_u32 s33, s24, 1511488
    buffer_load_dwordx4 v3, s[48:51], s33 offen lds
    s_add_u32 m0, s23, 24576
    s_add_u32 s33, s24, 1769472
    buffer_load_dwordx4 v3, s[48:51], s33 offen lds
    s_add_u32 m0, s23, 25600
    s_add_u32 s33, s24, 1806336
    buffer_load_dwordx4 v3, s[48:51], s33 offen lds
    s_add_u32 m0, s23, 26624
    s_add_u32 s33, s24, 1769536
    buffer_load_dwordx4 v3, s[48:51], s33 offen lds
    s_add_u32 m0, s23, 27648
    s_add_u32 s33, s24, 1806400
    buffer_load_dwordx4 v3, s[48:51], s33 offen lds
    s_add_u32 m0, s23, 28672
    s_add_u32 s33, s24, 2064384
    buffer_load_dwordx4 v3, s[48:51], s33 offen lds
    s_add_u32 m0, s23, 29696
    s_add_u32 s33, s24, 2101248
    buffer_load_dwordx4 v3, s[48:51], s33 offen lds
    s_add_u32 m0, s23, 30720
    s_add_u32 s33, s24, 2064448
    buffer_load_dwordx4 v3, s[48:51], s33 offen lds
    s_add_u32 m0, s23, 31744
    s_add_u32 s33, s24, 2101312
    buffer_load_dwordx4 v3, s[48:51], s33 offen lds
    s_waitcnt vmcnt(30)
    ds_read_b64_tr_b16 a[0:1], v4 offset:0
    ds_read_b64_tr_b16 a[2:3], v4 offset:1024
    ds_read_b64_tr_b16 a[4:5], v4 offset:8
    ds_read_b64_tr_b16 a[6:7], v4 offset:1032
    s_waitcnt lgkmcnt(0)
    s_add_u32 m0, s23, 0
    s_add_u32 s33, s24, 2359296
    buffer_load_dwordx4 v3, s[48:51], s33 offen lds
    s_add_u32 m0, s23, 1024
    s_add_u32 s33, s24, 2396160
    buffer_load_dwordx4 v3, s[48:51], s33 offen lds
    s_waitcnt vmcnt(30)
    ds_read_b64_tr_b16 a[8:9], v4 offset:2048
    ds_read_b64_tr_b16 a[10:11], v4 offset:3072
    ds_read_b64_tr_b16 a[12:13], v4 offset:2056
    ds_read_b64_tr_b16 a[14:15], v4 offset:3080
    s_waitcnt lgkmcnt(0)
    s_add_u32 m0, s23, 2048
    s_add_u32 s33, s24, 2359360
    buffer_load_dwordx4 v3, s[48:51], s33 offen lds
    s_add_u32 m0, s23, 3072
    s_add_u32 s33, s24, 2396224
    buffer_load_dwordx4 v3, s[48:51], s33 offen lds
    s_waitcnt vmcnt(30)
    ds_read_b64_tr_b16 a[16:17], v4 offset:4096
    ds_read_b64_tr_b16 a[18:19], v4 offset:5120
    ds_read_b64_tr_b16 a[20:21], v4 offset:4104
    ds_read_b64_tr_b16 a[22:23], v4 offset:5128
    s_waitcnt lgkmcnt(0)
    s_add_u32 m0, s23, 4096
    s_add_u32 s33, s24, 2654208
    buffer_load_dwordx4 v3, s[48:51], s33 offen lds
    s_add_u32 m0, s23, 5120
    s_add_u32 s33, s24, 2691072
    buffer_load_dwordx4 v3, s[48:51], s33 offen lds
    s_waitcnt vmcnt(30)
    ds_read_b64_tr_b16 a[24:25], v4 offset:6144
    ds_read_b64_tr_b16 a[26:27], v4 offset:7168
    ds_read_b64_tr_b16 a[28:29], v4 offset:6152
    ds_read_b64_tr_b16 a[30:31], v4 offset:7176
    s_waitcnt lgkmcnt(0)
    s_add_u32 m0, s23, 6144
    s_add_u32 s33, s24, 2654272
    buffer_load_dwordx4 v3, s[48:51], s33 offen lds
    s_add_u32 m0, s23, 7168
    s_add_u32 s33, s24, 2691136
    buffer_load_dwordx4 v3, s[48:51], s33 offen lds
    s_waitcnt vmcnt(30)
    ds_read_b64_tr_b16 a[32:33], v4 offset:8192
    ds_read_b64_tr_b16 a[34:35], v4 offset:9216
    ds_read_b64_tr_b16 a[36:37], v4 offset:8200
    ds_read_b64_tr_b16 a[38:39], v4 offset:9224
    s_waitcnt lgkmcnt(0)
    s_add_u32 m0, s23, 8192
    s_add_u32 s33, s24, 2949120
    buffer_load_dwordx4 v3, s[48:51], s33 offen lds
    s_add_u32 m0, s23, 9216
    s_add_u32 s33, s24, 2985984
    buffer_load_dwordx4 v3, s[48:51], s33 offen lds
    s_waitcnt vmcnt(30)
    ds_read_b64_tr_b16 a[40:41], v4 offset:10240
    ds_read_b64_tr_b16 a[42:43], v4 offset:11264
    ds_read_b64_tr_b16 a[44:45], v4 offset:10248
    ds_read_b64_tr_b16 a[46:47], v4 offset:11272
    s_waitcnt lgkmcnt(0)
    s_add_u32 m0, s23, 10240
    s_add_u32 s33, s24, 2949184
    buffer_load_dwordx4 v3, s[48:51], s33 offen lds
    s_add_u32 m0, s23, 11264
    s_add_u32 s33, s24, 2986048
    buffer_load_dwordx4 v3, s[48:51], s33 offen lds
    s_waitcnt vmcnt(30)
    ds_read_b64_tr_b16 a[48:49], v4 offset:12288
    ds_read_b64_tr_b16 a[50:51], v4 offset:13312
    ds_read_b64_tr_b16 a[52:53], v4 offset:12296
    ds_read_b64_tr_b16 a[54:55], v4 offset:13320
    s_waitcnt lgkmcnt(0)
    s_add_u32 m0, s23, 12288
    s_add_u32 s33, s24, 3244032
    buffer_load_dwordx4 v3, s[48:51], s33 offen lds
    s_add_u32 m0, s23, 13312
    s_add_u32 s33, s24, 3280896
    buffer_load_dwordx4 v3, s[48:51], s33 offen lds
    s_waitcnt vmcnt(30)
    ds_read_b64_tr_b16 a[56:57], v4 offset:14336
    ds_read_b64_tr_b16 a[58:59], v4 offset:15360
    ds_read_b64_tr_b16 a[60:61], v4 offset:14344
    ds_read_b64_tr_b16 a[62:63], v4 offset:15368
    s_waitcnt lgkmcnt(0)
    s_add_u32 m0, s23, 14336
    s_add_u32 s33, s24, 3244096
    buffer_load_dwordx4 v3, s[48:51], s33 offen lds
    s_add_u32 m0, s23, 15360
    s_add_u32 s33, s24, 3280960
    buffer_load_dwordx4 v3, s[48:51], s33 offen lds
    s_waitcnt vmcnt(30)
    ds_read_b64_tr_b16 a[64:65], v4 offset:16384
    ds_read_b64_tr_b16 a[66:67], v4 offset:17408
    ds_read_b64_tr_b16 a[68:69], v4 offset:16392
    ds_read_b64_tr_b16 a[70:71], v4 offset:17416
    s_waitcnt lgkmcnt(0)
    s_add_u32 m0, s23, 16384
    s_add_u32 s33, s24, 3538944
    buffer_load_dwordx4 v3, s[48:51], s33 offen lds
    s_add_u32 m0, s23, 17408
    s_add_u32 s33, s24, 3575808
    buffer_load_dwordx4 v3, s[48:51], s33 offen lds
    s_waitcnt vmcnt(30)
    ds_read_b64_tr_b16 a[72:73], v4 offset:18432
    ds_read_b64_tr_b16 a[74:75], v4 offset:19456
    ds_read_b64_tr_b16 a[76:77], v4 offset:18440
    ds_read_b64_tr_b16 a[78:79], v4 offset:19464
    s_waitcnt lgkmcnt(0)
    s_add_u32 m0, s23, 18432
    s_add_u32 s33, s24, 3539008
    buffer_load_dwordx4 v3, s[48:51], s33 offen lds
    s_add_u32 m0, s23, 19456
    s_add_u32 s33, s24, 3575872
    buffer_load_dwordx4 v3, s[48:51], s33 offen lds
    s_waitcnt vmcnt(30)
    ds_read_b64_tr_b16 a[80:81], v4 offset:20480
    ds_read_b64_tr_b16 a[82:83], v4 offset:21504
    ds_read_b64_tr_b16 a[84:85], v4 offset:20488
    ds_read_b64_tr_b16 a[86:87], v4 offset:21512
    s_waitcnt lgkmcnt(0)
    s_add_u32 m0, s23, 20480
    s_add_u32 s33, s24, 3833856
    buffer_load_dwordx4 v3, s[48:51], s33 offen lds
    s_add_u32 m0, s23, 21504
    s_add_u32 s33, s24, 3870720
    buffer_load_dwordx4 v3, s[48:51], s33 offen lds
    s_waitcnt vmcnt(30)
    ds_read_b64_tr_b16 a[88:89], v4 offset:22528
    ds_read_b64_tr_b16 a[90:91], v4 offset:23552
    ds_read_b64_tr_b16 a[92:93], v4 offset:22536
    ds_read_b64_tr_b16 a[94:95], v4 offset:23560
    s_waitcnt lgkmcnt(0)
    s_add_u32 m0, s23, 22528
    s_add_u32 s33, s24, 3833920
    buffer_load_dwordx4 v3, s[48:51], s33 offen lds
    s_add_u32 m0, s23, 23552
    s_add_u32 s33, s24, 3870784
    buffer_load_dwordx4 v3, s[48:51], s33 offen lds
    s_waitcnt vmcnt(30)
    ds_read_b64_tr_b16 a[96:97], v4 offset:24576
    ds_read_b64_tr_b16 a[98:99], v4 offset:25600
    ds_read_b64_tr_b16 a[100:101], v4 offset:24584
    ds_read_b64_tr_b16 a[102:103], v4 offset:25608
    s_waitcnt lgkmcnt(0)
    s_add_u32 m0, s23, 24576
    s_add_u32 s33, s24, 4128768
    buffer_load_dwordx4 v3, s[48:51], s33 offen lds
    s_add_u32 m0, s23, 25600
    s_add_u32 s33, s24, 4165632
    buffer_load_dwordx4 v3, s[48:51], s33 offen lds
    s_waitcnt vmcnt(30)
    ds_read_b64_tr_b16 a[104:105], v4 offset:26624
    ds_read_b64_tr_b16 a[106:107], v4 offset:27648
    ds_read_b64_tr_b16 a[108:109], v4 offset:26632
    ds_read_b64_tr_b16 a[110:111], v4 offset:27656
    s_waitcnt lgkmcnt(0)
    s_add_u32 m0, s23, 26624
    s_add_u32 s33, s24, 4128832
    buffer_load_dwordx4 v3, s[48:51], s33 offen lds
    s_add_u32 m0, s23, 27648
    s_add_u32 s33, s24, 4165696
    buffer_load_dwordx4 v3, s[48:51], s33 offen lds
    s_waitcnt vmcnt(30)
    ds_read_b64_tr_b16 a[112:113], v4 offset:28672
    ds_read_b64_tr_b16 a[114:115], v4 offset:29696
    ds_read_b64_tr_b16 a[116:117], v4 offset:28680
    ds_read_b64_tr_b16 a[118:119], v4 offset:29704
    s_waitcnt lgkmcnt(0)
    s_add_u32 m0, s23, 28672
    s_add_u32 s33, s24, 4423680
    buffer_load_dwordx4 v3, s[48:51], s33 offen lds
    s_add_u32 m0, s23, 29696
    s_add_u32 s33, s24, 4460544
    buffer_load_dwordx4 v3, s[48:51], s33 offen lds
    s_waitcnt vmcnt(30)
    ds_read_b64_tr_b16 a[120:121], v4 offset:30720
    ds_read_b64_tr_b16 a[122:123], v4 offset:31744
    ds_read_b64_tr_b16 a[124:125], v4 offset:30728
    ds_read_b64_tr_b16 a[126:127], v4 offset:31752
    s_waitcnt lgkmcnt(0)
    s_add_u32 m0, s23, 30720
    s_add_u32 s33, s24, 4423744
    buffer_load_dwordx4 v3, s[48:51], s33 offen lds
    s_add_u32 m0, s23, 31744
    s_add_u32 s33, s24, 4460608
    buffer_load_dwordx4 v3, s[48:51], s33 offen lds
    s_waitcnt vmcnt(30)
    ds_read_b64_tr_b16 a[128:129], v4 offset:0
    ds_read_b64_tr_b16 a[130:131], v4 offset:1024
    ds_read_b64_tr_b16 a[132:133], v4 offset:8
    ds_read_b64_tr_b16 a[134:135], v4 offset:1032
    s_waitcnt lgkmcnt(0)
    s_add_u32 m0, s23, 0
    s_add_u32 s33, s24, 4718592
    buffer_load_dwordx4 v3, s[48:51], s33 offen lds
    s_add_u32 m0, s23, 1024
    s_add_u32 s33, s24, 4755456
    buffer_load_dwordx4 v3, s[48:51], s33 offen lds
    s_waitcnt vmcnt(30)
    ds_read_b64_tr_b16 a[136:137], v4 offset:2048
    ds_read_b64_tr_b16 a[138:139], v4 offset:3072
    ds_read_b64_tr_b16 a[140:141], v4 offset:2056
    ds_read_b64_tr_b16 a[142:143], v4 offset:3080
    s_waitcnt lgkmcnt(0)
    s_add_u32 m0, s23, 2048
    s_add_u32 s33, s24, 4718656
    buffer_load_dwordx4 v3, s[48:51], s33 offen lds
    s_add_u32 m0, s23, 3072
    s_add_u32 s33, s24, 4755520
    buffer_load_dwordx4 v3, s[48:51], s33 offen lds
    s_waitcnt vmcnt(30)
    ds_read_b64_tr_b16 a[144:145], v4 offset:4096
    ds_read_b64_tr_b16 a[146:147], v4 offset:5120
    ds_read_b64_tr_b16 a[148:149], v4 offset:4104
    ds_read_b64_tr_b16 a[150:151], v4 offset:5128
    s_waitcnt lgkmcnt(0)
    s_add_u32 m0, s23, 4096
    s_add_u32 s33, s24, 5013504
    buffer_load_dwordx4 v3, s[48:51], s33 offen lds
    s_add_u32 m0, s23, 5120
    s_add_u32 s33, s24, 5050368
    buffer_load_dwordx4 v3, s[48:51], s33 offen lds
    s_waitcnt vmcnt(30)
    ds_read_b64_tr_b16 a[152:153], v4 offset:6144
    ds_read_b64_tr_b16 a[154:155], v4 offset:7168
    ds_read_b64_tr_b16 a[156:157], v4 offset:6152
    ds_read_b64_tr_b16 a[158:159], v4 offset:7176
    s_waitcnt lgkmcnt(0)
    s_add_u32 m0, s23, 6144
    s_add_u32 s33, s24, 5013568
    buffer_load_dwordx4 v3, s[48:51], s33 offen lds
    s_add_u32 m0, s23, 7168
    s_add_u32 s33, s24, 5050432
    buffer_load_dwordx4 v3, s[48:51], s33 offen lds
    s_waitcnt vmcnt(30)
    ds_read_b64_tr_b16 a[160:161], v4 offset:8192
    ds_read_b64_tr_b16 a[162:163], v4 offset:9216
    ds_read_b64_tr_b16 a[164:165], v4 offset:8200
    ds_read_b64_tr_b16 a[166:167], v4 offset:9224
    s_waitcnt vmcnt(28)
    ds_read_b64_tr_b16 a[168:169], v4 offset:10240
    ds_read_b64_tr_b16 a[170:171], v4 offset:11264
    ds_read_b64_tr_b16 a[172:173], v4 offset:10248
    ds_read_b64_tr_b16 a[174:175], v4 offset:11272
    s_waitcnt vmcnt(26)
    ds_read_b64_tr_b16 a[176:177], v4 offset:12288
    ds_read_b64_tr_b16 a[178:179], v4 offset:13312
    ds_read_b64_tr_b16 a[180:181], v4 offset:12296
    ds_read_b64_tr_b16 a[182:183], v4 offset:13320
    s_waitcnt vmcnt(24)
    ds_read_b64_tr_b16 a[184:185], v4 offset:14336
    ds_read_b64_tr_b16 a[186:187], v4 offset:15360
    ds_read_b64_tr_b16 a[188:189], v4 offset:14344
    ds_read_b64_tr_b16 a[190:191], v4 offset:15368
    s_waitcnt vmcnt(22)
    ds_read_b64_tr_b16 a[192:193], v4 offset:16384
    ds_read_b64_tr_b16 a[194:195], v4 offset:17408
    ds_read_b64_tr_b16 a[196:197], v4 offset:16392
    ds_read_b64_tr_b16 a[198:199], v4 offset:17416
    s_waitcnt vmcnt(20)
    ds_read_b64_tr_b16 a[200:201], v4 offset:18432
    ds_read_b64_tr_b16 a[202:203], v4 offset:19456
    ds_read_b64_tr_b16 a[204:205], v4 offset:18440
    ds_read_b64_tr_b16 a[206:207], v4 offset:19464
    s_waitcnt vmcnt(18)
    ds_read_b64_tr_b16 a[208:209], v4 offset:20480
    ds_read_b64_tr_b16 a[210:211], v4 offset:21504
    ds_read_b64_tr_b16 a[212:213], v4 offset:20488
    ds_read_b64_tr_b16 a[214:215], v4 offset:21512
    s_waitcnt vmcnt(16)
    ds_read_b64_tr_b16 a[216:217], v4 offset:22528
    ds_read_b64_tr_b16 a[218:219], v4 offset:23552
    ds_read_b64_tr_b16 a[220:221], v4 offset:22536
    ds_read_b64_tr_b16 a[222:223], v4 offset:23560
    s_waitcnt vmcnt(14)
    ds_read_b64_tr_b16 a[224:225], v4 offset:24576
    ds_read_b64_tr_b16 a[226:227], v4 offset:25600
    ds_read_b64_tr_b16 a[228:229], v4 offset:24584
    ds_read_b64_tr_b16 a[230:231], v4 offset:25608
    s_waitcnt vmcnt(12)
    ds_read_b64_tr_b16 a[232:233], v4 offset:26624
    ds_read_b64_tr_b16 a[234:235], v4 offset:27648
    ds_read_b64_tr_b16 a[236:237], v4 offset:26632
    ds_read_b64_tr_b16 a[238:239], v4 offset:27656
    s_waitcnt vmcnt(10)
    ds_read_b64_tr_b16 a[240:241], v4 offset:28672
    ds_read_b64_tr_b16 a[242:243], v4 offset:29696
    ds_read_b64_tr_b16 a[244:245], v4 offset:28680
    ds_read_b64_tr_b16 a[246:247], v4 offset:29704
    s_waitcnt vmcnt(8)
    ds_read_b64_tr_b16 a[248:249], v4 offset:30720
    ds_read_b64_tr_b16 a[250:251], v4 offset:31744
    ds_read_b64_tr_b16 a[252:253], v4 offset:30728
    ds_read_b64_tr_b16 a[254:255], v4 offset:31752
    s_waitcnt vmcnt(6)
    ds_read_b64_tr_b16 v[224:225], v4 offset:0
    ds_read_b64_tr_b16 v[226:227], v4 offset:1024
    ds_read_b64_tr_b16 v[228:229], v4 offset:8
    ds_read_b64_tr_b16 v[230:231], v4 offset:1032
    s_waitcnt vmcnt(4)
    ds_read_b64_tr_b16 v[232:233], v4 offset:2048
    ds_read_b64_tr_b16 v[234:235], v4 offset:3072
    ds_read_b64_tr_b16 v[236:237], v4 offset:2056
    ds_read_b64_tr_b16 v[238:239], v4 offset:3080
    s_waitcnt vmcnt(2)
    ds_read_b64_tr_b16 v[240:241], v4 offset:4096
    ds_read_b64_tr_b16 v[242:243], v4 offset:5120
    ds_read_b64_tr_b16 v[244:245], v4 offset:4104
    ds_read_b64_tr_b16 v[246:247], v4 offset:5128
    s_waitcnt vmcnt(0)
    ds_read_b64_tr_b16 v[248:249], v4 offset:6144
    ds_read_b64_tr_b16 v[250:251], v4 offset:7168
    ds_read_b64_tr_b16 v[252:253], v4 offset:6152
    ds_read_b64_tr_b16 v[254:255], v4 offset:7176
    s_waitcnt lgkmcnt(0)
    v_mov_b32 v20, 0x3f803f80
    v_mov_b32 v21, 0x3f803f80
    v_mov_b32 v22, 0x3f803f80
    v_mov_b32 v23, 0x3f803f80
    s_nop 1
    v_mfma_f32_16x16x32_bf16 v[48:51], a[0:3], v[20:23], 0
    v_mfma_f32_16x16x32_bf16 v[52:55], a[4:7], v[20:23], 0
    v_mfma_f32_16x16x32_bf16 v[56:59], a[8:11], v[20:23], 0
    v_mfma_f32_16x16x32_bf16 v[60:63], a[12:15], v[20:23], 0
    v_mfma_f32_16x16x32_bf16 v[48:51], a[16:19], v[20:23], v[48:51]
    v_mfma_f32_16x16x32_bf16 v[52:55], a[20:23], v[20:23], v[52:55]
    v_mfma_f32_16x16x32_bf16 v[56:59], a[24:27], v[20:23], v[56:59]
    v_mfma_f32_16x16x32_bf16 v[60:63], a[28:31], v[20:23], v[60:63]
    v_mfma_f32_16x16x32_bf16 v[48:51], a[32:35], v[20:23], v[48:51]
    v_mfma_f32_16x16x32_bf16 v[52:55], a[36:39], v[20:23], v[52:55]
    v_mfma_f32_16x16x32_bf16 v[56:59], a[40:43], v[20:23], v[56:59]
    v_mfma_f32_16x16x32_bf16 v[60:63], a[44:47], v[20:23], v[60:63]
    v_mfma_f32_16x16x32_bf16 v[48:51], a[48:51], v[20:23], v[48:51]
    v_mfma_f32_16x16x32_bf16 v[52:55], a[52:55], v[20:23], v[52:55]
    v_mfma_f32_16x16x32_bf16 v[56:59], a[56:59], v[20:23], v[56:59]
    v_mfma_f32_16x16x32_bf16 v[60:63], a[60:63], v[20:23], v[60:63]
    v_mfma_f32_16x16x32_bf16 v[48:51], a[64:67], v[20:23], v[48:51]
    v_mfma_f32_16x16x32_bf16 v[52:55], a[68:71], v[20:23], v[52:55]
    v_mfma_f32_16x16x32_bf16 v[56:59], a[72:75], v[20:23], v[56:59]
    v_mfma_f32_16x16x32_bf16 v[60:63], a[76:79], v[20:23], v[60:63]
    v_mfma_f32_16x16x32_bf16 v[48:51], a[80:83], v[20:23], v[48:51]
    v_mfma_f32_16x16x32_bf16 v[52:55], a[84:87], v[20:23], v[52:55]
    v_mfma_f32_16x16x32_bf16 v[56:59], a[88:91], v[20:23], v[56:59]
    v_mfma_f32_16x16x32_bf16 v[60:63], a[92:95], v[20:23], v[60:63]
    v_mfma_f32_16x16x32_bf16 v[48:51], a[96:99], v[20:23], v[48:51]
    v_mfma_f32_16x16x32_bf16 v[52:55], a[100:103], v[20:23], v[52:55]
    v_mfma_f32_16x16x32_bf16 v[56:59], a[104:107], v[20:23], v[56:59]
    v_mfma_f32_16x16x32_bf16 v[60:63], a[108:111], v[20:23], v[60:63]
    v_mfma_f32_16x16x32_bf16 v[48:51], a[112:115], v[20:23], v[48:51]
    v_mfma_f32_16x16x32_bf16 v[52:55], a[116:119], v[20:23], v[52:55]
    v_mfma_f32_16x16x32_bf16 v[56:59], a[120:123], v[20:23], v[56:59]
    v_mfma_f32_16x16x32_bf16 v[60:63], a[124:127], v[20:23], v[60:63]
    v_mfma_f32_16x16x32_bf16 v[48:51], a[128:131], v[20:23], v[48:51]
    v_mfma_f32_16x16x32_bf16 v[52:55], a[132:135], v[20:23], v[52:55]
    v_mfma_f32_16x16x32_bf16 v[56:59], a[136:139], v[20:23], v[56:59]
    v_mfma_f32_16x16x32_bf16 v[60:63], a[140:143], v[20:23], v[60:63]
    v_mfma_f32_16x16x32_bf16 v[48:51], a[144:147], v[20:23], v[48:51]
    v_mfma_f32_16x16x32_bf16 v[52:55], a[148:151], v[20:23], v[52:55]
    v_mfma_f32_16x16x32_bf16 v[56:59], a[152:155], v[20:23], v[56:59]
    v_mfma_f32_16x16x32_bf16 v[60:63], a[156:159], v[20:23], v[60:63]
    v_mfma_f32_16x16x32_bf16 v[48:51], a[160:163], v[20:23], v[48:51]
    v_mfma_f32_16x16x32_bf16 v[52:55], a[164:167], v[20:23], v[52:55]
    v_mfma_f32_16x16x32_bf16 v[56:59], a[168:171], v[20:23], v[56:59]
    v_mfma_f32_16x16x32_bf16 v[60:63], a[172:175], v[20:23], v[60:63]
    v_mfma_f32_16x16x32_bf16 v[48:51], a[176:179], v[20:23], v[48:51]
    v_mfma_f32_16x16x32_bf16 v[52:55], a[180:183], v[20:23], v[52:55]
    v_mfma_f32_16x16x32_bf16 v[56:59], a[184:187], v[20:23], v[56:59]
    v_mfma_f32_16x16x32_bf16 v[60:63], a[188:191], v[20:23], v[60:63]
    v_mfma_f32_16x16x32_bf16 v[48:51], a[192:195], v[20:23], v[48:51]
    v_mfma_f32_16x16x32_bf16 v[52:55], a[196:199], v[20:23], v[52:55]
    v_mfma_f32_16x16x32_bf16 v[56:59], a[200:203], v[20:23], v[56:59]
    v_mfma_f32_16x16x32_bf16 v[60:63], a[204:207], v[20:23], v[60:63]
    v_mfma_f32_16x16x32_bf16 v[48:51], a[208:211], v[20:23], v[48:51]
    v_mfma_f32_16x16x32_bf16 v[52:55], a[212:215], v[20:23], v[52:55]
    v_mfma_f32_16x16x32_bf16 v[56:59], a[216:219], v[20:23], v[56:59]
    v_mfma_f32_16x16x32_bf16 v[60:63], a[220:223], v[20:23], v[60:63]
    v_mfma_f32_16x16x32_bf16 v[48:51], a[224:227], v[20:23], v[48:51]
    v_mfma_f32_16x16x32_bf16 v[52:55], a[228:231], v[20:23], v[52:55]
    v_mfma_f32_16x16x32_bf16 v[56:59], a[232:235], v[20:23], v[56:59]
    v_mfma_f32_16x16x32_bf16 v[60:63], a[236:239], v[20:23], v[60:63]
    v_mfma_f32_16x16x32_bf16 v[48:51], a[240:243], v[20:23], v[48:51]
    v_mfma_f32_16x16x32_bf16 v[52:55], a[244:247], v[20:23], v[52:55]
    v_mfma_f32_16x16x32_bf16 v[56:59], a[248:251], v[20:23], v[56:59]
    v_mfma_f32_16x16x32_bf16 v[60:63], a[252:255], v[20:23], v[60:63]
    v_mfma_f32_16x16x32_bf16 v[48:51], v[224:227], v[20:23], v[48:51]
    v_mfma_f32_16x16x32_bf16 v[52:55], v[228:231], v[20:23], v[52:55]
    v_mfma_f32_16x16x32_bf16 v[56:59], v[232:235], v[20:23], v[56:59]
    v_mfma_f32_16x16x32_bf16 v[60:63], v[236:239], v[20:23], v[60:63]
    v_mfma_f32_16x16x32_bf16 v[48:51], v[240:243], v[20:23], v[48:51]
    v_mfma_f32_16x16x32_bf16 v[52:55], v[244:247], v[20:23], v[52:55]
    v_mfma_f32_16x16x32_bf16 v[56:59], v[248:251], v[20:23], v[56:59]
    v_mfma_f32_16x16x32_bf16 v[60:63], v[252:255], v[20:23], v[60:63]
    s_mov_b32 s28, 0xc0135761
    s_mov_b32 s34, 0xbdd2d3e8
    v_mov_b32 v9, v2
    v_mov_b32 v19, s28
    s_mul_i32 s35, s17, 5120
    s_min_u32 s35, s35, 13312
    s_mov_b32 s23, s35
    s_mov_b32 s20, s65
    s_barrier
L_s4_slow:
    s_add_u32 s22, s20, 0
    s_min_u32 s22, s22, 127
    s_lshl_b32 s22, s22, 7
    s_add_u32 s22, s22, 119586816
    s_mov_b32 s29, 0
L_s4_p:
    buffer_load_dword v10, v6, s[8:11], s22 offen sc1
    s_add_u32 s29, s29, 1
    s_cmp_ge_u32 s29, 4194304
    s_cbranch_scc1 L_abort
    s_waitcnt vmcnt(0)
    v_cmp_eq_u32 vcc, 0, v10
    s_cbranch_vccz L_s4_ok
    s_sleep 2
    s_branch L_s4_p
L_s4_ok:
    s_add_u32 s31, s20, 0
    s_mul_i32 s21, s31, 18432
    s_add_u32 s21, s21, s35
    s_add_u32 s21, s21, 88080384
    s_mul_i32 s27, s31, 2304
    s_add_u32 s27, s27, 92274688
    s_add_u32 s22, s20, 4
    s_min_u32 s22, s22, 127
    s_lshl_b32 s22, s22, 7
    s_add_u32 s22, s22, 119586816
    s_mov_b32 m0, s23
    s_nop 0
    buffer_load_dwordx4 v2, s[8:11], s21 offen offset:0 sc1 lds
    buffer_load_dwordx4 v2, s[8:11], s21 offen offset:1024 sc1 lds
    buffer_load_dwordx4 v2, s[8:11], s21 offen offset:2048 sc1 lds
    buffer_load_dwordx4 v2, s[8:11], s21 offen offset:3072 sc1 lds
    s_add_u32 m0, s23, 4096
    s_add_u32 s21, s21, 4096
    buffer_load_dwordx4 v2, s[8:11], s21 offen sc1 lds
    buffer_load_dwordx2 v[80:81], v7, s[8:11], s27 offen offset:0 sc1
    buffer_load_dwordx2 v[82:83], v7, s[8:11], s27 offen offset:512 sc1
    buffer_load_dwordx2 v[84:85], v7, s[8:11], s27 offen offset:1024 sc1
    buffer_load_dwordx2 v[86:87], v7, s[8:11], s27 offen offset:1536 sc1
    buffer_load_dwordx2 v[88:89], v18, s[8:11], s27 offen sc1
    buffer_load_dword v10, v6, s[8:11], s22 offen sc1
    s_xor_b32 s23, s23, 0x8000
L_s4_top:
    s_mul_i32 s25, s20, 147456
    s_lshl_b32 s30, s69, 13
    s_add_u32 s25, s25, s30
    s_lshl_b32 s30, s17, 11
    s_add_u32 s25, s25, s30
    s_add_u32 s25, s25, 96468992
    s_lshl_b32 s26, s20, 9
    s_lshl_b32 s30, s69, 4
    s_add_u32 s26, s26, s30
    s_lshl_b32 s30, s17, 2
    s_add_u32 s26, s26, s30
    s_add_u32 s26, s26, 119603200
    s_waitcnt vmcnt(0)
    s_barrier
    ds_read_b128 v[20:23], v9 offset:0
    ds_read_b128 v[24:27], v9 offset:1024
    ds_read_b128 v[28:31], v9 offset:2048
    v_cmp_gt_u32 vcc, 32, v1
    s_nop 1
    v_cndmask_b32 v88, 0, v88, vcc
    v_cndmask_b32 v89, 0, v89, vcc
    v_add_f32 v12, v80, v82
    v_add_f32 v12, v12, v84
    v_add_f32 v12, v12, v86
    v_add_f32 v12, v12, v88
    v_mov_b32 v13, v12
    s_nop 1
    v_permlane16_swap_b32 v12, v13
    v_add_f32 v12, v12, v13
    v_mov_b32 v13, v12
    s_nop 1
    v_permlane32_swap_b32 v12, v13
    v_add_f32 v12, v12, v13
    v_mul_f32 v12, 0x3d638e39, v12
    v_add_f32 v11, v81, v83
    v_add_f32 v11, v11, v85
    v_add_f32 v11, v11, v87
    v_add_f32 v11, v11, v89
    v_sub_f32 v80, v80, v12
    v_sub_f32 v82, v82, v12
    v_sub_f32 v84, v84, v12
    v_sub_f32 v86, v86, v12
    v_sub_f32 v88, v88, v12
    v_mul_f32 v88, v88, v8
    v_mul_f32 v13, v80, v80
    v_fmac_f32 v13, v82, v82
    v_fmac_f32 v13, v84, v84
    v_fmac_f32 v13, v86, v86
    v_fmac_f32 v13, v88, v88
    v_fmac_f32 v11, 0x42000000, v13
    v_mov_b32 v13, v11
    s_nop 1
    v_permlane16_swap_b32 v11, v13
    v_add_f32 v11, v11, v13
    v_mov_b32 v13, v11
    s_nop 1
    v_permlane32_swap_b32 v11, v13
    v_add_f32 v11, v11, v13
    v_mov_b32 v13, 0x3727c5ac
    v_fmac_f32 v13, 0x3ae38e39, v11
    v_rsq_f32 v11, v13
    s_nop 0
    v_mul_f32 v12, v12, v11
    v_cmp_eq_u32 vcc, 0, v10
    s_add_u32 s30, s20, 4
    s_cmp_lt_u32 s30, 128
    s_cselect_b32 s40, 1, 0
    s_cmp_eq_u64 vcc, 0
    s_cselect_b32 s40, s40, 0
    s_cmp_eq_u32 s40, 0
    s_cbranch_scc1 L_s4_nopf
    s_add_u32 s31, s20, 4
    s_mul_i32 s21, s31, 18432
    s_add_u32 s21, s21, s35
    s_add_u32 s21, s21, 88080384
    s_mul_i32 s27, s31, 2304
    s_add_u32 s27, s27, 92274688
    s_add_u32 s22, s20, 8
    s_min_u32 s22, s22, 127
    s_lshl_b32 s22, s22, 7
    s_add_u32 s22, s22, 119586816
    s_mov_b32 m0, s23
    s_nop 0
    buffer_load_dwordx4 v2, s[8:11], s21 offen offset:0 sc1 lds
    buffer_load_dwordx4 v2, s[8:11], s21 offen offset:1024 sc1 lds
    buffer_load_dwordx4 v2, s[8:11], s21 offen offset:2048 sc1 lds
    buffer_load_dwordx4 v2, s[8:11], s21 offen offset:3072 sc1 lds
    s_add_u32 m0, s23, 4096
    s_add_u32 s21, s21, 4096
    buffer_load_dwordx4 v2, s[8:11], s21 offen sc1 lds
    buffer_load_dwordx2 v[80:81], v7, s[8:11], s27 offen offset:0 sc1
    buffer_load_dwordx2 v[82:83], v7, s[8:11], s27 offen offset:512 sc1
    buffer_load_dwordx2 v[84:85], v7, s[8:11], s27 offen offset:1024 sc1
    buffer_load_dwordx2 v[86:87], v7, s[8:11], s27 offen offset:1536 sc1
    buffer_load_dwordx2 v[88:89], v18, s[8:11], s27 offen sc1
    buffer_load_dword v10, v6, s[8:11], s22 offen sc1
    s_xor_b32 s23, s23, 0x8000
L_s4_nopf:
    s_waitcnt lgkmcnt(2)
    v_mfma_f32_16x16x32_bf16 v[32:35], a[0:3], v[20:23], 0
    v_mfma_f32_16x16x32_bf16 v[36:39], a[4:7], v[20:23], 0
    v_mfma_f32_16x16x32_bf16 v[40:43], a[8:11], v[20:23], 0
    v_mfma_f32_16x16x32_bf16 v[44:47], a[12:15], v[20:23], 0
    ds_read_b128 v[20:23], v9 offset:3072
    s_waitcnt lgkmcnt(2)
    v_mfma_f32_16x16x32_bf16 v[32:35], a[16:19], v[24:27], v[32:35]
    v_mfma_f32_16x16x32_bf16 v[36:39], a[20:23], v[24:27], v[36:39]
    v_mfma_f32_16x16x32_bf16 v[40:43], a[24:27], v[24:27], v[40:43]
    v_mfma_f32_16x16x32_bf16 v[44:47], a[28:31], v[24:27], v[44:47]
    ds_read_b128 v[24:27], v9 offset:4096
    s_waitcnt lgkmcnt(2)
    v_mfma_f32_16x16x32_bf16 v[32:35], a[32:35], v[28:31], v[32:35]
    v_mfma_f32_16x16x32_bf16 v[36:39], a[36:39], v[28:31], v[36:39]
    v_mfma_f32_16x16x32_bf16 v[40:43], a[40:43], v[28:31], v[40:43]
    v_mfma_f32_16x16x32_bf16 v[44:47], a[44:47], v[28:31], v[44:47]
    ds_read_b128 v[28:31], v9 offset:5120
    s_waitcnt lgkmcnt(2)
    v_mfma_f32_16x16x32_bf16 v[32:35], a[48:51], v[20:23], v[32:35]
    v_mfma_f32_16x16x32_bf16 v[36:39], a[52:55], v[20:23], v[36:39]
    v_mfma_f32_16x16x32_bf16 v[40:43], a[56:59], v[20:23], v[40:43]
    v_mfma_f32_16x16x32_bf16 v[44:47], a[60:63], v[20:23], v[44:47]
    ds_read_b128 v[20:23], v9 offset:6144
    s_waitcnt lgkmcnt(2)
    v_mfma_f32_16x16x32_bf16 v[32:35], a[64:67], v[24:27], v[32:35]
    v_mfma_f32_16x16x32_bf16 v[36:39], a[68:71], v[24:27], v[36:39]
    v_mfma_f32_16x16x32_bf16 v[40:43], a[72:75], v[24:27], v[40:43]
    v_mfma_f32_16x16x32_bf16 v[44:47], a[76:79], v[24:27], v[44:47]
    ds_read_b128 v[24:27], v9 offset:7168
    s_waitcnt lgkmcnt(2)
    v_mfma_f32_16x16x32_bf16 v[32:35], a[80:83], v[28:31], v[32:35]
    v_mfma_f32_16x16x32_bf16 v[36:39], a[84:87], v[28:31], v[36:39]
    v_mfma_f32_16x16x32_bf16 v[40:43], a[88:91], v[28:31], v[40:43]
    v_mfma_f32_16x16x32_bf16 v[44:47], a[92:95], v[28:31], v[44:47]
    ds_read_b128 v[28:31], v9 offset:8192
    s_waitcnt lgkmcnt(2)
    v_mfma_f32_16x16x32_bf16 v[32:35], a[96:99], v[20:23], v[32:35]
    v_mfma_f32_16x16x32_bf16 v[36:39], a[100:103], v[20:23], v[36:39]
    v_mfma_f32_16x16x32_bf16 v[40:43], a[104:107], v[20:23], v[40:43]
    v_mfma_f32_16x16x32_bf16 v[44:47], a[108:111], v[20:23], v[44:47]
    ds_read_b128 v[20:23], v9 offset:9216
    s_waitcnt lgkmcnt(2)
    v_mfma_f32_16x16x32_bf16 v[32:35], a[112:115], v[24:27], v[32:35]
    v_mfma_f32_16x16x32_bf16 v[36:39], a[116:119], v[24:27], v[36:39]
    v_mfma_f32_16x16x32_bf16 v[40:43], a[120:123], v[24:27], v[40:43]
    v_mfma_f32_16x16x32_bf16 v[44:47], a[124:127], v[24:27], v[44:47]
    ds_read_b128 v[24:27], v9 offset:10240
    s_waitcnt lgkmcnt(2)
    v_mfma_f32_16x16x32_bf16 v[32:35], a[128:131], v[28:31], v[32:35]
    v_mfma_f32_16x16x32_bf16 v[36:39], a[132:135], v[28:31], v[36:39]
    v_mfma_f32_16x16x32_bf16 v[40:43], a[136:139], v[28:31], v[40:43]
    v_mfma_f32_16x16x32_bf16 v[44:47], a[140:143], v[28:31], v[44:47]
    ds_read_b128 v[28:31], v9 offset:11264
    s_waitcnt lgkmcnt(2)
    v_mfma_f32_16x16x32_bf16 v[32:35], a[144:147], v[20:23], v[32:35]
    v_mfma_f32_16x16x32_bf16 v[36:39], a[148:151], v[20:23], v[36:39]
    v_mfma_f32_16x16x32_bf16 v[40:43], a[152:155], v[20:23], v[40:43]
    v_mfma_f32_16x16x32_bf16 v[44:47], a[156:159], v[20:23], v[44:47]
    ds_read_b128 v[20:23], v9 offset:12288
    s_waitcnt lgkmcnt(2)
    v_mfma_f32_16x16x32_bf16 v[32:35], a[160:163], v[24:27], v[32:35]
    v_mfma_f32_16x16x32_bf16 v[36:39], a[164:167], v[24:27], v[36:39]
    v_mfma_f32_16x16x32_bf16 v[40:43], a[168:171], v[24:27], v[40:43]
    v_mfma_f32_16x16x32_bf16 v[44:47], a[172:175], v[24:27], v[44:47]
    ds_read_b128 v[24:27], v9 offset:13312
    s_waitcnt lgkmcnt(2)
    v_mfma_f32_16x16x32_bf16 v[32:35], a[176:179], v[28:31], v[32:35]
    v_mfma_f32_16x16x32_bf16 v[36:39], a[180:183], v[28:31], v[36:39]
    v_mfma_f32_16x16x32_bf16 v[40:43], a[184:187], v[28:31], v[40:43]
    v_mfma_f32_16x16x32_bf16 v[44:47], a[188:191], v[28:31], v[44:47]
    ds_read_b128 v[28:31], v9 offset:14336
    s_waitcnt lgkmcnt(2)
    v_mfma_f32_16x16x32_bf16 v[32:35], a[192:195], v[20:23], v[32:35]
    v_mfma_f32_16x16x32_bf16 v[36:39], a[196:199], v[20:23], v[36:39]
    v_mfma_f32_16x16x32_bf16 v[40:43], a[200:203], v[20:23], v[40:43]
    v_mfma_f32_16x16x32_bf16 v[44:47], a[204:207], v[20:23], v[44:47]
    ds_read_b128 v[20:23], v9 offset:15360
    s_waitcnt lgkmcnt(2)
    v_mfma_f32_16x16x32_bf16 v[32:35], a[208:211], v[24:27], v[32:35]
    v_mfma_f32_16x16x32_bf16 v[36:39], a[212:215], v[24:27], v[36:39]
    v_mfma_f32_16x16x32_bf16 v[40:43], a[216:219], v[24:27], v[40:43]
    v_mfma_f32_16x16x32_bf16 v[44:47], a[220:223], v[24:27], v[44:47]
    ds_read_b128 v[24:27], v9 offset:16384
    s_waitcnt lgkmcnt(2)
    v_mfma_f32_16x16x32_bf16 v[32:35], a[224:227], v[28:31], v[32:35]
    v_mfma_f32_16x16x32_bf16 v[36:39], a[228:231], v[28:31], v[36:39]
    v_mfma_f32_16x16x32_bf16 v[40:43], a[232:235], v[28:31], v[40:43]
    v_mfma_f32_16x16x32_bf16 v[44:47], a[236:239], v[28:31], v[44:47]
    ds_read_b128 v[28:31], v9 offset:17408
    s_waitcnt lgkmcnt(2)
    v_mfma_f32_16x16x32_bf16 v[32:35], a[240:243], v[20:23], v[32:35]
    v_mfma_f32_16x16x32_bf16 v[36:39], a[244:247], v[20:23], v[36:39]
    v_mfma_f32_16x16x32_bf16 v[40:43], a[248:251], v[20:23], v[40:43]
    v_mfma_f32_16x16x32_bf16 v[44:47], a[252:255], v[20:23], v[44:47]
    s_waitcnt lgkmcnt(1)
    v_mfma_f32_16x16x32_bf16 v[32:35], v[224:227], v[24:27], v[32:35]
    v_mfma_f32_16x16x32_bf16 v[36:39], v[228:231], v[24:27], v[36:39]
    v_mfma_f32_16x16x32_bf16 v[40:43], v[232:235], v[24:27], v[40:43]
    v_mfma_f32_16x16x32_bf16 v[44:47], v[236:239], v[24:27], v[44:47]
    s_waitcnt lgkmcnt(0)
    v_mfma_f32_16x16x32_bf16 v[32:35], v[240:243], v[28:31], v[32:35]
    v_mfma_f32_16x16x32_bf16 v[36:39], v[244:247], v[28:31], v[36:39]
    v_mfma_f32_16x16x32_bf16 v[40:43], v[248:251], v[28:31], v[40:43]
    v_mfma_f32_16x16x32_bf16 v[44:47], v[252:255], v[28:31], v[44:47]
    v_xor_b32 v9, 0x8000, v9
    v_fma_f32 v104, -v12, v48, v64
    s_nop 2
    v_fma_f32 v32, v32, v11, v104
    v_fma_f32 v105, -v12, v49, v65
    v_fma_f32 v33, v33, v11, v105
    v_fma_f32 v106, -v12, v50, v66
    v_fma_f32 v34, v34, v11, v106
    v_fma_f32 v107, -v12, v51, v67
    v_fma_f32 v35, v35, v11, v107
    v_fma_f32 v108, -v12, v52, v68
    v_fma_f32 v36, v36, v11, v108
    v_fma_f32 v109, -v12, v53, v69
    v_fma_f32 v37, v37, v11, v109
    v_fma_f32 v110, -v12, v54, v70
    v_fma_f32 v38, v38, v11, v110
    v_fma_f32 v111, -v12, v55, v71
    v_fma_f32 v39, v39, v11, v111
    v_mul_f32 v104, v32, v32
    v_fma_f32 v112, v104, s34, v19
    v_mul_f32 v104, v32, v112
    v_exp_f32 v104, v104
    v_mul_f32 v105, v33, v33
    v_fma_f32 v113, v105, s34, v19
    v_mul_f32 v105, v33, v113
    v_exp_f32 v105, v105
    v_mul_f32 v106, v34, v34
    v_fma_f32 v114, v106, s34, v19
    v_mul_f32 v106, v34, v114
    v_exp_f32 v106, v106
    v_mul_f32 v107, v35, v35
    v_fma_f32 v115, v107, s34, v19
    v_mul_f32 v107, v35, v115
    v_exp_f32 v107, v107
    v_mul_f32 v108, v36, v36
    v_fma_f32 v116, v108, s34, v19
    v_mul_f32 v108, v36, v116
    v_exp_f32 v108, v108
    v_mul_f32 v109, v37, v37
    v_fma_f32 v117, v109, s34, v19
    v_mul_f32 v109, v37, v117
    v_exp_f32 v109, v109
    v_mul_f32 v110, v38, v38
    v_fma_f32 v118, v110, s34, v19
    v_mul_f32 v110, v38, v118
    v_exp_f32 v110, v110
    v_mul_f32 v111, v39, v39
    v_fma_f32 v119, v111, s34, v19
    v_mul_f32 v111, v39, v119
    v_exp_f32 v111, v111
    v_add_f32 v104, 1.0, v104
    v_rcp_f32 v104, v104
    v_add_f32 v105, 1.0, v105
    v_rcp_f32 v105, v105
    v_add_f32 v106, 1.0, v106
    v_rcp_f32 v106, v106
    v_add_f32 v107, 1.0, v107
    v_rcp_f32 v107, v107
    v_add_f32 v108, 1.0, v108
    v_rcp_f32 v108, v108
    v_add_f32 v109, 1.0, v109
    v_rcp_f32 v109, v109
    v_add_f32 v110, 1.0, v110
    v_rcp_f32 v110, v110
    v_add_f32 v111, 1.0, v111
    v_rcp_f32 v111, v111
    v_mul_f32 v32, v32, v104
    v_mul_f32 v33, v33, v105
    v_mul_f32 v34, v34, v106
    v_mul_f32 v35, v35, v107
    v_mul_f32 v36, v36, v108
    v_mul_f32 v37, v37, v109
    v_mul_f32 v38, v38, v110
    v_mul_f32 v39, v39, v111
    v_cvt_pk_bf16_f32 v96, v32, v33
    v_cvt_pk_bf16_f32 v97, v34, v35
    v_cvt_pk_bf16_f32 v98, v36, v37
    v_cvt_pk_bf16_f32 v99, v38, v39
    buffer_store_dwordx4 v[96:99], v2, s[8:11], s25 offen offset:0 sc1
    v_fma_f32 v104, -v12, v56, v72
    v_fma_f32 v40, v40, v11, v104
    v_fma_f32 v105, -v12, v57, v73
    v_fma_f32 v41, v41, v11, v105
    v_fma_f32 v106, -v12, v58, v74
    v_fma_f32 v42, v42, v11, v106
    v_fma_f32 v107, -v12, v59, v75
    v_fma_f32 v43, v43, v11, v107
    v_fma_f32 v108, -v12, v60, v76
    v_fma_f32 v44, v44, v11, v108
    v_fma_f32 v109, -v12, v61, v77
    v_fma_f32 v45, v45, v11, v109
    v_fma_f32 v110, -v12, v62, v78
    v_fma_f32 v46, v46, v11, v110
    v_fma_f32 v111, -v12, v63, v79
    v_fma_f32 v47, v47, v11, v111
    v_mul_f32 v104, v40, v40
    v_fma_f32 v112, v104, s34, v19
    v_mul_f32 v104, v40, v112
    v_exp_f32 v104, v104
    v_mul_f32 v105, v41, v41
    v_fma_f32 v113, v105, s34, v19
    v_mul_f32 v105, v41, v113
    v_exp_f32 v105, v105
    v_mul_f32 v106, v42, v42
    v_fma_f32 v114, v106, s34, v19
    v_mul_f32 v106, v42, v114
    v_exp_f32 v106, v106
    v_mul_f32 v107, v43, v43
    v_fma_f32 v115, v107, s34, v19
    v_mul_f32 v107, v43, v115
    v_exp_f32 v107, v107
    v_mul_f32 v108, v44, v44
    v_fma_f32 v116, v108, s34, v19
    v_mul_f32 v108, v44, v116
    v_exp_f32 v108, v108
    v_mul_f32 v109, v45, v45
    v_fma_f32 v117, v109, s34, v19
    v_mul_f32 v109, v45, v117
    v_exp_f32 v109, v109
    v_mul_f32 v110, v46, v46
    v_fma_f32 v118, v110, s34, v19
    v_mul_f32 v110, v46, v118
    v_exp_f32 v110, v110
    v_mul_f32 v111, v47, v47
    v_fma_f32 v119, v111, s34, v19
    v_mul_f32 v111, v47, v119
    v_exp_f32 v111, v111
    v_add_f32 v104, 1.0, v104
    v_rcp_f32 v104, v104
    v_add_f32 v105, 1.0, v105
    v_rcp_f32 v105, v105
    v_add_f32 v106, 1.0, v106
    v_rcp_f32 v106, v106
    v_add_f32 v107, 1.0, v107
    v_rcp_f32 v107, v107
    v_add_f32 v108, 1.0, v108
    v_rcp_f32 v108, v108
    v_add_f32 v109, 1.0, v109
    v_rcp_f32 v109, v109
    v_add_f32 v110, 1.0, v110
    v_rcp_f32 v110, v110
    v_add_f32 v111, 1.0, v111
    v_rcp_f32 v111, v111
    v_mul_f32 v40, v40, v104
    v_mul_f32 v41, v41, v105
    v_mul_f32 v42, v42, v106
    v_mul_f32 v43, v43, v107
    v_mul_f32 v44, v44, v108
    v_mul_f32 v45, v45, v109
    v_mul_f32 v46, v46, v110
    v_mul_f32 v47, v47, v111
    v_cvt_pk_bf16_f32 v100, v40, v41
    v_cvt_pk_bf16_f32 v101, v42, v43
    v_cvt_pk_bf16_f32 v102, v44, v45
    v_cvt_pk_bf16_f32 v103, v46, v47
    buffer_store_dwordx4 v[100:103], v2, s[8:11], s25 offen offset:1024 sc1
    s_add_u32 s20, s20, 4
    s_waitcnt vmcnt(0)
    s_mov_b64 exec, 1
    buffer_store_dword v5, off, s[8:11], s26 sc1
    s_mov_b64 exec, -1
    s_cmp_ge_u32 s20, 128
    s_cbranch_scc1 L_s4_end
    s_cmp_eq_u32 s40, 1
    s_cbranch_scc1 L_s4_top
    s_branch L_s4_slow
L_s4_end:
    s_endpgm
L_role_s5:
    s_load_dwordx2 s[36:37], s[0:1], 80
    s_load_dwordx2 s[38:39], s[0:1], 96
    s_load_dwordx2 s[40:41], s[0:1], 88
    v_and_b32 v1, 63, v0
    v_lshlrev_b32 v2, 4, v1
    v_mov_b32 v5, 1
    v_mov_b32 v3, 0
    v_bfe_u32 v36, v1, 0, 1
    v_lshl_add_u32 v3, v36, 4, v3
    v_bfe_u32 v36, v1, 1, 1
    v_lshl_add_u32 v3, v36, 5, v3
    v_bfe_u32 v36, v1, 2, 1
    s_mov_b32 s30, 1152
    v_mad_u32_u24 v3, v36, s30, v3
    v_bfe_u32 v36, v1, 3, 1
    s_mov_b32 s30, 2304
    v_mad_u32_u24 v3, v36, s30, v3
    v_bfe_u32 v36, v1, 4, 1
    s_mov_b32 s30, 9216
    v_mad_u32_u24 v3, v36, s30, v3
    v_bfe_u32 v36, v1, 5, 1
    s_mov_b32 s30, 18432
    v_mad_u32_u24 v3, v36, s30, v3
    s_lshl_b32 s23, s17, 15
    v_add_u32 v4, s23, v2
    s_mul_i32 s24, s17, 1327104
    s_lshl_b32 s30, s69, 6
    s_add_u32 s24, s24, s30
    v_mov_b32 v7, 0
    v_bfe_u32 v36, v1, 0, 1
    s_mov_b32 s30, 1152
    v_mad_u32_u24 v7, v36, s30, v7
    v_bfe_u32 v36, v1, 1, 1
    s_mov_b32 s30, 2304
    v_mad_u32_u24 v7, v36, s30, v7
    v_bfe_u32 v36, v1, 2, 1
    s_mov_b32 s30, 4608
    v_mad_u32_u24 v7, v36, s30, v7
    v_bfe_u32 v36, v1, 3, 1
    s_mov_b32 s30, 9216
    v_mad_u32_u24 v7, v36, s30, v7
    v_bfe_u32 v36, v1, 4, 1
    v_lshl_add_u32 v7, v36, 4, v7
    v_bfe_u32 v36, v1, 5, 1
    v_lshl_add_u32 v7, v36, 5, v7
    s_lshl_b32 s30, s69, 6
    v_add_u32 v7, s30, v7
    s_lshl_b32 s30, s17, 11
    v_add_u32 v8, s30, v2
    v_add_u32 v8, 131072, v8
    v_add_u32 v29, 131072, v2
    v_min_u32 v6, 17, v1
    s_mul_i32 s30, s17, 72
    v_lshlrev_b32 v6, 2, v6
    v_add_u32 v6, s30, v6
    v_and_b32 v9, 15, v1
    v_lshlrev_b32 v9, 3, v9
    s_waitcnt lgkmcnt(0)
    s_mov_b32 s48, s36
    s_and_b32 s49, s37, 0xffff
    s_mov_b32 s50, 5308416
    s_mov_b32 s51, 0x00020000
    s_mov_b32 s52, s38
    s_and_b32 s53, s39, 0xffff
    s_mov_b32 s54, 2359296
    s_mov_b32 s55, 0x00020000
    s_mov_b32 s56, s40
    s_and_b32 s57, s41, 0xffff
    s_mov_b32 s58, 1152
    s_mov_b32 s59, 0x00020000
    v_lshrrev_b32 v36, 4, v1
    v_lshlrev_b32 v36, 4, v36
    s_lshl_b32 s30, s69, 6
    buffer_load_dwordx4 v[40:43], v36, s[56:59], s30 offen
    s_waitcnt vmcnt(0)
    v_lshlrev_b32 v10, 16, v40
    v_and_b32 v11, 0xffff0000, v40
    v_lshlrev_b32 v12, 16, v41
    v_and_b32 v13, 0xffff0000, v41
    v_lshlrev_b32 v14, 16, v42
    v_and_b32 v15, 0xffff0000, v42
    v_lshlrev_b32 v16, 16, v43
    v_and_b32 v17, 0xffff0000, v43
    s_add_u32 m0, s23, 0
    s_add_u32 s33, s24, 0
    buffer_load_dwordx4 v3, s[48:51], s33 offen lds
    s_add_u32 m0, s23, 1024
    s_add_u32 s33, s24, 4608
    buffer_load_dwordx4 v3, s[48:51], s33 offen lds
    s_add_u32 m0, s23, 2048
    s_add_u32 s33, s24, 36864
    buffer_load_dwordx4 v3, s[48:51], s33 offen lds
    s_add_u32 m0, s23, 3072
    s_add_u32 s33, s24, 41472
    buffer_load_dwordx4 v3, s[48:51], s33 offen lds
    s_add_u32 m0, s23, 4096
    s_add_u32 s33, s24, 73728
    buffer_load_dwordx4 v3, s[48:51], s33 offen lds
    s_add_u32 m0, s23, 5120
    s_add_u32 s33, s24, 78336
    buffer_load_dwordx4 v3, s[48:51], s33 offen lds
    s_add_u32 m0, s23, 6144
    s_add_u32 s33, s24, 110592
    buffer_load_dwordx4 v3, s[48:51], s33 offen lds
    s_add_u32 m0, s23, 7168
    s_add_u32 s33, s24, 115200
    buffer_load_dwordx4 v3, s[48:51], s33 offen lds
    s_add_u32 m0, s23, 8192
    s_add_u32 s33, s24, 147456
    buffer_load_dwordx4 v3, s[48:51], s33 offen lds
    s_add_u32 m0, s23, 9216
    s_add_u32 s33, s24, 152064
    buffer_load_dwordx4 v3, s[48:51], s33 offen lds
    s_add_u32 m0, s23, 10240
    s_add_u32 s33, s24, 184320
    buffer_load_dwordx4 v3, s[48:51], s33 offen lds
    s_add_u32 m0, s23, 11264
    s_add_u32 s33, s24, 188928
    buffer_load_dwordx4 v3, s[48:51], s33 offen lds
    s_add_u32 m0, s23, 12288
    s_add_u32 s33, s24, 221184
    buffer_load_dwordx4 v3, s[48:51], s33 offen lds
    s_add_u32 m0, s23, 13312
    s_add_u32 s33, s24, 225792
    buffer_load_dwordx4 v3, s[48:51], s33 offen lds
    s_add_u32 m0, s23, 14336
    s_add_u32 s33, s24, 258048
    buffer_load_dwordx4 v3, s[48:51], s33 offen lds
    s_add_u32 m0, s23, 15360
    s_add_u32 s33, s24, 262656
    buffer_load_dwordx4 v3, s[48:51], s33 offen lds
    s_add_u32 m0, s23, 16384
    s_add_u32 s33, s24, 294912
    buffer_load_dwordx4 v3, s[48:51], s33 offen lds
    s_add_u32 m0, s23, 17408
    s_add_u32 s33, s24, 299520
    buffer_load_dwordx4 v3, s[48:51], s33 offen lds
    s_add_u32 m0, s23, 18432
    s_add_u32 s33, s24, 331776
    buffer_load_dwordx4 v3, s[48:51], s33 offen lds
    s_add_u32 m0, s23, 19456
    s_add_u32 s33, s24, 336384
    buffer_load_dwordx4 v3, s[48:51], s33 offen lds
    s_add_u32 m0, s23, 20480
    s_add_u32 s33, s24, 368640
    buffer_load_dwordx4 v3, s[48:51], s33 offen lds
    s_add_u32 m0, s23, 21504
    s_add_u32 s33, s24, 373248
    buffer_load_dwordx4 v3, s[48:51], s33 offen lds
    s_add_u32 m0, s23, 22528
    s_add_u32 s33, s24, 405504
    buffer_load_dwordx4 v3, s[48:51], s33 offen lds
    s_add_u32 m0, s23, 23552
    s_add_u32 s33, s24, 410112
    buffer_load_dwordx4 v3, s[48:51], s33 offen lds
    s_add_u32 m0, s23, 24576
    s_add_u32 s33, s24, 442368
    buffer_load_dwordx4 v3, s[48:51], s33 offen lds
    s_add_u32 m0, s23, 25600
    s_add_u32 s33, s24, 446976
    buffer_load_dwordx4 v3, s[48:51], s33 offen lds
    s_add_u32 m0, s23, 26624
    s_add_u32 s33, s24, 479232
    buffer_load_dwordx4 v3, s[48:51], s33 offen lds
    s_add_u32 m0, s23, 27648
    s_add_u32 s33, s24, 483840
    buffer_load_dwordx4 v3, s[48:51], s33 offen lds
    s_add_u32 m0, s23, 28672
    s_add_u32 s33, s24, 516096
    buffer_load_dwordx4 v3, s[48:51], s33 offen lds
    s_add_u32 m0, s23, 29696
    s_add_u32 s33, s24, 520704
    buffer_load_dwordx4 v3, s[48:51], s33 offen lds
    s_add_u32 m0, s23, 30720
    s_add_u32 s33, s24, 552960
    buffer_load_dwordx4 v3, s[48:51], s33 offen lds
    s_add_u32 m0, s23, 31744
    s_add_u32 s33, s24, 557568
    buffer_load_dwordx4 v3, s[48:51], s33 offen lds
    s_waitcnt vmcnt(30)
    ds_read_b64_tr_b16 a[0:1], v4 offset:0
    ds_read_b64_tr_b16 a[2:3], v4 offset:1024
    ds_read_b64_tr_b16 a[4:5], v4 offset:8
    ds_read_b64_tr_b16 a[6:7], v4 offset:1032
    s_waitcnt lgkmcnt(0)
    s_add_u32 m0, s23, 0
    s_add_u32 s33, s24, 589824
    buffer_load_dwordx4 v3, s[48:51], s33 offen lds
    s_add_u32 m0, s23, 1024
    s_add_u32 s33, s24, 594432
    buffer_load_dwordx4 v3, s[48:51], s33 offen lds
    s_waitcnt vmcnt(30)
    ds_read_b64_tr_b16 a[8:9], v4 offset:2048
    ds_read_b64_tr_b16 a[10:11], v4 offset:3072
    ds_read_b64_tr_b16 a[12:13], v4 offset:2056
    ds_read_b64_tr_b16 a[14:15], v4 offset:3080
    s_waitcnt lgkmcnt(0)
    s_add_u32 m0, s23, 2048
    s_add_u32 s33, s24, 626688
    buffer_load_dwordx4 v3, s[48:51], s33 offen lds
    s_add_u32 m0, s23, 3072
    s_add_u32 s33, s24, 631296
    buffer_load_dwordx4 v3, s[48:51], s33 offen lds
    s_waitcnt vmcnt(30)
    ds_read_b64_tr_b16 a[16:17], v4 offset:4096
    ds_read_b64_tr_b16 a[18:19], v4 offset:5120
    ds_read_b64_tr_b16 a[20:21], v4 offset:4104
    ds_read_b64_tr_b16 a[22:23], v4 offset:5128
    s_waitcnt lgkmcnt(0)
    s_add_u32 m0, s23, 4096
    s_add_u32 s33, s24, 663552
    buffer_load_dwordx4 v3, s[48:51], s33 offen lds
    s_add_u32 m0, s23, 5120
    s_add_u32 s33, s24, 668160
    buffer_load_dwordx4 v3, s[48:51], s33 offen lds
    s_waitcnt vmcnt(30)
    ds_read_b64_tr_b16 a[24:25], v4 offset:6144
    ds_read_b64_tr_b16 a[26:27], v4 offset:7168
    ds_read_b64_tr_b16 a[28:29], v4 offset:6152
    ds_read_b64_tr_b16 a[30:31], v4 offset:7176
    s_waitcnt lgkmcnt(0)
    s_add_u32 m0, s23, 6144
    s_add_u32 s33, s24, 700416
    buffer_load_dwordx4 v3, s[48:51], s33 offen lds
    s_add_u32 m0, s23, 7168
    s_add_u32 s33, s24, 705024
    buffer_load_dwordx4 v3, s[48:51], s33 offen lds
    s_waitcnt vmcnt(30)
    ds_read_b64_tr_b16 a[32:33], v4 offset:8192
    ds_read_b64_tr_b16 a[34:35], v4 offset:9216
    ds_read_b64_tr_b16 a[36:37], v4 offset:8200
    ds_read_b64_tr_b16 a[38:39], v4 offset:9224
    s_waitcnt lgkmcnt(0)
    s_add_u32 m0, s23, 8192
    s_add_u32 s33, s24, 737280
    buffer_load_dwordx4 v3, s[48:51], s33 offen lds
    s_add_u32 m0, s23, 9216
    s_add_u32 s33, s24, 741888
    buffer_load_dwordx4 v3, s[48:51], s33 offen lds
    s_waitcnt vmcnt(30)
    ds_read_b64_tr_b16 a[40:41], v4 offset:10240
    ds_read_b64_tr_b16 a[42:43], v4 offset:11264
    ds_read_b64_tr_b16 a[44:45], v4 offset:10248
    ds_read_b64_tr_b16 a[46:47], v4 offset:11272
    s_waitcnt lgkmcnt(0)
    s_add_u32 m0, s23, 10240
    s_add_u32 s33, s24, 774144
    buffer_load_dwordx4 v3, s[48:51], s33 offen lds
    s_add_u32 m0, s23, 11264
    s_add_u32 s33, s24, 778752
    buffer_load_dwordx4 v3, s[48:51], s33 offen lds
    s_waitcnt vmcnt(30)
    ds_read_b64_tr_b16 a[48:49], v4 offset:12288
    ds_read_b64_tr_b16 a[50:51], v4 offset:13312
    ds_read_b64_tr_b16 a[52:53], v4 offset:12296
    ds_read_b64_tr_b16 a[54:55], v4 offset:13320
    s_waitcnt lgkmcnt(0)
    s_add_u32 m0, s23, 12288
    s_add_u32 s33, s24, 811008
    buffer_load_dwordx4 v3, s[48:51], s33 offen lds
    s_add_u32 m0, s23, 13312
    s_add_u32 s33, s24, 815616
    buffer_load_dwordx4 v3, s[48:51], s33 offen lds
    s_waitcnt vmcnt(30)
    ds_read_b64_tr_b16 a[56:57], v4 offset:14336
    ds_read_b64_tr_b16 a[58:59], v4 offset:15360
    ds_read_b64_tr_b16 a[60:61], v4 offset:14344
    ds_read_b64_tr_b16 a[62:63], v4 offset:15368
    s_waitcnt lgkmcnt(0)
    s_add_u32 m0, s23, 14336
    s_add_u32 s33, s24, 847872
    buffer_load_dwordx4 v3, s[48:51], s33 offen lds
    s_add_u32 m0, s23, 15360
    s_add_u32 s33, s24, 852480
    buffer_load_dwordx4 v3, s[48:51], s33 offen lds
    s_waitcnt vmcnt(30)
    ds_read_b64_tr_b16 a[64:65], v4 offset:16384
    ds_read_b64_tr_b16 a[66:67], v4 offset:17408
    ds_read_b64_tr_b16 a[68:69], v4 offset:16392
    ds_read_b64_tr_b16 a[70:71], v4 offset:17416
    s_waitcnt lgkmcnt(0)
    s_add_u32 m0, s23, 16384
    s_add_u32 s33, s24, 884736
    buffer_load_dwordx4 v3, s[48:51], s33 offen lds
    s_add_u32 m0, s23, 17408
    s_add_u32 s33, s24, 889344
    buffer_load_dwordx4 v3, s[48:51], s33 offen lds
    s_waitcnt vmcnt(30)
    ds_read_b64_tr_b16 a[72:73], v4 offset:18432
    ds_read_b64_tr_b16 a[74:75], v4 offset:19456
    ds_read_b64_tr_b16 a[76:77], v4 offset:18440
    ds_read_b64_tr_b16 a[78:79], v4 offset:19464
    s_waitcnt lgkmcnt(0)
    s_add_u32 m0, s23, 18432
    s_add_u32 s33, s24, 921600
    buffer_load_dwordx4 v3, s[48:51], s33 offen lds
    s_add_u32 m0, s23, 19456
    s_add_u32 s33, s24, 926208
    buffer_load_dwordx4 v3, s[48:51], s33 offen lds
    s_waitcnt vmcnt(30)
    ds_read_b64_tr_b16 a[80:81], v4 offset:20480
    ds_read_b64_tr_b16 a[82:83], v4 offset:21504
    ds_read_b64_tr_b16 a[84:85], v4 offset:20488
    ds_read_b64_tr_b16 a[86:87], v4 offset:21512
    s_waitcnt lgkmcnt(0)
    s_add_u32 m0, s23, 20480
    s_add_u32 s33, s24, 958464
    buffer_load_dwordx4 v3, s[48:51], s33 offen lds
    s_add_u32 m0, s23, 21504
    s_add_u32 s33, s24, 963072
    buffer_load_dwordx4 v3, s[48:51], s33 offen lds
    s_waitcnt vmcnt(30)
    ds_read_b64_tr_b16 a[88:89], v4 offset:22528
    ds_read_b64_tr_b16 a[90:91], v4 offset:23552
    ds_read_b64_tr_b16 a[92:93], v4 offset:22536
    ds_read_b64_tr_b16 a[94:95], v4 offset:23560
    s_waitcnt lgkmcnt(0)
    s_add_u32 m0, s23, 22528
    s_add_u32 s33, s24, 995328
    buffer_load_dwordx4 v3, s[48:51], s33 offen lds
    s_add_u32 m0, s23, 23552
    s_add_u32 s33, s24, 999936
    buffer_load_dwordx4 v3, s[48:51], s33 offen lds
    s_waitcnt vmcnt(30)
    ds_read_b64_tr_b16 a[96:97], v4 offset:24576
    ds_read_b64_tr_b16 a[98:99], v4 offset:25600
    ds_read_b64_tr_b16 a[100:101], v4 offset:24584
    ds_read_b64_tr_b16 a[102:103], v4 offset:25608
    s_waitcnt lgkmcnt(0)
    s_add_u32 m0, s23, 24576
    s_add_u32 s33, s24, 1032192
    buffer_load_dwordx4 v3, s[48:51], s33 offen lds
    s_add_u32 m0, s23, 25600
    s_add_u32 s33, s24, 1036800
    buffer_load_dwordx4 v3, s[48:51], s33 offen lds
    s_waitcnt vmcnt(30)
    ds_read_b64_tr_b16 a[104:105], v4 offset:26624
    ds_read_b64_tr_b16 a[106:107], v4 offset:27648
    ds_read_b64_tr_b16 a[108:109], v4 offset:26632
    ds_read_b64_tr_b16 a[110:111], v4 offset:27656
    s_waitcnt lgkmcnt(0)
    s_add_u32 m0, s23, 26624
    s_add_u32 s33, s24, 1069056
    buffer_load_dwordx4 v3, s[48:51], s33 offen lds
    s_add_u32 m0, s23, 27648
    s_add_u32 s33, s24, 1073664
    buffer_load_dwordx4 v3, s[48:51], s33 offen lds
    s_waitcnt vmcnt(30)
    ds_read_b64_tr_b16 a[112:113], v4 offset:28672
    ds_read_b64_tr_b16 a[114:115], v4 offset:29696
    ds_read_b64_tr_b16 a[116:117], v4 offset:28680
    ds_read_b64_tr_b16 a[118:119], v4 offset:29704
    s_waitcnt lgkmcnt(0)
    s_add_u32 m0, s23, 28672
    s_add_u32 s33, s24, 1105920
    buffer_load_dwordx4 v3, s[48:51], s33 offen lds
    s_add_u32 m0, s23, 29696
    s_add_u32 s33, s24, 1110528
    buffer_load_dwordx4 v3, s[48:51], s33 offen lds
    s_waitcnt vmcnt(30)
    ds_read_b64_tr_b16 a[120:121], v4 offset:30720
    ds_read_b64_tr_b16 a[122:123], v4 offset:31744
    ds_read_b64_tr_b16 a[124:125], v4 offset:30728
    ds_read_b64_tr_b16 a[126:127], v4 offset:31752
    s_waitcnt lgkmcnt(0)
    s_add_u32 m0, s23, 30720
    s_add_u32 s33, s24, 1142784
    buffer_load_dwordx4 v3, s[48:51], s33 offen lds
    s_add_u32 m0, s23, 31744
    s_add_u32 s33, s24, 1147392
    buffer_load_dwordx4 v3, s[48:51], s33 offen lds
    s_waitcnt vmcnt(30)
    ds_read_b64_tr_b16 a[128:129], v4 offset:0
    ds_read_b64_tr_b16 a[130:131], v4 offset:1024
    ds_read_b64_tr_b16 a[132:133], v4 offset:8
    ds_read_b64_tr_b16 a[134:135], v4 offset:1032
    s_waitcnt lgkmcnt(0)
    s_add_u32 m0, s23, 0
    s_add_u32 s33, s24, 1179648
    buffer_load_dwordx4 v3, s[48:51], s33 offen lds
    s_add_u32 m0, s23, 1024
    s_add_u32 s33, s24, 1184256
    buffer_load_dwordx4 v3, s[48:51], s33 offen lds
    s_waitcnt vmcnt(30)
    ds_read_b64_tr_b16 a[136:137], v4 offset:2048
    ds_read_b64_tr_b16 a[138:139], v4 offset:3072
    ds_read_b64_tr_b16 a[140:141], v4 offset:2056
    ds_read_b64_tr_b16 a[142:143], v4 offset:3080
    s_waitcnt lgkmcnt(0)
    s_add_u32 m0, s23, 2048
    s_add_u32 s33, s24, 1216512
    buffer_load_dwordx4 v3, s[48:51], s33 offen lds
    s_add_u32 m0, s23, 3072
    s_add_u32 s33, s24, 1221120
    buffer_load_dwordx4 v3, s[48:51], s33 offen lds
    s_waitcnt vmcnt(30)
    ds_read_b64_tr_b16 a[144:145], v4 offset:4096
    ds_read_b64_tr_b16 a[146:147], v4 offset:5120
    ds_read_b64_tr_b16 a[148:149], v4 offset:4104
    ds_read_b64_tr_b16 a[150:151], v4 offset:5128
    s_waitcnt lgkmcnt(0)
    s_add_u32 m0, s23, 4096
    s_add_u32 s33, s24, 1253376
    buffer_load_dwordx4 v3, s[48:51], s33 offen lds
    s_add_u32 m0, s23, 5120
    s_add_u32 s33, s24, 1257984
    buffer_load_dwordx4 v3, s[48:51], s33 offen lds
    s_waitcnt vmcnt(30)
    ds_read_b64_tr_b16 a[152:153], v4 offset:6144
    ds_read_b64_tr_b16 a[154:155], v4 offset:7168
    ds_read_b64_tr_b16 a[156:157], v4 offset:6152
    ds_read_b64_tr_b16 a[158:159], v4 offset:7176
    s_waitcnt lgkmcnt(0)
    s_add_u32 m0, s23, 6144
    s_add_u32 s33, s24, 1290240
    buffer_load_dwordx4 v3, s[48:51], s33 offen lds
    s_add_u32 m0, s23, 7168
    s_add_u32 s33, s24, 1294848
    buffer_load_dwordx4 v3, s[48:51], s33 offen lds
    s_waitcnt vmcnt(30)
    ds_read_b64_tr_b16 a[160:161], v4 offset:8192
    ds_read_b64_tr_b16 a[162:163], v4 offset:9216
    ds_read_b64_tr_b16 a[164:165], v4 offset:8200
    ds_read_b64_tr_b16 a[166:167], v4 offset:9224
    s_waitcnt vmcnt(28)
    ds_read_b64_tr_b16 a[168:169], v4 offset:10240
    ds_read_b64_tr_b16 a[170:171], v4 offset:11264
    ds_read_b64_tr_b16 a[172:173], v4 offset:10248
    ds_read_b64_tr_b16 a[174:175], v4 offset:11272
    s_waitcnt vmcnt(26)
    ds_read_b64_tr_b16 a[176:177], v4 offset:12288
    ds_read_b64_tr_b16 a[178:179], v4 offset:13312
    ds_read_b64_tr_b16 a[180:181], v4 offset:12296
    ds_read_b64_tr_b16 a[182:183], v4 offset:13320
    s_waitcnt vmcnt(24)
    ds_read_b64_tr_b16 a[184:185], v4 offset:14336
    ds_read_b64_tr_b16 a[186:187], v4 offset:15360
    ds_read_b64_tr_b16 a[188:189], v4 offset:14344
    ds_read_b64_tr_b16 a[190:191], v4 offset:15368
    s_waitcnt vmcnt(22)
    ds_read_b64_tr_b16 a[192:193], v4 offset:16384
    ds_read_b64_tr_b16 a[194:195], v4 offset:17408
    ds_read_b64_tr_b16 a[196:197], v4 offset:16392
    ds_read_b64_tr_b16 a[198:199], v4 offset:17416
    s_waitcnt vmcnt(20)
    ds_read_b64_tr_b16 a[200:201], v4 offset:18432
    ds_read_b64_tr_b16 a[202:203], v4 offset:19456
    ds_read_b64_tr_b16 a[204:205], v4 offset:18440
    ds_read_b64_tr_b16 a[206:207], v4 offset:19464
    s_waitcnt vmcnt(18)
    ds_read_b64_tr_b16 a[208:209], v4 offset:20480
    ds_read_b64_tr_b16 a[210:211], v4 offset:21504
    ds_read_b64_tr_b16 a[212:213], v4 offset:20488
    ds_read_b64_tr_b16 a[214:215], v4 offset:21512
    s_waitcnt vmcnt(16)
    ds_read_b64_tr_b16 a[216:217], v4 offset:22528
    ds_read_b64_tr_b16 a[218:219], v4 offset:23552
    ds_read_b64_tr_b16 a[220:221], v4 offset:22536
    ds_read_b64_tr_b16 a[222:223], v4 offset:23560
    s_waitcnt vmcnt(14)
    ds_read_b64_tr_b16 a[224:225], v4 offset:24576
    ds_read_b64_tr_b16 a[226:227], v4 offset:25600
    ds_read_b64_tr_b16 a[228:229], v4 offset:24584
    ds_read_b64_tr_b16 a[230:231], v4 offset:25608
    s_waitcnt vmcnt(12)
    ds_read_b64_tr_b16 a[232:233], v4 offset:26624
    ds_read_b64_tr_b16 a[234:235], v4 offset:27648
    ds_read_b64_tr_b16 a[236:237], v4 offset:26632
    ds_read_b64_tr_b16 a[238:239], v4 offset:27656
    s_waitcnt vmcnt(10)
    ds_read_b64_tr_b16 a[240:241], v4 offset:28672
    ds_read_b64_tr_b16 a[242:243], v4 offset:29696
    ds_read_b64_tr_b16 a[244:245], v4 offset:28680
    ds_read_b64_tr_b16 a[246:247], v4 offset:29704
    s_waitcnt vmcnt(8)
    ds_read_b64_tr_b16 a[248:249], v4 offset:30720
    ds_read_b64_tr_b16 a[250:251], v4 offset:31744
    ds_read_b64_tr_b16 a[252:253], v4 offset:30728
    ds_read_b64_tr_b16 a[254:255], v4 offset:31752
    s_waitcnt vmcnt(6)
    ds_read_b64_tr_b16 v[224:225], v4 offset:0
    ds_read_b64_tr_b16 v[226:227], v4 offset:1024
    ds_read_b64_tr_b16 v[228:229], v4 offset:8
    ds_read_b64_tr_b16 v[230:231], v4 offset:1032
    s_waitcnt vmcnt(4)
    ds_read_b64_tr_b16 v[232:233], v4 offset:2048
    ds_read_b64_tr_b16 v[234:235], v4 offset:3072
    ds_read_b64_tr_b16 v[236:237], v4 offset:2056
    ds_read_b64_tr_b16 v[238:239], v4 offset:3080
    s_waitcnt vmcnt(2)
    ds_read_b64_tr_b16 v[240:241], v4 offset:4096
    ds_read_b64_tr_b16 v[242:243], v4 offset:5120
    ds_read_b64_tr_b16 v[244:245], v4 offset:4104
    ds_read_b64_tr_b16 v[246:247], v4 offset:5128
    s_waitcnt vmcnt(0)
    ds_read_b64_tr_b16 v[248:249], v4 offset:6144
    ds_read_b64_tr_b16 v[250:251], v4 offset:7168
    ds_read_b64_tr_b16 v[252:253], v4 offset:6152
    ds_read_b64_tr_b16 v[254:255], v4 offset:7176
    s_waitcnt lgkmcnt(0)
    s_mov_b32 s20, s65
    s_mov_b32 s34, 0
    s_mov_b32 s35, 0
    s_mul_i32 s21, s20, 147456
    s_mul_i32 s30, s17, 36864
    s_add_u32 s21, s21, s30
    s_add_u32 s21, s21, 96468992
L_s5_top:
    s_mul_i32 s26, s20, 18432
    s_mul_i32 s25, s20, 18432
    s_lshl_b32 s30, s69, 10
    s_add_u32 s25, s25, s30
    s_add_u32 s25, s25, 88080384
    s_cmp_eq_u32 s35, 1
    s_cbranch_scc1 L_s5_have
    s_add_u32 s22, s20, 0
    s_min_u32 s22, s22, 127
    s_lshl_b32 s22, s22, 9
    s_add_u32 s22, s22, 119603200
    s_mov_b32 s29, 0
L_s5_p:
    buffer_load_dword v28, v6, s[8:11], s22 offen sc1
    s_add_u32 s29, s29, 1
    s_cmp_ge_u32 s29, 4194304
    s_cbranch_scc1 L_abort
    s_waitcnt vmcnt(0)
    v_cmp_eq_u32 vcc, 0, v28
    s_cbranch_vccz L_s5_ok
    s_sleep 2
    s_branch L_s5_p
L_s5_ok:
    s_add_u32 s22, s20, 3
    s_min_u32 s22, s22, 127
    s_lshl_b32 s22, s22, 9
    s_add_u32 s22, s22, 119603200
    buffer_load_dword v28, v6, s[8:11], s22 offen sc1
    buffer_load_dwordx4 v[64:67], v2, s[8:11], s21 offen offset:0 sc1
    buffer_load_dwordx4 v[68:71], v2, s[8:11], s21 offen offset:1024 sc1
    buffer_load_dwordx4 v[72:75], v2, s[8:11], s21 offen offset:2048 sc1
    buffer_load_dwordx4 v[76:79], v2, s[8:11], s21 offen offset:3072 sc1
    s_add_u32 s21, s21, 4096
    buffer_load_dwordx4 v[80:83], v2, s[8:11], s21 offen offset:0 sc1
    buffer_load_dwordx4 v[84:87], v2, s[8:11], s21 offen offset:1024 sc1
    buffer_load_dwordx4 v[88:91], v2, s[8:11], s21 offen offset:2048 sc1
    buffer_load_dwordx4 v[92:95], v2, s[8:11], s21 offen offset:3072 sc1
    s_add_u32 s21, s21, 4096
    buffer_load_dwordx4 v[96:99], v2, s[8:11], s21 offen offset:0 sc1
    buffer_load_dwordx4 v[100:103], v2, s[8:11], s21 offen offset:1024 sc1
    buffer_load_dwordx4 v[104:107], v2, s[8:11], s21 offen offset:2048 sc1
    buffer_load_dwordx4 v[108:111], v2, s[8:11], s21 offen offset:3072 sc1
    s_add_u32 s21, s21, 4096
    buffer_load_dwordx4 v[112:115], v2, s[8:11], s21 offen offset:0 sc1
    buffer_load_dwordx4 v[116:119], v2, s[8:11], s21 offen offset:1024 sc1
    buffer_load_dwordx4 v[120:123], v2, s[8:11], s21 offen offset:2048 sc1
    buffer_load_dwordx4 v[124:127], v2, s[8:11], s21 offen offset:3072 sc1
    s_add_u32 s21, s21, 4096
    buffer_load_dwordx4 v[128:131], v2, s[8:11], s21 offen offset:0 sc1
    buffer_load_dwordx4 v[132:135], v2, s[8:11], s21 offen offset:1024 sc1
    buffer_load_dwordx4 v[136:139], v2, s[8:11], s21 offen offset:2048 sc1
    buffer_load_dwordx4 v[140:143], v2, s[8:11], s21 offen offset:3072 sc1
    s_add_u32 s21, s21, 4096
    buffer_load_dwordx4 v[144:147], v2, s[8:11], s21 offen offset:0 sc1
    buffer_load_dwordx4 v[148:151], v2, s[8:11], s21 offen offset:1024 sc1
    buffer_load_dwordx4 v[152:155], v2, s[8:11], s21 offen offset:2048 sc1
    buffer_load_dwordx4 v[156:159], v2, s[8:11], s21 offen offset:3072 sc1
    s_add_u32 s21, s21, 4096
    buffer_load_dwordx4 v[160:163], v2, s[8:11], s21 offen offset:0 sc1
    buffer_load_dwordx4 v[164:167], v2, s[8:11], s21 offen offset:1024 sc1
    buffer_load_dwordx4 v[168:171], v2, s[8:11], s21 offen offset:2048 sc1
    buffer_load_dwordx4 v[172:175], v2, s[8:11], s21 offen offset:3072 sc1
    s_add_u32 s21, s21, 4096
    buffer_load_dwordx4 v[176:179], v2, s[8:11], s21 offen offset:0 sc1
    buffer_load_dwordx4 v[180:183], v2, s[8:11], s21 offen offset:1024 sc1
    buffer_load_dwordx4 v[184:187], v2, s[8:11], s21 offen offset:2048 sc1
    buffer_load_dwordx4 v[188:191], v2, s[8:11], s21 offen offset:3072 sc1
    s_add_u32 s21, s21, 4096
    buffer_load_dwordx4 v[192:195], v2, s[8:11], s21 offen offset:0 sc1
    buffer_load_dwordx4 v[196:199], v2, s[8:11], s21 offen offset:1024 sc1
    buffer_load_dwordx4 v[200:203], v2, s[8:11], s21 offen offset:2048 sc1
    buffer_load_dwordx4 v[204:207], v2, s[8:11], s21 offen offset:3072 sc1
    s_add_u32 s21, s21, 409600
L_s5_have:
    s_add_u32 s22, s20, 6
    s_min_u32 s22, s22, 127
    s_lshl_b32 s22, s22, 9
    s_add_u32 s22, s22, 119603200
    s_waitcnt vmcnt(35)
    v_cmp_eq_u32 vcc, 0, v28
    s_add_u32 s30, s20, 3
    s_cmp_lt_u32 s30, 128
    s_cselect_b32 s35, 1, 0
    s_cmp_eq_u64 vcc, 0
    s_cselect_b32 s35, s35, 0
    buffer_load_dword v28, v6, s[8:11], s22 offen sc1
    buffer_load_dwordx4 v[32:35], v2, s[8:11], s25 offen sc1
    s_cmp_eq_u32 s35, 1
    s_cbranch_scc1 L_s5_pf
    v_mfma_f32_16x16x32_bf16 v[20:23], a[0:3], v[64:67], 0
    v_mfma_f32_16x16x32_bf16 v[24:27], a[4:7], v[64:67], 0
    s_waitcnt vmcnt(36)
    v_mfma_f32_16x16x32_bf16 v[20:23], a[8:11], v[68:71], v[20:23]
    v_mfma_f32_16x16x32_bf16 v[24:27], a[12:15], v[68:71], v[24:27]
    s_waitcnt vmcnt(35)
    v_mfma_f32_16x16x32_bf16 v[20:23], a[16:19], v[72:75], v[20:23]
    v_mfma_f32_16x16x32_bf16 v[24:27], a[20:23], v[72:75], v[24:27]
    s_waitcnt vmcnt(34)
    v_mfma_f32_16x16x32_bf16 v[20:23], a[24:27], v[76:79], v[20:23]
    v_mfma_f32_16x16x32_bf16 v[24:27], a[28:31], v[76:79], v[24:27]
    s_waitcnt vmcnt(33)
    v_mfma_f32_16x16x32_bf16 v[20:23], a[32:35], v[80:83], v[20:23]
    v_mfma_f32_16x16x32_bf16 v[24:27], a[36:39], v[80:83], v[24:27]
    s_waitcnt vmcnt(32)
    v_mfma_f32_16x16x32_bf16 v[20:23], a[40:43], v[84:87], v[20:23]
    v_mfma_f32_16x16x32_bf16 v[24:27], a[44:47], v[84:87], v[24:27]
    s_waitcnt vmcnt(31)
    v_mfma_f32_16x16x32_bf16 v[20:23], a[48:51], v[88:91], v[20:23]
    v_mfma_f32_16x16x32_bf16 v[24:27], a[52:55], v[88:91], v[24:27]
    s_waitcnt vmcnt(30)
    v_mfma_f32_16x16x32_bf16 v[20:23], a[56:59], v[92:95], v[20:23]
    v_mfma_f32_16x16x32_bf16 v[24:27], a[60:63], v[92:95], v[24:27]
    s_waitcnt vmcnt(29)
    v_mfma_f32_16x16x32_bf16 v[20:23], a[64:67], v[96:99], v[20:23]
    v_mfma_f32_16x16x32_bf16 v[24:27], a[68:71], v[96:99], v[24:27]
    s_waitcnt vmcnt(28)
    v_mfma_f32_16x16x32_bf16 v[20:23], a[72:75], v[100:103], v[20:23]
    v_mfma_f32_16x16x32_bf16 v[24:27], a[76:79], v[100:103], v[24:27]
    s_waitcnt vmcnt(27)
    v_mfma_f32_16x16x32_bf16 v[20:23], a[80:83], v[104:107], v[20:23]
    v_mfma_f32_16x16x32_bf16 v[24:27], a[84:87], v[104:107], v[24:27]
    s_waitcnt vmcnt(26)
    v_mfma_f32_16x16x32_bf16 v[20:23], a[88:91], v[108:111], v[20:23]
    v_mfma_f32_16x16x32_bf16 v[24:27], a[92:95], v[108:111], v[24:27]
    s_waitcnt vmcnt(25)
    v_mfma_f32_16x16x32_bf16 v[20:23], a[96:99], v[112:115], v[20:23]
    v_mfma_f32_16x16x32_bf16 v[24:27], a[100:103], v[112:115], v[24:27]
    s_waitcnt vmcnt(24)
    v_mfma_f32_16x16x32_bf16 v[20:23], a[104:107], v[116:119], v[20:23]
    v_mfma_f32_16x16x32_bf16 v[24:27], a[108:111], v[116:119], v[24:27]
    s_waitcnt vmcnt(23)
    v_mfma_f32_16x16x32_bf16 v[20:23], a[112:115], v[120:123], v[20:23]
    v_mfma_f32_16x16x32_bf16 v[24:27], a[116:119], v[120:123], v[24:27]
    s_waitcnt vmcnt(22)
    v_mfma_f32_16x16x32_bf16 v[20:23], a[120:123], v[124:127], v[20:23]
    v_mfma_f32_16x16x32_bf16 v[24:27], a[124:127], v[124:127], v[24:27]
    s_waitcnt vmcnt(21)
    v_mfma_f32_16x16x32_bf16 v[20:23], a[128:131], v[128:131], v[20:23]
    v_mfma_f32_16x16x32_bf16 v[24:27], a[132:135], v[128:131], v[24:27]
    s_waitcnt vmcnt(20)
    v_mfma_f32_16x16x32_bf16 v[20:23], a[136:139], v[132:135], v[20:23]
    v_mfma_f32_16x16x32_bf16 v[24:27], a[140:143], v[132:135], v[24:27]
    s_waitcnt vmcnt(19)
    v_mfma_f32_16x16x32_bf16 v[20:23], a[144:147], v[136:139], v[20:23]
    v_mfma_f32_16x16x32_bf16 v[24:27], a[148:151], v[136:139], v[24:27]
    s_waitcnt vmcnt(18)
    v_mfma_f32_16x16x32_bf16 v[20:23], a[152:155], v[140:143], v[20:23]
    v_mfma_f32_16x16x32_bf16 v[24:27], a[156:159], v[140:143], v[24:27]
    s_waitcnt vmcnt(17)
    v_mfma_f32_16x16x32_bf16 v[20:23], a[160:163], v[144:147], v[20:23]
    v_mfma_f32_16x16x32_bf16 v[24:27], a[164:167], v[144:147], v[24:27]
    s_waitcnt vmcnt(16)
    v_mfma_f32_16x16x32_bf16 v[20:23], a[168:171], v[148:151], v[20:23]
    v_mfma_f32_16x16x32_bf16 v[24:27], a[172:175], v[148:151], v[24:27]
    s_waitcnt vmcnt(15)
    v_mfma_f32_16x16x32_bf16 v[20:23], a[176:179], v[152:155], v[20:23]
    v_mfma_f32_16x16x32_bf16 v[24:27], a[180:183], v[152:155], v[24:27]
    s_waitcnt vmcnt(14)
    v_mfma_f32_16x16x32_bf16 v[20:23], a[184:187], v[156:159], v[20:23]
    v_mfma_f32_16x16x32_bf16 v[24:27], a[188:191], v[156:159], v[24:27]
    s_waitcnt vmcnt(13)
    v_mfma_f32_16x16x32_bf16 v[20:23], a[192:195], v[160:163], v[20:23]
    v_mfma_f32_16x16x32_bf16 v[24:27], a[196:199], v[160:163], v[24:27]
    s_waitcnt vmcnt(12)
    v_mfma_f32_16x16x32_bf16 v[20:23], a[200:203], v[164:167], v[20:23]
    v_mfma_f32_16x16x32_bf16 v[24:27], a[204:207], v[164:167], v[24:27]
    s_waitcnt vmcnt(11)
    v_mfma_f32_16x16x32_bf16 v[20:23], a[208:211], v[168:171], v[20:23]
    v_mfma_f32_16x16x32_bf16 v[24:27], a[212:215], v[168:171], v[24:27]
    s_waitcnt vmcnt(10)
    v_mfma_f32_16x16x32_bf16 v[20:23], a[216:219], v[172:175], v[20:23]
    v_mfma_f32_16x16x32_bf16 v[24:27], a[220:223], v[172:175], v[24:27]
    s_waitcnt vmcnt(9)
    v_mfma_f32_16x16x32_bf16 v[20:23], a[224:227], v[176:179], v[20:23]
    v_mfma_f32_16x16x32_bf16 v[24:27], a[228:231], v[176:179], v[24:27]
    s_waitcnt vmcnt(8)
    v_mfma_f32_16x16x32_bf16 v[20:23], a[232:235], v[180:183], v[20:23]
    v_mfma_f32_16x16x32_bf16 v[24:27], a[236:239], v[180:183], v[24:27]
    s_waitcnt vmcnt(7)
    v_mfma_f32_16x16x32_bf16 v[20:23], a[240:243], v[184:187], v[20:23]
    v_mfma_f32_16x16x32_bf16 v[24:27], a[244:247], v[184:187], v[24:27]
    s_waitcnt vmcnt(6)
    v_mfma_f32_16x16x32_bf16 v[20:23], a[248:251], v[188:191], v[20:23]
    v_mfma_f32_16x16x32_bf16 v[24:27], a[252:255], v[188:191], v[24:27]
    s_waitcnt vmcnt(5)
    v_mfma_f32_16x16x32_bf16 v[20:23], v[224:227], v[192:195], v[20:23]
    v_mfma_f32_16x16x32_bf16 v[24:27], v[228:231], v[192:195], v[24:27]
    s_waitcnt vmcnt(4)
    v_mfma_f32_16x16x32_bf16 v[20:23], v[232:235], v[196:199], v[20:23]
    v_mfma_f32_16x16x32_bf16 v[24:27], v[236:239], v[196:199], v[24:27]
    s_waitcnt vmcnt(3)
    v_mfma_f32_16x16x32_bf16 v[20:23], v[240:243], v[200:203], v[20:23]
    v_mfma_f32_16x16x32_bf16 v[24:27], v[244:247], v[200:203], v[24:27]
    s_waitcnt vmcnt(2)
    v_mfma_f32_16x16x32_bf16 v[20:23], v[248:251], v[204:207], v[20:23]
    v_mfma_f32_16x16x32_bf16 v[24:27], v[252:255], v[204:207], v[24:27]
    s_nop 7
    s_branch L_s5_red
L_s5_pf:
    v_mfma_f32_16x16x32_bf16 v[20:23], a[0:3], v[64:67], 0
    v_mfma_f32_16x16x32_bf16 v[24:27], a[4:7], v[64:67], 0
    buffer_load_dwordx4 v[64:67], v2, s[8:11], s21 offen offset:0 sc1
    s_waitcnt vmcnt(37)
    v_mfma_f32_16x16x32_bf16 v[20:23], a[8:11], v[68:71], v[20:23]
    v_mfma_f32_16x16x32_bf16 v[24:27], a[12:15], v[68:71], v[24:27]
    buffer_load_dwordx4 v[68:71], v2, s[8:11], s21 offen offset:1024 sc1
    s_waitcnt vmcnt(37)
    v_mfma_f32_16x16x32_bf16 v[20:23], a[16:19], v[72:75], v[20:23]
    v_mfma_f32_16x16x32_bf16 v[24:27], a[20:23], v[72:75], v[24:27]
    buffer_load_dwordx4 v[72:75], v2, s[8:11], s21 offen offset:2048 sc1
    s_waitcnt vmcnt(37)
    v_mfma_f32_16x16x32_bf16 v[20:23], a[24:27], v[76:79], v[20:23]
    v_mfma_f32_16x16x32_bf16 v[24:27], a[28:31], v[76:79], v[24:27]
    buffer_load_dwordx4 v[76:79], v2, s[8:11], s21 offen offset:3072 sc1
    s_waitcnt vmcnt(37)
    v_mfma_f32_16x16x32_bf16 v[20:23], a[32:35], v[80:83], v[20:23]
    v_mfma_f32_16x16x32_bf16 v[24:27], a[36:39], v[80:83], v[24:27]
    s_add_u32 s21, s21, 4096
    buffer_load_dwordx4 v[80:83], v2, s[8:11], s21 offen offset:0 sc1
    s_waitcnt vmcnt(37)
    v_mfma_f32_16x16x32_bf16 v[20:23], a[40:43], v[84:87], v[20:23]
    v_mfma_f32_16x16x32_bf16 v[24:27], a[44:47], v[84:87], v[24:27]
    buffer_load_dwordx4 v[84:87], v2, s[8:11], s21 offen offset:1024 sc1
    s_waitcnt vmcnt(37)
    v_mfma_f32_16x16x32_bf16 v[20:23], a[48:51], v[88:91], v[20:23]
    v_mfma_f32_16x16x32_bf16 v[24:27], a[52:55], v[88:91], v[24:27]
    buffer_load_dwordx4 v[88:91], v2, s[8:11], s21 offen offset:2048 sc1
    s_waitcnt vmcnt(37)
    v_mfma_f32_16x16x32_bf16 v[20:23], a[56:59], v[92:95], v[20:23]
    v_mfma_f32_16x16x32_bf16 v[24:27], a[60:63], v[92:95], v[24:27]
    buffer_load_dwordx4 v[92:95], v2, s[8:11], s21 offen offset:3072 sc1
    s_waitcnt vmcnt(37)
    v_mfma_f32_16x16x32_bf16 v[20:23], a[64:67], v[96:99], v[20:23]
    v_mfma_f32_16x16x32_bf16 v[24:27], a[68:71], v[96:99], v[24:27]
    s_add_u32 s21, s21, 4096
    buffer_load_dwordx4 v[96:99], v2, s[8:11], s21 offen offset:0 sc1
    s_waitcnt vmcnt(37)
    v_mfma_f32_16x16x32_bf16 v[20:23], a[72:75], v[100:103], v[20:23]
    v_mfma_f32_16x16x32_bf16 v[24:27], a[76:79], v[100:103], v[24:27]
    buffer_load_dwordx4 v[100:103], v2, s[8:11], s21 offen offset:1024 sc1
    s_waitcnt vmcnt(37)
    v_mfma_f32_16x16x32_bf16 v[20:23], a[80:83], v[104:107], v[20:23]
    v_mfma_f32_16x16x32_bf16 v[24:27], a[84:87], v[104:107], v[24:27]
    buffer_load_dwordx4 v[104:107], v2, s[8:11], s21 offen offset:2048 sc1
    s_waitcnt vmcnt(37)
    v_mfma_f32_16x16x32_bf16 v[20:23], a[88:91], v[108:111], v[20:23]
    v_mfma_f32_16x16x32_bf16 v[24:27], a[92:95], v[108:111], v[24:27]
    buffer_load_dwordx4 v[108:111], v2, s[8:11], s21 offen offset:3072 sc1
    s_waitcnt vmcnt(37)
    v_mfma_f32_16x16x32_bf16 v[20:23], a[96:99], v[112:115], v[20:23]
    v_mfma_f32_16x16x32_bf16 v[24:27], a[100:103], v[112:115], v[24:27]
    s_add_u32 s21, s21, 4096
    buffer_load_dwordx4 v[112:115], v2, s[8:11], s21 offen offset:0 sc1
    s_waitcnt vmcnt(37)
    v_mfma_f32_16x16x32_bf16 v[20:23], a[104:107], v[116:119], v[20:23]
    v_mfma_f32_16x16x32_bf16 v[24:27], a[108:111], v[116:119], v[24:27]
    buffer_load_dwordx4 v[116:119], v2, s[8:11], s21 offen offset:1024 sc1
    s_waitcnt vmcnt(37)
    v_mfma_f32_16x16x32_bf16 v[20:23], a[112:115], v[120:123], v[20:23]
    v_mfma_f32_16x16x32_bf16 v[24:27], a[116:119], v[120:123], v[24:27]
    buffer_load_dwordx4 v[120:123], v2, s[8:11], s21 offen offset:2048 sc1
    s_waitcnt vmcnt(37)
    v_mfma_f32_16x16x32_bf16 v[20:23], a[120:123], v[124:127], v[20:23]
    v_mfma_f32_16x16x32_bf16 v[24:27], a[124:127], v[124:127], v[24:27]
    buffer_load_dwordx4 v[124:127], v2, s[8:11], s21 offen offset:3072 sc1
    s_waitcnt vmcnt(37)
    v_mfma_f32_16x16x32_bf16 v[20:23], a[128:131], v[128:131], v[20:23]
    v_mfma_f32_16x16x32_bf16 v[24:27], a[132:135], v[128:131], v[24:27]
    s_add_u32 s21, s21, 4096
    buffer_load_dwordx4 v[128:131], v2, s[8:11], s21 offen offset:0 sc1
    s_waitcnt vmcnt(37)
    v_mfma_f32_16x16x32_bf16 v[20:23], a[136:139], v[132:135], v[20:23]
    v_mfma_f32_16x16x32_bf16 v[24:27], a[140:143], v[132:135], v[24:27]
    buffer_load_dwordx4 v[132:135], v2, s[8:11], s21 offen offset:1024 sc1
    s_waitcnt vmcnt(37)
    v_mfma_f32_16x16x32_bf16 v[20:23], a[144:147], v[136:139], v[20:23]
    v_mfma_f32_16x16x32_bf16 v[24:27], a[148:151], v[136:139], v[24:27]
    buffer_load_dwordx4 v[136:139], v2, s[8:11], s21 offen offset:2048 sc1
    s_waitcnt vmcnt(37)
    v_mfma_f32_16x16x32_bf16 v[20:23], a[152:155], v[140:143], v[20:23]
    v_mfma_f32_16x16x32_bf16 v[24:27], a[156:159], v[140:143], v[24:27]
    buffer_load_dwordx4 v[140:143], v2, s[8:11], s21 offen offset:3072 sc1
    s_waitcnt vmcnt(37)
    v_mfma_f32_16x16x32_bf16 v[20:23], a[160:163], v[144:147], v[20:23]
    v_mfma_f32_16x16x32_bf16 v[24:27], a[164:167], v[144:147], v[24:27]
    s_add_u32 s21, s21, 4096
    buffer_load_dwordx4 v[144:147], v2, s[8:11], s21 offen offset:0 sc1
    s_waitcnt vmcnt(37)
    v_mfma_f32_16x16x32_bf16 v[20:23], a[168:171], v[148:151], v[20:23]
    v_mfma_f32_16x16x32_bf16 v[24:27], a[172:175], v[148:151], v[24:27]
    buffer_load_dwordx4 v[148:151], v2, s[8:11], s21 offen offset:1024 sc1
    s_waitcnt vmcnt(37)
    v_mfma_f32_16x16x32_bf16 v[20:23], a[176:179], v[152:155], v[20:23]
    v_mfma_f32_16x16x32_bf16 v[24:27], a[180:183], v[152:155], v[24:27]
    buffer_load_dwordx4 v[152:155], v2, s[8:11], s21 offen offset:2048 sc1
    s_waitcnt vmcnt(37)
    v_mfma_f32_16x16x32_bf16 v[20:23], a[184:187], v[156:159], v[20:23]
    v_mfma_f32_16x16x32_bf16 v[24:27], a[188:191], v[156:159], v[24:27]
    buffer_load_dwordx4 v[156:159], v2, s[8:11], s21 offen offset:3072 sc1
    s_waitcnt vmcnt(37)
    v_mfma_f32_16x16x32_bf16 v[20:23], a[192:195], v[160:163], v[20:23]
    v_mfma_f32_16x16x32_bf16 v[24:27], a[196:199], v[160:163], v[24:27]
    s_add_u32 s21, s21, 4096
    buffer_load_dwordx4 v[160:163], v2, s[8:11], s21 offen offset:0 sc1
    s_waitcnt vmcnt(37)
    v_mfma_f32_16x16x32_bf16 v[20:23], a[200:203], v[164:167], v[20:23]
    v_mfma_f32_16x16x32_bf16 v[24:27], a[204:207], v[164:167], v[24:27]
    buffer_load_dwordx4 v[164:167], v2, s[8:11], s21 offen offset:1024 sc1
    s_waitcnt vmcnt(37)
    v_mfma_f32_16x16x32_bf16 v[20:23], a[208:211], v[168:171], v[20:23]
    v_mfma_f32_16x16x32_bf16 v[24:27], a[212:215], v[168:171], v[24:27]
    buffer_load_dwordx4 v[168:171], v2, s[8:11], s21 offen offset:2048 sc1
    s_waitcnt vmcnt(37)
    v_mfma_f32_16x16x32_bf16 v[20:23], a[216:219], v[172:175], v[20:23]
    v_mfma_f32_16x16x32_bf16 v[24:27], a[220:223], v[172:175], v[24:27]
    buffer_load_dwordx4 v[172:175], v2, s[8:11], s21 offen offset:3072 sc1
    s_waitcnt vmcnt(37)
    v_mfma_f32_16x16x32_bf16 v[20:23], a[224:227], v[176:179], v[20:23]
    v_mfma_f32_16x16x32_bf16 v[24:27], a[228:231], v[176:179], v[24:27]
    s_add_u32 s21, s21, 4096
    buffer_load_dwordx4 v[176:179], v2, s[8:11], s21 offen offset:0 sc1
    s_waitcnt vmcnt(37)
    v_mfma_f32_16x16x32_bf16 v[20:23], a[232:235], v[180:183], v[20:23]
    v_mfma_f32_16x16x32_bf16 v[24:27], a[236:239], v[180:183], v[24:27]
    buffer_load_dwordx4 v[180:183], v2, s[8:11], s21 offen offset:1024 sc1
    s_waitcnt vmcnt(37)
    v_mfma_f32_16x16x32_bf16 v[20:23], a[240:243], v[184:187], v[20:23]
    v_mfma_f32_16x16x32_bf16 v[24:27], a[244:247], v[184:187], v[24:27]
    buffer_load_dwordx4 v[184:187], v2, s[8:11], s21 offen offset:2048 sc1
    s_waitcnt vmcnt(37)
    v_mfma_f32_16x16x32_bf16 v[20:23], a[248:251], v[188:191], v[20:23]
    v_mfma_f32_16x16x32_bf16 v[24:27], a[252:255], v[188:191], v[24:27]
    buffer_load_dwordx4 v[188:191], v2, s[8:11], s21 offen offset:3072 sc1
    s_waitcnt vmcnt(37)
    v_mfma_f32_16x16x32_bf16 v[20:23], v[224:227], v[192:195], v[20:23]
    v_mfma_f32_16x16x32_bf16 v[24:27], v[228:231], v[192:195], v[24:27]
    s_add_u32 s21, s21, 4096
    buffer_load_dwordx4 v[192:195], v2, s[8:11], s21 offen offset:0 sc1
    s_waitcnt vmcnt(37)
    v_mfma_f32_16x16x32_bf16 v[20:23], v[232:235], v[196:199], v[20:23]
    v_mfma_f32_16x16x32_bf16 v[24:27], v[236:239], v[196:199], v[24:27]
    buffer_load_dwordx4 v[196:199], v2, s[8:11], s21 offen offset:1024 sc1
    s_waitcnt vmcnt(37)
    v_mfma_f32_16x16x32_bf16 v[20:23], v[240:243], v[200:203], v[20:23]
    v_mfma_f32_16x16x32_bf16 v[24:27], v[244:247], v[200:203], v[24:27]
    buffer_load_dwordx4 v[200:203], v2, s[8:11], s21 offen offset:2048 sc1
    s_waitcnt vmcnt(37)
    v_mfma_f32_16x16x32_bf16 v[20:23], v[248:251], v[204:207], v[20:23]
    v_mfma_f32_16x16x32_bf16 v[24:27], v[252:255], v[204:207], v[24:27]
    buffer_load_dwordx4 v[204:207], v2, s[8:11], s21 offen offset:3072 sc1
    s_add_u32 s21, s21, 409600
    s_nop 5
L_s5_red:
    v_xor_b32 v8, 0x2000, v8
    ds_write_b128 v8, v[20:23] offset:0
    ds_write_b128 v8, v[24:27] offset:1024
    s_waitcnt lgkmcnt(0)
    s_barrier
    v_xor_b32 v29, 0x2000, v29
    s_add_u32 s34, s34, 1
    s_and_b32 s30, s34, 3
    s_cmp_lg_u32 s17, s30
    s_cbranch_scc1 L_s5_next
    ds_read_b128 v[20:23], v29 offset:0
    ds_read_b128 v[24:27], v29 offset:1024
    ds_read_b128 v[36:39], v29 offset:2048
    ds_read_b128 v[40:43], v29 offset:3072
    ds_read_b128 v[44:47], v29 offset:4096
    ds_read_b128 v[48:51], v29 offset:5120
    ds_read_b128 v[52:55], v29 offset:6144
    ds_read_b128 v[56:59], v29 offset:7168
    s_cmp_eq_u32 s35, 1
    s_cbranch_scc1 L_s5_w1
    s_waitcnt vmcnt(0)
L_s5_w1:
    s_waitcnt vmcnt(36) lgkmcnt(0)
    v_add_f32 v36, v36, v44
    v_add_f32 v20, v20, v52
    v_add_f32 v37, v37, v45
    v_add_f32 v21, v21, v53
    v_add_f32 v38, v38, v46
    v_add_f32 v22, v22, v54
    v_add_f32 v39, v39, v47
    v_add_f32 v23, v23, v55
    v_add_f32 v40, v40, v48
    v_add_f32 v24, v24, v56
    v_add_f32 v41, v41, v49
    v_add_f32 v25, v25, v57
    v_add_f32 v42, v42, v50
    v_add_f32 v26, v26, v58
    v_add_f32 v43, v43, v51
    v_add_f32 v27, v27, v59
    v_lshlrev_b32 v44, 16, v32
    v_and_b32 v45, 0xffff0000, v32
    v_lshlrev_b32 v46, 16, v33
    v_and_b32 v47, 0xffff0000, v33
    v_lshlrev_b32 v48, 16, v34
    v_and_b32 v49, 0xffff0000, v34
    v_lshlrev_b32 v50, 16, v35
    v_and_b32 v51, 0xffff0000, v35
    v_add_f32 v20, v20, v36
    v_add_f32 v44, v44, v10
    v_add_f32 v20, v20, v44
    v_add_f32 v21, v21, v37
    v_add_f32 v45, v45, v11
    v_add_f32 v21, v21, v45
    v_add_f32 v22, v22, v38
    v_add_f32 v46, v46, v12
    v_add_f32 v22, v22, v46
    v_add_f32 v23, v23, v39
    v_add_f32 v47, v47, v13
    v_add_f32 v23, v23, v47
    v_add_f32 v24, v24, v40
    v_add_f32 v48, v48, v14
    v_add_f32 v24, v24, v48
    v_add_f32 v25, v25, v41
    v_add_f32 v49, v49, v15
    v_add_f32 v25, v25, v49
    v_add_f32 v26, v26, v42
    v_add_f32 v50, v50, v16
    v_add_f32 v26, v26, v50
    v_add_f32 v27, v27, v43
    v_add_f32 v51, v51, v17
    v_add_f32 v27, v27, v51
    v_cvt_pk_bf16_f32 v32, v20, v21
    v_cvt_pk_bf16_f32 v33, v22, v23
    v_cvt_pk_bf16_f32 v34, v24, v25
    v_cvt_pk_bf16_f32 v35, v26, v27
    buffer_store_dwordx4 v[32:35], v7, s[52:55], s26 offen
    s_nop 1
L_s5_next:
    s_add_u32 s20, s20, 3
    s_cmp_lt_u32 s20, 128
    s_cbranch_scc1 L_s5_top
    s_endpgm
L_role_s2:
    s_sub_u32 s64, s66, 32
    s_barrier
    v_and_b32 v1, 63, v0
    v_lshlrev_b32 v2, 4, v1
    v_lshlrev_b32 v3, 3, v1
    v_mov_b32 v8, 1
    v_mov_b32 v4, 17476
    v_bfe_u32 v184, v1, 1, 1
    s_mov_b32 s30, 43690
    v_mad_u32_u24 v4, v184, s30, v4
    v_mov_b32 v5, 41984
    v_bfe_u32 v184, v1, 0, 1
    v_lshl_add_u32 v5, v184, 5, v5
    v_bfe_u32 v184, v1, 1, 1
    v_lshl_add_u32 v5, v184, 6, v5
    v_bfe_u32 v184, v1, 2, 1
    v_lshl_add_u32 v5, v184, 9, v5
    v_bfe_u32 v184, v1, 3, 1
    v_lshl_add_u32 v5, v184, 7, v5
    v_bfe_u32 v184, v1, 4, 1
    v_lshl_add_u32 v5, v184, 3, v5
    v_bfe_u32 v184, v1, 5, 1
    v_lshl_add_u32 v5, v184, 4, v5
    s_lshl_b32 s31, s17, 10
    v_add_u32 v5, s31, v5
    v_add_u32 v7, s31, v2
    v_bfe_u32 v6, v1, 1, 2
    v_min_u32 v6, 2, v6
    v_lshlrev_b32 v6, 8, v6
    v_and_b32 v184, 1, v1
    v_lshl_add_u32 v6, v184, 2, v6
    s_lshl_b32 s31, s64, 3
    v_add_u32 v6, s31, v6
    v_and_b32 v184, 15, v1
    v_lshrrev_b32 v185, 4, v1
    v_lshlrev_b32 v185, 2, v185
    v_add_u32 v186, 0, v185
    v_cmp_le_u32 s[56:57], v186, v184
    v_add_u32 v186, 1, v185
    v_cmp_le_u32 s[58:59], v186, v184
    v_add_u32 v186, 2, v185
    v_cmp_le_u32 s[60:61], v186, v184
    v_add_u32 v186, 3, v185
    v_cmp_le_u32 s[62:63], v186, v184
    v_mov_b32 v140, 0x3f803f80
    v_mov_b32 v141, 0x3f803f80
    v_mov_b32 v142, 0x3f803f80
    v_mov_b32 v143, 0x3f803f80
    v_mov_b32 v144, 0x3f003f00
    v_mov_b32 v145, 0x3f003f00
    v_mov_b32 v130, 0
    v_mov_b32 v131, 0
    s_mov_b32 s31, 196
    s_cmp_lg_u32 s17, 0
    s_cbranch_scc1 L_s2_rw_go
    s_mov_b32 s29, 0
L_s2_rw_p:
    buffer_load_dword v184, off, s[12:15], s31 sc1
    s_add_u32 s29, s29, 1
    s_cmp_ge_u32 s29, 4194304
    s_cbranch_scc1 L_abort
    s_waitcnt vmcnt(0)
    v_cmp_eq_u32 vcc, 32, v184
    s_cbranch_vccnz L_s2_rw_go
    s_sleep 8
    s_branch L_s2_rw_p
L_s2_rw_go:
    s_barrier
    s_load_dwordx4 s[36:39], s[0:1], 24
    v_mov_b32 v188, 0
    v_bfe_u32 v184, v1, 0, 1
    v_lshl_add_u32 v188, v184, 4, v188
    v_bfe_u32 v184, v1, 1, 1
    v_lshl_add_u32 v188, v184, 5, v188
    v_bfe_u32 v184, v1, 2, 1
    v_lshl_add_u32 v188, v184, 17, v188
    v_bfe_u32 v184, v1, 3, 1
    v_lshl_add_u32 v188, v184, 14, v188
    v_bfe_u32 v184, v1, 4, 1
    v_lshl_add_u32 v188, v184, 13, v188
    v_bfe_u32 v184, v1, 5, 1
    v_lshl_add_u32 v188, v184, 15, v188
    v_mov_b32 v189, 1048576
    v_bfe_u32 v184, v1, 0, 1
    v_lshl_add_u32 v189, v184, 4, v189
    v_bfe_u32 v184, v1, 1, 1
    v_lshl_add_u32 v189, v184, 5, v189
    v_bfe_u32 v184, v1, 2, 1
    v_lshl_add_u32 v189, v184, 13, v189
    v_bfe_u32 v184, v1, 3, 1
    v_lshl_add_u32 v189, v184, 16, v189
    v_bfe_u32 v184, v1, 4, 1
    v_lshl_add_u32 v189, v184, 15, v189
    v_bfe_u32 v184, v1, 5, 1
    s_mov_b32 s30, 1179648
    v_mad_u32_u24 v189, v184, s30, v189
    v_mov_b32 v190, 0
    v_bfe_u32 v184, v1, 0, 1
    v_lshl_add_u32 v190, v184, 3, v190
    v_bfe_u32 v184, v1, 1, 1
    v_lshl_add_u32 v190, v184, 4, v190
    v_bfe_u32 v184, v1, 2, 1
    v_lshl_add_u32 v190, v184, 6, v190
    v_bfe_u32 v184, v1, 3, 1
    v_lshl_add_u32 v190, v184, 7, v190
    v_bfe_u32 v184, v1, 4, 1
    v_lshl_add_u32 v190, v184, 8, v190
    v_bfe_u32 v184, v1, 5, 1
    v_lshl_add_u32 v190, v184, 9, v190
    s_lshl_b32 s23, s17, 15
    v_add_u32 v190, s23, v190
    s_lshl_b32 s27, s64, 8
    s_lshl_b32 s31, s17, 6
    s_add_u32 s27, s27, s31
    s_waitcnt lgkmcnt(0)
    s_mov_b32 s48, s36
    s_and_b32 s49, s37, 0xffff
    s_mov_b32 s50, 4718592
    s_mov_b32 s51, 0x00020000
    s_mov_b32 s52, s38
    s_and_b32 s53, s39, 0xffff
    s_mov_b32 s54, 4718592
    s_mov_b32 s55, 0x00020000
    s_add_u32 m0, s23, 0
    s_add_u32 s33, s27, 0
    buffer_load_dwordx4 v188, s[48:51], s33 offen lds
    s_add_u32 m0, s23, 1024
    s_add_u32 s33, s27, 262144
    buffer_load_dwordx4 v188, s[48:51], s33 offen lds
    s_add_u32 m0, s23, 2048
    s_add_u32 s33, s27, 65536
    buffer_load_dwordx4 v188, s[48:51], s33 offen lds
    s_add_u32 m0, s23, 3072
    s_add_u32 s33, s27, 327680
    buffer_load_dwordx4 v188, s[48:51], s33 offen lds
    s_add_u32 m0, s23, 4096
    s_add_u32 s33, s27, 0
    buffer_load_dwordx4 v188, s[52:55], s33 offen lds
    s_add_u32 m0, s23, 5120
    s_add_u32 s33, s27, 262144
    buffer_load_dwordx4 v188, s[52:55], s33 offen lds
    s_add_u32 m0, s23, 6144
    s_add_u32 s33, s27, 65536
    buffer_load_dwordx4 v188, s[52:55], s33 offen lds
    s_add_u32 m0, s23, 7168
    s_add_u32 s33, s27, 327680
    buffer_load_dwordx4 v188, s[52:55], s33 offen lds
    s_add_u32 m0, s23, 8192
    s_add_u32 s33, s27, 524288
    buffer_load_dwordx4 v188, s[48:51], s33 offen lds
    s_add_u32 m0, s23, 9216
    s_add_u32 s33, s27, 786432
    buffer_load_dwordx4 v188, s[48:51], s33 offen lds
    s_add_u32 m0, s23, 10240
    s_add_u32 s33, s27, 589824
    buffer_load_dwordx4 v188, s[48:51], s33 offen lds
    s_add_u32 m0, s23, 11264
    s_add_u32 s33, s27, 851968
    buffer_load_dwordx4 v188, s[48:51], s33 offen lds
    s_add_u32 m0, s23, 12288
    s_add_u32 s33, s27, 524288
    buffer_load_dwordx4 v188, s[52:55], s33 offen lds
    s_add_u32 m0, s23, 13312
    s_add_u32 s33, s27, 786432
    buffer_load_dwordx4 v188, s[52:55], s33 offen lds
    s_add_u32 m0, s23, 14336
    s_add_u32 s33, s27, 589824
    buffer_load_dwordx4 v188, s[52:55], s33 offen lds
    s_add_u32 m0, s23, 15360
    s_add_u32 s33, s27, 851968
    buffer_load_dwordx4 v188, s[52:55], s33 offen lds
    s_add_u32 m0, s23, 16384
    s_add_u32 s33, s27, 1179648
    buffer_load_dwordx4 v188, s[48:51], s33 offen lds
    s_add_u32 m0, s23, 17408
    s_add_u32 s33, s27, 1441792
    buffer_load_dwordx4 v188, s[48:51], s33 offen lds
    s_add_u32 m0, s23, 18432
    s_add_u32 s33, s27, 1245184
    buffer_load_dwordx4 v188, s[48:51], s33 offen lds
    s_add_u32 m0, s23, 19456
    s_add_u32 s33, s27, 1507328
    buffer_load_dwordx4 v188, s[48:51], s33 offen lds
    s_add_u32 m0, s23, 20480
    s_add_u32 s33, s27, 1179648
    buffer_load_dwordx4 v188, s[52:55], s33 offen lds
    s_add_u32 m0, s23, 21504
    s_add_u32 s33, s27, 1441792
    buffer_load_dwordx4 v188, s[52:55], s33 offen lds
    s_add_u32 m0, s23, 22528
    s_add_u32 s33, s27, 1245184
    buffer_load_dwordx4 v188, s[52:55], s33 offen lds
    s_add_u32 m0, s23, 23552
    s_add_u32 s33, s27, 1507328
    buffer_load_dwordx4 v188, s[52:55], s33 offen lds
    s_add_u32 m0, s23, 24576
    s_add_u32 s33, s27, 1703936
    buffer_load_dwordx4 v188, s[48:51], s33 offen lds
    s_add_u32 m0, s23, 25600
    s_add_u32 s33, s27, 1966080
    buffer_load_dwordx4 v188, s[48:51], s33 offen lds
    s_add_u32 m0, s23, 26624
    s_add_u32 s33, s27, 1769472
    buffer_load_dwordx4 v188, s[48:51], s33 offen lds
    s_add_u32 m0, s23, 27648
    s_add_u32 s33, s27, 2031616
    buffer_load_dwordx4 v188, s[48:51], s33 offen lds
    s_add_u32 m0, s23, 28672
    s_add_u32 s33, s27, 1703936
    buffer_load_dwordx4 v188, s[52:55], s33 offen lds
    s_add_u32 m0, s23, 29696
    s_add_u32 s33, s27, 1966080
    buffer_load_dwordx4 v188, s[52:55], s33 offen lds
    s_add_u32 m0, s23, 30720
    s_add_u32 s33, s27, 1769472
    buffer_load_dwordx4 v188, s[52:55], s33 offen lds
    s_add_u32 m0, s23, 31744
    s_add_u32 s33, s27, 2031616
    buffer_load_dwordx4 v188, s[52:55], s33 offen lds
    s_waitcnt vmcnt(28)
    ds_read_b64_tr_b16 a[0:1], v190 offset:0
    ds_read_b64_tr_b16 a[2:3], v190 offset:1024
    ds_read_b64_tr_b16 a[4:5], v190 offset:2048
    ds_read_b64_tr_b16 a[6:7], v190 offset:3072
    ds_read_b64_tr_b16 a[8:9], v190 offset:32
    ds_read_b64_tr_b16 a[10:11], v190 offset:1056
    ds_read_b64_tr_b16 a[12:13], v190 offset:2080
    ds_read_b64_tr_b16 a[14:15], v190 offset:3104
    s_waitcnt lgkmcnt(0)
    s_add_u32 m0, s23, 0
    s_add_u32 s33, s27, 2359296
    buffer_load_dwordx4 v188, s[48:51], s33 offen lds
    s_add_u32 m0, s23, 1024
    s_add_u32 s33, s27, 2621440
    buffer_load_dwordx4 v188, s[48:51], s33 offen lds
    s_add_u32 m0, s23, 2048
    s_add_u32 s33, s27, 2424832
    buffer_load_dwordx4 v188, s[48:51], s33 offen lds
    s_add_u32 m0, s23, 3072
    s_add_u32 s33, s27, 2686976
    buffer_load_dwordx4 v188, s[48:51], s33 offen lds
    s_waitcnt vmcnt(28)
    ds_read_b64_tr_b16 a[16:17], v190 offset:4096
    ds_read_b64_tr_b16 a[18:19], v190 offset:5120
    ds_read_b64_tr_b16 a[20:21], v190 offset:6144
    ds_read_b64_tr_b16 a[22:23], v190 offset:7168
    ds_read_b64_tr_b16 a[24:25], v190 offset:4128
    ds_read_b64_tr_b16 a[26:27], v190 offset:5152
    ds_read_b64_tr_b16 a[28:29], v190 offset:6176
    ds_read_b64_tr_b16 a[30:31], v190 offset:7200
    s_waitcnt lgkmcnt(0)
    s_add_u32 m0, s23, 4096
    s_add_u32 s33, s27, 2359296
    buffer_load_dwordx4 v188, s[52:55], s33 offen lds
    s_add_u32 m0, s23, 5120
    s_add_u32 s33, s27, 2621440
    buffer_load_dwordx4 v188, s[52:55], s33 offen lds
    s_add_u32 m0, s23, 6144
    s_add_u32 s33, s27, 2424832
    buffer_load_dwordx4 v188, s[52:55], s33 offen lds
    s_add_u32 m0, s23, 7168
    s_add_u32 s33, s27, 2686976
    buffer_load_dwordx4 v188, s[52:55], s33 offen lds
    s_waitcnt vmcnt(28)
    ds_read_b64_tr_b16 a[32:33], v190 offset:8192
    ds_read_b64_tr_b16 a[34:35], v190 offset:9216
    ds_read_b64_tr_b16 a[36:37], v190 offset:10240
    ds_read_b64_tr_b16 a[38:39], v190 offset:11264
    ds_read_b64_tr_b16 a[40:41], v190 offset:8224
    ds_read_b64_tr_b16 a[42:43], v190 offset:9248
    ds_read_b64_tr_b16 a[44:45], v190 offset:10272
    ds_read_b64_tr_b16 a[46:47], v190 offset:11296
    s_waitcnt lgkmcnt(0)
    s_add_u32 m0, s23, 8192
    s_add_u32 s33, s27, 2883584
    buffer_load_dwordx4 v188, s[48:51], s33 offen lds
    s_add_u32 m0, s23, 9216
    s_add_u32 s33, s27, 3145728
    buffer_load_dwordx4 v188, s[48:51], s33 offen lds
    s_add_u32 m0, s23, 10240
    s_add_u32 s33, s27, 2949120
    buffer_load_dwordx4 v188, s[48:51], s33 offen lds
    s_add_u32 m0, s23, 11264
    s_add_u32 s33, s27, 3211264
    buffer_load_dwordx4 v188, s[48:51], s33 offen lds
    s_waitcnt vmcnt(28)
    ds_read_b64_tr_b16 a[48:49], v190 offset:12288
    ds_read_b64_tr_b16 a[50:51], v190 offset:13312
    ds_read_b64_tr_b16 a[52:53], v190 offset:14336
    ds_read_b64_tr_b16 a[54:55], v190 offset:15360
    ds_read_b64_tr_b16 a[56:57], v190 offset:12320
    ds_read_b64_tr_b16 a[58:59], v190 offset:13344
    ds_read_b64_tr_b16 a[60:61], v190 offset:14368
    ds_read_b64_tr_b16 a[62:63], v190 offset:15392
    s_waitcnt lgkmcnt(0)
    s_add_u32 m0, s23, 12288
    s_add_u32 s33, s27, 2883584
    buffer_load_dwordx4 v188, s[52:55], s33 offen lds
    s_add_u32 m0, s23, 13312
    s_add_u32 s33, s27, 3145728
    buffer_load_dwordx4 v188, s[52:55], s33 offen lds
    s_add_u32 m0, s23, 14336
    s_add_u32 s33, s27, 2949120
    buffer_load_dwordx4 v188, s[52:55], s33 offen lds
    s_add_u32 m0, s23, 15360
    s_add_u32 s33, s27, 3211264
    buffer_load_dwordx4 v188, s[52:55], s33 offen lds
    s_waitcnt vmcnt(28)
    ds_read_b64_tr_b16 a[64:65], v190 offset:16384
    ds_read_b64_tr_b16 a[66:67], v190 offset:17408
    ds_read_b64_tr_b16 a[68:69], v190 offset:18432
    ds_read_b64_tr_b16 a[70:71], v190 offset:19456
    ds_read_b64_tr_b16 a[72:73], v190 offset:16416
    ds_read_b64_tr_b16 a[74:75], v190 offset:17440
    ds_read_b64_tr_b16 a[76:77], v190 offset:18464
    ds_read_b64_tr_b16 a[78:79], v190 offset:19488
    s_waitcnt lgkmcnt(0)
    s_add_u32 m0, s23, 16384
    s_add_u32 s33, s27, 3538944
    buffer_load_dwordx4 v188, s[48:51], s33 offen lds
    s_add_u32 m0, s23, 17408
    s_add_u32 s33, s27, 3801088
    buffer_load_dwordx4 v188, s[48:51], s33 offen lds
    s_add_u32 m0, s23, 18432
    s_add_u32 s33, s27, 3604480
    buffer_load_dwordx4 v188, s[48:51], s33 offen lds
    s_add_u32 m0, s23, 19456
    s_add_u32 s33, s27, 3866624
    buffer_load_dwordx4 v188, s[48:51], s33 offen lds
    s_waitcnt vmcnt(28)
    ds_read_b64_tr_b16 a[80:81], v190 offset:20480
    ds_read_b64_tr_b16 a[82:83], v190 offset:21504
    ds_read_b64_tr_b16 a[84:85], v190 offset:22528
    ds_read_b64_tr_b16 a[86:87], v190 offset:23552
    ds_read_b64_tr_b16 a[88:89], v190 offset:20512
    ds_read_b64_tr_b16 a[90:91], v190 offset:21536
    ds_read_b64_tr_b16 a[92:93], v190 offset:22560
    ds_read_b64_tr_b16 a[94:95], v190 offset:23584
    s_waitcnt lgkmcnt(0)
    s_add_u32 m0, s23, 20480
    s_add_u32 s33, s27, 3538944
    buffer_load_dwordx4 v188, s[52:55], s33 offen lds
    s_add_u32 m0, s23, 21504
    s_add_u32 s33, s27, 3801088
    buffer_load_dwordx4 v188, s[52:55], s33 offen lds
    s_add_u32 m0, s23, 22528
    s_add_u32 s33, s27, 3604480
    buffer_load_dwordx4 v188, s[52:55], s33 offen lds
    s_add_u32 m0, s23, 23552
    s_add_u32 s33, s27, 3866624
    buffer_load_dwordx4 v188, s[52:55], s33 offen lds
    s_waitcnt vmcnt(28)
    ds_read_b64_tr_b16 a[96:97], v190 offset:24576
    ds_read_b64_tr_b16 a[98:99], v190 offset:25600
    ds_read_b64_tr_b16 a[100:101], v190 offset:26624
    ds_read_b64_tr_b16 a[102:103], v190 offset:27648
    ds_read_b64_tr_b16 a[104:105], v190 offset:24608
    ds_read_b64_tr_b16 a[106:107], v190 offset:25632
    ds_read_b64_tr_b16 a[108:109], v190 offset:26656
    ds_read_b64_tr_b16 a[110:111], v190 offset:27680
    s_waitcnt lgkmcnt(0)
    s_add_u32 m0, s23, 24576
    s_add_u32 s33, s27, 4063232
    buffer_load_dwordx4 v188, s[48:51], s33 offen lds
    s_add_u32 m0, s23, 25600
    s_add_u32 s33, s27, 4325376
    buffer_load_dwordx4 v188, s[48:51], s33 offen lds
    s_add_u32 m0, s23, 26624
    s_add_u32 s33, s27, 4128768
    buffer_load_dwordx4 v188, s[48:51], s33 offen lds
    s_add_u32 m0, s23, 27648
    s_add_u32 s33, s27, 4390912
    buffer_load_dwordx4 v188, s[48:51], s33 offen lds
    s_waitcnt vmcnt(28)
    ds_read_b64_tr_b16 a[112:113], v190 offset:28672
    ds_read_b64_tr_b16 a[114:115], v190 offset:29696
    ds_read_b64_tr_b16 a[116:117], v190 offset:30720
    ds_read_b64_tr_b16 a[118:119], v190 offset:31744
    ds_read_b64_tr_b16 a[120:121], v190 offset:28704
    ds_read_b64_tr_b16 a[122:123], v190 offset:29728
    ds_read_b64_tr_b16 a[124:125], v190 offset:30752
    ds_read_b64_tr_b16 a[126:127], v190 offset:31776
    s_waitcnt lgkmcnt(0)
    s_add_u32 m0, s23, 28672
    s_add_u32 s33, s27, 4063232
    buffer_load_dwordx4 v188, s[52:55], s33 offen lds
    s_add_u32 m0, s23, 29696
    s_add_u32 s33, s27, 4325376
    buffer_load_dwordx4 v188, s[52:55], s33 offen lds
    s_add_u32 m0, s23, 30720
    s_add_u32 s33, s27, 4128768
    buffer_load_dwordx4 v188, s[52:55], s33 offen lds
    s_add_u32 m0, s23, 31744
    s_add_u32 s33, s27, 4390912
    buffer_load_dwordx4 v188, s[52:55], s33 offen lds
    s_waitcnt vmcnt(28)
    ds_read_b64_tr_b16 a[128:129], v190 offset:0
    ds_read_b64_tr_b16 a[130:131], v190 offset:1024
    ds_read_b64_tr_b16 a[132:133], v190 offset:2048
    ds_read_b64_tr_b16 a[134:135], v190 offset:3072
    ds_read_b64_tr_b16 a[136:137], v190 offset:32
    ds_read_b64_tr_b16 a[138:139], v190 offset:1056
    ds_read_b64_tr_b16 a[140:141], v190 offset:2080
    ds_read_b64_tr_b16 a[142:143], v190 offset:3104
    s_waitcnt lgkmcnt(0)
    s_add_u32 m0, s23, 0
    s_add_u32 s33, s27, 0
    buffer_load_dwordx4 v189, s[48:51], s33 offen lds
    s_add_u32 m0, s23, 1024
    s_add_u32 s33, s27, 16384
    buffer_load_dwordx4 v189, s[48:51], s33 offen lds
    s_add_u32 m0, s23, 2048
    s_add_u32 s33, s27, 2359296
    buffer_load_dwordx4 v189, s[48:51], s33 offen lds
    s_add_u32 m0, s23, 3072
    s_add_u32 s33, s27, 2375680
    buffer_load_dwordx4 v189, s[48:51], s33 offen lds
    s_waitcnt vmcnt(28)
    ds_read_b64_tr_b16 a[144:145], v190 offset:4096
    ds_read_b64_tr_b16 a[146:147], v190 offset:5120
    ds_read_b64_tr_b16 a[148:149], v190 offset:6144
    ds_read_b64_tr_b16 a[150:151], v190 offset:7168
    ds_read_b64_tr_b16 a[152:153], v190 offset:4128
    ds_read_b64_tr_b16 a[154:155], v190 offset:5152
    ds_read_b64_tr_b16 a[156:157], v190 offset:6176
    ds_read_b64_tr_b16 a[158:159], v190 offset:7200
    s_waitcnt lgkmcnt(0)
    s_add_u32 m0, s23, 4096
    s_add_u32 s33, s27, 0
    buffer_load_dwordx4 v189, s[52:55], s33 offen lds
    s_add_u32 m0, s23, 5120
    s_add_u32 s33, s27, 16384
    buffer_load_dwordx4 v189, s[52:55], s33 offen lds
    s_add_u32 m0, s23, 6144
    s_add_u32 s33, s27, 2359296
    buffer_load_dwordx4 v189, s[52:55], s33 offen lds
    s_add_u32 m0, s23, 7168
    s_add_u32 s33, s27, 2375680
    buffer_load_dwordx4 v189, s[52:55], s33 offen lds
    s_waitcnt vmcnt(28)
    ds_read_b64_tr_b16 a[160:161], v190 offset:8192
    ds_read_b64_tr_b16 a[162:163], v190 offset:9216
    ds_read_b64_tr_b16 a[164:165], v190 offset:10240
    ds_read_b64_tr_b16 a[166:167], v190 offset:11264
    ds_read_b64_tr_b16 a[168:169], v190 offset:8224
    ds_read_b64_tr_b16 a[170:171], v190 offset:9248
    ds_read_b64_tr_b16 a[172:173], v190 offset:10272
    ds_read_b64_tr_b16 a[174:175], v190 offset:11296
    s_waitcnt vmcnt(24)
    ds_read_b64_tr_b16 a[176:177], v190 offset:12288
    ds_read_b64_tr_b16 a[178:179], v190 offset:13312
    ds_read_b64_tr_b16 a[180:181], v190 offset:14336
    ds_read_b64_tr_b16 a[182:183], v190 offset:15360
    ds_read_b64_tr_b16 a[184:185], v190 offset:12320
    ds_read_b64_tr_b16 a[186:187], v190 offset:13344
    ds_read_b64_tr_b16 a[188:189], v190 offset:14368
    ds_read_b64_tr_b16 a[190:191], v190 offset:15392
    s_waitcnt vmcnt(20)
    ds_read_b64_tr_b16 a[192:193], v190 offset:16384
    ds_read_b64_tr_b16 a[194:195], v190 offset:17408
    ds_read_b64_tr_b16 a[196:197], v190 offset:18432
    ds_read_b64_tr_b16 a[198:199], v190 offset:19456
    ds_read_b64_tr_b16 a[200:201], v190 offset:16416
    ds_read_b64_tr_b16 a[202:203], v190 offset:17440
    ds_read_b64_tr_b16 a[204:205], v190 offset:18464
    ds_read_b64_tr_b16 a[206:207], v190 offset:19488
    s_waitcnt vmcnt(16)
    ds_read_b64_tr_b16 a[208:209], v190 offset:20480
    ds_read_b64_tr_b16 a[210:211], v190 offset:21504
    ds_read_b64_tr_b16 a[212:213], v190 offset:22528
    ds_read_b64_tr_b16 a[214:215], v190 offset:23552
    ds_read_b64_tr_b16 a[216:217], v190 offset:20512
    ds_read_b64_tr_b16 a[218:219], v190 offset:21536
    ds_read_b64_tr_b16 a[220:221], v190 offset:22560
    ds_read_b64_tr_b16 a[222:223], v190 offset:23584
    s_waitcnt vmcnt(12)
    ds_read_b64_tr_b16 a[224:225], v190 offset:24576
    ds_read_b64_tr_b16 a[226:227], v190 offset:25600
    ds_read_b64_tr_b16 a[228:229], v190 offset:26624
    ds_read_b64_tr_b16 a[230:231], v190 offset:27648
    ds_read_b64_tr_b16 a[232:233], v190 offset:24608
    ds_read_b64_tr_b16 a[234:235], v190 offset:25632
    ds_read_b64_tr_b16 a[236:237], v190 offset:26656
    ds_read_b64_tr_b16 a[238:239], v190 offset:27680
    s_waitcnt vmcnt(8)
    ds_read_b64_tr_b16 a[240:241], v190 offset:28672
    ds_read_b64_tr_b16 a[242:243], v190 offset:29696
    ds_read_b64_tr_b16 a[244:245], v190 offset:30720
    ds_read_b64_tr_b16 a[246:247], v190 offset:31744
    ds_read_b64_tr_b16 a[248:249], v190 offset:28704
    ds_read_b64_tr_b16 a[250:251], v190 offset:29728
    ds_read_b64_tr_b16 a[252:253], v190 offset:30752
    ds_read_b64_tr_b16 a[254:255], v190 offset:31776
    s_waitcnt vmcnt(4)
    ds_read_b64_tr_b16 v[224:225], v190 offset:0
    ds_read_b64_tr_b16 v[226:227], v190 offset:1024
    ds_read_b64_tr_b16 v[228:229], v190 offset:2048
    ds_read_b64_tr_b16 v[230:231], v190 offset:3072
    ds_read_b64_tr_b16 v[232:233], v190 offset:32
    ds_read_b64_tr_b16 v[234:235], v190 offset:1056
    ds_read_b64_tr_b16 v[236:237], v190 offset:2080
    ds_read_b64_tr_b16 v[238:239], v190 offset:3104
    s_waitcnt vmcnt(0)
    ds_read_b64_tr_b16 v[240:241], v190 offset:4096
    ds_read_b64_tr_b16 v[242:243], v190 offset:5120
    ds_read_b64_tr_b16 v[244:245], v190 offset:6144
    ds_read_b64_tr_b16 v[246:247], v190 offset:7168
    ds_read_b64_tr_b16 v[248:249], v190 offset:4128
    ds_read_b64_tr_b16 v[250:251], v190 offset:5152
    ds_read_b64_tr_b16 v[252:253], v190 offset:6176
    ds_read_b64_tr_b16 v[254:255], v190 offset:7200
    s_waitcnt lgkmcnt(0)
    s_mov_b32 s28, 0x3e0293ee
    s_mov_b32 s20, 0
    s_mov_b32 s21, 54525952
    s_mov_b32 s22, 119668736
    s_lshl_b32 s24, s64, 13
    s_lshl_b32 s31, s17, 11
    s_add_u32 s24, s24, s31
    s_add_u32 s24, s24, 4194304
    s_add_u32 s34, s31, 9216
    s_lshl_b32 s25, s64, 12
    s_lshl_b32 s31, s17, 10
    s_add_u32 s25, s25, s31
    s_add_u32 s25, s25, 71303168
    s_lshl_b32 s26, s64, 4
    s_lshl_b32 s31, s17, 2
    s_add_u32 s26, s26, s31
    s_add_u32 s26, s26, 119554048
    v_add_u32 v9, 9216, v2
    s_mov_b32 s31, 160
    s_cmp_lg_u32 s17, 0
    s_cbranch_scc1 L_s2_init_go
    s_mov_b32 s29, 0
L_s2_init_p:
    buffer_load_dword v184, off, s[12:15], s31 sc1
    s_add_u32 s29, s29, 1
    s_cmp_ge_u32 s29, 4194304
    s_cbranch_scc1 L_abort
    s_waitcnt vmcnt(0)
    v_cmp_eq_u32 vcc, 0xe0, v184
    s_cbranch_vccnz L_s2_init_go
    s_sleep 8
    s_branch L_s2_init_p
L_s2_init_go:
    s_barrier
    s_mov_b32 s29, 0
L_s2f0_p:
    buffer_load_dword v10, v6, s[8:11], s22 offen sc1
    s_add_u32 s29, s29, 1
    s_cmp_ge_u32 s29, 4194304
    s_cbranch_scc1 L_abort
    s_waitcnt vmcnt(0)
    v_cmp_eq_u32 vcc, 0, v10
    s_cbranch_vccz L_s2f0_ok
    s_sleep 4
    s_branch L_s2f0_p
L_s2f0_ok:
    s_mov_b32 m0, s34
    s_nop 0
    buffer_load_dwordx4 v2, s[8:11], s24 offen offset:0 sc1 lds
    buffer_load_dwordx4 v2, s[8:11], s24 offen offset:1024 sc1 lds
    s_add_u32 m0, s34, 8192
    s_add_u32 s30, s24, 16777216
    buffer_load_dwordx4 v2, s[8:11], s30 offen offset:0 sc1 lds
    buffer_load_dwordx4 v2, s[8:11], s30 offen offset:1024 sc1 lds
    s_add_u32 s30, s24, 33554432
    buffer_load_dwordx4 v[52:55], v2, s[8:11], s30 offen offset:0 sc1
    buffer_load_dwordx4 v[56:59], v2, s[8:11], s30 offen offset:1024 sc1
    s_add_u32 s22, s22, 1024
    s_min_u32 s22, s22, 119733248
    buffer_load_dword v10, v6, s[8:11], s22 offen sc1
    v_mov_b32 v24, 0
    v_mov_b32 v25, 0
    v_mov_b32 v26, 0
    v_mov_b32 v27, 0
    v_mov_b32 v28, 0
    v_mov_b32 v29, 0
    v_mov_b32 v30, 0
    v_mov_b32 v31, 0
    v_mov_b32 v32, 0
    v_mov_b32 v33, 0
    v_mov_b32 v34, 0
    v_mov_b32 v35, 0
    v_mov_b32 v36, 0
    v_mov_b32 v37, 0
    v_mov_b32 v38, 0
    v_mov_b32 v39, 0
    s_mov_b32 s29, 0
    s_nop 0
L_s2_m:
    s_add_u32 s31, s21, 4096
    s_add_u32 s32, s21, 8192
    buffer_load_dwordx4 v[40:43], v7, s[8:11], s21 offen sc1
    buffer_load_dwordx4 v[44:47], v7, s[8:11], s31 offen sc1
    buffer_load_dwordx4 v[48:51], v2, s[8:11], s32 offen sc1
L_s2_top:
    s_add_u32 s29, s29, 1
    s_cmp_ge_u32 s29, 4194304
    s_cbranch_scc1 L_abort
    s_waitcnt vmcnt(0)
    v_max3_u32 v11, v40, v41, v42
    v_max3_u32 v11, v11, v43, v44
    v_max3_u32 v11, v11, v45, v46
    v_max3_u32 v11, v11, v47, v48
    v_max3_u32 v11, v11, v49, v50
    v_max_u32 v11, v11, v51
    v_cmp_eq_u32 vcc, -1, v11
    s_nop 0
    s_cbranch_vccz L_s2_mok
    s_sleep 3
    s_branch L_s2_m
L_s2_mok:
    ds_write_b128 v7, v[40:43] offset:0
    ds_write_b128 v7, v[44:47] offset:4096
    ds_write_b128 v2, v[48:51] offset:8192
    s_waitcnt lgkmcnt(0)
    s_barrier
    ds_read_b128 v[12:15], v2 offset:0
    ds_read_b128 v[16:19], v2 offset:1024
    ds_read_b128 v[20:23], v2 offset:2048
    s_waitcnt lgkmcnt(2)
    v_smfmac_f32_16x16x64_bf16 v[24:27], v[12:15], a[0:7], v4
    v_smfmac_f32_16x16x64_bf16 v[28:31], v[12:15], a[8:15], v4
    v_smfmac_f32_16x16x64_bf16 v[32:35], v[12:15], a[16:23], v4
    v_smfmac_f32_16x16x64_bf16 v[36:39], v[12:15], a[24:31], v4
    ds_read_b128 v[12:15], v2 offset:3072
    s_waitcnt lgkmcnt(2)
    v_smfmac_f32_16x16x64_bf16 v[24:27], v[16:19], a[32:39], v4
    v_smfmac_f32_16x16x64_bf16 v[28:31], v[16:19], a[40:47], v4
    v_smfmac_f32_16x16x64_bf16 v[32:35], v[16:19], a[48:55], v4
    v_smfmac_f32_16x16x64_bf16 v[36:39], v[16:19], a[56:63], v4
    ds_read_b128 v[16:19], v2 offset:4096
    s_waitcnt lgkmcnt(2)
    v_smfmac_f32_16x16x64_bf16 v[24:27], v[20:23], a[64:71], v4
    v_smfmac_f32_16x16x64_bf16 v[28:31], v[20:23], a[72:79], v4
    v_smfmac_f32_16x16x64_bf16 v[32:35], v[20:23], a[80:87], v4
    v_smfmac_f32_16x16x64_bf16 v[36:39], v[20:23], a[88:95], v4
    ds_read_b128 v[20:23], v2 offset:5120
    s_waitcnt lgkmcnt(2)
    v_smfmac_f32_16x16x64_bf16 v[24:27], v[12:15], a[96:103], v4
    v_smfmac_f32_16x16x64_bf16 v[28:31], v[12:15], a[104:111], v4
    v_smfmac_f32_16x16x64_bf16 v[32:35], v[12:15], a[112:119], v4
    v_smfmac_f32_16x16x64_bf16 v[36:39], v[12:15], a[120:127], v4
    ds_read_b128 v[12:15], v2 offset:6144
    s_waitcnt lgkmcnt(2)
    v_smfmac_f32_16x16x64_bf16 v[24:27], v[16:19], a[128:135], v4
    v_smfmac_f32_16x16x64_bf16 v[28:31], v[16:19], a[136:143], v4
    v_smfmac_f32_16x16x64_bf16 v[32:35], v[16:19], a[144:151], v4
    v_smfmac_f32_16x16x64_bf16 v[36:39], v[16:19], a[152:159], v4
    ds_read_b128 v[16:19], v2 offset:7168
    s_waitcnt lgkmcnt(2)
    v_smfmac_f32_16x16x64_bf16 v[24:27], v[20:23], a[160:167], v4
    v_smfmac_f32_16x16x64_bf16 v[28:31], v[20:23], a[168:175], v4
    v_smfmac_f32_16x16x64_bf16 v[32:35], v[20:23], a[176:183], v4
    v_smfmac_f32_16x16x64_bf16 v[36:39], v[20:23], a[184:191], v4
    ds_read_b128 v[20:23], v2 offset:8192
    s_waitcnt lgkmcnt(2)
    v_smfmac_f32_16x16x64_bf16 v[24:27], v[12:15], a[192:199], v4
    v_smfmac_f32_16x16x64_bf16 v[28:31], v[12:15], a[200:207], v4
    v_smfmac_f32_16x16x64_bf16 v[32:35], v[12:15], a[208:215], v4
    v_smfmac_f32_16x16x64_bf16 v[36:39], v[12:15], a[216:223], v4
    s_waitcnt lgkmcnt(1)
    v_smfmac_f32_16x16x64_bf16 v[24:27], v[16:19], a[224:231], v4
    v_smfmac_f32_16x16x64_bf16 v[28:31], v[16:19], a[232:239], v4
    v_smfmac_f32_16x16x64_bf16 v[32:35], v[16:19], a[240:247], v4
    v_smfmac_f32_16x16x64_bf16 v[36:39], v[16:19], a[248:255], v4
    s_waitcnt lgkmcnt(0)
    v_smfmac_f32_16x16x64_bf16 v[24:27], v[20:23], v[224:231], v4
    v_smfmac_f32_16x16x64_bf16 v[28:31], v[20:23], v[232:239], v4
    v_smfmac_f32_16x16x64_bf16 v[32:35], v[20:23], v[240:247], v4
    v_smfmac_f32_16x16x64_bf16 v[36:39], v[20:23], v[248:255], v4
    ds_read_b128 v[76:79], v9 offset:0
    ds_read_b128 v[92:95], v9 offset:8192
    ds_read_b128 v[80:83], v9 offset:1024
    ds_read_b128 v[96:99], v9 offset:9216
    ds_read_b128 v[84:87], v9 offset:2048
    ds_read_b128 v[100:103], v9 offset:10240
    ds_read_b128 v[88:91], v9 offset:3072
    ds_read_b128 v[104:107], v9 offset:11264
    v_add_f32 v24, v24, v26
    v_add_f32 v25, v25, v27
    v_cvt_pk_bf16_f32 v24, v24, v25
    ds_write_b32 v5, v24 offset:0
    v_add_f32 v28, v28, v30
    v_add_f32 v29, v29, v31
    v_cvt_pk_bf16_f32 v28, v28, v29
    ds_write_b32 v5, v28 offset:256
    v_cvt_pk_bf16_f32 v180, v32, v33
    v_cvt_pk_bf16_f32 v181, v34, v35
    v_cvt_pk_bf16_f32 v182, v36, v37
    v_cvt_pk_bf16_f32 v183, v38, v39
    s_waitcnt lgkmcnt(0)
    s_barrier
    ds_read_b64_tr_b16 v[60:61], v3 offset:41984
    ds_read_b64_tr_b16 v[62:63], v3 offset:42496
    ds_read_b64_tr_b16 v[64:65], v3 offset:43008
    ds_read_b64_tr_b16 v[66:67], v3 offset:43520
    ds_read_b64_tr_b16 v[68:69], v3 offset:44032
    ds_read_b64_tr_b16 v[70:71], v3 offset:44544
    ds_read_b64_tr_b16 v[72:73], v3 offset:45056
    ds_read_b64_tr_b16 v[74:75], v3 offset:45568
    s_waitcnt lgkmcnt(6)
    v_mfma_f32_16x16x32_bf16 v[108:111], v[60:63], v[76:79], 0
    v_mfma_f32_16x16x32_bf16 v[112:115], v[92:95], v[76:79], 0
    v_mfma_f32_16x16x32_bf16 v[116:119], v[60:63], v[80:83], 0
    v_mfma_f32_16x16x32_bf16 v[120:123], v[92:95], v[80:83], 0
    v_mfma_f32_16x16x32_bf16 v[124:127], v[96:99], v[80:83], 0
    ds_read_b128 v[76:79], v9 offset:4096
    ds_read_b128 v[92:95], v9 offset:12288
    ds_read_b128 v[80:83], v9 offset:5120
    ds_read_b128 v[96:99], v9 offset:13312
    s_waitcnt lgkmcnt(8)
    v_mfma_f32_16x16x32_bf16 v[108:111], v[64:67], v[84:87], v[108:111]
    v_mfma_f32_16x16x32_bf16 v[112:115], v[100:103], v[84:87], v[112:115]
    v_mfma_f32_16x16x32_bf16 v[116:119], v[64:67], v[88:91], v[116:119]
    v_mfma_f32_16x16x32_bf16 v[120:123], v[100:103], v[88:91], v[120:123]
    v_mfma_f32_16x16x32_bf16 v[124:127], v[104:107], v[88:91], v[124:127]
    ds_read_b128 v[84:87], v9 offset:6144
    ds_read_b128 v[100:103], v9 offset:14336
    ds_read_b128 v[88:91], v9 offset:7168
    ds_read_b128 v[104:107], v9 offset:15360
    s_waitcnt lgkmcnt(4)
    v_mfma_f32_16x16x32_bf16 v[108:111], v[68:71], v[76:79], v[108:111]
    v_mfma_f32_16x16x32_bf16 v[112:115], v[92:95], v[76:79], v[112:115]
    v_mfma_f32_16x16x32_bf16 v[116:119], v[68:71], v[80:83], v[116:119]
    v_mfma_f32_16x16x32_bf16 v[120:123], v[92:95], v[80:83], v[120:123]
    v_mfma_f32_16x16x32_bf16 v[124:127], v[96:99], v[80:83], v[124:127]
    s_waitcnt lgkmcnt(0)
    v_mfma_f32_16x16x32_bf16 v[108:111], v[72:75], v[84:87], v[108:111]
    v_mfma_f32_16x16x32_bf16 v[112:115], v[100:103], v[84:87], v[112:115]
    v_mfma_f32_16x16x32_bf16 v[116:119], v[72:75], v[88:91], v[116:119]
    v_mfma_f32_16x16x32_bf16 v[120:123], v[100:103], v[88:91], v[120:123]
    v_mfma_f32_16x16x32_bf16 v[124:127], v[104:107], v[88:91], v[124:127]
    s_bitcmp1_b32 s20, 0
    s_cselect_b32 s31, -1, 1
    s_lshl_b32 s31, s31, 14
    s_add_u32 s34, s34, s31
    v_add_u32 v9, s31, v9
    s_add_u32 s24, s24, 262144
    v_cmp_eq_u32 vcc, 0, v10
    s_nop 0
    s_cbranch_vccz L_s2_fok
    s_mov_b32 s29, 0
L_s2f1_p:
    buffer_load_dword v10, v6, s[8:11], s22 offen sc1
    s_add_u32 s29, s29, 1
    s_cmp_ge_u32 s29, 4194304
    s_cbranch_scc1 L_abort
    s_waitcnt vmcnt(0)
    v_cmp_eq_u32 vcc, 0, v10
    s_cbranch_vccz L_s2f1_ok
    s_sleep 4
    s_branch L_s2f1_p
L_s2f1_ok:
L_s2_fok:
    s_mov_b32 m0, s34
    s_nop 0
    buffer_load_dwordx4 v2, s[8:11], s24 offen offset:0 sc1 lds
    buffer_load_dwordx4 v2, s[8:11], s24 offen offset:1024 sc1 lds
    s_add_u32 m0, s34, 8192
    s_add_u32 s30, s24, 16777216
    buffer_load_dwordx4 v2, s[8:11], s30 offen offset:0 sc1 lds
    buffer_load_dwordx4 v2, s[8:11], s30 offen offset:1024 sc1 lds
    s_add_u32 s22, s22, 1024
    s_min_u32 s22, s22, 119733248
    buffer_load_dword v10, v6, s[8:11], s22 offen sc1
    v_mov_b32 v186, 0xff7fffff
    v_cndmask_b32 v112, v186, v112, s[56:57]
    v_cndmask_b32 v113, v186, v113, s[58:59]
    v_cndmask_b32 v114, v186, v114, s[60:61]
    v_cndmask_b32 v115, v186, v115, s[62:63]
    v_max3_f32 v184, v112, v113, v114
    v_max3_f32 v184, v184, v115, v108
    v_max_f32 v184, v184, v109
    v_mov_b32 v185, v184
    s_nop 1
    v_permlane16_swap_b32 v184, v185
    v_max_f32 v184, v184, v185
    v_mov_b32 v185, v184
    s_nop 1
    v_permlane32_swap_b32 v184, v185
    v_max_f32 v184, v184, v185
    v_mul_f32 v184, 0xbe0293ee, v184
    v_fma_f32 v112, v112, s28, v184
    v_fma_f32 v113, v113, s28, v184
    v_fma_f32 v114, v114, s28, v184
    v_fma_f32 v115, v115, s28, v184
    v_fma_f32 v108, v108, s28, v184
    v_fma_f32 v109, v109, s28, v184
    v_exp_f32 v112, v112
    v_exp_f32 v113, v113
    v_exp_f32 v114, v114
    v_exp_f32 v115, v115
    v_exp_f32 v108, v108
    v_exp_f32 v109, v109
    v_cvt_pk_bf16_f32 v128, v112, v113
    v_cvt_pk_bf16_f32 v129, v114, v115
    v_cvt_pk_bf16_f32 v136, v108, v109
    v_cvt_pk_bf16_f32 v137, v108, v109
    v_mfma_f32_16x16x32_bf16 v[148:151], v[140:143], v[128:131], 0
    v_mfma_f32_16x16x32_bf16 v[156:159], v[52:55], v[128:131], 0
    v_mfma_f32_16x16x32_bf16 v[160:163], v[56:59], v[128:131], 0
    s_nop 3
    v_mfma_f32_16x16x16_bf16 v[148:151], v[144:145], v[136:137], v[148:151]
    v_mfma_f32_16x16x16_bf16 v[156:159], v[180:181], v[136:137], v[156:159]
    v_mfma_f32_16x16x16_bf16 v[160:163], v[182:183], v[136:137], v[160:163]
    v_cndmask_b32 v124, v186, v124, s[56:57]
    v_cndmask_b32 v125, v186, v125, s[58:59]
    v_cndmask_b32 v126, v186, v126, s[60:61]
    v_cndmask_b32 v127, v186, v127, s[62:63]
    v_max3_f32 v184, v120, v121, v122
    v_max3_f32 v184, v184, v123, v124
    v_max3_f32 v184, v184, v125, v126
    v_max3_f32 v184, v184, v127, v116
    v_max_f32 v184, v184, v117
    v_mov_b32 v185, v184
    s_nop 1
    v_permlane16_swap_b32 v184, v185
    v_max_f32 v184, v184, v185
    v_mov_b32 v185, v184
    s_nop 1
    v_permlane32_swap_b32 v184, v185
    v_max_f32 v184, v184, v185
    v_mul_f32 v184, 0xbe0293ee, v184
    v_fma_f32 v120, v120, s28, v184
    v_fma_f32 v121, v121, s28, v184
    v_fma_f32 v122, v122, s28, v184
    v_fma_f32 v123, v123, s28, v184
    v_fma_f32 v124, v124, s28, v184
    v_fma_f32 v125, v125, s28, v184
    v_fma_f32 v126, v126, s28, v184
    v_fma_f32 v127, v127, s28, v184
    v_fma_f32 v116, v116, s28, v184
    v_fma_f32 v117, v117, s28, v184
    v_exp_f32 v120, v120
    v_exp_f32 v121, v121
    v_exp_f32 v122, v122
    v_exp_f32 v123, v123
    v_exp_f32 v124, v124
    v_exp_f32 v125, v125
    v_exp_f32 v126, v126
    v_exp_f32 v127, v127
    v_exp_f32 v116, v116
    v_exp_f32 v117, v117
    v_cvt_pk_bf16_f32 v132, v120, v121
    v_cvt_pk_bf16_f32 v133, v122, v123
    v_cvt_pk_bf16_f32 v134, v124, v125
    v_cvt_pk_bf16_f32 v135, v126, v127
    v_cvt_pk_bf16_f32 v138, v116, v117
    v_cvt_pk_bf16_f32 v139, v116, v117
    v_mfma_f32_16x16x32_bf16 v[152:155], v[140:143], v[132:135], 0
    v_mfma_f32_16x16x32_bf16 v[164:167], v[52:55], v[132:135], 0
    v_mfma_f32_16x16x32_bf16 v[168:171], v[56:59], v[132:135], 0
    s_nop 3
    v_mfma_f32_16x16x16_bf16 v[152:155], v[144:145], v[138:139], v[152:155]
    v_mfma_f32_16x16x16_bf16 v[164:167], v[180:181], v[138:139], v[164:167]
    v_mfma_f32_16x16x16_bf16 v[168:171], v[182:183], v[138:139], v[168:171]
    v_rcp_f32 v184, v148
    s_nop 0
    v_mul_f32 v156, v156, v184
    v_mul_f32 v157, v157, v184
    v_mul_f32 v158, v158, v184
    v_mul_f32 v159, v159, v184
    v_mul_f32 v160, v160, v184
    v_mul_f32 v161, v161, v184
    v_mul_f32 v162, v162, v184
    v_mul_f32 v163, v163, v184
    v_cvt_pk_bf16_f32 v172, v156, v157
    v_cvt_pk_bf16_f32 v173, v158, v159
    v_cvt_pk_bf16_f32 v174, v160, v161
    v_cvt_pk_bf16_f32 v175, v162, v163
    buffer_store_dwordx4 v[172:175], v2, s[8:11], s25 offen sc1
    s_add_u32 s25, s25, 131072
    v_rcp_f32 v184, v152
    s_nop 0
    v_mul_f32 v164, v164, v184
    v_mul_f32 v165, v165, v184
    v_mul_f32 v166, v166, v184
    v_mul_f32 v167, v167, v184
    v_mul_f32 v168, v168, v184
    v_mul_f32 v169, v169, v184
    v_mul_f32 v170, v170, v184
    v_mul_f32 v171, v171, v184
    v_cvt_pk_bf16_f32 v176, v164, v165
    v_cvt_pk_bf16_f32 v177, v166, v167
    v_cvt_pk_bf16_f32 v178, v168, v169
    v_cvt_pk_bf16_f32 v179, v170, v171
    buffer_store_dwordx4 v[176:179], v2, s[8:11], s25 offen sc1
    s_add_u32 s25, s25, 131072
    s_add_u32 s21, s21, 9216
    s_add_u32 s31, s21, 4096
    s_add_u32 s32, s21, 8192
    buffer_load_dwordx4 v[40:43], v7, s[8:11], s21 offen sc1
    buffer_load_dwordx4 v[44:47], v7, s[8:11], s31 offen sc1
    buffer_load_dwordx4 v[48:51], v2, s[8:11], s32 offen sc1
    s_add_u32 s30, s24, 33554432
    buffer_load_dwordx4 v[52:55], v2, s[8:11], s30 offen offset:0 sc1
    buffer_load_dwordx4 v[56:59], v2, s[8:11], s30 offen offset:1024 sc1
    v_mov_b32 v24, 0
    v_mov_b32 v25, 0
    v_mov_b32 v26, 0
    v_mov_b32 v27, 0
    v_mov_b32 v28, 0
    v_mov_b32 v29, 0
    v_mov_b32 v30, 0
    v_mov_b32 v31, 0
    v_mov_b32 v32, 0
    v_mov_b32 v33, 0
    v_mov_b32 v34, 0
    v_mov_b32 v35, 0
    v_mov_b32 v36, 0
    v_mov_b32 v37, 0
    v_mov_b32 v38, 0
    v_mov_b32 v39, 0
    s_mov_b32 s29, 0
    s_waitcnt vmcnt(5)
    s_mov_b64 exec, 1
    buffer_store_dword v8, off, s[8:11], s26 sc1
    s_mov_b64 exec, -1
    s_add_u32 s26, s26, 512
    s_add_u32 s20, s20, 1
    s_cmp_lt_u32 s20, 64
    s_cbranch_scc1 L_s2_top
    s_endpgm
L_role_r:
    s_mov_b32 s16, s66
    v_and_b32 v21, 63, v0
    v_lshlrev_b32 v1, 4, v21
    v_mov_b32 v3, 17476
    v_bfe_u32 v20, v21, 1, 1
    s_mov_b32 s30, 43690
    v_mad_u32_u24 v3, v20, s30, v3
    s_lshl_b32 s21, s17, 10
    v_mov_b32 v4, 17408
    v_bfe_u32 v20, v21, 0, 1
    v_lshl_add_u32 v4, v20, 5, v4
    v_bfe_u32 v20, v21, 1, 1
    v_lshl_add_u32 v4, v20, 6, v4
    v_bfe_u32 v20, v21, 2, 1
    v_lshl_add_u32 v4, v20, 9, v4
    v_bfe_u32 v20, v21, 3, 1
    v_lshl_add_u32 v4, v20, 7, v4
    v_bfe_u32 v20, v21, 4, 1
    v_lshl_add_u32 v4, v20, 3, v4
    v_bfe_u32 v20, v21, 5, 1
    v_lshl_add_u32 v4, v20, 4, v4
    v_add_u32 v4, s21, v4
    v_mov_b32 v5, 21504
    v_bfe_u32 v20, v21, 0, 1
    v_lshl_add_u32 v5, v20, 4, v5
    v_bfe_u32 v20, v21, 2, 1
    v_lshl_add_u32 v5, v20, 6, v5
    v_bfe_u32 v20, v21, 3, 1
    v_lshl_add_u32 v5, v20, 7, v5
    v_bfe_u32 v20, v21, 4, 1
    v_lshl_add_u32 v5, v20, 5, v5
    v_bfe_u32 v20, v21, 5, 1
    v_lshl_add_u32 v5, v20, 8, v5
    s_lshr_b32 s31, s17, 1
    s_lshl_b32 s31, s31, 10
    s_and_b32 s32, s17, 1
    s_lshl_b32 s32, s32, 9
    s_add_u32 s31, s31, s32
    v_add_u32 v5, s31, v5
    s_mul_i32 s31, s17, 2304
    v_mov_b32 v8, 0
    v_bfe_u32 v20, v21, 0, 1
    v_lshl_add_u32 v8, v20, 4, v8
    v_bfe_u32 v20, v21, 1, 1
    v_lshl_add_u32 v8, v20, 5, v8
    v_bfe_u32 v20, v21, 2, 1
    v_lshl_add_u32 v8, v20, 8, v8
    v_bfe_u32 v20, v21, 3, 1
    v_lshl_add_u32 v8, v20, 9, v8
    v_bfe_u32 v20, v21, 4, 1
    v_lshl_add_u32 v8, v20, 6, v8
    v_bfe_u32 v20, v21, 5, 1
    v_lshl_add_u32 v8, v20, 7, v8
    v_add_u32 v8, s31, v8
    s_mul_i32 s64, s17, 34816
    s_add_u32 s64, s64, 24576
    v_add_u32 v10, s64, v1
    s_lshl_b32 s65, s17, 10
    s_add_u32 s69, s65, 6144
    s_min_u32 s69, s69, 7168
    s_mul_i32 s31, s66, 43
    s_lshr_b32 s31, s31, 7
    s_mul_i32 s31, s31, 3
    s_sub_u32 s31, s66, s31
    s_cmp_eq_u32 s17, 3
    s_cselect_b32 s26, s31, s17
    s_mul_i32 s31, s26, 3072
    v_add_u32 v11, s31, v1
    s_add_u32 s31, s31, 3072
    s_cmp_ge_u32 s31, 9216
    s_cselect_b32 s31, 0, s31
    v_add_u32 v2, s31, v1
    s_add_u32 s31, s31, 3072
    s_cmp_ge_u32 s31, 9216
    s_cselect_b32 s31, 0, s31
    v_add_u32 v9, s31, v1
    s_add_u32 s31, s31, 3072
    s_cmp_ge_u32 s31, 9216
    s_cselect_b32 s31, 0, s31
    s_lshl_b32 s31, s17, 5
    s_add_u32 s31, s31, s66
    s_cmp_lt_u32 s31, 72
    s_cselect_b32 s28, 1, 0
    s_min_u32 s31, s31, 71
    s_lshr_b32 s32, s31, 3
    s_bfe_u32 s33, s31, 131073
    s_and_b32 s31, s31, 1
    v_mov_b32 v7, 0
    v_bfe_u32 v20, v21, 0, 1
    v_lshl_add_u32 v7, v20, 3, v7
    v_bfe_u32 v20, v21, 1, 1
    v_lshl_add_u32 v7, v20, 5, v7
    v_bfe_u32 v20, v21, 2, 1
    v_lshl_add_u32 v7, v20, 6, v7
    v_bfe_u32 v20, v21, 4, 1
    v_lshl_add_u32 v7, v20, 4, v7
    s_lshl_b32 s44, s32, 10
    s_lshl_b32 s45, s33, 8
    s_add_u32 s44, s44, s45
    s_lshl_b32 s45, s31, 7
    s_add_u32 s44, s44, s45
    v_add_u32 v7, s44, v7
    v_mov_b32 v6, 0
    v_bfe_u32 v20, v21, 0, 1
    v_lshl_add_u32 v6, v20, 4, v6
    v_bfe_u32 v20, v21, 1, 1
    v_lshl_add_u32 v6, v20, 5, v6
    v_bfe_u32 v20, v21, 2, 1
    v_lshl_add_u32 v6, v20, 6, v6
    v_bfe_u32 v20, v21, 3, 1
    s_mov_b32 s30, 37376
    v_mad_u32_u24 v6, v20, s30, v6
    v_bfe_u32 v20, v21, 4, 1
    s_mov_b32 s30, 9344
    v_mad_u32_u24 v6, v20, s30, v6
    v_bfe_u32 v20, v21, 5, 1
    s_mov_b32 s30, 18688
    v_mad_u32_u24 v6, v20, s30, v6
    s_lshr_b32 s44, s32, 1
    s_mul_i32 s44, s44, 2304
    s_and_b32 s45, s32, 1
    s_lshl_b32 s45, s45, 10
    s_add_u32 s44, s44, s45
    s_lshl_b32 s45, s33, 8
    s_add_u32 s44, s44, s45
    s_mul_i32 s45, s33, 2304
    s_add_u32 s45, s45, 2048
    s_cmp_eq_u32 s32, 8
    s_cselect_b32 s44, s45, s44
    s_lshl_b32 s46, s31, 7
    s_add_u32 s44, s44, s46
    v_add_u32 v6, s44, v6
    v_bfe_u32 v22, v21, 2, 1
    v_lshlrev_b32 v22, 4, v22
    v_mov_b32 v23, 0x3f80
    v_lshlrev_b32 v23, v22, v23
    v_and_b32 v22, 11, v21
    v_cmp_eq_u32 vcc, 0, v22
    s_nop 1
    v_cndmask_b32 v24, 0, v23, vcc
    v_cmp_eq_u32 vcc, 1, v22
    s_nop 1
    v_cndmask_b32 v25, 0, v23, vcc
    v_cmp_eq_u32 vcc, 2, v22
    s_nop 1
    v_cndmask_b32 v26, 0, v23, vcc
    v_cmp_eq_u32 vcc, 3, v22
    s_nop 1
    v_cndmask_b32 v27, 0, v23, vcc
    s_barrier
    ds_write_b128 v1, v[24:27] offset:23552
    v_bfe_u32 v22, v21, 4, 2
    v_lshlrev_b32 v22, 1, v22
    v_and_b32 v23, 15, v21
    v_xor_b32 v23, v23, v22
    v_lshlrev_b32 v23, 4, v23
    v_xor_b32 v22, 0x80, v23
    v_mov_b32 v68, 0
    v_bfe_u32 v20, v21, 4, 1
    v_lshl_add_u32 v68, v20, 17, v68
    v_bfe_u32 v20, v21, 5, 1
    v_lshl_add_u32 v68, v20, 14, v68
    v_mov_b32 v69, 1048576
    v_bfe_u32 v20, v21, 4, 1
    v_lshl_add_u32 v69, v20, 13, v69
    v_bfe_u32 v20, v21, 5, 1
    v_lshl_add_u32 v69, v20, 16, v69
    v_add_u32 v188, v68, v22
    v_add_u32 v68, v68, v23
    v_add_u32 v189, v69, v22
    v_add_u32 v69, v69, v23
    v_mov_b32 v70, 0
    v_bfe_u32 v20, v21, 0, 1
    v_lshl_add_u32 v70, v20, 4, v70
    v_bfe_u32 v20, v21, 1, 1
    v_lshl_add_u32 v70, v20, 5, v70
    v_bfe_u32 v20, v21, 2, 1
    s_mov_b32 s30, 1152
    v_mad_u32_u24 v70, v20, s30, v70
    v_bfe_u32 v20, v21, 3, 1
    s_mov_b32 s30, 4608
    v_mad_u32_u24 v70, v20, s30, v70
    v_bfe_u32 v20, v21, 4, 1
    s_mov_b32 s30, 18432
    v_mad_u32_u24 v70, v20, s30, v70
    v_bfe_u32 v20, v21, 5, 1
    s_mov_b32 s30, 9216
    v_mad_u32_u24 v70, v20, s30, v70
    v_mov_b32 v71, 0
    v_bfe_u32 v20, v21, 0, 1
    v_lshl_add_u32 v71, v20, 3, v71
    v_bfe_u32 v20, v21, 1, 1
    v_lshl_add_u32 v71, v20, 4, v71
    v_bfe_u32 v20, v21, 2, 1
    v_lshl_add_u32 v71, v20, 6, v71
    v_bfe_u32 v20, v21, 3, 1
    v_lshl_add_u32 v71, v20, 7, v71
    v_bfe_u32 v20, v21, 4, 1
    v_lshl_add_u32 v71, v20, 8, v71
    v_bfe_u32 v20, v21, 5, 1
    v_lshl_add_u32 v71, v20, 9, v71
    v_add_u32 v71, s64, v71
    v_bfe_u32 v22, v21, 2, 3
    v_lshlrev_b32 v22, 1, v22
    v_bfe_u32 v23, v21, 1, 1
    s_lshl_b32 s31, s17, 2
    v_add_u32 v23, s31, v23
    v_mov_b32 v24, 24576
    v_bfe_u32 v20, v21, 0, 1
    v_lshl_add_u32 v24, v20, 3, v24
    v_bfe_u32 v20, v21, 2, 1
    v_lshl_add_u32 v24, v20, 8, v24
    v_bfe_u32 v20, v21, 3, 1
    v_lshl_add_u32 v24, v20, 9, v24
    v_bfe_u32 v20, v21, 4, 1
    v_lshl_add_u32 v24, v20, 10, v24
    v_bfe_u32 v20, v21, 5, 1
    v_lshl_add_u32 v24, v20, 11, v24
    v_add_u32 v25, 0, v23
    v_xor_b32 v25, v25, v22
    v_lshl_add_u32 v184, v25, 4, v24
    v_add_u32 v185, 69632, v184
    v_add_u32 v25, 2, v23
    v_xor_b32 v25, v25, v22
    v_lshl_add_u32 v186, v25, 4, v24
    v_add_u32 v187, 69632, v186
    s_lshl_b32 s31, s16, 3
    v_and_b32 v191, 1, v0
    v_lshlrev_b32 v191, 2, v191
    v_bfe_u32 v25, v0, 1, 1
    v_lshl_add_u32 v191, v25, 8, v191
    v_bfe_u32 v25, v0, 2, 2
    v_min_u32 v25, 2, v25
    v_lshl_add_u32 v191, v25, 10, v191
    v_add_u32 v191, s31, v191
    v_and_b32 v190, 15, v21
    v_lshlrev_b32 v190, 2, v190
    s_load_dwordx8 s[36:43], s[0:1], 16
    s_lshl_b32 s31, s16, 8
    s_and_b32 s32, s17, 1
    s_lshr_b32 s33, s17, 1
    s_mul_i32 s27, s32, 262144
    s_mul_i32 s30, s33, 65536
    s_add_u32 s27, s27, s30
    s_add_u32 s27, s27, s31
    s_mul_i32 s34, s32, 16384
    s_mul_i32 s30, s33, 2359296
    s_add_u32 s34, s34, s30
    s_add_u32 s34, s34, s31
    s_mul_i32 s32, s16, 147456
    s_mul_i32 s33, s17, 288
    s_add_u32 s32, s32, s33
    s_waitcnt lgkmcnt(0)
    s_mov_b32 s48, s36
    s_and_b32 s49, s37, 0xffff
    s_mov_b32 s50, 4718592
    s_mov_b32 s51, 0x00020000
    s_mov_b32 s52, s38
    s_and_b32 s53, s39, 0xffff
    s_mov_b32 s54, 4718592
    s_mov_b32 s55, 0x00020000
    s_mov_b32 s56, s40
    s_and_b32 s57, s41, 0xffff
    s_mov_b32 s58, 4718592
    s_mov_b32 s59, 0x00020000
    s_mov_b32 s60, s42
    s_and_b32 s61, s43, 0xffff
    s_mov_b32 s62, 4718592
    s_mov_b32 s63, 0x00020000
    s_cmp_eq_u32 s26, 1
    s_cbranch_scc1 L_r_ld1
    s_cmp_eq_u32 s26, 2
    s_cbranch_scc1 L_r_ld2
    s_add_u32 m0, s64, 0
    s_add_u32 s33, s27, 0
    buffer_load_dwordx4 v68, s[48:51], s33 offen lds
    s_add_u32 m0, s64, 1024
    s_add_u32 s33, s27, 8192
    buffer_load_dwordx4 v188, s[48:51], s33 offen lds
    s_add_u32 m0, s64, 2048
    s_add_u32 s33, s27, 32768
    buffer_load_dwordx4 v68, s[48:51], s33 offen lds
    s_add_u32 m0, s64, 3072
    s_add_u32 s33, s27, 40960
    buffer_load_dwordx4 v188, s[48:51], s33 offen lds
    s_add_u32 m0, s64, 4096
    s_add_u32 s33, s27, 524288
    buffer_load_dwordx4 v68, s[48:51], s33 offen lds
    s_add_u32 m0, s64, 5120
    s_add_u32 s33, s27, 532480
    buffer_load_dwordx4 v188, s[48:51], s33 offen lds
    s_add_u32 m0, s64, 6144
    s_add_u32 s33, s27, 557056
    buffer_load_dwordx4 v68, s[48:51], s33 offen lds
    s_add_u32 m0, s64, 7168
    s_add_u32 s33, s27, 565248
    buffer_load_dwordx4 v188, s[48:51], s33 offen lds
    s_add_u32 m0, s64, 8192
    s_add_u32 s33, s27, 1179648
    buffer_load_dwordx4 v68, s[48:51], s33 offen lds
    s_add_u32 m0, s64, 9216
    s_add_u32 s33, s27, 1187840
    buffer_load_dwordx4 v188, s[48:51], s33 offen lds
    s_add_u32 m0, s64, 10240
    s_add_u32 s33, s27, 1212416
    buffer_load_dwordx4 v68, s[48:51], s33 offen lds
    s_add_u32 m0, s64, 11264
    s_add_u32 s33, s27, 1220608
    buffer_load_dwordx4 v188, s[48:51], s33 offen lds
    s_add_u32 m0, s64, 12288
    s_add_u32 s33, s27, 1703936
    buffer_load_dwordx4 v68, s[48:51], s33 offen lds
    s_add_u32 m0, s64, 13312
    s_add_u32 s33, s27, 1712128
    buffer_load_dwordx4 v188, s[48:51], s33 offen lds
    s_add_u32 m0, s64, 14336
    s_add_u32 s33, s27, 1736704
    buffer_load_dwordx4 v68, s[48:51], s33 offen lds
    s_add_u32 m0, s64, 15360
    s_add_u32 s33, s27, 1744896
    buffer_load_dwordx4 v188, s[48:51], s33 offen lds
    s_add_u32 m0, s64, 16384
    s_add_u32 s33, s27, 2359296
    buffer_load_dwordx4 v68, s[48:51], s33 offen lds
    s_add_u32 m0, s64, 17408
    s_add_u32 s33, s27, 2367488
    buffer_load_dwordx4 v188, s[48:51], s33 offen lds
    s_add_u32 m0, s64, 18432
    s_add_u32 s33, s27, 2392064
    buffer_load_dwordx4 v68, s[48:51], s33 offen lds
    s_add_u32 m0, s64, 19456
    s_add_u32 s33, s27, 2400256
    buffer_load_dwordx4 v188, s[48:51], s33 offen lds
    s_add_u32 m0, s64, 20480
    s_add_u32 s33, s27, 2883584
    buffer_load_dwordx4 v68, s[48:51], s33 offen lds
    s_add_u32 m0, s64, 21504
    s_add_u32 s33, s27, 2891776
    buffer_load_dwordx4 v188, s[48:51], s33 offen lds
    s_add_u32 m0, s64, 22528
    s_add_u32 s33, s27, 2916352
    buffer_load_dwordx4 v68, s[48:51], s33 offen lds
    s_add_u32 m0, s64, 23552
    s_add_u32 s33, s27, 2924544
    buffer_load_dwordx4 v188, s[48:51], s33 offen lds
    s_add_u32 m0, s64, 24576
    s_add_u32 s33, s27, 3538944
    buffer_load_dwordx4 v68, s[48:51], s33 offen lds
    s_add_u32 m0, s64, 25600
    s_add_u32 s33, s27, 3547136
    buffer_load_dwordx4 v188, s[48:51], s33 offen lds
    s_add_u32 m0, s64, 26624
    s_add_u32 s33, s27, 3571712
    buffer_load_dwordx4 v68, s[48:51], s33 offen lds
    s_add_u32 m0, s64, 27648
    s_add_u32 s33, s27, 3579904
    buffer_load_dwordx4 v188, s[48:51], s33 offen lds
    s_add_u32 m0, s64, 28672
    s_add_u32 s33, s27, 4063232
    buffer_load_dwordx4 v68, s[48:51], s33 offen lds
    s_add_u32 m0, s64, 29696
    s_add_u32 s33, s27, 4071424
    buffer_load_dwordx4 v188, s[48:51], s33 offen lds
    s_add_u32 m0, s64, 30720
    s_add_u32 s33, s27, 4096000
    buffer_load_dwordx4 v68, s[48:51], s33 offen lds
    s_add_u32 m0, s64, 31744
    s_add_u32 s33, s27, 4104192
    buffer_load_dwordx4 v188, s[48:51], s33 offen lds
    s_waitcnt vmcnt(28)
    s_barrier
    ds_read_b64_tr_b16 a[0:1], v184 offset:0
    ds_read_b64_tr_b16 a[2:3], v184 offset:34816
    ds_read_b64_tr_b16 a[4:5], v185 offset:0
    ds_read_b64_tr_b16 a[6:7], v185 offset:34816
    ds_read_b64_tr_b16 a[8:9], v186 offset:0
    ds_read_b64_tr_b16 a[10:11], v186 offset:34816
    ds_read_b64_tr_b16 a[12:13], v187 offset:0
    ds_read_b64_tr_b16 a[14:15], v187 offset:34816
    s_waitcnt lgkmcnt(0)
    s_waitcnt vmcnt(24)
    s_barrier
    s_add_u32 m0, s64, 0
    s_add_u32 s33, s34, 0
    buffer_load_dwordx4 v69, s[48:51], s33 offen lds
    s_add_u32 m0, s64, 1024
    s_add_u32 s33, s34, 32768
    buffer_load_dwordx4 v189, s[48:51], s33 offen lds
    s_add_u32 m0, s64, 2048
    s_add_u32 s33, s34, 1179648
    buffer_load_dwordx4 v69, s[48:51], s33 offen lds
    s_add_u32 m0, s64, 3072
    s_add_u32 s33, s34, 1212416
    buffer_load_dwordx4 v189, s[48:51], s33 offen lds
    ds_read_b64_tr_b16 a[16:17], v184 offset:4096
    ds_read_b64_tr_b16 a[18:19], v184 offset:38912
    ds_read_b64_tr_b16 a[20:21], v185 offset:4096
    ds_read_b64_tr_b16 a[22:23], v185 offset:38912
    ds_read_b64_tr_b16 a[24:25], v186 offset:4096
    ds_read_b64_tr_b16 a[26:27], v186 offset:38912
    ds_read_b64_tr_b16 a[28:29], v187 offset:4096
    ds_read_b64_tr_b16 a[30:31], v187 offset:38912
    s_waitcnt lgkmcnt(0)
    s_waitcnt vmcnt(24)
    s_barrier
    s_add_u32 m0, s64, 4096
    s_add_u32 s33, s27, 0
    buffer_load_dwordx4 v68, s[56:59], s33 offen lds
    s_add_u32 m0, s64, 5120
    s_add_u32 s33, s27, 8192
    buffer_load_dwordx4 v188, s[56:59], s33 offen lds
    s_add_u32 m0, s64, 6144
    s_add_u32 s33, s27, 32768
    buffer_load_dwordx4 v68, s[56:59], s33 offen lds
    s_add_u32 m0, s64, 7168
    s_add_u32 s33, s27, 40960
    buffer_load_dwordx4 v188, s[56:59], s33 offen lds
    ds_read_b64_tr_b16 a[32:33], v184 offset:8192
    ds_read_b64_tr_b16 a[34:35], v184 offset:43008
    ds_read_b64_tr_b16 a[36:37], v185 offset:8192
    ds_read_b64_tr_b16 a[38:39], v185 offset:43008
    ds_read_b64_tr_b16 a[40:41], v186 offset:8192
    ds_read_b64_tr_b16 a[42:43], v186 offset:43008
    ds_read_b64_tr_b16 a[44:45], v187 offset:8192
    ds_read_b64_tr_b16 a[46:47], v187 offset:43008
    s_waitcnt lgkmcnt(0)
    s_waitcnt vmcnt(24)
    s_barrier
    s_add_u32 m0, s64, 8192
    s_add_u32 s33, s27, 524288
    buffer_load_dwordx4 v68, s[56:59], s33 offen lds
    s_add_u32 m0, s64, 9216
    s_add_u32 s33, s27, 532480
    buffer_load_dwordx4 v188, s[56:59], s33 offen lds
    s_add_u32 m0, s64, 10240
    s_add_u32 s33, s27, 557056
    buffer_load_dwordx4 v68, s[56:59], s33 offen lds
    s_add_u32 m0, s64, 11264
    s_add_u32 s33, s27, 565248
    buffer_load_dwordx4 v188, s[56:59], s33 offen lds
    ds_read_b64_tr_b16 a[48:49], v184 offset:12288
    ds_read_b64_tr_b16 a[50:51], v184 offset:47104
    ds_read_b64_tr_b16 a[52:53], v185 offset:12288
    ds_read_b64_tr_b16 a[54:55], v185 offset:47104
    ds_read_b64_tr_b16 a[56:57], v186 offset:12288
    ds_read_b64_tr_b16 a[58:59], v186 offset:47104
    ds_read_b64_tr_b16 a[60:61], v187 offset:12288
    ds_read_b64_tr_b16 a[62:63], v187 offset:47104
    s_waitcnt lgkmcnt(0)
    s_waitcnt vmcnt(24)
    s_barrier
    s_add_u32 m0, s64, 12288
    s_add_u32 s33, s27, 1179648
    buffer_load_dwordx4 v68, s[56:59], s33 offen lds
    s_add_u32 m0, s64, 13312
    s_add_u32 s33, s27, 1187840
    buffer_load_dwordx4 v188, s[56:59], s33 offen lds
    s_add_u32 m0, s64, 14336
    s_add_u32 s33, s27, 1212416
    buffer_load_dwordx4 v68, s[56:59], s33 offen lds
    s_add_u32 m0, s64, 15360
    s_add_u32 s33, s27, 1220608
    buffer_load_dwordx4 v188, s[56:59], s33 offen lds
    ds_read_b64_tr_b16 a[64:65], v184 offset:16384
    ds_read_b64_tr_b16 a[66:67], v184 offset:51200
    ds_read_b64_tr_b16 a[68:69], v185 offset:16384
    ds_read_b64_tr_b16 a[70:71], v185 offset:51200
    ds_read_b64_tr_b16 a[72:73], v186 offset:16384
    ds_read_b64_tr_b16 a[74:75], v186 offset:51200
    ds_read_b64_tr_b16 a[76:77], v187 offset:16384
    ds_read_b64_tr_b16 a[78:79], v187 offset:51200
    s_waitcnt lgkmcnt(0)
    s_waitcnt vmcnt(24)
    s_barrier
    s_add_u32 m0, s64, 16384
    s_add_u32 s33, s27, 1703936
    buffer_load_dwordx4 v68, s[56:59], s33 offen lds
    s_add_u32 m0, s64, 17408
    s_add_u32 s33, s27, 1712128
    buffer_load_dwordx4 v188, s[56:59], s33 offen lds
    s_add_u32 m0, s64, 18432
    s_add_u32 s33, s27, 1736704
    buffer_load_dwordx4 v68, s[56:59], s33 offen lds
    s_add_u32 m0, s64, 19456
    s_add_u32 s33, s27, 1744896
    buffer_load_dwordx4 v188, s[56:59], s33 offen lds
    ds_read_b64_tr_b16 a[80:81], v184 offset:20480
    ds_read_b64_tr_b16 a[82:83], v184 offset:55296
    ds_read_b64_tr_b16 a[84:85], v185 offset:20480
    ds_read_b64_tr_b16 a[86:87], v185 offset:55296
    ds_read_b64_tr_b16 a[88:89], v186 offset:20480
    ds_read_b64_tr_b16 a[90:91], v186 offset:55296
    ds_read_b64_tr_b16 a[92:93], v187 offset:20480
    ds_read_b64_tr_b16 a[94:95], v187 offset:55296
    s_waitcnt lgkmcnt(0)
    s_waitcnt vmcnt(24)
    s_barrier
    s_add_u32 m0, s64, 20480
    s_add_u32 s33, s27, 2359296
    buffer_load_dwordx4 v68, s[56:59], s33 offen lds
    s_add_u32 m0, s64, 21504
    s_add_u32 s33, s27, 2367488
    buffer_load_dwordx4 v188, s[56:59], s33 offen lds
    s_add_u32 m0, s64, 22528
    s_add_u32 s33, s27, 2392064
    buffer_load_dwordx4 v68, s[56:59], s33 offen lds
    s_add_u32 m0, s64, 23552
    s_add_u32 s33, s27, 2400256
    buffer_load_dwordx4 v188, s[56:59], s33 offen lds
    ds_read_b64_tr_b16 a[96:97], v184 offset:24576
    ds_read_b64_tr_b16 a[98:99], v184 offset:59392
    ds_read_b64_tr_b16 a[100:101], v185 offset:24576
    ds_read_b64_tr_b16 a[102:103], v185 offset:59392
    ds_read_b64_tr_b16 a[104:105], v186 offset:24576
    ds_read_b64_tr_b16 a[106:107], v186 offset:59392
    ds_read_b64_tr_b16 a[108:109], v187 offset:24576
    ds_read_b64_tr_b16 a[110:111], v187 offset:59392
    s_waitcnt lgkmcnt(0)
    s_waitcnt vmcnt(24)
    s_barrier
    s_add_u32 m0, s64, 24576
    s_add_u32 s33, s27, 2883584
    buffer_load_dwordx4 v68, s[56:59], s33 offen lds
    s_add_u32 m0, s64, 25600
    s_add_u32 s33, s27, 2891776
    buffer_load_dwordx4 v188, s[56:59], s33 offen lds
    s_add_u32 m0, s64, 26624
    s_add_u32 s33, s27, 2916352
    buffer_load_dwordx4 v68, s[56:59], s33 offen lds
    s_add_u32 m0, s64, 27648
    s_add_u32 s33, s27, 2924544
    buffer_load_dwordx4 v188, s[56:59], s33 offen lds
    ds_read_b64_tr_b16 a[112:113], v184 offset:28672
    ds_read_b64_tr_b16 a[114:115], v184 offset:63488
    ds_read_b64_tr_b16 a[116:117], v185 offset:28672
    ds_read_b64_tr_b16 a[118:119], v185 offset:63488
    ds_read_b64_tr_b16 a[120:121], v186 offset:28672
    ds_read_b64_tr_b16 a[122:123], v186 offset:63488
    ds_read_b64_tr_b16 a[124:125], v187 offset:28672
    ds_read_b64_tr_b16 a[126:127], v187 offset:63488
    s_waitcnt lgkmcnt(0)
    s_waitcnt vmcnt(24)
    s_barrier
    s_add_u32 m0, s64, 28672
    s_add_u32 s33, s27, 3538944
    buffer_load_dwordx4 v68, s[56:59], s33 offen lds
    s_add_u32 m0, s64, 29696
    s_add_u32 s33, s27, 3547136
    buffer_load_dwordx4 v188, s[56:59], s33 offen lds
    s_add_u32 m0, s64, 30720
    s_add_u32 s33, s27, 3571712
    buffer_load_dwordx4 v68, s[56:59], s33 offen lds
    s_add_u32 m0, s64, 31744
    s_add_u32 s33, s27, 3579904
    buffer_load_dwordx4 v188, s[56:59], s33 offen lds
    ds_read_b64_tr_b16 a[128:129], v184 offset:0
    ds_read_b64_tr_b16 a[130:131], v184 offset:34816
    ds_read_b64_tr_b16 a[132:133], v185 offset:0
    ds_read_b64_tr_b16 a[134:135], v185 offset:34816
    ds_read_b64_tr_b16 a[136:137], v186 offset:0
    ds_read_b64_tr_b16 a[138:139], v186 offset:34816
    ds_read_b64_tr_b16 a[140:141], v187 offset:0
    ds_read_b64_tr_b16 a[142:143], v187 offset:34816
    s_waitcnt lgkmcnt(0)
    s_waitcnt vmcnt(24)
    s_barrier
    s_add_u32 m0, s64, 0
    s_add_u32 s33, s27, 4063232
    buffer_load_dwordx4 v68, s[56:59], s33 offen lds
    s_add_u32 m0, s64, 1024
    s_add_u32 s33, s27, 4071424
    buffer_load_dwordx4 v188, s[56:59], s33 offen lds
    s_add_u32 m0, s64, 2048
    s_add_u32 s33, s27, 4096000
    buffer_load_dwordx4 v68, s[56:59], s33 offen lds
    s_add_u32 m0, s64, 3072
    s_add_u32 s33, s27, 4104192
    buffer_load_dwordx4 v188, s[56:59], s33 offen lds
    ds_read_b64_tr_b16 a[216:217], v184 offset:4096
    ds_read_b64_tr_b16 a[218:219], v184 offset:38912
    ds_read_b64_tr_b16 a[220:221], v185 offset:4096
    ds_read_b64_tr_b16 a[222:223], v185 offset:38912
    ds_read_b64_tr_b16 a[224:225], v186 offset:4096
    ds_read_b64_tr_b16 a[226:227], v186 offset:38912
    ds_read_b64_tr_b16 a[228:229], v187 offset:4096
    ds_read_b64_tr_b16 a[230:231], v187 offset:38912
    s_waitcnt lgkmcnt(0)
    s_waitcnt vmcnt(24)
    s_barrier
    s_add_u32 m0, s64, 4096
    s_add_u32 s33, s34, 0
    buffer_load_dwordx4 v69, s[56:59], s33 offen lds
    s_add_u32 m0, s64, 5120
    s_add_u32 s33, s34, 32768
    buffer_load_dwordx4 v189, s[56:59], s33 offen lds
    s_add_u32 m0, s64, 6144
    s_add_u32 s33, s34, 1179648
    buffer_load_dwordx4 v69, s[56:59], s33 offen lds
    s_add_u32 m0, s64, 7168
    s_add_u32 s33, s34, 1212416
    buffer_load_dwordx4 v189, s[56:59], s33 offen lds
    s_mov_b32 s30, 160
    buffer_load_dword v190, v190, s[12:15], s30 offen sc1
    ds_read_b64_tr_b16 a[232:233], v184 offset:8192
    ds_read_b64_tr_b16 a[234:235], v184 offset:43008
    ds_read_b64_tr_b16 a[236:237], v185 offset:8192
    ds_read_b64_tr_b16 a[238:239], v185 offset:43008
    ds_read_b64_tr_b16 a[240:241], v186 offset:8192
    ds_read_b64_tr_b16 a[242:243], v186 offset:43008
    ds_read_b64_tr_b16 a[244:245], v187 offset:8192
    ds_read_b64_tr_b16 a[246:247], v187 offset:43008
    s_waitcnt lgkmcnt(0)
    s_waitcnt vmcnt(25)
    s_barrier
    s_add_u32 m0, s64, 8192
    s_add_u32 s33, s32, 0
    buffer_load_dwordx4 v70, s[60:63], s33 offen lds
    s_add_u32 m0, s64, 9216
    s_add_u32 s33, s32, 2304
    buffer_load_dwordx4 v70, s[60:63], s33 offen lds
    s_add_u32 m0, s64, 10240
    s_add_u32 s33, s32, 36864
    buffer_load_dwordx4 v70, s[60:63], s33 offen lds
    s_add_u32 m0, s64, 11264
    s_add_u32 s33, s32, 39168
    buffer_load_dwordx4 v70, s[60:63], s33 offen lds
    ds_read_b64_tr_b16 a[248:249], v184 offset:12288
    ds_read_b64_tr_b16 a[250:251], v184 offset:47104
    ds_read_b64_tr_b16 a[252:253], v185 offset:12288
    ds_read_b64_tr_b16 a[254:255], v185 offset:47104
    ds_read_b64_tr_b16 v[72:73], v186 offset:12288
    ds_read_b64_tr_b16 v[74:75], v186 offset:47104
    ds_read_b64_tr_b16 v[76:77], v187 offset:12288
    ds_read_b64_tr_b16 v[78:79], v187 offset:47104
    s_waitcnt lgkmcnt(0)
    s_waitcnt vmcnt(25)
    s_barrier
    s_add_u32 m0, s64, 12288
    s_add_u32 s33, s32, 64
    buffer_load_dwordx4 v70, s[60:63], s33 offen lds
    s_add_u32 m0, s64, 13312
    s_add_u32 s33, s32, 2368
    buffer_load_dwordx4 v70, s[60:63], s33 offen lds
    s_add_u32 m0, s64, 14336
    s_add_u32 s33, s32, 36928
    buffer_load_dwordx4 v70, s[60:63], s33 offen lds
    s_add_u32 m0, s64, 15360
    s_add_u32 s33, s32, 39232
    buffer_load_dwordx4 v70, s[60:63], s33 offen lds
    ds_read_b64_tr_b16 v[80:81], v184 offset:16384
    ds_read_b64_tr_b16 v[82:83], v184 offset:51200
    ds_read_b64_tr_b16 v[84:85], v185 offset:16384
    ds_read_b64_tr_b16 v[86:87], v185 offset:51200
    ds_read_b64_tr_b16 v[88:89], v186 offset:16384
    ds_read_b64_tr_b16 v[90:91], v186 offset:51200
    ds_read_b64_tr_b16 v[92:93], v187 offset:16384
    ds_read_b64_tr_b16 v[94:95], v187 offset:51200
    s_waitcnt lgkmcnt(0)
    s_waitcnt vmcnt(25)
    s_barrier
    s_add_u32 m0, s64, 16384
    s_add_u32 s33, s32, 128
    buffer_load_dwordx4 v70, s[60:63], s33 offen lds
    s_add_u32 m0, s64, 17408
    s_add_u32 s33, s32, 2432
    buffer_load_dwordx4 v70, s[60:63], s33 offen lds
    s_add_u32 m0, s64, 18432
    s_add_u32 s33, s32, 36992
    buffer_load_dwordx4 v70, s[60:63], s33 offen lds
    s_add_u32 m0, s64, 19456
    s_add_u32 s33, s32, 39296
    buffer_load_dwordx4 v70, s[60:63], s33 offen lds
    ds_read_b64_tr_b16 v[96:97], v184 offset:20480
    ds_read_b64_tr_b16 v[98:99], v184 offset:55296
    ds_read_b64_tr_b16 v[100:101], v185 offset:20480
    ds_read_b64_tr_b16 v[102:103], v185 offset:55296
    ds_read_b64_tr_b16 v[104:105], v186 offset:20480
    ds_read_b64_tr_b16 v[106:107], v186 offset:55296
    ds_read_b64_tr_b16 v[108:109], v187 offset:20480
    ds_read_b64_tr_b16 v[110:111], v187 offset:55296
    s_waitcnt lgkmcnt(0)
    s_waitcnt vmcnt(25)
    s_barrier
    s_add_u32 m0, s64, 20480
    s_add_u32 s33, s32, 192
    buffer_load_dwordx4 v70, s[60:63], s33 offen lds
    s_add_u32 m0, s64, 21504
    s_add_u32 s33, s32, 2496
    buffer_load_dwordx4 v70, s[60:63], s33 offen lds
    s_add_u32 m0, s64, 22528
    s_add_u32 s33, s32, 37056
    buffer_load_dwordx4 v70, s[60:63], s33 offen lds
    s_add_u32 m0, s64, 23552
    s_add_u32 s33, s32, 39360
    buffer_load_dwordx4 v70, s[60:63], s33 offen lds
    ds_read_b64_tr_b16 v[112:113], v184 offset:24576
    ds_read_b64_tr_b16 v[114:115], v184 offset:59392
    ds_read_b64_tr_b16 v[116:117], v185 offset:24576
    ds_read_b64_tr_b16 v[118:119], v185 offset:59392
    ds_read_b64_tr_b16 v[120:121], v186 offset:24576
    ds_read_b64_tr_b16 v[122:123], v186 offset:59392
    ds_read_b64_tr_b16 v[124:125], v187 offset:24576
    ds_read_b64_tr_b16 v[126:127], v187 offset:59392
    s_waitcnt lgkmcnt(0)
    s_waitcnt vmcnt(25)
    s_barrier
    s_add_u32 m0, s64, 24576
    s_add_u32 s33, s32, 256
    buffer_load_dwordx4 v70, s[60:63], s33 offen lds
    s_add_u32 m0, s64, 25600
    s_add_u32 s33, s32, 2560
    buffer_load_dwordx4 v70, s[60:63], s33 offen lds
    s_add_u32 m0, s64, 26624
    s_add_u32 s33, s32, 37120
    buffer_load_dwordx4 v70, s[60:63], s33 offen lds
    s_add_u32 m0, s64, 27648
    s_add_u32 s33, s32, 39424
    buffer_load_dwordx4 v70, s[60:63], s33 offen lds
    ds_read_b64_tr_b16 v[128:129], v184 offset:28672
    ds_read_b64_tr_b16 v[130:131], v184 offset:63488
    ds_read_b64_tr_b16 v[132:133], v185 offset:28672
    ds_read_b64_tr_b16 v[134:135], v185 offset:63488
    ds_read_b64_tr_b16 v[136:137], v186 offset:28672
    ds_read_b64_tr_b16 v[138:139], v186 offset:63488
    ds_read_b64_tr_b16 v[140:141], v187 offset:28672
    ds_read_b64_tr_b16 v[142:143], v187 offset:63488
    s_waitcnt lgkmcnt(0)
    s_waitcnt vmcnt(25)
    s_barrier
    s_add_u32 m0, s64, 28672
    s_add_u32 s33, s27, 0
    buffer_load_dwordx4 v68, s[52:55], s33 offen lds
    s_add_u32 m0, s64, 29696
    s_add_u32 s33, s27, 8192
    buffer_load_dwordx4 v188, s[52:55], s33 offen lds
    s_add_u32 m0, s64, 30720
    s_add_u32 s33, s27, 32768
    buffer_load_dwordx4 v68, s[52:55], s33 offen lds
    s_add_u32 m0, s64, 31744
    s_add_u32 s33, s27, 40960
    buffer_load_dwordx4 v188, s[52:55], s33 offen lds
    ds_read_b64_tr_b16 v[144:145], v184 offset:0
    ds_read_b64_tr_b16 v[146:147], v184 offset:34816
    ds_read_b64_tr_b16 v[148:149], v185 offset:0
    ds_read_b64_tr_b16 v[150:151], v185 offset:34816
    ds_read_b64_tr_b16 v[152:153], v186 offset:0
    ds_read_b64_tr_b16 v[154:155], v186 offset:34816
    ds_read_b64_tr_b16 v[156:157], v187 offset:0
    ds_read_b64_tr_b16 v[158:159], v187 offset:34816
    s_waitcnt lgkmcnt(0)
    s_waitcnt vmcnt(25)
    s_barrier
    s_add_u32 m0, s64, 0
    s_add_u32 s33, s27, 524288
    buffer_load_dwordx4 v68, s[52:55], s33 offen lds
    s_add_u32 m0, s64, 1024
    s_add_u32 s33, s27, 532480
    buffer_load_dwordx4 v188, s[52:55], s33 offen lds
    s_add_u32 m0, s64, 2048
    s_add_u32 s33, s27, 557056
    buffer_load_dwordx4 v68, s[52:55], s33 offen lds
    s_add_u32 m0, s64, 3072
    s_add_u32 s33, s27, 565248
    buffer_load_dwordx4 v188, s[52:55], s33 offen lds
    ds_read_b64_tr_b16 v[160:161], v184 offset:4096
    ds_read_b64_tr_b16 v[162:163], v184 offset:38912
    ds_read_b64_tr_b16 v[164:165], v185 offset:4096
    ds_read_b64_tr_b16 v[166:167], v185 offset:38912
    ds_read_b64_tr_b16 v[168:169], v186 offset:4096
    ds_read_b64_tr_b16 v[170:171], v186 offset:38912
    ds_read_b64_tr_b16 v[172:173], v187 offset:4096
    ds_read_b64_tr_b16 v[174:175], v187 offset:38912
    s_waitcnt lgkmcnt(0)
    s_waitcnt vmcnt(24)
    s_barrier
    s_add_u32 m0, s64, 4096
    s_add_u32 s33, s27, 1179648
    buffer_load_dwordx4 v68, s[52:55], s33 offen lds
    s_add_u32 m0, s64, 5120
    s_add_u32 s33, s27, 1187840
    buffer_load_dwordx4 v188, s[52:55], s33 offen lds
    s_add_u32 m0, s64, 6144
    s_add_u32 s33, s27, 1212416
    buffer_load_dwordx4 v68, s[52:55], s33 offen lds
    s_add_u32 m0, s64, 7168
    s_add_u32 s33, s27, 1220608
    buffer_load_dwordx4 v188, s[52:55], s33 offen lds
    ds_read_b64_tr_b16 v[176:177], v71 offset:8192
    ds_read_b64_tr_b16 v[178:179], v71 offset:9216
    ds_read_b64_tr_b16 v[180:181], v71 offset:10240
    ds_read_b64_tr_b16 v[182:183], v71 offset:11264
    ds_read_b64_tr_b16 v[192:193], v71 offset:8224
    ds_read_b64_tr_b16 v[194:195], v71 offset:9248
    ds_read_b64_tr_b16 v[196:197], v71 offset:10272
    ds_read_b64_tr_b16 v[198:199], v71 offset:11296
    s_waitcnt lgkmcnt(0)
    s_waitcnt vmcnt(24)
    s_barrier
    s_add_u32 m0, s64, 8192
    s_add_u32 s33, s27, 1703936
    buffer_load_dwordx4 v68, s[52:55], s33 offen lds
    s_add_u32 m0, s64, 9216
    s_add_u32 s33, s27, 1712128
    buffer_load_dwordx4 v188, s[52:55], s33 offen lds
    s_add_u32 m0, s64, 10240
    s_add_u32 s33, s27, 1736704
    buffer_load_dwordx4 v68, s[52:55], s33 offen lds
    s_add_u32 m0, s64, 11264
    s_add_u32 s33, s27, 1744896
    buffer_load_dwordx4 v188, s[52:55], s33 offen lds
    ds_read_b64_tr_b16 v[200:201], v71 offset:12288
    ds_read_b64_tr_b16 v[202:203], v71 offset:13312
    ds_read_b64_tr_b16 v[204:205], v71 offset:14336
    ds_read_b64_tr_b16 v[206:207], v71 offset:15360
    ds_read_b64_tr_b16 v[208:209], v71 offset:12320
    ds_read_b64_tr_b16 v[210:211], v71 offset:13344
    ds_read_b64_tr_b16 v[212:213], v71 offset:14368
    ds_read_b64_tr_b16 v[214:215], v71 offset:15392
    s_waitcnt lgkmcnt(0)
    s_waitcnt vmcnt(24)
    s_barrier
    s_add_u32 m0, s64, 12288
    s_add_u32 s33, s27, 2359296
    buffer_load_dwordx4 v68, s[52:55], s33 offen lds
    s_add_u32 m0, s64, 13312
    s_add_u32 s33, s27, 2367488
    buffer_load_dwordx4 v188, s[52:55], s33 offen lds
    s_add_u32 m0, s64, 14336
    s_add_u32 s33, s27, 2392064
    buffer_load_dwordx4 v68, s[52:55], s33 offen lds
    s_add_u32 m0, s64, 15360
    s_add_u32 s33, s27, 2400256
    buffer_load_dwordx4 v188, s[52:55], s33 offen lds
    v_readlane_b32 s30, v190, 0
    s_nop 0
    s_cmp_eq_u32 s30, 224
    s_cselect_b32 s18, 1, 0
    s_mov_b32 s29, 0
    s_mov_b32 s19, 0
    v_readlane_b32 s30, v190, 1
    s_nop 0
    s_add_u32 s29, s29, s30
    s_max_u32 s19, s19, s30
    v_readlane_b32 s30, v190, 2
    s_nop 0
    s_add_u32 s29, s29, s30
    s_max_u32 s19, s19, s30
    v_readlane_b32 s30, v190, 3
    s_nop 0
    s_add_u32 s29, s29, s30
    s_max_u32 s19, s19, s30
    v_readlane_b32 s30, v190, 4
    s_nop 0
    s_add_u32 s29, s29, s30
    s_max_u32 s19, s19, s30
    v_readlane_b32 s30, v190, 5
    s_nop 0
    s_add_u32 s29, s29, s30
    s_max_u32 s19, s19, s30
    v_readlane_b32 s30, v190, 6
    s_nop 0
    s_add_u32 s29, s29, s30
    s_max_u32 s19, s19, s30
    v_readlane_b32 s30, v190, 7
    s_nop 0
    s_add_u32 s29, s29, s30
    s_max_u32 s19, s19, s30
    v_readlane_b32 s30, v190, 8
    s_nop 0
    s_add_u32 s29, s29, s30
    s_max_u32 s19, s19, s30
    s_cmp_eq_u32 s29, 32
    s_cselect_b32 s18, s18, 0
    ds_read_b64_tr_b16 v[216:217], v71 offset:16384
    ds_read_b64_tr_b16 v[218:219], v71 offset:17408
    ds_read_b64_tr_b16 v[220:221], v71 offset:18432
    ds_read_b64_tr_b16 v[222:223], v71 offset:19456
    ds_read_b64_tr_b16 v[224:225], v71 offset:16416
    ds_read_b64_tr_b16 v[226:227], v71 offset:17440
    ds_read_b64_tr_b16 v[228:229], v71 offset:18464
    ds_read_b64_tr_b16 v[230:231], v71 offset:19488
    s_waitcnt lgkmcnt(0)
    s_waitcnt vmcnt(24)
    s_barrier
    s_add_u32 m0, s64, 16384
    s_add_u32 s33, s27, 2883584
    buffer_load_dwordx4 v68, s[52:55], s33 offen lds
    s_add_u32 m0, s64, 17408
    s_add_u32 s33, s27, 2891776
    buffer_load_dwordx4 v188, s[52:55], s33 offen lds
    s_add_u32 m0, s64, 18432
    s_add_u32 s33, s27, 2916352
    buffer_load_dwordx4 v68, s[52:55], s33 offen lds
    s_add_u32 m0, s64, 19456
    s_add_u32 s33, s27, 2924544
    buffer_load_dwordx4 v188, s[52:55], s33 offen lds
    ds_read_b64_tr_b16 v[232:233], v71 offset:20480
    ds_read_b64_tr_b16 v[234:235], v71 offset:21504
    ds_read_b64_tr_b16 v[236:237], v71 offset:22528
    ds_read_b64_tr_b16 v[238:239], v71 offset:23552
    ds_read_b64_tr_b16 v[240:241], v71 offset:20512
    ds_read_b64_tr_b16 v[242:243], v71 offset:21536
    ds_read_b64_tr_b16 v[244:245], v71 offset:22560
    ds_read_b64_tr_b16 v[246:247], v71 offset:23584
    s_waitcnt lgkmcnt(0)
    s_waitcnt vmcnt(24)
    s_barrier
    s_add_u32 m0, s64, 20480
    s_add_u32 s33, s27, 3538944
    buffer_load_dwordx4 v68, s[52:55], s33 offen lds
    s_add_u32 m0, s64, 21504
    s_add_u32 s33, s27, 3547136
    buffer_load_dwordx4 v188, s[52:55], s33 offen lds
    s_add_u32 m0, s64, 22528
    s_add_u32 s33, s27, 3571712
    buffer_load_dwordx4 v68, s[52:55], s33 offen lds
    s_add_u32 m0, s64, 23552
    s_add_u32 s33, s27, 3579904
    buffer_load_dwordx4 v188, s[52:55], s33 offen lds
    ds_read_b64_tr_b16 v[248:249], v71 offset:24576
    ds_read_b64_tr_b16 v[250:251], v71 offset:25600
    ds_read_b64_tr_b16 v[252:253], v71 offset:26624
    ds_read_b64_tr_b16 v[254:255], v71 offset:27648
    s_waitcnt lgkmcnt(0)
    s_waitcnt vmcnt(24)
    s_barrier
    s_add_u32 m0, s64, 24576
    s_add_u32 s33, s27, 4063232
    buffer_load_dwordx4 v68, s[52:55], s33 offen lds
    s_add_u32 m0, s64, 25600
    s_add_u32 s33, s27, 4071424
    buffer_load_dwordx4 v188, s[52:55], s33 offen lds
    s_add_u32 m0, s64, 26624
    s_add_u32 s33, s27, 4096000
    buffer_load_dwordx4 v68, s[52:55], s33 offen lds
    s_add_u32 m0, s64, 27648
    s_add_u32 s33, s27, 4104192
    buffer_load_dwordx4 v188, s[52:55], s33 offen lds
    ds_read_b64_tr_b16 a[144:145], v184 offset:28672
    ds_read_b64_tr_b16 a[146:147], v184 offset:63488
    ds_read_b64_tr_b16 a[148:149], v185 offset:28672
    ds_read_b64_tr_b16 a[150:151], v185 offset:63488
    ds_read_b64_tr_b16 v[12:13], v186 offset:28672
    ds_read_b64_tr_b16 v[14:15], v186 offset:63488
    ds_read_b64_tr_b16 v[16:17], v187 offset:28672
    ds_read_b64_tr_b16 v[18:19], v187 offset:63488
    s_waitcnt lgkmcnt(0)
    s_waitcnt vmcnt(24)
    s_barrier
    s_add_u32 m0, s64, 28672
    s_add_u32 s33, s34, 0
    buffer_load_dwordx4 v69, s[52:55], s33 offen lds
    s_add_u32 m0, s64, 29696
    s_add_u32 s33, s34, 32768
    buffer_load_dwordx4 v189, s[52:55], s33 offen lds
    s_add_u32 m0, s64, 30720
    s_add_u32 s33, s34, 1179648
    buffer_load_dwordx4 v69, s[52:55], s33 offen lds
    s_add_u32 m0, s64, 31744
    s_add_u32 s33, s34, 1212416
    buffer_load_dwordx4 v189, s[52:55], s33 offen lds
    ds_read_b64_tr_b16 a[152:153], v184 offset:0
    ds_read_b64_tr_b16 a[154:155], v184 offset:34816
    ds_read_b64_tr_b16 a[156:157], v185 offset:0
    ds_read_b64_tr_b16 a[158:159], v185 offset:34816
    ds_read_b64_tr_b16 v[20:21], v186 offset:0
    ds_read_b64_tr_b16 v[22:23], v186 offset:34816
    ds_read_b64_tr_b16 v[24:25], v187 offset:0
    ds_read_b64_tr_b16 v[26:27], v187 offset:34816
    s_waitcnt lgkmcnt(0)
    s_waitcnt vmcnt(24)
    s_barrier
    s_add_u32 m0, s64, 0
    s_add_u32 s33, s32, 73984
    buffer_load_dwordx4 v70, s[60:63], s33 offen lds
    s_add_u32 m0, s64, 1024
    s_add_u32 s33, s32, 76288
    buffer_load_dwordx4 v70, s[60:63], s33 offen lds
    s_add_u32 m0, s64, 2048
    s_add_u32 s33, s32, 110848
    buffer_load_dwordx4 v70, s[60:63], s33 offen lds
    s_add_u32 m0, s64, 3072
    s_add_u32 s33, s32, 113152
    buffer_load_dwordx4 v70, s[60:63], s33 offen lds
    ds_read_b64_tr_b16 a[160:161], v184 offset:4096
    ds_read_b64_tr_b16 a[162:163], v184 offset:38912
    ds_read_b64_tr_b16 a[164:165], v185 offset:4096
    ds_read_b64_tr_b16 a[166:167], v185 offset:38912
    ds_read_b64_tr_b16 v[28:29], v186 offset:4096
    ds_read_b64_tr_b16 v[30:31], v186 offset:38912
    ds_read_b64_tr_b16 v[32:33], v187 offset:4096
    ds_read_b64_tr_b16 v[34:35], v187 offset:38912
    s_waitcnt lgkmcnt(0)
    s_waitcnt vmcnt(24)
    s_barrier
    s_add_u32 m0, s64, 4096
    s_add_u32 s33, s32, 73792
    buffer_load_dwordx4 v70, s[60:63], s33 offen lds
    s_add_u32 m0, s64, 5120
    s_add_u32 s33, s32, 76096
    buffer_load_dwordx4 v70, s[60:63], s33 offen lds
    s_add_u32 m0, s64, 6144
    s_add_u32 s33, s32, 110656
    buffer_load_dwordx4 v70, s[60:63], s33 offen lds
    s_add_u32 m0, s64, 7168
    s_add_u32 s33, s32, 112960
    buffer_load_dwordx4 v70, s[60:63], s33 offen lds
    s_mov_b32 s30, 119668992
    buffer_load_dword v190, v191, s[8:11], s30 offen sc1
    ds_read_b64_tr_b16 a[168:169], v184 offset:8192
    ds_read_b64_tr_b16 a[170:171], v184 offset:43008
    ds_read_b64_tr_b16 a[172:173], v185 offset:8192
    ds_read_b64_tr_b16 a[174:175], v185 offset:43008
    ds_read_b64_tr_b16 v[36:37], v186 offset:8192
    ds_read_b64_tr_b16 v[38:39], v186 offset:43008
    ds_read_b64_tr_b16 v[40:41], v187 offset:8192
    ds_read_b64_tr_b16 v[42:43], v187 offset:43008
    s_waitcnt lgkmcnt(0)
    s_waitcnt vmcnt(25)
    s_barrier
    s_add_u32 m0, s64, 8192
    s_add_u32 s33, s32, 73856
    buffer_load_dwordx4 v70, s[60:63], s33 offen lds
    s_add_u32 m0, s64, 9216
    s_add_u32 s33, s32, 76160
    buffer_load_dwordx4 v70, s[60:63], s33 offen lds
    s_add_u32 m0, s64, 10240
    s_add_u32 s33, s32, 110720
    buffer_load_dwordx4 v70, s[60:63], s33 offen lds
    s_add_u32 m0, s64, 11264
    s_add_u32 s33, s32, 113024
    buffer_load_dwordx4 v70, s[60:63], s33 offen lds
    ds_read_b64_tr_b16 a[176:177], v184 offset:12288
    ds_read_b64_tr_b16 a[178:179], v184 offset:47104
    ds_read_b64_tr_b16 a[180:181], v185 offset:12288
    ds_read_b64_tr_b16 a[182:183], v185 offset:47104
    ds_read_b64_tr_b16 v[44:45], v186 offset:12288
    ds_read_b64_tr_b16 v[46:47], v186 offset:47104
    ds_read_b64_tr_b16 v[48:49], v187 offset:12288
    ds_read_b64_tr_b16 v[50:51], v187 offset:47104
    s_waitcnt lgkmcnt(0)
    s_waitcnt vmcnt(25)
    s_barrier
    s_add_u32 m0, s64, 12288
    s_add_u32 s33, s32, 73920
    buffer_load_dwordx4 v70, s[60:63], s33 offen lds
    s_add_u32 m0, s64, 13312
    s_add_u32 s33, s32, 76224
    buffer_load_dwordx4 v70, s[60:63], s33 offen lds
    s_add_u32 m0, s64, 14336
    s_add_u32 s33, s32, 110784
    buffer_load_dwordx4 v70, s[60:63], s33 offen lds
    s_add_u32 m0, s64, 15360
    s_add_u32 s33, s32, 113088
    buffer_load_dwordx4 v70, s[60:63], s33 offen lds
    ds_write_b128 v10, v[12:15] offset:32768
    ds_write_b128 v10, v[16:19] offset:33792
    ds_read_b64_tr_b16 a[184:185], v184 offset:16384
    ds_read_b64_tr_b16 a[186:187], v184 offset:51200
    ds_read_b64_tr_b16 a[188:189], v185 offset:16384
    ds_read_b64_tr_b16 a[190:191], v185 offset:51200
    ds_read_b64_tr_b16 v[52:53], v186 offset:16384
    ds_read_b64_tr_b16 v[54:55], v186 offset:51200
    ds_read_b64_tr_b16 v[56:57], v187 offset:16384
    ds_read_b64_tr_b16 v[58:59], v187 offset:51200
    s_waitcnt lgkmcnt(0)
    s_waitcnt vmcnt(25)
    s_barrier
    s_add_u32 m0, s64, 16384
    s_add_u32 s33, s32, 73728
    buffer_load_dwordx4 v70, s[60:63], s33 offen lds
    s_add_u32 m0, s64, 17408
    s_add_u32 s33, s32, 76032
    buffer_load_dwordx4 v70, s[60:63], s33 offen lds
    s_add_u32 m0, s64, 18432
    s_add_u32 s33, s32, 110592
    buffer_load_dwordx4 v70, s[60:63], s33 offen lds
    s_add_u32 m0, s64, 19456
    s_add_u32 s33, s32, 112896
    buffer_load_dwordx4 v70, s[60:63], s33 offen lds
    ds_read_b64_tr_b16 a[192:193], v184 offset:20480
    ds_read_b64_tr_b16 a[194:195], v184 offset:55296
    ds_read_b64_tr_b16 a[196:197], v185 offset:20480
    ds_read_b64_tr_b16 a[198:199], v185 offset:55296
    ds_read_b64_tr_b16 v[60:61], v186 offset:20480
    ds_read_b64_tr_b16 v[62:63], v186 offset:55296
    ds_read_b64_tr_b16 v[64:65], v187 offset:20480
    ds_read_b64_tr_b16 v[66:67], v187 offset:55296
    s_waitcnt lgkmcnt(0)
    s_waitcnt vmcnt(25)
    s_barrier
    ds_write_b128 v10, v[36:39] offset:20480
    ds_write_b128 v10, v[40:43] offset:21504
    ds_write_b128 v10, v[60:63] offset:22528
    ds_write_b128 v10, v[64:67] offset:23552
    ds_read_b64_tr_b16 a[200:201], v184 offset:24576
    ds_read_b64_tr_b16 a[202:203], v184 offset:59392
    ds_read_b64_tr_b16 a[204:205], v185 offset:24576
    ds_read_b64_tr_b16 a[206:207], v185 offset:59392
    ds_read_b64_tr_b16 v[12:13], v186 offset:24576
    ds_read_b64_tr_b16 v[14:15], v186 offset:59392
    ds_read_b64_tr_b16 v[16:17], v187 offset:24576
    ds_read_b64_tr_b16 v[18:19], v187 offset:59392
    s_waitcnt lgkmcnt(0)
    s_waitcnt vmcnt(21)
    s_barrier
    ds_write_b128 v10, v[20:23] offset:24576
    ds_write_b128 v10, v[24:27] offset:25600
    ds_write_b128 v10, v[44:47] offset:26624
    ds_write_b128 v10, v[48:51] offset:27648
    ds_read_b64_tr_b16 a[208:209], v184 offset:28672
    ds_read_b64_tr_b16 a[210:211], v184 offset:63488
    ds_read_b64_tr_b16 a[212:213], v185 offset:28672
    ds_read_b64_tr_b16 a[214:215], v185 offset:63488
    ds_read_b64_tr_b16 v[36:37], v186 offset:28672
    ds_read_b64_tr_b16 v[38:39], v186 offset:63488
    ds_read_b64_tr_b16 v[40:41], v187 offset:28672
    ds_read_b64_tr_b16 v[42:43], v187 offset:63488
    s_waitcnt lgkmcnt(0)
    s_waitcnt vmcnt(17)
    s_barrier
    ds_write_b128 v10, v[28:31] offset:30720
    ds_write_b128 v10, v[32:35] offset:31744
    ds_write_b128 v10, v[12:15] offset:28672
    ds_write_b128 v10, v[16:19] offset:29696
    ds_read_b64_tr_b16 v[60:61], v71 offset:0
    ds_read_b64_tr_b16 v[62:63], v71 offset:1024
    ds_read_b64_tr_b16 v[64:65], v71 offset:2048
    ds_read_b64_tr_b16 v[66:67], v71 offset:3072
    s_waitcnt lgkmcnt(0)
    s_waitcnt vmcnt(13)
    s_barrier
    ds_write_b128 v10, v[52:55] offset:0
    ds_write_b128 v10, v[56:59] offset:1024
    ds_write_b128 v10, v[36:39] offset:2048
    ds_write_b128 v10, v[40:43] offset:3072
    ds_read_b64_tr_b16 v[20:21], v71 offset:4096
    ds_read_b64_tr_b16 v[22:23], v71 offset:5120
    ds_read_b64_tr_b16 v[24:25], v71 offset:6144
    ds_read_b64_tr_b16 v[26:27], v71 offset:7168
    ds_read_b64_tr_b16 v[44:45], v71 offset:4128
    ds_read_b64_tr_b16 v[46:47], v71 offset:5152
    ds_read_b64_tr_b16 v[48:49], v71 offset:6176
    ds_read_b64_tr_b16 v[50:51], v71 offset:7200
    s_waitcnt lgkmcnt(0)
    s_waitcnt vmcnt(8)
    s_barrier
    ds_write_b128 v10, v[60:63] offset:4096
    ds_write_b128 v10, v[64:67] offset:5120
    ds_write_b128 v10, v[20:23] offset:6144
    ds_write_b128 v10, v[24:27] offset:7168
    ds_read_b64_tr_b16 v[28:29], v71 offset:8192
    ds_read_b64_tr_b16 v[30:31], v71 offset:9216
    ds_read_b64_tr_b16 v[32:33], v71 offset:10240
    ds_read_b64_tr_b16 v[34:35], v71 offset:11264
    ds_read_b64_tr_b16 v[12:13], v71 offset:8224
    ds_read_b64_tr_b16 v[14:15], v71 offset:9248
    ds_read_b64_tr_b16 v[16:17], v71 offset:10272
    ds_read_b64_tr_b16 v[18:19], v71 offset:11296
    s_waitcnt lgkmcnt(0)
    s_waitcnt vmcnt(4)
    s_barrier
    ds_write_b128 v10, v[44:47] offset:8192
    ds_write_b128 v10, v[48:51] offset:9216
    ds_write_b128 v10, v[28:31] offset:10240
    ds_write_b128 v10, v[32:35] offset:11264
    v_cmp_eq_u32 vcc, 0, v190
    s_nop 0
    s_cmp_eq_u64 vcc, 0
    s_cselect_b32 s30, 3, 1
    s_mul_i32 s18, s18, s30
    ds_read_b64_tr_b16 v[52:53], v71 offset:12288
    ds_read_b64_tr_b16 v[54:55], v71 offset:13312
    ds_read_b64_tr_b16 v[56:57], v71 offset:14336
    ds_read_b64_tr_b16 v[58:59], v71 offset:15360
    ds_read_b64_tr_b16 v[36:37], v71 offset:12320
    ds_read_b64_tr_b16 v[38:39], v71 offset:13344
    ds_read_b64_tr_b16 v[40:41], v71 offset:14368
    ds_read_b64_tr_b16 v[42:43], v71 offset:15392
    s_waitcnt lgkmcnt(0)
    s_waitcnt vmcnt(0)
    s_barrier
    ds_write_b128 v10, v[12:15] offset:12288
    ds_write_b128 v10, v[16:19] offset:13312
    ds_write_b128 v10, v[52:55] offset:14336
    ds_write_b128 v10, v[56:59] offset:15360
    ds_read_b64_tr_b16 v[184:185], v71 offset:16384
    ds_read_b64_tr_b16 v[186:187], v71 offset:17408
    ds_read_b64_tr_b16 v[188:189], v71 offset:18432
    ds_read_b64_tr_b16 v[190:191], v71 offset:19456
    ds_read_b64_tr_b16 v[60:61], v71 offset:16416
    ds_read_b64_tr_b16 v[62:63], v71 offset:17440
    ds_read_b64_tr_b16 v[64:65], v71 offset:18464
    ds_read_b64_tr_b16 v[66:67], v71 offset:19488
    s_waitcnt lgkmcnt(0)
    ds_write_b128 v10, v[36:39] offset:16384
    ds_write_b128 v10, v[40:43] offset:17408
    ds_write_b128 v10, v[60:63] offset:18432
    ds_write_b128 v10, v[64:67] offset:19456
    s_waitcnt lgkmcnt(0)
    s_branch L_r_ldx
L_r_ld1:
    s_add_u32 m0, s64, 0
    s_add_u32 s33, s27, 0
    buffer_load_dwordx4 v68, s[48:51], s33 offen lds
    s_add_u32 m0, s64, 1024
    s_add_u32 s33, s27, 8192
    buffer_load_dwordx4 v188, s[48:51], s33 offen lds
    s_add_u32 m0, s64, 2048
    s_add_u32 s33, s27, 32768
    buffer_load_dwordx4 v68, s[48:51], s33 offen lds
    s_add_u32 m0, s64, 3072
    s_add_u32 s33, s27, 40960
    buffer_load_dwordx4 v188, s[48:51], s33 offen lds
    s_add_u32 m0, s64, 4096
    s_add_u32 s33, s27, 524288
    buffer_load_dwordx4 v68, s[48:51], s33 offen lds
    s_add_u32 m0, s64, 5120
    s_add_u32 s33, s27, 532480
    buffer_load_dwordx4 v188, s[48:51], s33 offen lds
    s_add_u32 m0, s64, 6144
    s_add_u32 s33, s27, 557056
    buffer_load_dwordx4 v68, s[48:51], s33 offen lds
    s_add_u32 m0, s64, 7168
    s_add_u32 s33, s27, 565248
    buffer_load_dwordx4 v188, s[48:51], s33 offen lds
    s_add_u32 m0, s64, 8192
    s_add_u32 s33, s27, 1179648
    buffer_load_dwordx4 v68, s[48:51], s33 offen lds
    s_add_u32 m0, s64, 9216
    s_add_u32 s33, s27, 1187840
    buffer_load_dwordx4 v188, s[48:51], s33 offen lds
    s_add_u32 m0, s64, 10240
    s_add_u32 s33, s27, 1212416
    buffer_load_dwordx4 v68, s[48:51], s33 offen lds
    s_add_u32 m0, s64, 11264
    s_add_u32 s33, s27, 1220608
    buffer_load_dwordx4 v188, s[48:51], s33 offen lds
    s_add_u32 m0, s64, 12288
    s_add_u32 s33, s27, 1703936
    buffer_load_dwordx4 v68, s[48:51], s33 offen lds
    s_add_u32 m0, s64, 13312
    s_add_u32 s33, s27, 1712128
    buffer_load_dwordx4 v188, s[48:51], s33 offen lds
    s_add_u32 m0, s64, 14336
    s_add_u32 s33, s27, 1736704
    buffer_load_dwordx4 v68, s[48:51], s33 offen lds
    s_add_u32 m0, s64, 15360
    s_add_u32 s33, s27, 1744896
    buffer_load_dwordx4 v188, s[48:51], s33 offen lds
    s_add_u32 m0, s64, 16384
    s_add_u32 s33, s27, 2359296
    buffer_load_dwordx4 v68, s[48:51], s33 offen lds
    s_add_u32 m0, s64, 17408
    s_add_u32 s33, s27, 2367488
    buffer_load_dwordx4 v188, s[48:51], s33 offen lds
    s_add_u32 m0, s64, 18432
    s_add_u32 s33, s27, 2392064
    buffer_load_dwordx4 v68, s[48:51], s33 offen lds
    s_add_u32 m0, s64, 19456
    s_add_u32 s33, s27, 2400256
    buffer_load_dwordx4 v188, s[48:51], s33 offen lds
    s_add_u32 m0, s64, 20480
    s_add_u32 s33, s27, 2883584
    buffer_load_dwordx4 v68, s[48:51], s33 offen lds
    s_add_u32 m0, s64, 21504
    s_add_u32 s33, s27, 2891776
    buffer_load_dwordx4 v188, s[48:51], s33 offen lds
    s_add_u32 m0, s64, 22528
    s_add_u32 s33, s27, 2916352
    buffer_load_dwordx4 v68, s[48:51], s33 offen lds
    s_add_u32 m0, s64, 23552
    s_add_u32 s33, s27, 2924544
    buffer_load_dwordx4 v188, s[48:51], s33 offen lds
    s_add_u32 m0, s64, 24576
    s_add_u32 s33, s27, 3538944
    buffer_load_dwordx4 v68, s[48:51], s33 offen lds
    s_add_u32 m0, s64, 25600
    s_add_u32 s33, s27, 3547136
    buffer_load_dwordx4 v188, s[48:51], s33 offen lds
    s_add_u32 m0, s64, 26624
    s_add_u32 s33, s27, 3571712
    buffer_load_dwordx4 v68, s[48:51], s33 offen lds
    s_add_u32 m0, s64, 27648
    s_add_u32 s33, s27, 3579904
    buffer_load_dwordx4 v188, s[48:51], s33 offen lds
    s_add_u32 m0, s64, 28672
    s_add_u32 s33, s27, 4063232
    buffer_load_dwordx4 v68, s[48:51], s33 offen lds
    s_add_u32 m0, s64, 29696
    s_add_u32 s33, s27, 4071424
    buffer_load_dwordx4 v188, s[48:51], s33 offen lds
    s_add_u32 m0, s64, 30720
    s_add_u32 s33, s27, 4096000
    buffer_load_dwordx4 v68, s[48:51], s33 offen lds
    s_add_u32 m0, s64, 31744
    s_add_u32 s33, s27, 4104192
    buffer_load_dwordx4 v188, s[48:51], s33 offen lds
    s_waitcnt vmcnt(28)
    s_barrier
    ds_read_b64_tr_b16 a[96:97], v184 offset:0
    ds_read_b64_tr_b16 a[98:99], v184 offset:34816
    ds_read_b64_tr_b16 a[100:101], v185 offset:0
    ds_read_b64_tr_b16 a[102:103], v185 offset:34816
    ds_read_b64_tr_b16 a[104:105], v186 offset:0
    ds_read_b64_tr_b16 a[106:107], v186 offset:34816
    ds_read_b64_tr_b16 a[108:109], v187 offset:0
    ds_read_b64_tr_b16 a[110:111], v187 offset:34816
    s_waitcnt lgkmcnt(0)
    s_waitcnt vmcnt(24)
    s_barrier
    s_add_u32 m0, s64, 0
    s_add_u32 s33, s34, 0
    buffer_load_dwordx4 v69, s[48:51], s33 offen lds
    s_add_u32 m0, s64, 1024
    s_add_u32 s33, s34, 32768
    buffer_load_dwordx4 v189, s[48:51], s33 offen lds
    s_add_u32 m0, s64, 2048
    s_add_u32 s33, s34, 1179648
    buffer_load_dwordx4 v69, s[48:51], s33 offen lds
    s_add_u32 m0, s64, 3072
    s_add_u32 s33, s34, 1212416
    buffer_load_dwordx4 v189, s[48:51], s33 offen lds
    ds_read_b64_tr_b16 a[112:113], v184 offset:4096
    ds_read_b64_tr_b16 a[114:115], v184 offset:38912
    ds_read_b64_tr_b16 a[116:117], v185 offset:4096
    ds_read_b64_tr_b16 a[118:119], v185 offset:38912
    ds_read_b64_tr_b16 a[120:121], v186 offset:4096
    ds_read_b64_tr_b16 a[122:123], v186 offset:38912
    ds_read_b64_tr_b16 a[124:125], v187 offset:4096
    ds_read_b64_tr_b16 a[126:127], v187 offset:38912
    s_waitcnt lgkmcnt(0)
    s_waitcnt vmcnt(24)
    s_barrier
    s_add_u32 m0, s64, 4096
    s_add_u32 s33, s27, 0
    buffer_load_dwordx4 v68, s[56:59], s33 offen lds
    s_add_u32 m0, s64, 5120
    s_add_u32 s33, s27, 8192
    buffer_load_dwordx4 v188, s[56:59], s33 offen lds
    s_add_u32 m0, s64, 6144
    s_add_u32 s33, s27, 32768
    buffer_load_dwordx4 v68, s[56:59], s33 offen lds
    s_add_u32 m0, s64, 7168
    s_add_u32 s33, s27, 40960
    buffer_load_dwordx4 v188, s[56:59], s33 offen lds
    ds_read_b64_tr_b16 a[128:129], v184 offset:8192
    ds_read_b64_tr_b16 a[130:131], v184 offset:43008
    ds_read_b64_tr_b16 a[132:133], v185 offset:8192
    ds_read_b64_tr_b16 a[134:135], v185 offset:43008
    ds_read_b64_tr_b16 a[136:137], v186 offset:8192
    ds_read_b64_tr_b16 a[138:139], v186 offset:43008
    ds_read_b64_tr_b16 a[140:141], v187 offset:8192
    ds_read_b64_tr_b16 a[142:143], v187 offset:43008
    s_waitcnt lgkmcnt(0)
    s_waitcnt vmcnt(24)
    s_barrier
    s_add_u32 m0, s64, 8192
    s_add_u32 s33, s27, 524288
    buffer_load_dwordx4 v68, s[56:59], s33 offen lds
    s_add_u32 m0, s64, 9216
    s_add_u32 s33, s27, 532480
    buffer_load_dwordx4 v188, s[56:59], s33 offen lds
    s_add_u32 m0, s64, 10240
    s_add_u32 s33, s27, 557056
    buffer_load_dwordx4 v68, s[56:59], s33 offen lds
    s_add_u32 m0, s64, 11264
    s_add_u32 s33, s27, 565248
    buffer_load_dwordx4 v188, s[56:59], s33 offen lds
    ds_read_b64_tr_b16 a[0:1], v184 offset:12288
    ds_read_b64_tr_b16 a[2:3], v184 offset:47104
    ds_read_b64_tr_b16 a[4:5], v185 offset:12288
    ds_read_b64_tr_b16 a[6:7], v185 offset:47104
    ds_read_b64_tr_b16 a[8:9], v186 offset:12288
    ds_read_b64_tr_b16 a[10:11], v186 offset:47104
    ds_read_b64_tr_b16 a[12:13], v187 offset:12288
    ds_read_b64_tr_b16 a[14:15], v187 offset:47104
    s_waitcnt lgkmcnt(0)
    s_waitcnt vmcnt(24)
    s_barrier
    s_add_u32 m0, s64, 12288
    s_add_u32 s33, s27, 1179648
    buffer_load_dwordx4 v68, s[56:59], s33 offen lds
    s_add_u32 m0, s64, 13312
    s_add_u32 s33, s27, 1187840
    buffer_load_dwordx4 v188, s[56:59], s33 offen lds
    s_add_u32 m0, s64, 14336
    s_add_u32 s33, s27, 1212416
    buffer_load_dwordx4 v68, s[56:59], s33 offen lds
    s_add_u32 m0, s64, 15360
    s_add_u32 s33, s27, 1220608
    buffer_load_dwordx4 v188, s[56:59], s33 offen lds
    ds_read_b64_tr_b16 a[16:17], v184 offset:16384
    ds_read_b64_tr_b16 a[18:19], v184 offset:51200
    ds_read_b64_tr_b16 a[20:21], v185 offset:16384
    ds_read_b64_tr_b16 a[22:23], v185 offset:51200
    ds_read_b64_tr_b16 a[24:25], v186 offset:16384
    ds_read_b64_tr_b16 a[26:27], v186 offset:51200
    ds_read_b64_tr_b16 a[28:29], v187 offset:16384
    ds_read_b64_tr_b16 a[30:31], v187 offset:51200
    s_waitcnt lgkmcnt(0)
    s_waitcnt vmcnt(24)
    s_barrier
    s_add_u32 m0, s64, 16384
    s_add_u32 s33, s27, 1703936
    buffer_load_dwordx4 v68, s[56:59], s33 offen lds
    s_add_u32 m0, s64, 17408
    s_add_u32 s33, s27, 1712128
    buffer_load_dwordx4 v188, s[56:59], s33 offen lds
    s_add_u32 m0, s64, 18432
    s_add_u32 s33, s27, 1736704
    buffer_load_dwordx4 v68, s[56:59], s33 offen lds
    s_add_u32 m0, s64, 19456
    s_add_u32 s33, s27, 1744896
    buffer_load_dwordx4 v188, s[56:59], s33 offen lds
    ds_read_b64_tr_b16 a[32:33], v184 offset:20480
    ds_read_b64_tr_b16 a[34:35], v184 offset:55296
    ds_read_b64_tr_b16 a[36:37], v185 offset:20480
    ds_read_b64_tr_b16 a[38:39], v185 offset:55296
    ds_read_b64_tr_b16 a[40:41], v186 offset:20480
    ds_read_b64_tr_b16 a[42:43], v186 offset:55296
    ds_read_b64_tr_b16 a[44:45], v187 offset:20480
    ds_read_b64_tr_b16 a[46:47], v187 offset:55296
    s_waitcnt lgkmcnt(0)
    s_waitcnt vmcnt(24)
    s_barrier
    s_add_u32 m0, s64, 20480
    s_add_u32 s33, s27, 2359296
    buffer_load_dwordx4 v68, s[56:59], s33 offen lds
    s_add_u32 m0, s64, 21504
    s_add_u32 s33, s27, 2367488
    buffer_load_dwordx4 v188, s[56:59], s33 offen lds
    s_add_u32 m0, s64, 22528
    s_add_u32 s33, s27, 2392064
    buffer_load_dwordx4 v68, s[56:59], s33 offen lds
    s_add_u32 m0, s64, 23552
    s_add_u32 s33, s27, 2400256
    buffer_load_dwordx4 v188, s[56:59], s33 offen lds
    ds_read_b64_tr_b16 a[48:49], v184 offset:24576
    ds_read_b64_tr_b16 a[50:51], v184 offset:59392
    ds_read_b64_tr_b16 a[52:53], v185 offset:24576
    ds_read_b64_tr_b16 a[54:55], v185 offset:59392
    ds_read_b64_tr_b16 a[56:57], v186 offset:24576
    ds_read_b64_tr_b16 a[58:59], v186 offset:59392
    ds_read_b64_tr_b16 a[60:61], v187 offset:24576
    ds_read_b64_tr_b16 a[62:63], v187 offset:59392
    s_waitcnt lgkmcnt(0)
    s_waitcnt vmcnt(24)
    s_barrier
    s_add_u32 m0, s64, 24576
    s_add_u32 s33, s27, 2883584
    buffer_load_dwordx4 v68, s[56:59], s33 offen lds
    s_add_u32 m0, s64, 25600
    s_add_u32 s33, s27, 2891776
    buffer_load_dwordx4 v188, s[56:59], s33 offen lds
    s_add_u32 m0, s64, 26624
    s_add_u32 s33, s27, 2916352
    buffer_load_dwordx4 v68, s[56:59], s33 offen lds
    s_add_u32 m0, s64, 27648
    s_add_u32 s33, s27, 2924544
    buffer_load_dwordx4 v188, s[56:59], s33 offen lds
    ds_read_b64_tr_b16 a[64:65], v184 offset:28672
    ds_read_b64_tr_b16 a[66:67], v184 offset:63488
    ds_read_b64_tr_b16 a[68:69], v185 offset:28672
    ds_read_b64_tr_b16 a[70:71], v185 offset:63488
    ds_read_b64_tr_b16 a[72:73], v186 offset:28672
    ds_read_b64_tr_b16 a[74:75], v186 offset:63488
    ds_read_b64_tr_b16 a[76:77], v187 offset:28672
    ds_read_b64_tr_b16 a[78:79], v187 offset:63488
    s_waitcnt lgkmcnt(0)
    s_waitcnt vmcnt(24)
    s_barrier
    s_add_u32 m0, s64, 28672
    s_add_u32 s33, s27, 3538944
    buffer_load_dwordx4 v68, s[56:59], s33 offen lds
    s_add_u32 m0, s64, 29696
    s_add_u32 s33, s27, 3547136
    buffer_load_dwordx4 v188, s[56:59], s33 offen lds
    s_add_u32 m0, s64, 30720
    s_add_u32 s33, s27, 3571712
    buffer_load_dwordx4 v68, s[56:59], s33 offen lds
    s_add_u32 m0, s64, 31744
    s_add_u32 s33, s27, 3579904
    buffer_load_dwordx4 v188, s[56:59], s33 offen lds
    ds_read_b64_tr_b16 a[80:81], v184 offset:0
    ds_read_b64_tr_b16 a[82:83], v184 offset:34816
    ds_read_b64_tr_b16 a[84:85], v185 offset:0
    ds_read_b64_tr_b16 a[86:87], v185 offset:34816
    ds_read_b64_tr_b16 a[88:89], v186 offset:0
    ds_read_b64_tr_b16 a[90:91], v186 offset:34816
    ds_read_b64_tr_b16 a[92:93], v187 offset:0
    ds_read_b64_tr_b16 a[94:95], v187 offset:34816
    s_waitcnt lgkmcnt(0)
    s_waitcnt vmcnt(24)
    s_barrier
    s_add_u32 m0, s64, 0
    s_add_u32 s33, s27, 4063232
    buffer_load_dwordx4 v68, s[56:59], s33 offen lds
    s_add_u32 m0, s64, 1024
    s_add_u32 s33, s27, 4071424
    buffer_load_dwordx4 v188, s[56:59], s33 offen lds
    s_add_u32 m0, s64, 2048
    s_add_u32 s33, s27, 4096000
    buffer_load_dwordx4 v68, s[56:59], s33 offen lds
    s_add_u32 m0, s64, 3072
    s_add_u32 s33, s27, 4104192
    buffer_load_dwordx4 v188, s[56:59], s33 offen lds
    ds_read_b64_tr_b16 v[128:129], v184 offset:4096
    ds_read_b64_tr_b16 v[130:131], v184 offset:38912
    ds_read_b64_tr_b16 v[132:133], v185 offset:4096
    ds_read_b64_tr_b16 v[134:135], v185 offset:38912
    ds_read_b64_tr_b16 v[136:137], v186 offset:4096
    ds_read_b64_tr_b16 v[138:139], v186 offset:38912
    ds_read_b64_tr_b16 v[140:141], v187 offset:4096
    ds_read_b64_tr_b16 v[142:143], v187 offset:38912
    s_waitcnt lgkmcnt(0)
    s_waitcnt vmcnt(24)
    s_barrier
    s_add_u32 m0, s64, 4096
    s_add_u32 s33, s34, 0
    buffer_load_dwordx4 v69, s[56:59], s33 offen lds
    s_add_u32 m0, s64, 5120
    s_add_u32 s33, s34, 32768
    buffer_load_dwordx4 v189, s[56:59], s33 offen lds
    s_add_u32 m0, s64, 6144
    s_add_u32 s33, s34, 1179648
    buffer_load_dwordx4 v69, s[56:59], s33 offen lds
    s_add_u32 m0, s64, 7168
    s_add_u32 s33, s34, 1212416
    buffer_load_dwordx4 v189, s[56:59], s33 offen lds
    s_mov_b32 s30, 160
    buffer_load_dword v190, v190, s[12:15], s30 offen sc1
    ds_read_b64_tr_b16 v[144:145], v184 offset:8192
    ds_read_b64_tr_b16 v[146:147], v184 offset:43008
    ds_read_b64_tr_b16 v[148:149], v185 offset:8192
    ds_read_b64_tr_b16 v[150:151], v185 offset:43008
    ds_read_b64_tr_b16 v[152:153], v186 offset:8192
    ds_read_b64_tr_b16 v[154:155], v186 offset:43008
    ds_read_b64_tr_b16 v[156:157], v187 offset:8192
    ds_read_b64_tr_b16 v[158:159], v187 offset:43008
    s_waitcnt lgkmcnt(0)
    s_waitcnt vmcnt(25)
    s_barrier
    s_add_u32 m0, s64, 8192
    s_add_u32 s33, s32, 0
    buffer_load_dwordx4 v70, s[60:63], s33 offen lds
    s_add_u32 m0, s64, 9216
    s_add_u32 s33, s32, 2304
    buffer_load_dwordx4 v70, s[60:63], s33 offen lds
    s_add_u32 m0, s64, 10240
    s_add_u32 s33, s32, 36864
    buffer_load_dwordx4 v70, s[60:63], s33 offen lds
    s_add_u32 m0, s64, 11264
    s_add_u32 s33, s32, 39168
    buffer_load_dwordx4 v70, s[60:63], s33 offen lds
    ds_read_b64_tr_b16 v[160:161], v184 offset:12288
    ds_read_b64_tr_b16 v[162:163], v184 offset:47104
    ds_read_b64_tr_b16 v[164:165], v185 offset:12288
    ds_read_b64_tr_b16 v[166:167], v185 offset:47104
    ds_read_b64_tr_b16 v[168:169], v186 offset:12288
    ds_read_b64_tr_b16 v[170:171], v186 offset:47104
    ds_read_b64_tr_b16 v[172:173], v187 offset:12288
    ds_read_b64_tr_b16 v[174:175], v187 offset:47104
    s_waitcnt lgkmcnt(0)
    s_waitcnt vmcnt(25)
    s_barrier
    s_add_u32 m0, s64, 12288
    s_add_u32 s33, s32, 64
    buffer_load_dwordx4 v70, s[60:63], s33 offen lds
    s_add_u32 m0, s64, 13312
    s_add_u32 s33, s32, 2368
    buffer_load_dwordx4 v70, s[60:63], s33 offen lds
    s_add_u32 m0, s64, 14336
    s_add_u32 s33, s32, 36928
    buffer_load_dwordx4 v70, s[60:63], s33 offen lds
    s_add_u32 m0, s64, 15360
    s_add_u32 s33, s32, 39232
    buffer_load_dwordx4 v70, s[60:63], s33 offen lds
    ds_read_b64_tr_b16 a[216:217], v184 offset:16384
    ds_read_b64_tr_b16 a[218:219], v184 offset:51200
    ds_read_b64_tr_b16 a[220:221], v185 offset:16384
    ds_read_b64_tr_b16 a[222:223], v185 offset:51200
    ds_read_b64_tr_b16 a[224:225], v186 offset:16384
    ds_read_b64_tr_b16 a[226:227], v186 offset:51200
    ds_read_b64_tr_b16 a[228:229], v187 offset:16384
    ds_read_b64_tr_b16 a[230:231], v187 offset:51200
    s_waitcnt lgkmcnt(0)
    s_waitcnt vmcnt(25)
    s_barrier
    s_add_u32 m0, s64, 16384
    s_add_u32 s33, s32, 128
    buffer_load_dwordx4 v70, s[60:63], s33 offen lds
    s_add_u32 m0, s64, 17408
    s_add_u32 s33, s32, 2432
    buffer_load_dwordx4 v70, s[60:63], s33 offen lds
    s_add_u32 m0, s64, 18432
    s_add_u32 s33, s32, 36992
    buffer_load_dwordx4 v70, s[60:63], s33 offen lds
    s_add_u32 m0, s64, 19456
    s_add_u32 s33, s32, 39296
    buffer_load_dwordx4 v70, s[60:63], s33 offen lds
    ds_read_b64_tr_b16 a[232:233], v184 offset:20480
    ds_read_b64_tr_b16 a[234:235], v184 offset:55296
    ds_read_b64_tr_b16 a[236:237], v185 offset:20480
    ds_read_b64_tr_b16 a[238:239], v185 offset:55296
    ds_read_b64_tr_b16 a[240:241], v186 offset:20480
    ds_read_b64_tr_b16 a[242:243], v186 offset:55296
    ds_read_b64_tr_b16 a[244:245], v187 offset:20480
    ds_read_b64_tr_b16 a[246:247], v187 offset:55296
    s_waitcnt lgkmcnt(0)
    s_waitcnt vmcnt(25)
    s_barrier
    s_add_u32 m0, s64, 20480
    s_add_u32 s33, s32, 192
    buffer_load_dwordx4 v70, s[60:63], s33 offen lds
    s_add_u32 m0, s64, 21504
    s_add_u32 s33, s32, 2496
    buffer_load_dwordx4 v70, s[60:63], s33 offen lds
    s_add_u32 m0, s64, 22528
    s_add_u32 s33, s32, 37056
    buffer_load_dwordx4 v70, s[60:63], s33 offen lds
    s_add_u32 m0, s64, 23552
    s_add_u32 s33, s32, 39360
    buffer_load_dwordx4 v70, s[60:63], s33 offen lds
    ds_read_b64_tr_b16 a[248:249], v184 offset:24576
    ds_read_b64_tr_b16 a[250:251], v184 offset:59392
    ds_read_b64_tr_b16 a[252:253], v185 offset:24576
    ds_read_b64_tr_b16 a[254:255], v185 offset:59392
    ds_read_b64_tr_b16 v[72:73], v186 offset:24576
    ds_read_b64_tr_b16 v[74:75], v186 offset:59392
    ds_read_b64_tr_b16 v[76:77], v187 offset:24576
    ds_read_b64_tr_b16 v[78:79], v187 offset:59392
    s_waitcnt lgkmcnt(0)
    s_waitcnt vmcnt(25)
    s_barrier
    s_add_u32 m0, s64, 24576
    s_add_u32 s33, s32, 256
    buffer_load_dwordx4 v70, s[60:63], s33 offen lds
    s_add_u32 m0, s64, 25600
    s_add_u32 s33, s32, 2560
    buffer_load_dwordx4 v70, s[60:63], s33 offen lds
    s_add_u32 m0, s64, 26624
    s_add_u32 s33, s32, 37120
    buffer_load_dwordx4 v70, s[60:63], s33 offen lds
    s_add_u32 m0, s64, 27648
    s_add_u32 s33, s32, 39424
    buffer_load_dwordx4 v70, s[60:63], s33 offen lds
    ds_read_b64_tr_b16 v[80:81], v184 offset:28672
    ds_read_b64_tr_b16 v[82:83], v184 offset:63488
    ds_read_b64_tr_b16 v[84:85], v185 offset:28672
    ds_read_b64_tr_b16 v[86:87], v185 offset:63488
    ds_read_b64_tr_b16 v[88:89], v186 offset:28672
    ds_read_b64_tr_b16 v[90:91], v186 offset:63488
    ds_read_b64_tr_b16 v[92:93], v187 offset:28672
    ds_read_b64_tr_b16 v[94:95], v187 offset:63488
    s_waitcnt lgkmcnt(0)
    s_waitcnt vmcnt(25)
    s_barrier
    s_add_u32 m0, s64, 28672
    s_add_u32 s33, s27, 0
    buffer_load_dwordx4 v68, s[52:55], s33 offen lds
    s_add_u32 m0, s64, 29696
    s_add_u32 s33, s27, 8192
    buffer_load_dwordx4 v188, s[52:55], s33 offen lds
    s_add_u32 m0, s64, 30720
    s_add_u32 s33, s27, 32768
    buffer_load_dwordx4 v68, s[52:55], s33 offen lds
    s_add_u32 m0, s64, 31744
    s_add_u32 s33, s27, 40960
    buffer_load_dwordx4 v188, s[52:55], s33 offen lds
    ds_read_b64_tr_b16 v[96:97], v184 offset:0
    ds_read_b64_tr_b16 v[98:99], v184 offset:34816
    ds_read_b64_tr_b16 v[100:101], v185 offset:0
    ds_read_b64_tr_b16 v[102:103], v185 offset:34816
    ds_read_b64_tr_b16 v[104:105], v186 offset:0
    ds_read_b64_tr_b16 v[106:107], v186 offset:34816
    ds_read_b64_tr_b16 v[108:109], v187 offset:0
    ds_read_b64_tr_b16 v[110:111], v187 offset:34816
    s_waitcnt lgkmcnt(0)
    s_waitcnt vmcnt(25)
    s_barrier
    s_add_u32 m0, s64, 0
    s_add_u32 s33, s27, 524288
    buffer_load_dwordx4 v68, s[52:55], s33 offen lds
    s_add_u32 m0, s64, 1024
    s_add_u32 s33, s27, 532480
    buffer_load_dwordx4 v188, s[52:55], s33 offen lds
    s_add_u32 m0, s64, 2048
    s_add_u32 s33, s27, 557056
    buffer_load_dwordx4 v68, s[52:55], s33 offen lds
    s_add_u32 m0, s64, 3072
    s_add_u32 s33, s27, 565248
    buffer_load_dwordx4 v188, s[52:55], s33 offen lds
    ds_read_b64_tr_b16 v[112:113], v184 offset:4096
    ds_read_b64_tr_b16 v[114:115], v184 offset:38912
    ds_read_b64_tr_b16 v[116:117], v185 offset:4096
    ds_read_b64_tr_b16 v[118:119], v185 offset:38912
    ds_read_b64_tr_b16 v[120:121], v186 offset:4096
    ds_read_b64_tr_b16 v[122:123], v186 offset:38912
    ds_read_b64_tr_b16 v[124:125], v187 offset:4096
    ds_read_b64_tr_b16 v[126:127], v187 offset:38912
    s_waitcnt lgkmcnt(0)
    s_waitcnt vmcnt(24)
    s_barrier
    s_add_u32 m0, s64, 4096
    s_add_u32 s33, s27, 1179648
    buffer_load_dwordx4 v68, s[52:55], s33 offen lds
    s_add_u32 m0, s64, 5120
    s_add_u32 s33, s27, 1187840
    buffer_load_dwordx4 v188, s[52:55], s33 offen lds
    s_add_u32 m0, s64, 6144
    s_add_u32 s33, s27, 1212416
    buffer_load_dwordx4 v68, s[52:55], s33 offen lds
    s_add_u32 m0, s64, 7168
    s_add_u32 s33, s27, 1220608
    buffer_load_dwordx4 v188, s[52:55], s33 offen lds
    ds_read_b64_tr_b16 v[176:177], v71 offset:8192
    ds_read_b64_tr_b16 v[178:179], v71 offset:9216
    ds_read_b64_tr_b16 v[180:181], v71 offset:10240
    ds_read_b64_tr_b16 v[182:183], v71 offset:11264
    ds_read_b64_tr_b16 v[192:193], v71 offset:8224
    ds_read_b64_tr_b16 v[194:195], v71 offset:9248
    ds_read_b64_tr_b16 v[196:197], v71 offset:10272
    ds_read_b64_tr_b16 v[198:199], v71 offset:11296
    s_waitcnt lgkmcnt(0)
    s_waitcnt vmcnt(24)
    s_barrier
    s_add_u32 m0, s64, 8192
    s_add_u32 s33, s27, 1703936
    buffer_load_dwordx4 v68, s[52:55], s33 offen lds
    s_add_u32 m0, s64, 9216
    s_add_u32 s33, s27, 1712128
    buffer_load_dwordx4 v188, s[52:55], s33 offen lds
    s_add_u32 m0, s64, 10240
    s_add_u32 s33, s27, 1736704
    buffer_load_dwordx4 v68, s[52:55], s33 offen lds
    s_add_u32 m0, s64, 11264
    s_add_u32 s33, s27, 1744896
    buffer_load_dwordx4 v188, s[52:55], s33 offen lds
    ds_read_b64_tr_b16 v[200:201], v71 offset:12288
    ds_read_b64_tr_b16 v[202:203], v71 offset:13312
    ds_read_b64_tr_b16 v[204:205], v71 offset:14336
    ds_read_b64_tr_b16 v[206:207], v71 offset:15360
    ds_read_b64_tr_b16 v[208:209], v71 offset:12320
    ds_read_b64_tr_b16 v[210:211], v71 offset:13344
    ds_read_b64_tr_b16 v[212:213], v71 offset:14368
    ds_read_b64_tr_b16 v[214:215], v71 offset:15392
    s_waitcnt lgkmcnt(0)
    s_waitcnt vmcnt(24)
    s_barrier
    s_add_u32 m0, s64, 12288
    s_add_u32 s33, s27, 2359296
    buffer_load_dwordx4 v68, s[52:55], s33 offen lds
    s_add_u32 m0, s64, 13312
    s_add_u32 s33, s27, 2367488
    buffer_load_dwordx4 v188, s[52:55], s33 offen lds
    s_add_u32 m0, s64, 14336
    s_add_u32 s33, s27, 2392064
    buffer_load_dwordx4 v68, s[52:55], s33 offen lds
    s_add_u32 m0, s64, 15360
    s_add_u32 s33, s27, 2400256
    buffer_load_dwordx4 v188, s[52:55], s33 offen lds
    v_readlane_b32 s30, v190, 0
    s_nop 0
    s_cmp_eq_u32 s30, 224
    s_cselect_b32 s18, 1, 0
    s_mov_b32 s29, 0
    s_mov_b32 s19, 0
    v_readlane_b32 s30, v190, 1
    s_nop 0
    s_add_u32 s29, s29, s30
    s_max_u32 s19, s19, s30
    v_readlane_b32 s30, v190, 2
    s_nop 0
    s_add_u32 s29, s29, s30
    s_max_u32 s19, s19, s30
    v_readlane_b32 s30, v190, 3
    s_nop 0
    s_add_u32 s29, s29, s30
    s_max_u32 s19, s19, s30
    v_readlane_b32 s30, v190, 4
    s_nop 0
    s_add_u32 s29, s29, s30
    s_max_u32 s19, s19, s30
    v_readlane_b32 s30, v190, 5
    s_nop 0
    s_add_u32 s29, s29, s30
    s_max_u32 s19, s19, s30
    v_readlane_b32 s30, v190, 6
    s_nop 0
    s_add_u32 s29, s29, s30
    s_max_u32 s19, s19, s30
    v_readlane_b32 s30, v190, 7
    s_nop 0
    s_add_u32 s29, s29, s30
    s_max_u32 s19, s19, s30
    v_readlane_b32 s30, v190, 8
    s_nop 0
    s_add_u32 s29, s29, s30
    s_max_u32 s19, s19, s30
    s_cmp_eq_u32 s29, 32
    s_cselect_b32 s18, s18, 0
    ds_read_b64_tr_b16 v[216:217], v71 offset:16384
    ds_read_b64_tr_b16 v[218:219], v71 offset:17408
    ds_read_b64_tr_b16 v[220:221], v71 offset:18432
    ds_read_b64_tr_b16 v[222:223], v71 offset:19456
    ds_read_b64_tr_b16 v[224:225], v71 offset:16416
    ds_read_b64_tr_b16 v[226:227], v71 offset:17440
    ds_read_b64_tr_b16 v[228:229], v71 offset:18464
    ds_read_b64_tr_b16 v[230:231], v71 offset:19488
    s_waitcnt lgkmcnt(0)
    s_waitcnt vmcnt(24)
    s_barrier
    s_add_u32 m0, s64, 16384
    s_add_u32 s33, s27, 2883584
    buffer_load_dwordx4 v68, s[52:55], s33 offen lds
    s_add_u32 m0, s64, 17408
    s_add_u32 s33, s27, 2891776
    buffer_load_dwordx4 v188, s[52:55], s33 offen lds
    s_add_u32 m0, s64, 18432
    s_add_u32 s33, s27, 2916352
    buffer_load_dwordx4 v68, s[52:55], s33 offen lds
    s_add_u32 m0, s64, 19456
    s_add_u32 s33, s27, 2924544
    buffer_load_dwordx4 v188, s[52:55], s33 offen lds
    ds_read_b64_tr_b16 v[232:233], v71 offset:20480
    ds_read_b64_tr_b16 v[234:235], v71 offset:21504
    ds_read_b64_tr_b16 v[236:237], v71 offset:22528
    ds_read_b64_tr_b16 v[238:239], v71 offset:23552
    ds_read_b64_tr_b16 v[240:241], v71 offset:20512
    ds_read_b64_tr_b16 v[242:243], v71 offset:21536
    ds_read_b64_tr_b16 v[244:245], v71 offset:22560
    ds_read_b64_tr_b16 v[246:247], v71 offset:23584
    s_waitcnt lgkmcnt(0)
    s_waitcnt vmcnt(24)
    s_barrier
    s_add_u32 m0, s64, 20480
    s_add_u32 s33, s27, 3538944
    buffer_load_dwordx4 v68, s[52:55], s33 offen lds
    s_add_u32 m0, s64, 21504
    s_add_u32 s33, s27, 3547136
    buffer_load_dwordx4 v188, s[52:55], s33 offen lds
    s_add_u32 m0, s64, 22528
    s_add_u32 s33, s27, 3571712
    buffer_load_dwordx4 v68, s[52:55], s33 offen lds
    s_add_u32 m0, s64, 23552
    s_add_u32 s33, s27, 3579904
    buffer_load_dwordx4 v188, s[52:55], s33 offen lds
    ds_read_b64_tr_b16 v[248:249], v71 offset:24576
    ds_read_b64_tr_b16 v[250:251], v71 offset:25600
    ds_read_b64_tr_b16 v[252:253], v71 offset:26624
    ds_read_b64_tr_b16 v[254:255], v71 offset:27648
    s_waitcnt lgkmcnt(0)
    s_waitcnt vmcnt(24)
    s_barrier
    s_add_u32 m0, s64, 24576
    s_add_u32 s33, s27, 4063232
    buffer_load_dwordx4 v68, s[52:55], s33 offen lds
    s_add_u32 m0, s64, 25600
    s_add_u32 s33, s27, 4071424
    buffer_load_dwordx4 v188, s[52:55], s33 offen lds
    s_add_u32 m0, s64, 26624
    s_add_u32 s33, s27, 4096000
    buffer_load_dwordx4 v68, s[52:55], s33 offen lds
    s_add_u32 m0, s64, 27648
    s_add_u32 s33, s27, 4104192
    buffer_load_dwordx4 v188, s[52:55], s33 offen lds
    ds_read_b64_tr_b16 a[192:193], v184 offset:28672
    ds_read_b64_tr_b16 a[194:195], v184 offset:63488
    ds_read_b64_tr_b16 a[196:197], v185 offset:28672
    ds_read_b64_tr_b16 a[198:199], v185 offset:63488
    ds_read_b64_tr_b16 v[12:13], v186 offset:28672
    ds_read_b64_tr_b16 v[14:15], v186 offset:63488
    ds_read_b64_tr_b16 v[16:17], v187 offset:28672
    ds_read_b64_tr_b16 v[18:19], v187 offset:63488
    s_waitcnt lgkmcnt(0)
    s_waitcnt vmcnt(24)
    s_barrier
    s_add_u32 m0, s64, 28672
    s_add_u32 s33, s34, 0
    buffer_load_dwordx4 v69, s[52:55], s33 offen lds
    s_add_u32 m0, s64, 29696
    s_add_u32 s33, s34, 32768
    buffer_load_dwordx4 v189, s[52:55], s33 offen lds
    s_add_u32 m0, s64, 30720
    s_add_u32 s33, s34, 1179648
    buffer_load_dwordx4 v69, s[52:55], s33 offen lds
    s_add_u32 m0, s64, 31744
    s_add_u32 s33, s34, 1212416
    buffer_load_dwordx4 v189, s[52:55], s33 offen lds
    ds_read_b64_tr_b16 a[200:201], v184 offset:0
    ds_read_b64_tr_b16 a[202:203], v184 offset:34816
    ds_read_b64_tr_b16 a[204:205], v185 offset:0
    ds_read_b64_tr_b16 a[206:207], v185 offset:34816
    ds_read_b64_tr_b16 v[20:21], v186 offset:0
    ds_read_b64_tr_b16 v[22:23], v186 offset:34816
    ds_read_b64_tr_b16 v[24:25], v187 offset:0
    ds_read_b64_tr_b16 v[26:27], v187 offset:34816
    s_waitcnt lgkmcnt(0)
    s_waitcnt vmcnt(24)
    s_barrier
    s_add_u32 m0, s64, 0
    s_add_u32 s33, s32, 73984
    buffer_load_dwordx4 v70, s[60:63], s33 offen lds
    s_add_u32 m0, s64, 1024
    s_add_u32 s33, s32, 76288
    buffer_load_dwordx4 v70, s[60:63], s33 offen lds
    s_add_u32 m0, s64, 2048
    s_add_u32 s33, s32, 110848
    buffer_load_dwordx4 v70, s[60:63], s33 offen lds
    s_add_u32 m0, s64, 3072
    s_add_u32 s33, s32, 113152
    buffer_load_dwordx4 v70, s[60:63], s33 offen lds
    ds_read_b64_tr_b16 a[208:209], v184 offset:4096
    ds_read_b64_tr_b16 a[210:211], v184 offset:38912
    ds_read_b64_tr_b16 a[212:213], v185 offset:4096
    ds_read_b64_tr_b16 a[214:215], v185 offset:38912
    ds_read_b64_tr_b16 v[28:29], v186 offset:4096
    ds_read_b64_tr_b16 v[30:31], v186 offset:38912
    ds_read_b64_tr_b16 v[32:33], v187 offset:4096
    ds_read_b64_tr_b16 v[34:35], v187 offset:38912
    s_waitcnt lgkmcnt(0)
    s_waitcnt vmcnt(24)
    s_barrier
    s_add_u32 m0, s64, 4096
    s_add_u32 s33, s32, 73792
    buffer_load_dwordx4 v70, s[60:63], s33 offen lds
    s_add_u32 m0, s64, 5120
    s_add_u32 s33, s32, 76096
    buffer_load_dwordx4 v70, s[60:63], s33 offen lds
    s_add_u32 m0, s64, 6144
    s_add_u32 s33, s32, 110656
    buffer_load_dwordx4 v70, s[60:63], s33 offen lds
    s_add_u32 m0, s64, 7168
    s_add_u32 s33, s32, 112960
    buffer_load_dwordx4 v70, s[60:63], s33 offen lds
    s_mov_b32 s30, 119668992
    buffer_load_dword v190, v191, s[8:11], s30 offen sc1
    ds_read_b64_tr_b16 a[144:145], v184 offset:8192
    ds_read_b64_tr_b16 a[146:147], v184 offset:43008
    ds_read_b64_tr_b16 a[148:149], v185 offset:8192
    ds_read_b64_tr_b16 a[150:151], v185 offset:43008
    ds_read_b64_tr_b16 v[36:37], v186 offset:8192
    ds_read_b64_tr_b16 v[38:39], v186 offset:43008
    ds_read_b64_tr_b16 v[40:41], v187 offset:8192
    ds_read_b64_tr_b16 v[42:43], v187 offset:43008
    s_waitcnt lgkmcnt(0)
    s_waitcnt vmcnt(25)
    s_barrier
    s_add_u32 m0, s64, 8192
    s_add_u32 s33, s32, 73856
    buffer_load_dwordx4 v70, s[60:63], s33 offen lds
    s_add_u32 m0, s64, 9216
    s_add_u32 s33, s32, 76160
    buffer_load_dwordx4 v70, s[60:63], s33 offen lds
    s_add_u32 m0, s64, 10240
    s_add_u32 s33, s32, 110720
    buffer_load_dwordx4 v70, s[60:63], s33 offen lds
    s_add_u32 m0, s64, 11264
    s_add_u32 s33, s32, 113024
    buffer_load_dwordx4 v70, s[60:63], s33 offen lds
    ds_read_b64_tr_b16 a[152:153], v184 offset:12288
    ds_read_b64_tr_b16 a[154:155], v184 offset:47104
    ds_read_b64_tr_b16 a[156:157], v185 offset:12288
    ds_read_b64_tr_b16 a[158:159], v185 offset:47104
    ds_read_b64_tr_b16 v[44:45], v186 offset:12288
    ds_read_b64_tr_b16 v[46:47], v186 offset:47104
    ds_read_b64_tr_b16 v[48:49], v187 offset:12288
    ds_read_b64_tr_b16 v[50:51], v187 offset:47104
    s_waitcnt lgkmcnt(0)
    s_waitcnt vmcnt(25)
    s_barrier
    s_add_u32 m0, s64, 12288
    s_add_u32 s33, s32, 73920
    buffer_load_dwordx4 v70, s[60:63], s33 offen lds
    s_add_u32 m0, s64, 13312
    s_add_u32 s33, s32, 76224
    buffer_load_dwordx4 v70, s[60:63], s33 offen lds
    s_add_u32 m0, s64, 14336
    s_add_u32 s33, s32, 110784
    buffer_load_dwordx4 v70, s[60:63], s33 offen lds
    s_add_u32 m0, s64, 15360
    s_add_u32 s33, s32, 113088
    buffer_load_dwordx4 v70, s[60:63], s33 offen lds
    ds_write_b128 v10, v[36:39] offset:32768
    ds_write_b128 v10, v[40:43] offset:33792
    ds_read_b64_tr_b16 a[160:161], v184 offset:16384
    ds_read_b64_tr_b16 a[162:163], v184 offset:51200
    ds_read_b64_tr_b16 a[164:165], v185 offset:16384
    ds_read_b64_tr_b16 a[166:167], v185 offset:51200
    ds_read_b64_tr_b16 v[52:53], v186 offset:16384
    ds_read_b64_tr_b16 v[54:55], v186 offset:51200
    ds_read_b64_tr_b16 v[56:57], v187 offset:16384
    ds_read_b64_tr_b16 v[58:59], v187 offset:51200
    s_waitcnt lgkmcnt(0)
    s_waitcnt vmcnt(25)
    s_barrier
    s_add_u32 m0, s64, 16384
    s_add_u32 s33, s32, 73728
    buffer_load_dwordx4 v70, s[60:63], s33 offen lds
    s_add_u32 m0, s64, 17408
    s_add_u32 s33, s32, 76032
    buffer_load_dwordx4 v70, s[60:63], s33 offen lds
    s_add_u32 m0, s64, 18432
    s_add_u32 s33, s32, 110592
    buffer_load_dwordx4 v70, s[60:63], s33 offen lds
    s_add_u32 m0, s64, 19456
    s_add_u32 s33, s32, 112896
    buffer_load_dwordx4 v70, s[60:63], s33 offen lds
    ds_read_b64_tr_b16 a[168:169], v184 offset:20480
    ds_read_b64_tr_b16 a[170:171], v184 offset:55296
    ds_read_b64_tr_b16 a[172:173], v185 offset:20480
    ds_read_b64_tr_b16 a[174:175], v185 offset:55296
    ds_read_b64_tr_b16 v[60:61], v186 offset:20480
    ds_read_b64_tr_b16 v[62:63], v186 offset:55296
    ds_read_b64_tr_b16 v[64:65], v187 offset:20480
    ds_read_b64_tr_b16 v[66:67], v187 offset:55296
    s_waitcnt lgkmcnt(0)
    s_waitcnt vmcnt(25)
    s_barrier
    ds_write_b128 v10, v[12:15] offset:22528
    ds_write_b128 v10, v[16:19] offset:23552
    ds_write_b128 v10, v[60:63] offset:20480
    ds_write_b128 v10, v[64:67] offset:21504
    ds_read_b64_tr_b16 a[176:177], v184 offset:24576
    ds_read_b64_tr_b16 a[178:179], v184 offset:59392
    ds_read_b64_tr_b16 a[180:181], v185 offset:24576
    ds_read_b64_tr_b16 a[182:183], v185 offset:59392
    ds_read_b64_tr_b16 v[36:37], v186 offset:24576
    ds_read_b64_tr_b16 v[38:39], v186 offset:59392
    ds_read_b64_tr_b16 v[40:41], v187 offset:24576
    ds_read_b64_tr_b16 v[42:43], v187 offset:59392
    s_waitcnt lgkmcnt(0)
    s_waitcnt vmcnt(21)
    s_barrier
    ds_write_b128 v10, v[44:47] offset:24576
    ds_write_b128 v10, v[48:51] offset:25600
    ds_write_b128 v10, v[36:39] offset:26624
    ds_write_b128 v10, v[40:43] offset:27648
    ds_read_b64_tr_b16 a[184:185], v184 offset:28672
    ds_read_b64_tr_b16 a[186:187], v184 offset:63488
    ds_read_b64_tr_b16 a[188:189], v185 offset:28672
    ds_read_b64_tr_b16 a[190:191], v185 offset:63488
    ds_read_b64_tr_b16 v[12:13], v186 offset:28672
    ds_read_b64_tr_b16 v[14:15], v186 offset:63488
    ds_read_b64_tr_b16 v[16:17], v187 offset:28672
    ds_read_b64_tr_b16 v[18:19], v187 offset:63488
    s_waitcnt lgkmcnt(0)
    s_waitcnt vmcnt(17)
    s_barrier
    ds_write_b128 v10, v[20:23] offset:28672
    ds_write_b128 v10, v[24:27] offset:29696
    ds_write_b128 v10, v[52:55] offset:30720
    ds_write_b128 v10, v[56:59] offset:31744
    ds_read_b64_tr_b16 v[60:61], v71 offset:0
    ds_read_b64_tr_b16 v[62:63], v71 offset:1024
    ds_read_b64_tr_b16 v[64:65], v71 offset:2048
    ds_read_b64_tr_b16 v[66:67], v71 offset:3072
    s_waitcnt lgkmcnt(0)
    s_waitcnt vmcnt(13)
    s_barrier
    ds_write_b128 v10, v[28:31] offset:2048
    ds_write_b128 v10, v[32:35] offset:3072
    ds_write_b128 v10, v[12:15] offset:0
    ds_write_b128 v10, v[16:19] offset:1024
    ds_read_b64_tr_b16 v[44:45], v71 offset:4096
    ds_read_b64_tr_b16 v[46:47], v71 offset:5120
    ds_read_b64_tr_b16 v[48:49], v71 offset:6144
    ds_read_b64_tr_b16 v[50:51], v71 offset:7168
    ds_read_b64_tr_b16 v[36:37], v71 offset:4128
    ds_read_b64_tr_b16 v[38:39], v71 offset:5152
    ds_read_b64_tr_b16 v[40:41], v71 offset:6176
    ds_read_b64_tr_b16 v[42:43], v71 offset:7200
    s_waitcnt lgkmcnt(0)
    s_waitcnt vmcnt(8)
    s_barrier
    ds_write_b128 v10, v[60:63] offset:4096
    ds_write_b128 v10, v[64:67] offset:5120
    ds_write_b128 v10, v[44:47] offset:6144
    ds_write_b128 v10, v[48:51] offset:7168
    ds_read_b64_tr_b16 v[20:21], v71 offset:8192
    ds_read_b64_tr_b16 v[22:23], v71 offset:9216
    ds_read_b64_tr_b16 v[24:25], v71 offset:10240
    ds_read_b64_tr_b16 v[26:27], v71 offset:11264
    ds_read_b64_tr_b16 v[52:53], v71 offset:8224
    ds_read_b64_tr_b16 v[54:55], v71 offset:9248
    ds_read_b64_tr_b16 v[56:57], v71 offset:10272
    ds_read_b64_tr_b16 v[58:59], v71 offset:11296
    s_waitcnt lgkmcnt(0)
    s_waitcnt vmcnt(4)
    s_barrier
    ds_write_b128 v10, v[36:39] offset:8192
    ds_write_b128 v10, v[40:43] offset:9216
    ds_write_b128 v10, v[20:23] offset:10240
    ds_write_b128 v10, v[24:27] offset:11264
    v_cmp_eq_u32 vcc, 0, v190
    s_nop 0
    s_cmp_eq_u64 vcc, 0
    s_cselect_b32 s30, 3, 1
    s_mul_i32 s18, s18, s30
    ds_read_b64_tr_b16 v[28:29], v71 offset:12288
    ds_read_b64_tr_b16 v[30:31], v71 offset:13312
    ds_read_b64_tr_b16 v[32:33], v71 offset:14336
    ds_read_b64_tr_b16 v[34:35], v71 offset:15360
    ds_read_b64_tr_b16 v[12:13], v71 offset:12320
    ds_read_b64_tr_b16 v[14:15], v71 offset:13344
    ds_read_b64_tr_b16 v[16:17], v71 offset:14368
    ds_read_b64_tr_b16 v[18:19], v71 offset:15392
    s_waitcnt lgkmcnt(0)
    s_waitcnt vmcnt(0)
    s_barrier
    ds_write_b128 v10, v[52:55] offset:12288
    ds_write_b128 v10, v[56:59] offset:13312
    ds_write_b128 v10, v[28:31] offset:14336
    ds_write_b128 v10, v[32:35] offset:15360
    ds_read_b64_tr_b16 v[184:185], v71 offset:16384
    ds_read_b64_tr_b16 v[186:187], v71 offset:17408
    ds_read_b64_tr_b16 v[188:189], v71 offset:18432
    ds_read_b64_tr_b16 v[190:191], v71 offset:19456
    ds_read_b64_tr_b16 v[60:61], v71 offset:16416
    ds_read_b64_tr_b16 v[62:63], v71 offset:17440
    ds_read_b64_tr_b16 v[64:65], v71 offset:18464
    ds_read_b64_tr_b16 v[66:67], v71 offset:19488
    s_waitcnt lgkmcnt(0)
    ds_write_b128 v10, v[12:15] offset:16384
    ds_write_b128 v10, v[16:19] offset:17408
    ds_write_b128 v10, v[60:63] offset:18432
    ds_write_b128 v10, v[64:67] offset:19456
    s_waitcnt lgkmcnt(0)
    s_branch L_r_ldx
L_r_ld2:
    s_add_u32 m0, s64, 0
    s_add_u32 s33, s27, 0
    buffer_load_dwordx4 v68, s[48:51], s33 offen lds
    s_add_u32 m0, s64, 1024
    s_add_u32 s33, s27, 8192
    buffer_load_dwordx4 v188, s[48:51], s33 offen lds
    s_add_u32 m0, s64, 2048
    s_add_u32 s33, s27, 32768
    buffer_load_dwordx4 v68, s[48:51], s33 offen lds
    s_add_u32 m0, s64, 3072
    s_add_u32 s33, s27, 40960
    buffer_load_dwordx4 v188, s[48:51], s33 offen lds
    s_add_u32 m0, s64, 4096
    s_add_u32 s33, s27, 524288
    buffer_load_dwordx4 v68, s[48:51], s33 offen lds
    s_add_u32 m0, s64, 5120
    s_add_u32 s33, s27, 532480
    buffer_load_dwordx4 v188, s[48:51], s33 offen lds
    s_add_u32 m0, s64, 6144
    s_add_u32 s33, s27, 557056
    buffer_load_dwordx4 v68, s[48:51], s33 offen lds
    s_add_u32 m0, s64, 7168
    s_add_u32 s33, s27, 565248
    buffer_load_dwordx4 v188, s[48:51], s33 offen lds
    s_add_u32 m0, s64, 8192
    s_add_u32 s33, s27, 1179648
    buffer_load_dwordx4 v68, s[48:51], s33 offen lds
    s_add_u32 m0, s64, 9216
    s_add_u32 s33, s27, 1187840
    buffer_load_dwordx4 v188, s[48:51], s33 offen lds
    s_add_u32 m0, s64, 10240
    s_add_u32 s33, s27, 1212416
    buffer_load_dwordx4 v68, s[48:51], s33 offen lds
    s_add_u32 m0, s64, 11264
    s_add_u32 s33, s27, 1220608
    buffer_load_dwordx4 v188, s[48:51], s33 offen lds
    s_add_u32 m0, s64, 12288
    s_add_u32 s33, s27, 1703936
    buffer_load_dwordx4 v68, s[48:51], s33 offen lds
    s_add_u32 m0, s64, 13312
    s_add_u32 s33, s27, 1712128
    buffer_load_dwordx4 v188, s[48:51], s33 offen lds
    s_add_u32 m0, s64, 14336
    s_add_u32 s33, s27, 1736704
    buffer_load_dwordx4 v68, s[48:51], s33 offen lds
    s_add_u32 m0, s64, 15360
    s_add_u32 s33, s27, 1744896
    buffer_load_dwordx4 v188, s[48:51], s33 offen lds
    s_add_u32 m0, s64, 16384
    s_add_u32 s33, s27, 2359296
    buffer_load_dwordx4 v68, s[48:51], s33 offen lds
    s_add_u32 m0, s64, 17408
    s_add_u32 s33, s27, 2367488
    buffer_load_dwordx4 v188, s[48:51], s33 offen lds
    s_add_u32 m0, s64, 18432
    s_add_u32 s33, s27, 2392064
    buffer_load_dwordx4 v68, s[48:51], s33 offen lds
    s_add_u32 m0, s64, 19456
    s_add_u32 s33, s27, 2400256
    buffer_load_dwordx4 v188, s[48:51], s33 offen lds
    s_add_u32 m0, s64, 20480
    s_add_u32 s33, s27, 2883584
    buffer_load_dwordx4 v68, s[48:51], s33 offen lds
    s_add_u32 m0, s64, 21504
    s_add_u32 s33, s27, 2891776
    buffer_load_dwordx4 v188, s[48:51], s33 offen lds
    s_add_u32 m0, s64, 22528
    s_add_u32 s33, s27, 2916352
    buffer_load_dwordx4 v68, s[48:51], s33 offen lds
    s_add_u32 m0, s64, 23552
    s_add_u32 s33, s27, 2924544
    buffer_load_dwordx4 v188, s[48:51], s33 offen lds
    s_add_u32 m0, s64, 24576
    s_add_u32 s33, s27, 3538944
    buffer_load_dwordx4 v68, s[48:51], s33 offen lds
    s_add_u32 m0, s64, 25600
    s_add_u32 s33, s27, 3547136
    buffer_load_dwordx4 v188, s[48:51], s33 offen lds
    s_add_u32 m0, s64, 26624
    s_add_u32 s33, s27, 3571712
    buffer_load_dwordx4 v68, s[48:51], s33 offen lds
    s_add_u32 m0, s64, 27648
    s_add_u32 s33, s27, 3579904
    buffer_load_dwordx4 v188, s[48:51], s33 offen lds
    s_add_u32 m0, s64, 28672
    s_add_u32 s33, s27, 4063232
    buffer_load_dwordx4 v68, s[48:51], s33 offen lds
    s_add_u32 m0, s64, 29696
    s_add_u32 s33, s27, 4071424
    buffer_load_dwordx4 v188, s[48:51], s33 offen lds
    s_add_u32 m0, s64, 30720
    s_add_u32 s33, s27, 4096000
    buffer_load_dwordx4 v68, s[48:51], s33 offen lds
    s_add_u32 m0, s64, 31744
    s_add_u32 s33, s27, 4104192
    buffer_load_dwordx4 v188, s[48:51], s33 offen lds
    s_waitcnt vmcnt(28)
    s_barrier
    ds_read_b64_tr_b16 a[48:49], v184 offset:0
    ds_read_b64_tr_b16 a[50:51], v184 offset:34816
    ds_read_b64_tr_b16 a[52:53], v185 offset:0
    ds_read_b64_tr_b16 a[54:55], v185 offset:34816
    ds_read_b64_tr_b16 a[56:57], v186 offset:0
    ds_read_b64_tr_b16 a[58:59], v186 offset:34816
    ds_read_b64_tr_b16 a[60:61], v187 offset:0
    ds_read_b64_tr_b16 a[62:63], v187 offset:34816
    s_waitcnt lgkmcnt(0)
    s_waitcnt vmcnt(24)
    s_barrier
    s_add_u32 m0, s64, 0
    s_add_u32 s33, s34, 0
    buffer_load_dwordx4 v69, s[48:51], s33 offen lds
    s_add_u32 m0, s64, 1024
    s_add_u32 s33, s34, 32768
    buffer_load_dwordx4 v189, s[48:51], s33 offen lds
    s_add_u32 m0, s64, 2048
    s_add_u32 s33, s34, 1179648
    buffer_load_dwordx4 v69, s[48:51], s33 offen lds
    s_add_u32 m0, s64, 3072
    s_add_u32 s33, s34, 1212416
    buffer_load_dwordx4 v189, s[48:51], s33 offen lds
    ds_read_b64_tr_b16 a[64:65], v184 offset:4096
    ds_read_b64_tr_b16 a[66:67], v184 offset:38912
    ds_read_b64_tr_b16 a[68:69], v185 offset:4096
    ds_read_b64_tr_b16 a[70:71], v185 offset:38912
    ds_read_b64_tr_b16 a[72:73], v186 offset:4096
    ds_read_b64_tr_b16 a[74:75], v186 offset:38912
    ds_read_b64_tr_b16 a[76:77], v187 offset:4096
    ds_read_b64_tr_b16 a[78:79], v187 offset:38912
    s_waitcnt lgkmcnt(0)
    s_waitcnt vmcnt(24)
    s_barrier
    s_add_u32 m0, s64, 4096
    s_add_u32 s33, s27, 0
    buffer_load_dwordx4 v68, s[56:59], s33 offen lds
    s_add_u32 m0, s64, 5120
    s_add_u32 s33, s27, 8192
    buffer_load_dwordx4 v188, s[56:59], s33 offen lds
    s_add_u32 m0, s64, 6144
    s_add_u32 s33, s27, 32768
    buffer_load_dwordx4 v68, s[56:59], s33 offen lds
    s_add_u32 m0, s64, 7168
    s_add_u32 s33, s27, 40960
    buffer_load_dwordx4 v188, s[56:59], s33 offen lds
    ds_read_b64_tr_b16 a[80:81], v184 offset:8192
    ds_read_b64_tr_b16 a[82:83], v184 offset:43008
    ds_read_b64_tr_b16 a[84:85], v185 offset:8192
    ds_read_b64_tr_b16 a[86:87], v185 offset:43008
    ds_read_b64_tr_b16 a[88:89], v186 offset:8192
    ds_read_b64_tr_b16 a[90:91], v186 offset:43008
    ds_read_b64_tr_b16 a[92:93], v187 offset:8192
    ds_read_b64_tr_b16 a[94:95], v187 offset:43008
    s_waitcnt lgkmcnt(0)
    s_waitcnt vmcnt(24)
    s_barrier
    s_add_u32 m0, s64, 8192
    s_add_u32 s33, s27, 524288
    buffer_load_dwordx4 v68, s[56:59], s33 offen lds
    s_add_u32 m0, s64, 9216
    s_add_u32 s33, s27, 532480
    buffer_load_dwordx4 v188, s[56:59], s33 offen lds
    s_add_u32 m0, s64, 10240
    s_add_u32 s33, s27, 557056
    buffer_load_dwordx4 v68, s[56:59], s33 offen lds
    s_add_u32 m0, s64, 11264
    s_add_u32 s33, s27, 565248
    buffer_load_dwordx4 v188, s[56:59], s33 offen lds
    ds_read_b64_tr_b16 a[96:97], v184 offset:12288
    ds_read_b64_tr_b16 a[98:99], v184 offset:47104
    ds_read_b64_tr_b16 a[100:101], v185 offset:12288
    ds_read_b64_tr_b16 a[102:103], v185 offset:47104
    ds_read_b64_tr_b16 a[104:105], v186 offset:12288
    ds_read_b64_tr_b16 a[106:107], v186 offset:47104
    ds_read_b64_tr_b16 a[108:109], v187 offset:12288
    ds_read_b64_tr_b16 a[110:111], v187 offset:47104
    s_waitcnt lgkmcnt(0)
    s_waitcnt vmcnt(24)
    s_barrier
    s_add_u32 m0, s64, 12288
    s_add_u32 s33, s27, 1179648
    buffer_load_dwordx4 v68, s[56:59], s33 offen lds
    s_add_u32 m0, s64, 13312
    s_add_u32 s33, s27, 1187840
    buffer_load_dwordx4 v188, s[56:59], s33 offen lds
    s_add_u32 m0, s64, 14336
    s_add_u32 s33, s27, 1212416
    buffer_load_dwordx4 v68, s[56:59], s33 offen lds
    s_add_u32 m0, s64, 15360
    s_add_u32 s33, s27, 1220608
    buffer_load_dwordx4 v188, s[56:59], s33 offen lds
    ds_read_b64_tr_b16 a[112:113], v184 offset:16384
    ds_read_b64_tr_b16 a[114:115], v184 offset:51200
    ds_read_b64_tr_b16 a[116:117], v185 offset:16384
    ds_read_b64_tr_b16 a[118:119], v185 offset:51200
    ds_read_b64_tr_b16 a[120:121], v186 offset:16384
    ds_read_b64_tr_b16 a[122:123], v186 offset:51200
    ds_read_b64_tr_b16 a[124:125], v187 offset:16384
    ds_read_b64_tr_b16 a[126:127], v187 offset:51200
    s_waitcnt lgkmcnt(0)
    s_waitcnt vmcnt(24)
    s_barrier
    s_add_u32 m0, s64, 16384
    s_add_u32 s33, s27, 1703936
    buffer_load_dwordx4 v68, s[56:59], s33 offen lds
    s_add_u32 m0, s64, 17408
    s_add_u32 s33, s27, 1712128
    buffer_load_dwordx4 v188, s[56:59], s33 offen lds
    s_add_u32 m0, s64, 18432
    s_add_u32 s33, s27, 1736704
    buffer_load_dwordx4 v68, s[56:59], s33 offen lds
    s_add_u32 m0, s64, 19456
    s_add_u32 s33, s27, 1744896
    buffer_load_dwordx4 v188, s[56:59], s33 offen lds
    ds_read_b64_tr_b16 a[128:129], v184 offset:20480
    ds_read_b64_tr_b16 a[130:131], v184 offset:55296
    ds_read_b64_tr_b16 a[132:133], v185 offset:20480
    ds_read_b64_tr_b16 a[134:135], v185 offset:55296
    ds_read_b64_tr_b16 a[136:137], v186 offset:20480
    ds_read_b64_tr_b16 a[138:139], v186 offset:55296
    ds_read_b64_tr_b16 a[140:141], v187 offset:20480
    ds_read_b64_tr_b16 a[142:143], v187 offset:55296
    s_waitcnt lgkmcnt(0)
    s_waitcnt vmcnt(24)
    s_barrier
    s_add_u32 m0, s64, 20480
    s_add_u32 s33, s27, 2359296
    buffer_load_dwordx4 v68, s[56:59], s33 offen lds
    s_add_u32 m0, s64, 21504
    s_add_u32 s33, s27, 2367488
    buffer_load_dwordx4 v188, s[56:59], s33 offen lds
    s_add_u32 m0, s64, 22528
    s_add_u32 s33, s27, 2392064
    buffer_load_dwordx4 v68, s[56:59], s33 offen lds
    s_add_u32 m0, s64, 23552
    s_add_u32 s33, s27, 2400256
    buffer_load_dwordx4 v188, s[56:59], s33 offen lds
    ds_read_b64_tr_b16 a[0:1], v184 offset:24576
    ds_read_b64_tr_b16 a[2:3], v184 offset:59392
    ds_read_b64_tr_b16 a[4:5], v185 offset:24576
    ds_read_b64_tr_b16 a[6:7], v185 offset:59392
    ds_read_b64_tr_b16 a[8:9], v186 offset:24576
    ds_read_b64_tr_b16 a[10:11], v186 offset:59392
    ds_read_b64_tr_b16 a[12:13], v187 offset:24576
    ds_read_b64_tr_b16 a[14:15], v187 offset:59392
    s_waitcnt lgkmcnt(0)
    s_waitcnt vmcnt(24)
    s_barrier
    s_add_u32 m0, s64, 24576
    s_add_u32 s33, s27, 2883584
    buffer_load_dwordx4 v68, s[56:59], s33 offen lds
    s_add_u32 m0, s64, 25600
    s_add_u32 s33, s27, 2891776
    buffer_load_dwordx4 v188, s[56:59], s33 offen lds
    s_add_u32 m0, s64, 26624
    s_add_u32 s33, s27, 2916352
    buffer_load_dwordx4 v68, s[56:59], s33 offen lds
    s_add_u32 m0, s64, 27648
    s_add_u32 s33, s27, 2924544
    buffer_load_dwordx4 v188, s[56:59], s33 offen lds
    ds_read_b64_tr_b16 a[16:17], v184 offset:28672
    ds_read_b64_tr_b16 a[18:19], v184 offset:63488
    ds_read_b64_tr_b16 a[20:21], v185 offset:28672
    ds_read_b64_tr_b16 a[22:23], v185 offset:63488
    ds_read_b64_tr_b16 a[24:25], v186 offset:28672
    ds_read_b64_tr_b16 a[26:27], v186 offset:63488
    ds_read_b64_tr_b16 a[28:29], v187 offset:28672
    ds_read_b64_tr_b16 a[30:31], v187 offset:63488
    s_waitcnt lgkmcnt(0)
    s_waitcnt vmcnt(24)
    s_barrier
    s_add_u32 m0, s64, 28672
    s_add_u32 s33, s27, 3538944
    buffer_load_dwordx4 v68, s[56:59], s33 offen lds
    s_add_u32 m0, s64, 29696
    s_add_u32 s33, s27, 3547136
    buffer_load_dwordx4 v188, s[56:59], s33 offen lds
    s_add_u32 m0, s64, 30720
    s_add_u32 s33, s27, 3571712
    buffer_load_dwordx4 v68, s[56:59], s33 offen lds
    s_add_u32 m0, s64, 31744
    s_add_u32 s33, s27, 3579904
    buffer_load_dwordx4 v188, s[56:59], s33 offen lds
    ds_read_b64_tr_b16 a[32:33], v184 offset:0
    ds_read_b64_tr_b16 a[34:35], v184 offset:34816
    ds_read_b64_tr_b16 a[36:37], v185 offset:0
    ds_read_b64_tr_b16 a[38:39], v185 offset:34816
    ds_read_b64_tr_b16 a[40:41], v186 offset:0
    ds_read_b64_tr_b16 a[42:43], v186 offset:34816
    ds_read_b64_tr_b16 a[44:45], v187 offset:0
    ds_read_b64_tr_b16 a[46:47], v187 offset:34816
    s_waitcnt lgkmcnt(0)
    s_waitcnt vmcnt(24)
    s_barrier
    s_add_u32 m0, s64, 0
    s_add_u32 s33, s27, 4063232
    buffer_load_dwordx4 v68, s[56:59], s33 offen lds
    s_add_u32 m0, s64, 1024
    s_add_u32 s33, s27, 4071424
    buffer_load_dwordx4 v188, s[56:59], s33 offen lds
    s_add_u32 m0, s64, 2048
    s_add_u32 s33, s27, 4096000
    buffer_load_dwordx4 v68, s[56:59], s33 offen lds
    s_add_u32 m0, s64, 3072
    s_add_u32 s33, s27, 4104192
    buffer_load_dwordx4 v188, s[56:59], s33 offen lds
    ds_read_b64_tr_b16 v[80:81], v184 offset:4096
    ds_read_b64_tr_b16 v[82:83], v184 offset:38912
    ds_read_b64_tr_b16 v[84:85], v185 offset:4096
    ds_read_b64_tr_b16 v[86:87], v185 offset:38912
    ds_read_b64_tr_b16 v[88:89], v186 offset:4096
    ds_read_b64_tr_b16 v[90:91], v186 offset:38912
    ds_read_b64_tr_b16 v[92:93], v187 offset:4096
    ds_read_b64_tr_b16 v[94:95], v187 offset:38912
    s_waitcnt lgkmcnt(0)
    s_waitcnt vmcnt(24)
    s_barrier
    s_add_u32 m0, s64, 4096
    s_add_u32 s33, s34, 0
    buffer_load_dwordx4 v69, s[56:59], s33 offen lds
    s_add_u32 m0, s64, 5120
    s_add_u32 s33, s34, 32768
    buffer_load_dwordx4 v189, s[56:59], s33 offen lds
    s_add_u32 m0, s64, 6144
    s_add_u32 s33, s34, 1179648
    buffer_load_dwordx4 v69, s[56:59], s33 offen lds
    s_add_u32 m0, s64, 7168
    s_add_u32 s33, s34, 1212416
    buffer_load_dwordx4 v189, s[56:59], s33 offen lds
    s_mov_b32 s30, 160
    buffer_load_dword v190, v190, s[12:15], s30 offen sc1
    ds_read_b64_tr_b16 v[96:97], v184 offset:8192
    ds_read_b64_tr_b16 v[98:99], v184 offset:43008
    ds_read_b64_tr_b16 v[100:101], v185 offset:8192
    ds_read_b64_tr_b16 v[102:103], v185 offset:43008
    ds_read_b64_tr_b16 v[104:105], v186 offset:8192
    ds_read_b64_tr_b16 v[106:107], v186 offset:43008
    ds_read_b64_tr_b16 v[108:109], v187 offset:8192
    ds_read_b64_tr_b16 v[110:111], v187 offset:43008
    s_waitcnt lgkmcnt(0)
    s_waitcnt vmcnt(25)
    s_barrier
    s_add_u32 m0, s64, 8192
    s_add_u32 s33, s32, 0
    buffer_load_dwordx4 v70, s[60:63], s33 offen lds
    s_add_u32 m0, s64, 9216
    s_add_u32 s33, s32, 2304
    buffer_load_dwordx4 v70, s[60:63], s33 offen lds
    s_add_u32 m0, s64, 10240
    s_add_u32 s33, s32, 36864
    buffer_load_dwordx4 v70, s[60:63], s33 offen lds
    s_add_u32 m0, s64, 11264
    s_add_u32 s33, s32, 39168
    buffer_load_dwordx4 v70, s[60:63], s33 offen lds
    ds_read_b64_tr_b16 v[112:113], v184 offset:12288
    ds_read_b64_tr_b16 v[114:115], v184 offset:47104
    ds_read_b64_tr_b16 v[116:117], v185 offset:12288
    ds_read_b64_tr_b16 v[118:119], v185 offset:47104
    ds_read_b64_tr_b16 v[120:121], v186 offset:12288
    ds_read_b64_tr_b16 v[122:123], v186 offset:47104
    ds_read_b64_tr_b16 v[124:125], v187 offset:12288
    ds_read_b64_tr_b16 v[126:127], v187 offset:47104
    s_waitcnt lgkmcnt(0)
    s_waitcnt vmcnt(25)
    s_barrier
    s_add_u32 m0, s64, 12288
    s_add_u32 s33, s32, 64
    buffer_load_dwordx4 v70, s[60:63], s33 offen lds
    s_add_u32 m0, s64, 13312
    s_add_u32 s33, s32, 2368
    buffer_load_dwordx4 v70, s[60:63], s33 offen lds
    s_add_u32 m0, s64, 14336
    s_add_u32 s33, s32, 36928
    buffer_load_dwordx4 v70, s[60:63], s33 offen lds
    s_add_u32 m0, s64, 15360
    s_add_u32 s33, s32, 39232
    buffer_load_dwordx4 v70, s[60:63], s33 offen lds
    ds_read_b64_tr_b16 v[128:129], v184 offset:16384
    ds_read_b64_tr_b16 v[130:131], v184 offset:51200
    ds_read_b64_tr_b16 v[132:133], v185 offset:16384
    ds_read_b64_tr_b16 v[134:135], v185 offset:51200
    ds_read_b64_tr_b16 v[136:137], v186 offset:16384
    ds_read_b64_tr_b16 v[138:139], v186 offset:51200
    ds_read_b64_tr_b16 v[140:141], v187 offset:16384
    ds_read_b64_tr_b16 v[142:143], v187 offset:51200
    s_waitcnt lgkmcnt(0)
    s_waitcnt vmcnt(25)
    s_barrier
    s_add_u32 m0, s64, 16384
    s_add_u32 s33, s32, 128
    buffer_load_dwordx4 v70, s[60:63], s33 offen lds
    s_add_u32 m0, s64, 17408
    s_add_u32 s33, s32, 2432
    buffer_load_dwordx4 v70, s[60:63], s33 offen lds
    s_add_u32 m0, s64, 18432
    s_add_u32 s33, s32, 36992
    buffer_load_dwordx4 v70, s[60:63], s33 offen lds
    s_add_u32 m0, s64, 19456
    s_add_u32 s33, s32, 39296
    buffer_load_dwordx4 v70, s[60:63], s33 offen lds
    ds_read_b64_tr_b16 v[144:145], v184 offset:20480
    ds_read_b64_tr_b16 v[146:147], v184 offset:55296
    ds_read_b64_tr_b16 v[148:149], v185 offset:20480
    ds_read_b64_tr_b16 v[150:151], v185 offset:55296
    ds_read_b64_tr_b16 v[152:153], v186 offset:20480
    ds_read_b64_tr_b16 v[154:155], v186 offset:55296
    ds_read_b64_tr_b16 v[156:157], v187 offset:20480
    ds_read_b64_tr_b16 v[158:159], v187 offset:55296
    s_waitcnt lgkmcnt(0)
    s_waitcnt vmcnt(25)
    s_barrier
    s_add_u32 m0, s64, 20480
    s_add_u32 s33, s32, 192
    buffer_load_dwordx4 v70, s[60:63], s33 offen lds
    s_add_u32 m0, s64, 21504
    s_add_u32 s33, s32, 2496
    buffer_load_dwordx4 v70, s[60:63], s33 offen lds
    s_add_u32 m0, s64, 22528
    s_add_u32 s33, s32, 37056
    buffer_load_dwordx4 v70, s[60:63], s33 offen lds
    s_add_u32 m0, s64, 23552
    s_add_u32 s33, s32, 39360
    buffer_load_dwordx4 v70, s[60:63], s33 offen lds
    ds_read_b64_tr_b16 v[160:161], v184 offset:24576
    ds_read_b64_tr_b16 v[162:163], v184 offset:59392
    ds_read_b64_tr_b16 v[164:165], v185 offset:24576
    ds_read_b64_tr_b16 v[166:167], v185 offset:59392
    ds_read_b64_tr_b16 v[168:169], v186 offset:24576
    ds_read_b64_tr_b16 v[170:171], v186 offset:59392
    ds_read_b64_tr_b16 v[172:173], v187 offset:24576
    ds_read_b64_tr_b16 v[174:175], v187 offset:59392
    s_waitcnt lgkmcnt(0)
    s_waitcnt vmcnt(25)
    s_barrier
    s_add_u32 m0, s64, 24576
    s_add_u32 s33, s32, 256
    buffer_load_dwordx4 v70, s[60:63], s33 offen lds
    s_add_u32 m0, s64, 25600
    s_add_u32 s33, s32, 2560
    buffer_load_dwordx4 v70, s[60:63], s33 offen lds
    s_add_u32 m0, s64, 26624
    s_add_u32 s33, s32, 37120
    buffer_load_dwordx4 v70, s[60:63], s33 offen lds
    s_add_u32 m0, s64, 27648
    s_add_u32 s33, s32, 39424
    buffer_load_dwordx4 v70, s[60:63], s33 offen lds
    ds_read_b64_tr_b16 a[216:217], v184 offset:28672
    ds_read_b64_tr_b16 a[218:219], v184 offset:63488
    ds_read_b64_tr_b16 a[220:221], v185 offset:28672
    ds_read_b64_tr_b16 a[222:223], v185 offset:63488
    ds_read_b64_tr_b16 a[224:225], v186 offset:28672
    ds_read_b64_tr_b16 a[226:227], v186 offset:63488
    ds_read_b64_tr_b16 a[228:229], v187 offset:28672
    ds_read_b64_tr_b16 a[230:231], v187 offset:63488
    s_waitcnt lgkmcnt(0)
    s_waitcnt vmcnt(25)
    s_barrier
    s_add_u32 m0, s64, 28672
    s_add_u32 s33, s27, 0
    buffer_load_dwordx4 v68, s[52:55], s33 offen lds
    s_add_u32 m0, s64, 29696
    s_add_u32 s33, s27, 8192
    buffer_load_dwordx4 v188, s[52:55], s33 offen lds
    s_add_u32 m0, s64, 30720
    s_add_u32 s33, s27, 32768
    buffer_load_dwordx4 v68, s[52:55], s33 offen lds
    s_add_u32 m0, s64, 31744
    s_add_u32 s33, s27, 40960
    buffer_load_dwordx4 v188, s[52:55], s33 offen lds
    ds_read_b64_tr_b16 a[232:233], v184 offset:0
    ds_read_b64_tr_b16 a[234:235], v184 offset:34816
    ds_read_b64_tr_b16 a[236:237], v185 offset:0
    ds_read_b64_tr_b16 a[238:239], v185 offset:34816
    ds_read_b64_tr_b16 a[240:241], v186 offset:0
    ds_read_b64_tr_b16 a[242:243], v186 offset:34816
    ds_read_b64_tr_b16 a[244:245], v187 offset:0
    ds_read_b64_tr_b16 a[246:247], v187 offset:34816
    s_waitcnt lgkmcnt(0)
    s_waitcnt vmcnt(25)
    s_barrier
    s_add_u32 m0, s64, 0
    s_add_u32 s33, s27, 524288
    buffer_load_dwordx4 v68, s[52:55], s33 offen lds
    s_add_u32 m0, s64, 1024
    s_add_u32 s33, s27, 532480
    buffer_load_dwordx4 v188, s[52:55], s33 offen lds
    s_add_u32 m0, s64, 2048
    s_add_u32 s33, s27, 557056
    buffer_load_dwordx4 v68, s[52:55], s33 offen lds
    s_add_u32 m0, s64, 3072
    s_add_u32 s33, s27, 565248
    buffer_load_dwordx4 v188, s[52:55], s33 offen lds
    ds_read_b64_tr_b16 a[248:249], v184 offset:4096
    ds_read_b64_tr_b16 a[250:251], v184 offset:38912
    ds_read_b64_tr_b16 a[252:253], v185 offset:4096
    ds_read_b64_tr_b16 a[254:255], v185 offset:38912
    ds_read_b64_tr_b16 v[72:73], v186 offset:4096
    ds_read_b64_tr_b16 v[74:75], v186 offset:38912
    ds_read_b64_tr_b16 v[76:77], v187 offset:4096
    ds_read_b64_tr_b16 v[78:79], v187 offset:38912
    s_waitcnt lgkmcnt(0)
    s_waitcnt vmcnt(24)
    s_barrier
    s_add_u32 m0, s64, 4096
    s_add_u32 s33, s27, 1179648
    buffer_load_dwordx4 v68, s[52:55], s33 offen lds
    s_add_u32 m0, s64, 5120
    s_add_u32 s33, s27, 1187840
    buffer_load_dwordx4 v188, s[52:55], s33 offen lds
    s_add_u32 m0, s64, 6144
    s_add_u32 s33, s27, 1212416
    buffer_load_dwordx4 v68, s[52:55], s33 offen lds
    s_add_u32 m0, s64, 7168
    s_add_u32 s33, s27, 1220608
    buffer_load_dwordx4 v188, s[52:55], s33 offen lds
    ds_read_b64_tr_b16 v[176:177], v71 offset:8192
    ds_read_b64_tr_b16 v[178:179], v71 offset:9216
    ds_read_b64_tr_b16 v[180:181], v71 offset:10240
    ds_read_b64_tr_b16 v[182:183], v71 offset:11264
    ds_read_b64_tr_b16 v[192:193], v71 offset:8224
    ds_read_b64_tr_b16 v[194:195], v71 offset:9248
    ds_read_b64_tr_b16 v[196:197], v71 offset:10272
    ds_read_b64_tr_b16 v[198:199], v71 offset:11296
    s_waitcnt lgkmcnt(0)
    s_waitcnt vmcnt(24)
    s_barrier
    s_add_u32 m0, s64, 8192
    s_add_u32 s33, s27, 1703936
    buffer_load_dwordx4 v68, s[52:55], s33 offen lds
    s_add_u32 m0, s64, 9216
    s_add_u32 s33, s27, 1712128
    buffer_load_dwordx4 v188, s[52:55], s33 offen lds
    s_add_u32 m0, s64, 10240
    s_add_u32 s33, s27, 1736704
    buffer_load_dwordx4 v68, s[52:55], s33 offen lds
    s_add_u32 m0, s64, 11264
    s_add_u32 s33, s27, 1744896
    buffer_load_dwordx4 v188, s[52:55], s33 offen lds
    ds_read_b64_tr_b16 v[200:201], v71 offset:12288
    ds_read_b64_tr_b16 v[202:203], v71 offset:13312
    ds_read_b64_tr_b16 v[204:205], v71 offset:14336
    ds_read_b64_tr_b16 v[206:207], v71 offset:15360
    ds_read_b64_tr_b16 v[208:209], v71 offset:12320
    ds_read_b64_tr_b16 v[210:211], v71 offset:13344
    ds_read_b64_tr_b16 v[212:213], v71 offset:14368
    ds_read_b64_tr_b16 v[214:215], v71 offset:15392
    s_waitcnt lgkmcnt(0)
    s_waitcnt vmcnt(24)
    s_barrier
    s_add_u32 m0, s64, 12288
    s_add_u32 s33, s27, 2359296
    buffer_load_dwordx4 v68, s[52:55], s33 offen lds
    s_add_u32 m0, s64, 13312
    s_add_u32 s33, s27, 2367488
    buffer_load_dwordx4 v188, s[52:55], s33 offen lds
    s_add_u32 m0, s64, 14336
    s_add_u32 s33, s27, 2392064
    buffer_load_dwordx4 v68, s[52:55], s33 offen lds
    s_add_u32 m0, s64, 15360
    s_add_u32 s33, s27, 2400256
    buffer_load_dwordx4 v188, s[52:55], s33 offen lds
    v_readlane_b32 s30, v190, 0
    s_nop 0
    s_cmp_eq_u32 s30, 224
    s_cselect_b32 s18, 1, 0
    s_mov_b32 s29, 0
    s_mov_b32 s19, 0
    v_readlane_b32 s30, v190, 1
    s_nop 0
    s_add_u32 s29, s29, s30
    s_max_u32 s19, s19, s30
    v_readlane_b32 s30, v190, 2
    s_nop 0
    s_add_u32 s29, s29, s30
    s_max_u32 s19, s19, s30
    v_readlane_b32 s30, v190, 3
    s_nop 0
    s_add_u32 s29, s29, s30
    s_max_u32 s19, s19, s30
    v_readlane_b32 s30, v190, 4
    s_nop 0
    s_add_u32 s29, s29, s30
    s_max_u32 s19, s19, s30
    v_readlane_b32 s30, v190, 5
    s_nop 0
    s_add_u32 s29, s29, s30
    s_max_u32 s19, s19, s30
    v_readlane_b32 s30, v190, 6
    s_nop 0
    s_add_u32 s29, s29, s30
    s_max_u32 s19, s19, s30
    v_readlane_b32 s30, v190, 7
    s_nop 0
    s_add_u32 s29, s29, s30
    s_max_u32 s19, s19, s30
    v_readlane_b32 s30, v190, 8
    s_nop 0
    s_add_u32 s29, s29, s30
    s_max_u32 s19, s19, s30
    s_cmp_eq_u32 s29, 32
    s_cselect_b32 s18, s18, 0
    ds_read_b64_tr_b16 v[216:217], v71 offset:16384
    ds_read_b64_tr_b16 v[218:219], v71 offset:17408
    ds_read_b64_tr_b16 v[220:221], v71 offset:18432
    ds_read_b64_tr_b16 v[222:223], v71 offset:19456
    ds_read_b64_tr_b16 v[224:225], v71 offset:16416
    ds_read_b64_tr_b16 v[226:227], v71 offset:17440
    ds_read_b64_tr_b16 v[228:229], v71 offset:18464
    ds_read_b64_tr_b16 v[230:231], v71 offset:19488
    s_waitcnt lgkmcnt(0)
    s_waitcnt vmcnt(24)
    s_barrier
    s_add_u32 m0, s64, 16384
    s_add_u32 s33, s27, 2883584
    buffer_load_dwordx4 v68, s[52:55], s33 offen lds
    s_add_u32 m0, s64, 17408
    s_add_u32 s33, s27, 2891776
    buffer_load_dwordx4 v188, s[52:55], s33 offen lds
    s_add_u32 m0, s64, 18432
    s_add_u32 s33, s27, 2916352
    buffer_load_dwordx4 v68, s[52:55], s33 offen lds
    s_add_u32 m0, s64, 19456
    s_add_u32 s33, s27, 2924544
    buffer_load_dwordx4 v188, s[52:55], s33 offen lds
    ds_read_b64_tr_b16 v[232:233], v71 offset:20480
    ds_read_b64_tr_b16 v[234:235], v71 offset:21504
    ds_read_b64_tr_b16 v[236:237], v71 offset:22528
    ds_read_b64_tr_b16 v[238:239], v71 offset:23552
    ds_read_b64_tr_b16 v[240:241], v71 offset:20512
    ds_read_b64_tr_b16 v[242:243], v71 offset:21536
    ds_read_b64_tr_b16 v[244:245], v71 offset:22560
    ds_read_b64_tr_b16 v[246:247], v71 offset:23584
    s_waitcnt lgkmcnt(0)
    s_waitcnt vmcnt(24)
    s_barrier
    s_add_u32 m0, s64, 20480
    s_add_u32 s33, s27, 3538944
    buffer_load_dwordx4 v68, s[52:55], s33 offen lds
    s_add_u32 m0, s64, 21504
    s_add_u32 s33, s27, 3547136
    buffer_load_dwordx4 v188, s[52:55], s33 offen lds
    s_add_u32 m0, s64, 22528
    s_add_u32 s33, s27, 3571712
    buffer_load_dwordx4 v68, s[52:55], s33 offen lds
    s_add_u32 m0, s64, 23552
    s_add_u32 s33, s27, 3579904
    buffer_load_dwordx4 v188, s[52:55], s33 offen lds
    ds_read_b64_tr_b16 v[248:249], v71 offset:24576
    ds_read_b64_tr_b16 v[250:251], v71 offset:25600
    ds_read_b64_tr_b16 v[252:253], v71 offset:26624
    ds_read_b64_tr_b16 v[254:255], v71 offset:27648
    s_waitcnt lgkmcnt(0)
    s_waitcnt vmcnt(24)
    s_barrier
    s_add_u32 m0, s64, 24576
    s_add_u32 s33, s27, 4063232
    buffer_load_dwordx4 v68, s[52:55], s33 offen lds
    s_add_u32 m0, s64, 25600
    s_add_u32 s33, s27, 4071424
    buffer_load_dwordx4 v188, s[52:55], s33 offen lds
    s_add_u32 m0, s64, 26624
    s_add_u32 s33, s27, 4096000
    buffer_load_dwordx4 v68, s[52:55], s33 offen lds
    s_add_u32 m0, s64, 27648
    s_add_u32 s33, s27, 4104192
    buffer_load_dwordx4 v188, s[52:55], s33 offen lds
    ds_read_b64_tr_b16 a[168:169], v184 offset:28672
    ds_read_b64_tr_b16 a[170:171], v184 offset:63488
    ds_read_b64_tr_b16 a[172:173], v185 offset:28672
    ds_read_b64_tr_b16 a[174:175], v185 offset:63488
    ds_read_b64_tr_b16 v[12:13], v186 offset:28672
    ds_read_b64_tr_b16 v[14:15], v186 offset:63488
    ds_read_b64_tr_b16 v[16:17], v187 offset:28672
    ds_read_b64_tr_b16 v[18:19], v187 offset:63488
    s_waitcnt lgkmcnt(0)
    s_waitcnt vmcnt(24)
    s_barrier
    s_add_u32 m0, s64, 28672
    s_add_u32 s33, s34, 0
    buffer_load_dwordx4 v69, s[52:55], s33 offen lds
    s_add_u32 m0, s64, 29696
    s_add_u32 s33, s34, 32768
    buffer_load_dwordx4 v189, s[52:55], s33 offen lds
    s_add_u32 m0, s64, 30720
    s_add_u32 s33, s34, 1179648
    buffer_load_dwordx4 v69, s[52:55], s33 offen lds
    s_add_u32 m0, s64, 31744
    s_add_u32 s33, s34, 1212416
    buffer_load_dwordx4 v189, s[52:55], s33 offen lds
    ds_read_b64_tr_b16 a[176:177], v184 offset:0
    ds_read_b64_tr_b16 a[178:179], v184 offset:34816
    ds_read_b64_tr_b16 a[180:181], v185 offset:0
    ds_read_b64_tr_b16 a[182:183], v185 offset:34816
    ds_read_b64_tr_b16 v[20:21], v186 offset:0
    ds_read_b64_tr_b16 v[22:23], v186 offset:34816
    ds_read_b64_tr_b16 v[24:25], v187 offset:0
    ds_read_b64_tr_b16 v[26:27], v187 offset:34816
    s_waitcnt lgkmcnt(0)
    s_waitcnt vmcnt(24)
    s_barrier
    s_add_u32 m0, s64, 0
    s_add_u32 s33, s32, 73984
    buffer_load_dwordx4 v70, s[60:63], s33 offen lds
    s_add_u32 m0, s64, 1024
    s_add_u32 s33, s32, 76288
    buffer_load_dwordx4 v70, s[60:63], s33 offen lds
    s_add_u32 m0, s64, 2048
    s_add_u32 s33, s32, 110848
    buffer_load_dwordx4 v70, s[60:63], s33 offen lds
    s_add_u32 m0, s64, 3072
    s_add_u32 s33, s32, 113152
    buffer_load_dwordx4 v70, s[60:63], s33 offen lds
    ds_read_b64_tr_b16 a[184:185], v184 offset:4096
    ds_read_b64_tr_b16 a[186:187], v184 offset:38912
    ds_read_b64_tr_b16 a[188:189], v185 offset:4096
    ds_read_b64_tr_b16 a[190:191], v185 offset:38912
    ds_read_b64_tr_b16 v[28:29], v186 offset:4096
    ds_read_b64_tr_b16 v[30:31], v186 offset:38912
    ds_read_b64_tr_b16 v[32:33], v187 offset:4096
    ds_read_b64_tr_b16 v[34:35], v187 offset:38912
    s_waitcnt lgkmcnt(0)
    s_waitcnt vmcnt(24)
    s_barrier
    s_add_u32 m0, s64, 4096
    s_add_u32 s33, s32, 73792
    buffer_load_dwordx4 v70, s[60:63], s33 offen lds
    s_add_u32 m0, s64, 5120
    s_add_u32 s33, s32, 76096
    buffer_load_dwordx4 v70, s[60:63], s33 offen lds
    s_add_u32 m0, s64, 6144
    s_add_u32 s33, s32, 110656
    buffer_load_dwordx4 v70, s[60:63], s33 offen lds
    s_add_u32 m0, s64, 7168
    s_add_u32 s33, s32, 112960
    buffer_load_dwordx4 v70, s[60:63], s33 offen lds
    s_mov_b32 s30, 119668992
    buffer_load_dword v190, v191, s[8:11], s30 offen sc1
    ds_read_b64_tr_b16 a[192:193], v184 offset:8192
    ds_read_b64_tr_b16 a[194:195], v184 offset:43008
    ds_read_b64_tr_b16 a[196:197], v185 offset:8192
    ds_read_b64_tr_b16 a[198:199], v185 offset:43008
    ds_read_b64_tr_b16 v[36:37], v186 offset:8192
    ds_read_b64_tr_b16 v[38:39], v186 offset:43008
    ds_read_b64_tr_b16 v[40:41], v187 offset:8192
    ds_read_b64_tr_b16 v[42:43], v187 offset:43008
    s_waitcnt lgkmcnt(0)
    s_waitcnt vmcnt(25)
    s_barrier
    s_add_u32 m0, s64, 8192
    s_add_u32 s33, s32, 73856
    buffer_load_dwordx4 v70, s[60:63], s33 offen lds
    s_add_u32 m0, s64, 9216
    s_add_u32 s33, s32, 76160
    buffer_load_dwordx4 v70, s[60:63], s33 offen lds
    s_add_u32 m0, s64, 10240
    s_add_u32 s33, s32, 110720
    buffer_load_dwordx4 v70, s[60:63], s33 offen lds
    s_add_u32 m0, s64, 11264
    s_add_u32 s33, s32, 113024
    buffer_load_dwordx4 v70, s[60:63], s33 offen lds
    ds_read_b64_tr_b16 a[200:201], v184 offset:12288
    ds_read_b64_tr_b16 a[202:203], v184 offset:47104
    ds_read_b64_tr_b16 a[204:205], v185 offset:12288
    ds_read_b64_tr_b16 a[206:207], v185 offset:47104
    ds_read_b64_tr_b16 v[44:45], v186 offset:12288
    ds_read_b64_tr_b16 v[46:47], v186 offset:47104
    ds_read_b64_tr_b16 v[48:49], v187 offset:12288
    ds_read_b64_tr_b16 v[50:51], v187 offset:47104
    s_waitcnt lgkmcnt(0)
    s_waitcnt vmcnt(25)
    s_barrier
    s_add_u32 m0, s64, 12288
    s_add_u32 s33, s32, 73920
    buffer_load_dwordx4 v70, s[60:63], s33 offen lds
    s_add_u32 m0, s64, 13312
    s_add_u32 s33, s32, 76224
    buffer_load_dwordx4 v70, s[60:63], s33 offen lds
    s_add_u32 m0, s64, 14336
    s_add_u32 s33, s32, 110784
    buffer_load_dwordx4 v70, s[60:63], s33 offen lds
    s_add_u32 m0, s64, 15360
    s_add_u32 s33, s32, 113088
    buffer_load_dwordx4 v70, s[60:63], s33 offen lds
    ds_read_b64_tr_b16 a[208:209], v184 offset:16384
    ds_read_b64_tr_b16 a[210:211], v184 offset:51200
    ds_read_b64_tr_b16 a[212:213], v185 offset:16384
    ds_read_b64_tr_b16 a[214:215], v185 offset:51200
    ds_read_b64_tr_b16 v[52:53], v186 offset:16384
    ds_read_b64_tr_b16 v[54:55], v186 offset:51200
    ds_read_b64_tr_b16 v[56:57], v187 offset:16384
    ds_read_b64_tr_b16 v[58:59], v187 offset:51200
    s_waitcnt lgkmcnt(0)
    s_waitcnt vmcnt(25)
    s_barrier
    s_add_u32 m0, s64, 16384
    s_add_u32 s33, s32, 73728
    buffer_load_dwordx4 v70, s[60:63], s33 offen lds
    s_add_u32 m0, s64, 17408
    s_add_u32 s33, s32, 76032
    buffer_load_dwordx4 v70, s[60:63], s33 offen lds
    s_add_u32 m0, s64, 18432
    s_add_u32 s33, s32, 110592
    buffer_load_dwordx4 v70, s[60:63], s33 offen lds
    s_add_u32 m0, s64, 19456
    s_add_u32 s33, s32, 112896
    buffer_load_dwordx4 v70, s[60:63], s33 offen lds
    ds_read_b64_tr_b16 a[144:145], v184 offset:20480
    ds_read_b64_tr_b16 a[146:147], v184 offset:55296
    ds_read_b64_tr_b16 a[148:149], v185 offset:20480
    ds_read_b64_tr_b16 a[150:151], v185 offset:55296
    ds_read_b64_tr_b16 v[60:61], v186 offset:20480
    ds_read_b64_tr_b16 v[62:63], v186 offset:55296
    ds_read_b64_tr_b16 v[64:65], v187 offset:20480
    ds_read_b64_tr_b16 v[66:67], v187 offset:55296
    s_waitcnt lgkmcnt(0)
    s_waitcnt vmcnt(25)
    s_barrier
    ds_write_b128 v10, v[12:15] offset:20480
    ds_write_b128 v10, v[16:19] offset:21504
    ds_write_b128 v10, v[36:39] offset:22528
    ds_write_b128 v10, v[40:43] offset:23552
    ds_write_b128 v10, v[60:63] offset:32768
    ds_write_b128 v10, v[64:67] offset:33792
    ds_read_b64_tr_b16 a[152:153], v184 offset:24576
    ds_read_b64_tr_b16 a[154:155], v184 offset:59392
    ds_read_b64_tr_b16 a[156:157], v185 offset:24576
    ds_read_b64_tr_b16 a[158:159], v185 offset:59392
    ds_read_b64_tr_b16 v[12:13], v186 offset:24576
    ds_read_b64_tr_b16 v[14:15], v186 offset:59392
    ds_read_b64_tr_b16 v[16:17], v187 offset:24576
    ds_read_b64_tr_b16 v[18:19], v187 offset:59392
    s_waitcnt lgkmcnt(0)
    s_waitcnt vmcnt(21)
    s_barrier
    ds_write_b128 v10, v[20:23] offset:26624
    ds_write_b128 v10, v[24:27] offset:27648
    ds_write_b128 v10, v[12:15] offset:24576
    ds_write_b128 v10, v[16:19] offset:25600
    ds_read_b64_tr_b16 a[160:161], v184 offset:28672
    ds_read_b64_tr_b16 a[162:163], v184 offset:63488
    ds_read_b64_tr_b16 a[164:165], v185 offset:28672
    ds_read_b64_tr_b16 a[166:167], v185 offset:63488
    ds_read_b64_tr_b16 v[36:37], v186 offset:28672
    ds_read_b64_tr_b16 v[38:39], v186 offset:63488
    ds_read_b64_tr_b16 v[40:41], v187 offset:28672
    ds_read_b64_tr_b16 v[42:43], v187 offset:63488
    s_waitcnt lgkmcnt(0)
    s_waitcnt vmcnt(17)
    s_barrier
    ds_write_b128 v10, v[44:47] offset:28672
    ds_write_b128 v10, v[48:51] offset:29696
    ds_write_b128 v10, v[36:39] offset:30720
    ds_write_b128 v10, v[40:43] offset:31744
    ds_read_b64_tr_b16 v[60:61], v71 offset:0
    ds_read_b64_tr_b16 v[62:63], v71 offset:1024
    ds_read_b64_tr_b16 v[64:65], v71 offset:2048
    ds_read_b64_tr_b16 v[66:67], v71 offset:3072
    s_waitcnt lgkmcnt(0)
    s_waitcnt vmcnt(13)
    s_barrier
    ds_write_b128 v10, v[28:31] offset:0
    ds_write_b128 v10, v[32:35] offset:1024
    ds_write_b128 v10, v[52:55] offset:2048
    ds_write_b128 v10, v[56:59] offset:3072
    ds_read_b64_tr_b16 v[20:21], v71 offset:4096
    ds_read_b64_tr_b16 v[22:23], v71 offset:5120
    ds_read_b64_tr_b16 v[24:25], v71 offset:6144
    ds_read_b64_tr_b16 v[26:27], v71 offset:7168
    ds_read_b64_tr_b16 v[12:13], v71 offset:4128
    ds_read_b64_tr_b16 v[14:15], v71 offset:5152
    ds_read_b64_tr_b16 v[16:17], v71 offset:6176
    ds_read_b64_tr_b16 v[18:19], v71 offset:7200
    s_waitcnt lgkmcnt(0)
    s_waitcnt vmcnt(8)
    s_barrier
    ds_write_b128 v10, v[60:63] offset:4096
    ds_write_b128 v10, v[64:67] offset:5120
    ds_write_b128 v10, v[20:23] offset:6144
    ds_write_b128 v10, v[24:27] offset:7168
    ds_read_b64_tr_b16 v[44:45], v71 offset:8192
    ds_read_b64_tr_b16 v[46:47], v71 offset:9216
    ds_read_b64_tr_b16 v[48:49], v71 offset:10240
    ds_read_b64_tr_b16 v[50:51], v71 offset:11264
    ds_read_b64_tr_b16 v[36:37], v71 offset:8224
    ds_read_b64_tr_b16 v[38:39], v71 offset:9248
    ds_read_b64_tr_b16 v[40:41], v71 offset:10272
    ds_read_b64_tr_b16 v[42:43], v71 offset:11296
    s_waitcnt lgkmcnt(0)
    s_waitcnt vmcnt(4)
    s_barrier
    ds_write_b128 v10, v[12:15] offset:8192
    ds_write_b128 v10, v[16:19] offset:9216
    ds_write_b128 v10, v[44:47] offset:10240
    ds_write_b128 v10, v[48:51] offset:11264
    v_cmp_eq_u32 vcc, 0, v190
    s_nop 0
    s_cmp_eq_u64 vcc, 0
    s_cselect_b32 s30, 3, 1
    s_mul_i32 s18, s18, s30
    ds_read_b64_tr_b16 v[28:29], v71 offset:12288
    ds_read_b64_tr_b16 v[30:31], v71 offset:13312
    ds_read_b64_tr_b16 v[32:33], v71 offset:14336
    ds_read_b64_tr_b16 v[34:35], v71 offset:15360
    ds_read_b64_tr_b16 v[52:53], v71 offset:12320
    ds_read_b64_tr_b16 v[54:55], v71 offset:13344
    ds_read_b64_tr_b16 v[56:57], v71 offset:14368
    ds_read_b64_tr_b16 v[58:59], v71 offset:15392
    s_waitcnt lgkmcnt(0)
    s_waitcnt vmcnt(0)
    s_barrier
    ds_write_b128 v10, v[36:39] offset:12288
    ds_write_b128 v10, v[40:43] offset:13312
    ds_write_b128 v10, v[28:31] offset:14336
    ds_write_b128 v10, v[32:35] offset:15360
    ds_read_b64_tr_b16 v[184:185], v71 offset:16384
    ds_read_b64_tr_b16 v[186:187], v71 offset:17408
    ds_read_b64_tr_b16 v[188:189], v71 offset:18432
    ds_read_b64_tr_b16 v[190:191], v71 offset:19456
    ds_read_b64_tr_b16 v[60:61], v71 offset:16416
    ds_read_b64_tr_b16 v[62:63], v71 offset:17440
    ds_read_b64_tr_b16 v[64:65], v71 offset:18464
    ds_read_b64_tr_b16 v[66:67], v71 offset:19488
    s_waitcnt lgkmcnt(0)
    ds_write_b128 v10, v[52:55] offset:16384
    ds_write_b128 v10, v[56:59] offset:17408
    ds_write_b128 v10, v[60:63] offset:18432
    ds_write_b128 v10, v[64:67] offset:19456
    s_waitcnt lgkmcnt(0)
L_r_ldx:
    s_mov_b32 s29, 0
    s_mov_b32 s33, s19
    s_mov_b32 s62, s18
    s_cmp_lg_u32 s18, 0
    s_cbranch_scc1 L_r_regok
    s_mov_b32 s31, 160
L_r_ini:
    buffer_load_dword v22, off, s[12:15], s31 sc1
    s_add_u32 s29, s29, 1
    s_cmp_ge_u32 s29, 4194304
    s_cbranch_scc1 L_abort
    s_waitcnt vmcnt(0)
    v_readfirstlane_b32 s30, v22
    s_nop 0
    s_cmp_eq_u32 s30, 224
    s_nop 2
    s_cbranch_scc1 L_r_iniok
    s_sleep 8
    s_branch L_r_ini
L_r_iniok:
    v_and_b32 v21, 7, v0
    v_lshlrev_b32 v21, 2, v21
    s_mov_b32 s31, 164
    s_mov_b32 s29, 0
L_r_reg:
    buffer_load_dword v22, v21, s[12:15], s31 offen sc1
    s_add_u32 s29, s29, 1
    s_cmp_ge_u32 s29, 4194304
    s_cbranch_scc1 L_abort
    s_waitcnt vmcnt(0)
    s_mov_b32 s32, 0
    s_mov_b32 s33, 0
    v_readlane_b32 s30, v22, 0
    s_nop 0
    s_add_u32 s32, s32, s30
    s_max_u32 s33, s33, s30
    v_readlane_b32 s30, v22, 1
    s_nop 0
    s_add_u32 s32, s32, s30
    s_max_u32 s33, s33, s30
    v_readlane_b32 s30, v22, 2
    s_nop 0
    s_add_u32 s32, s32, s30
    s_max_u32 s33, s33, s30
    v_readlane_b32 s30, v22, 3
    s_nop 0
    s_add_u32 s32, s32, s30
    s_max_u32 s33, s33, s30
    v_readlane_b32 s30, v22, 4
    s_nop 0
    s_add_u32 s32, s32, s30
    s_max_u32 s33, s33, s30
    v_readlane_b32 s30, v22, 5
    s_nop 0
    s_add_u32 s32, s32, s30
    s_max_u32 s33, s33, s30
    v_readlane_b32 s30, v22, 6
    s_nop 0
    s_add_u32 s32, s32, s30
    s_max_u32 s33, s33, s30
    v_readlane_b32 s30, v22, 7
    s_nop 0
    s_add_u32 s32, s32, s30
    s_max_u32 s33, s33, s30
    s_cmp_lt_u32 s32, 32
    s_nop 0
    s_cbranch_scc1 L_r_reg
L_r_regok:
    s_waitcnt vmcnt(0)
    s_barrier
    s_cmp_lg_u32 s17, 0
    s_cbranch_scc1 L_r_rw
    s_mov_b32 s31, 196
    s_mov_b64 exec, 1
    v_mov_b32 v20, 1
    buffer_atomic_add v20, off, s[12:15], s31 sc1
    s_mov_b64 exec, -1
L_r_rw:
    s_cmp_lg_u32 s33, 32
    s_cselect_b32 s19, 1, 0
    s_mov_b32 s18, 0
    s_mov_b32 s35, 118489088
    s_mov_b32 s23, 118498304
    s_mov_b32 s22, 118507520
    s_mul_i32 s20, s16, 9344
    s_add_u32 s20, s20, 117440512
    s_mul_i32 s61, s17, 2304
    s_add_u32 s61, s61, 2048
    s_add_u32 s61, s61, s20
    s_mov_b32 s44, 117964800
    s_mov_b32 s45, 118039552
    s_mov_b32 s46, 118114304
    s_mov_b32 s47, 118189056
    s_lshl_b32 s31, s16, 13
    s_add_u32 s24, s31, 20971520
    s_lshl_b32 s32, s17, 11
    s_add_u32 s32, s31, s32
    s_add_u32 s25, s32, 37748736
    s_mov_b32 s38, 120061952
    s_mov_b32 s39, 54535168
    s_cmp_eq_u32 s28, 1
    s_cselect_b32 s40, 0x00ff00ff, 0
    s_mov_b32 s41, 0
    s_cmp_lt_u32 s66, 3
    s_cselect_b64 s[42:43], -1, 0
    s_mov_b32 s68, 0x3e0293ee
    s_lshl_b32 s31, s16, 3
    v_and_b32 v21, 1, v0
    v_lshlrev_b32 v21, 2, v21
    v_bfe_u32 v20, v0, 1, 1
    v_lshl_add_u32 v21, v20, 8, v21
    v_bfe_u32 v20, v0, 2, 2
    v_min_u32 v20, 2, v20
    v_lshl_add_u32 v21, v20, 10, v21
    v_add_u32 v21, s31, v21
    s_mov_b32 s36, 119668992
    s_mov_b32 s29, 0
    s_cmp_eq_u32 s62, 3
    s_cbranch_scc1 L_r_f01ok
L_r_f01:
    buffer_load_dword v22, v21, s[8:11], s36 offen sc1
    s_add_u32 s29, s29, 1
    s_cmp_ge_u32 s29, 4194304
    s_cbranch_scc1 L_abort
    s_waitcnt vmcnt(0)
    v_cmp_eq_u32 vcc, 0, v22
    s_cbranch_vccz L_r_f01ok
    s_sleep 4
    s_branch L_r_f01
L_r_f01ok:
    s_cmp_eq_u32 s19, 1
    s_cbranch_scc1 L_r_slow
    s_cmp_eq_u32 s17, 3
    s_cbranch_scc1 L_rfi_entry
    s_cmp_eq_u32 s28, 0
    s_cbranch_scc1 L_rfg_entry
L_rfr_entry:
    v_mov_b32 v24, 0
    v_mov_b32 v25, 0
    v_mov_b32 v26, 0
    v_mov_b32 v27, 0
    v_mov_b32 v28, 0
    v_mov_b32 v29, 0
    v_mov_b32 v30, 0
    v_mov_b32 v31, 0
    v_mov_b32 v32, 0
    v_mov_b32 v33, 0
    v_mov_b32 v34, 0
    v_mov_b32 v35, 0
    v_mov_b32 v36, 0
    v_mov_b32 v37, 0
    v_mov_b32 v38, 0
    v_mov_b32 v39, 0
    s_add_u32 m0, s65, 9216
    s_add_u32 s30, s24, s65
    buffer_load_dwordx4 v1, s[8:11], s30 offen lds
    buffer_load_dwordx4 v1, s[8:11], s30 offen offset:3072 lds
    s_add_u32 m0, s69, 9216
    s_add_u32 s30, s24, s69
    buffer_load_dwordx4 v1, s[8:11], s30 offen lds
    s_add_u32 s24, s24, 262144
    s_branch L_rfr_gather
L_rfr_top:
    s_mov_b32 s29, 0
    s_nop 7
    s_nop 7
    buffer_load_dwordx4 v[40:43], v6, s[8:11], s44 offen sc1
    buffer_load_dwordx4 v[44:47], v6, s[8:11], s45 offen sc1
    buffer_load_dwordx4 v[48:51], v6, s[8:11], s46 offen sc1
    buffer_load_dwordx4 v[52:55], v6, s[8:11], s47 offen sc1
    s_nop 7
    s_nop 7
    s_nop 7
    s_nop 7
    s_nop 7
    s_nop 7
L_rfr_e1:
    buffer_load_dwordx4 v[56:59], v6, s[8:11], s44 offen sc1
    buffer_load_dwordx4 v[60:63], v6, s[8:11], s45 offen sc1
    buffer_load_dwordx4 v[68:71], v6, s[8:11], s46 offen sc1
    buffer_load_dwordx4 v[20:23], v6, s[8:11], s47 offen sc1
    s_waitcnt vmcnt(7) lgkmcnt(0)
    v_mfma_f32_16x16x32_bf16 v[16:19], v[12:15], v[40:43], 0
    s_waitcnt vmcnt(6) lgkmcnt(0)
    v_mfma_f32_16x16x32_bf16 v[16:19], v[12:15], v[44:47], v[16:19]
    s_waitcnt vmcnt(5) lgkmcnt(0)
    v_mfma_f32_16x16x32_bf16 v[16:19], v[12:15], v[48:51], v[16:19]
    s_waitcnt vmcnt(4) lgkmcnt(0)
    v_mfma_f32_16x16x32_bf16 v[16:19], v[12:15], v[52:55], v[16:19]
    s_add_u32 s29, s29, 1
    s_mov_b32 exec_hi, 0
    s_nop 5
    v_cmp_u_f32 vcc, v16, v16
    s_cbranch_vccz L_rfr_e1ok
    s_mov_b32 exec_hi, -1
    buffer_load_dwordx4 v[40:43], v6, s[8:11], s44 offen sc1
    buffer_load_dwordx4 v[44:47], v6, s[8:11], s45 offen sc1
    buffer_load_dwordx4 v[48:51], v6, s[8:11], s46 offen sc1
    buffer_load_dwordx4 v[52:55], v6, s[8:11], s47 offen sc1
    s_waitcnt vmcnt(7) lgkmcnt(0)
    v_mfma_f32_16x16x32_bf16 v[16:19], v[12:15], v[56:59], 0
    s_waitcnt vmcnt(6) lgkmcnt(0)
    v_mfma_f32_16x16x32_bf16 v[16:19], v[12:15], v[60:63], v[16:19]
    s_waitcnt vmcnt(5) lgkmcnt(0)
    v_mfma_f32_16x16x32_bf16 v[16:19], v[12:15], v[68:71], v[16:19]
    s_waitcnt vmcnt(4) lgkmcnt(0)
    v_mfma_f32_16x16x32_bf16 v[16:19], v[12:15], v[20:23], v[16:19]
    s_add_u32 s29, s29, 1
    s_mov_b32 exec_hi, 0
    s_nop 5
    v_cmp_u_f32 vcc, v16, v16
    s_cbranch_vccz L_rfr_e1ok
    s_mov_b32 exec_hi, -1
    s_cmp_lt_u32 s29, 4096
    s_cbranch_scc1 L_rfr_e1
    s_branch L_rfr_e1x
L_rfr_e1ok:
    v_add_f32_dpp v16, v16, v16 row_ror:8 row_mask:0xf bank_mask:0xf
    v_add_f32_dpp v17, v17, v17 row_ror:8 row_mask:0xf bank_mask:0xf
    v_add_f32_dpp v18, v18, v18 row_ror:8 row_mask:0xf bank_mask:0xf
    v_add_f32_dpp v19, v19, v19 row_ror:8 row_mask:0xf bank_mask:0xf
    v_cvt_pk_bf16_f32 v64, v16, v17
    v_cvt_pk_bf16_f32 v65, v18, v19
    s_mov_b32 exec_lo, 0x00ff00ff
    buffer_store_dwordx2 v[64:65], v7, s[8:11], s35 offen
    s_mov_b64 exec, -1
    s_cmp_ge_u32 s18, 63
    s_cbranch_scc1 L_rfr_last
L_rfr_gather:
    s_barrier
    s_mov_b32 s30, s22
    s_mov_b32 s22, s35
    s_mov_b32 s35, s23
    s_mov_b32 s23, s30
    s_mov_b32 s56, s44
    s_xor_b32 s44, s44, 524288
    s_mov_b32 s57, s45
    s_xor_b32 s45, s45, 524288
    s_mov_b32 s58, s46
    s_xor_b32 s46, s46, 524288
    s_mov_b32 s59, s47
    s_xor_b32 s47, s47, 524288
    s_waitcnt vmcnt(1)
    v_mov_b32 v68, -1
    v_mov_b32 v69, -1
    v_mov_b32 v70, -1
    v_mov_b32 v71, -1
    s_mov_b32 s29, 1
    ds_read_b128 v[40:43], v10 offset:32768
    ds_read_b128 v[44:47], v10 offset:33792
    ds_read_b128 v[48:51], v10 offset:24576
    ds_read_b128 v[52:55], v10 offset:25600
    ds_read_b128 v[56:59], v10 offset:30720
    ds_read_b128 v[60:63], v10 offset:31744
    s_nop 7
    s_nop 7
    buffer_load_dwordx4 v[12:15], v11, s[8:11], s22 offen offset:0 sc1
    buffer_load_dwordx4 v[16:19], v11, s[8:11], s22 offen offset:1024 sc1
    buffer_load_dwordx4 v[20:23], v11, s[8:11], s22 offen offset:2048 sc1
    s_waitcnt vmcnt(2)
    v_max3_u32 v66, v12, v13, v14
    s_waitcnt vmcnt(1)
    v_max3_u32 v66, v66, v15, v16
    v_max3_u32 v66, v66, v17, v18
    s_waitcnt vmcnt(0)
    v_max3_u32 v66, v66, v19, v20
    v_max3_u32 v66, v66, v21, v22
    v_max_u32 v66, v66, v23
    v_cmp_eq_u32 vcc, -1, v66
    s_nop 0
    s_cbranch_vccnz L_rfr_e2
L_rfr_e2ok:
    ds_write_b128 v11, v[12:15] offset:0
    ds_write_b128 v11, v[16:19] offset:1024
    ds_write_b128 v11, v[20:23] offset:2048
    s_waitcnt lgkmcnt(7)
    v_smfmac_f32_16x16x64_bf16 v[36:39], v[12:15], v[40:47], v3
    ds_read_b128 v[40:43], v10 offset:20480
    v_smfmac_f32_16x16x64_bf16 v[24:27], v[12:15], a[0:7], v3
    ds_read_b128 v[44:47], v10 offset:21504
    v_smfmac_f32_16x16x64_bf16 v[32:35], v[12:15], a[144:151], v3
    buffer_store_dwordx4 v[68:71], v6, s[8:11], s56 offen
    v_smfmac_f32_16x16x64_bf16 v[28:31], v[12:15], a[8:15], v3
    buffer_store_dwordx4 v[68:71], v6, s[8:11], s57 offen
    s_waitcnt lgkmcnt(7)
    v_smfmac_f32_16x16x64_bf16 v[36:39], v[16:19], v[48:55], v3
    ds_read_b128 v[48:51], v10 offset:26624
    v_smfmac_f32_16x16x64_bf16 v[24:27], v[16:19], a[16:23], v3
    s_waitcnt lgkmcnt(3)
    s_barrier
    ds_read_b128 v[12:15], v2 offset:0
    v_smfmac_f32_16x16x64_bf16 v[32:35], v[16:19], a[152:159], v3
    ds_read_b128 v[52:55], v10 offset:27648
    v_smfmac_f32_16x16x64_bf16 v[28:31], v[16:19], a[24:31], v3
    buffer_store_dwordx4 v[68:71], v6, s[8:11], s58 offen
    buffer_store_dwordx4 v[68:71], v6, s[8:11], s59 offen
    v_smfmac_f32_16x16x64_bf16 v[36:39], v[20:23], v[56:63], v3
    ds_read_b128 v[16:19], v2 offset:1024
    v_smfmac_f32_16x16x64_bf16 v[24:27], v[20:23], a[32:39], v3
    ds_read_b128 v[56:59], v10 offset:0
    v_smfmac_f32_16x16x64_bf16 v[32:35], v[20:23], a[160:167], v3
    ds_read_b128 v[60:63], v10 offset:1024
    v_smfmac_f32_16x16x64_bf16 v[28:31], v[20:23], a[40:47], v3
    s_waitcnt lgkmcnt(4)
    v_smfmac_f32_16x16x64_bf16 v[36:39], v[12:15], v[40:47], v3
    ds_read_b128 v[40:43], v10 offset:22528
    v_smfmac_f32_16x16x64_bf16 v[24:27], v[12:15], a[48:55], v3
    ds_read_b128 v[44:47], v10 offset:23552
    v_smfmac_f32_16x16x64_bf16 v[32:35], v[12:15], a[168:175], v3
    ds_read_b128 v[20:23], v2 offset:2048
    v_smfmac_f32_16x16x64_bf16 v[28:31], v[12:15], a[56:63], v3
    s_mov_b64 exec, s[40:41]
    buffer_store_dwordx2 v[68:69], v7, s[8:11], s23 offen
    s_mov_b64 exec, -1
    s_waitcnt lgkmcnt(5)
    v_smfmac_f32_16x16x64_bf16 v[36:39], v[16:19], v[48:55], v3
    ds_read_b128 v[48:51], v10 offset:28672
    v_smfmac_f32_16x16x64_bf16 v[24:27], v[16:19], a[64:71], v3
    ds_read_b128 v[52:55], v10 offset:29696
    v_smfmac_f32_16x16x64_bf16 v[32:35], v[16:19], a[176:183], v3
    ds_read_b128 v[12:15], v9 offset:0
    v_smfmac_f32_16x16x64_bf16 v[28:31], v[16:19], a[72:79], v3
    s_waitcnt lgkmcnt(3)
    v_smfmac_f32_16x16x64_bf16 v[36:39], v[20:23], v[56:63], v3
    ds_read_b128 v[56:59], v10 offset:2048
    v_smfmac_f32_16x16x64_bf16 v[24:27], v[20:23], a[80:87], v3
    ds_read_b128 v[60:63], v10 offset:3072
    v_smfmac_f32_16x16x64_bf16 v[32:35], v[20:23], a[184:191], v3
    ds_read_b128 v[16:19], v9 offset:1024
    v_smfmac_f32_16x16x64_bf16 v[28:31], v[20:23], a[88:95], v3
    s_waitcnt lgkmcnt(3)
    v_smfmac_f32_16x16x64_bf16 v[36:39], v[12:15], v[40:47], v3
    ds_read_b128 v[64:67], v1 offset:9216
    v_smfmac_f32_16x16x64_bf16 v[24:27], v[12:15], a[96:103], v3
    ds_read_b128 v[68:71], v1 offset:10240
    v_smfmac_f32_16x16x64_bf16 v[32:35], v[12:15], a[192:199], v3
    ds_read_b128 v[20:23], v9 offset:2048
    v_smfmac_f32_16x16x64_bf16 v[28:31], v[12:15], a[104:111], v3
    s_waitcnt lgkmcnt(3)
    v_smfmac_f32_16x16x64_bf16 v[36:39], v[16:19], v[48:55], v3
    v_mov_b32 v40, 0
    v_smfmac_f32_16x16x64_bf16 v[24:27], v[16:19], a[112:119], v3
    v_mov_b32 v41, 0
    v_smfmac_f32_16x16x64_bf16 v[32:35], v[16:19], a[200:207], v3
    ds_read_b128 v[12:15], v11 offset:0
    v_smfmac_f32_16x16x64_bf16 v[28:31], v[16:19], a[120:127], v3
    v_mov_b32 v42, 0
    v_mov_b32 v43, 0
    s_waitcnt lgkmcnt(1)
    v_smfmac_f32_16x16x64_bf16 v[32:35], v[20:23], a[208:215], v3
    v_mov_b32 v44, 0
    v_smfmac_f32_16x16x64_bf16 v[24:27], v[20:23], a[128:135], v3
    v_mov_b32 v45, 0
    v_smfmac_f32_16x16x64_bf16 v[36:39], v[20:23], v[56:63], v3
    ds_read_b128 v[16:19], v11 offset:1024
    v_smfmac_f32_16x16x64_bf16 v[28:31], v[20:23], a[136:143], v3
    v_mov_b32 v46, 0
    v_mov_b32 v47, 0
    ds_read_b128 v[20:23], v11 offset:2048
    s_waitcnt lgkmcnt(2)
    v_smfmac_f32_16x16x64_bf16 v[40:43], v[12:15], a[216:223], v3
    v_add_f32 v32, v32, v34
    v_add_f32 v33, v33, v35
    v_add_f32 v24, v24, v26
    v_add_f32 v25, v25, v27
    v_cvt_pk_bf16_f32 v32, v32, v33
    v_cvt_pk_bf16_f32 v33, v24, v25
    ds_write_b64 v4, v[32:33] offset:0
    v_add_f32 v36, v36, v38
    v_add_f32 v37, v37, v39
    v_add_f32 v28, v28, v30
    v_add_f32 v29, v29, v31
    v_cvt_pk_bf16_f32 v36, v36, v37
    v_cvt_pk_bf16_f32 v37, v28, v29
    ds_write_b64 v4, v[36:37] offset:256
    v_lshrrev_b32 v35, 1, v1
    ds_read_b128 v[24:27], v1 offset:11264
    ds_read_b128 v[28:31], v1 offset:12288
    v_smfmac_f32_16x16x64_bf16 v[44:47], v[12:15], a[224:231], v3
    ds_read_b128 v[12:15], v2 offset:0
    s_waitcnt lgkmcnt(6)
    v_smfmac_f32_16x16x64_bf16 v[40:43], v[16:19], a[232:239], v3
    v_smfmac_f32_16x16x64_bf16 v[44:47], v[16:19], a[240:247], v3
    ds_read_b128 v[16:19], v2 offset:1024
    s_waitcnt lgkmcnt(4)
    s_barrier
    ds_read_b64_tr_b16 v[48:49], v35 offset:17408
    ds_read_b64_tr_b16 v[50:51], v35 offset:17920
    ds_read_b64_tr_b16 v[52:53], v35 offset:18432
    ds_read_b64_tr_b16 v[54:55], v35 offset:18944
    ds_read_b64_tr_b16 v[56:57], v35 offset:19456
    ds_read_b64_tr_b16 v[58:59], v35 offset:19968
    ds_read_b64_tr_b16 v[60:61], v35 offset:20480
    ds_read_b64_tr_b16 v[62:63], v35 offset:20992
    v_smfmac_f32_16x16x64_bf16 v[40:43], v[20:23], a[248:255], v3
    v_smfmac_f32_16x16x64_bf16 v[44:47], v[20:23], v[72:79], v3
    s_waitcnt lgkmcnt(6)
    v_mfma_f32_16x16x32_bf16 v[32:35], v[48:51], v[48:51], 0
    v_mfma_f32_16x16x32_bf16 v[36:39], v[64:67], v[48:51], 0
    ds_read_b128 v[64:67], v1 offset:13312
    v_mfma_f32_16x16x32_bf16 v[20:23], v[68:71], v[48:51], 0
    ds_read_b128 v[68:71], v1 offset:14336
    s_waitcnt lgkmcnt(6)
    v_mfma_f32_16x16x32_bf16 v[32:35], v[52:55], v[52:55], v[32:35]
    v_mfma_f32_16x16x32_bf16 v[36:39], v[24:27], v[52:55], v[36:39]
    ds_read_b128 v[24:27], v1 offset:15360
    v_mfma_f32_16x16x32_bf16 v[20:23], v[28:31], v[52:55], v[20:23]
    ds_read_b128 v[28:31], v1 offset:16384
    v_smfmac_f32_16x16x64_bf16 v[40:43], v[12:15], v[80:87], v3
    s_waitcnt lgkmcnt(2)
    v_mfma_f32_16x16x32_bf16 v[32:35], v[56:59], v[56:59], v[32:35]
    v_mfma_f32_16x16x32_bf16 v[36:39], v[64:67], v[56:59], v[36:39]
    v_mfma_f32_16x16x32_bf16 v[20:23], v[68:71], v[56:59], v[20:23]
    ds_read_b128 v[56:59], v2 offset:2048
    s_waitcnt lgkmcnt(1)
    v_mfma_f32_16x16x32_bf16 v[32:35], v[60:63], v[60:63], v[32:35]
    v_mfma_f32_16x16x32_bf16 v[36:39], v[24:27], v[60:63], v[36:39]
    v_mov_b32 v48, 0x3f803f80
    v_mov_b32 v49, 0x3f803f80
    v_mfma_f32_16x16x32_bf16 v[20:23], v[28:31], v[60:63], v[20:23]
    v_mov_b32 v50, 0x3f803f80
    v_mov_b32 v51, 0x3f803f80
    ds_read_b128 v[60:63], v9 offset:0
    v_smfmac_f32_16x16x64_bf16 v[44:47], v[12:15], v[88:95], v3
    ds_read_b128 v[12:15], v9 offset:1024
    buffer_load_dwordx4 v[64:67], v1, s[8:11], s25 offen offset:0
    v_smfmac_f32_16x16x64_bf16 v[40:43], v[16:19], v[96:103], v3
    buffer_load_dwordx4 v[68:71], v1, s[8:11], s25 offen offset:1024
    v_max3_f32 v30, v32, v33, v36
    v_max3_f32 v31, v37, v38, v39
    v_max3_f32 v30, v30, v20, v21
    v_max3_f32 v31, v31, v22, v23
    v_max_f32 v30, v30, v31
    v_max_f32 v31, v30, v31
    v_smfmac_f32_16x16x64_bf16 v[44:47], v[16:19], v[104:111], v3
    ds_read_b128 v[16:19], v9 offset:2048
    v_mov_b32 v52, 0x3f003f00
    v_permlane16_swap_b32 v30, v31
    v_max_f32 v30, v30, v31
    v_max_f32 v31, v30, v31
    s_waitcnt lgkmcnt(3)
    v_smfmac_f32_16x16x64_bf16 v[40:43], v[56:59], v[112:119], v3
    v_mov_b32 v53, 0x3f003f00
    v_permlane32_swap_b32 v30, v31
    v_max_f32 v30, v30, v31
    v_mul_f32 v30, 0xbe0293ee, v30
    v_fma_f32 v36, v36, s68, v30
    v_exp_f32 v36, v36
    v_smfmac_f32_16x16x64_bf16 v[44:47], v[56:59], v[120:127], v3
    v_fma_f32 v37, v37, s68, v30
    v_exp_f32 v37, v37
    s_waitcnt lgkmcnt(2)
    v_smfmac_f32_16x16x64_bf16 v[40:43], v[60:63], v[128:135], v3
    v_fma_f32 v38, v38, s68, v30
    v_cvt_pk_bf16_f32 v24, v36, v37
    v_exp_f32 v38, v38
    v_smfmac_f32_16x16x64_bf16 v[44:47], v[60:63], v[136:143], v3
    v_fma_f32 v39, v39, s68, v30
    v_exp_f32 v39, v39
    s_waitcnt lgkmcnt(1)
    v_smfmac_f32_16x16x64_bf16 v[40:43], v[12:15], v[144:151], v3
    v_fma_f32 v20, v20, s68, v30
    v_cvt_pk_bf16_f32 v25, v38, v39
    v_exp_f32 v20, v20
    v_smfmac_f32_16x16x64_bf16 v[44:47], v[12:15], v[152:159], v3
    v_fma_f32 v21, v21, s68, v30
    v_exp_f32 v21, v21
    s_waitcnt lgkmcnt(0)
    v_smfmac_f32_16x16x64_bf16 v[40:43], v[16:19], v[160:167], v3
    v_fma_f32 v22, v22, s68, v30
    v_cvt_pk_bf16_f32 v26, v20, v21
    v_exp_f32 v22, v22
    v_smfmac_f32_16x16x64_bf16 v[44:47], v[16:19], v[168:175], v3
    v_fma_f32 v23, v23, s68, v30
    v_exp_f32 v23, v23
    v_fma_f32 v32, v32, s68, v30
    v_cvt_pk_bf16_f32 v27, v22, v23
    v_exp_f32 v32, v32
    v_fma_f32 v33, v33, s68, v30
    v_exp_f32 v33, v33
    s_waitcnt vmcnt(0)
    v_cvt_pk_bf16_f32 v28, v32, v33
    v_cvt_pk_bf16_f32 v29, v32, v33
    v_mfma_f32_16x16x32_bf16 v[56:59], v[48:51], v[24:27], 0
    v_mfma_f32_16x16x32_bf16 v[32:35], v[64:67], v[24:27], 0
    v_cvt_pk_bf16_f32 v64, v40, v41
    v_cvt_pk_bf16_f32 v65, v42, v43
    v_mfma_f32_16x16x32_bf16 v[36:39], v[68:71], v[24:27], 0
    v_cvt_pk_bf16_f32 v66, v44, v45
    v_cvt_pk_bf16_f32 v67, v46, v47
    v_mfma_f32_16x16x16_bf16 v[56:59], v[52:53], v[28:29], v[56:59]
    v_mfma_f32_16x16x16_bf16 v[32:35], v[64:65], v[28:29], v[32:35]
    ds_read_b128 v[48:51], v10 offset:18432
    ds_read_b128 v[52:55], v10 offset:19456
    v_mfma_f32_16x16x16_bf16 v[36:39], v[66:67], v[28:29], v[36:39]
    v_mov_b32 v24, 0
    v_mov_b32 v25, 0
    v_mov_b32 v26, 0
    v_mov_b32 v27, 0
    v_rcp_f32 v30, v56
    s_mov_b32 exec_lo, 0xcccccccc
    s_mov_b32 exec_hi, 0xcccccccc
    v_mul_f32 v32, v32, v30
    v_mul_f32 v33, v33, v30
    v_mul_f32 v34, v34, v30
    v_mul_f32 v35, v35, v30
    v_cvt_pk_bf16_f32 v20, v32, v33
    v_cvt_pk_bf16_f32 v21, v34, v35
    v_mul_f32 v36, v36, v30
    v_mul_f32 v37, v37, v30
    v_mul_f32 v38, v38, v30
    v_mul_f32 v39, v39, v30
    v_cvt_pk_bf16_f32 v22, v36, v37
    v_cvt_pk_bf16_f32 v23, v38, v39
    ds_write_b128 v5, v[20:23]
    s_mov_b64 exec, -1
    ds_read_b128 v[56:59], v10 offset:6144
    ds_read_b128 v[60:63], v10 offset:7168
    v_mov_b32 v28, 0
    v_mov_b32 v29, 0
    v_mov_b32 v30, 0
    v_mov_b32 v31, 0
    v_mov_b32 v40, 0
    v_mov_b32 v41, 0
    v_mov_b32 v42, 0
    v_mov_b32 v43, 0
    v_mov_b32 v44, 0
    v_mov_b32 v45, 0
    v_mov_b32 v46, 0
    v_mov_b32 v47, 0
    v_mov_b32 v68, 0
    v_mov_b32 v69, 0
    v_mov_b32 v70, 0
    v_mov_b32 v71, 0
    s_waitcnt lgkmcnt(2)
    s_barrier
    ds_read_b128 v[12:15], v1 offset:21504
    ds_read_b128 v[16:19], v1 offset:22528
    s_add_u32 m0, s65, 9216
    s_add_u32 s30, s24, s65
    buffer_load_dwordx4 v1, s[8:11], s30 offen lds
    buffer_load_dwordx4 v1, s[8:11], s30 offen offset:3072 lds
    s_add_u32 m0, s69, 9216
    s_add_u32 s30, s24, s69
    buffer_load_dwordx4 v1, s[8:11], s30 offen lds
    v_mov_b32 v32, 0
    v_mov_b32 v33, 0
    v_mov_b32 v34, 0
    v_mov_b32 v35, 0
    s_waitcnt lgkmcnt(1)
    v_smfmac_f32_16x16x64_bf16 v[24:27], v[12:15], v[176:183], v3
    v_mov_b32 v36, 0
    v_mov_b32 v37, 0
    s_waitcnt lgkmcnt(0)
    v_smfmac_f32_16x16x64_bf16 v[24:27], v[16:19], v[184:191], v3
    v_mov_b32 v38, 0
    v_mov_b32 v39, 0
    v_smfmac_f32_16x16x64_bf16 v[28:31], v[12:15], v[192:199], v3
    v_mov_b32 v20, 0
    v_mov_b32 v21, 0
    v_smfmac_f32_16x16x64_bf16 v[28:31], v[16:19], v[48:55], v3
    ds_read_b128 v[48:51], v10 offset:8192
    ds_read_b128 v[52:55], v10 offset:9216
    v_mov_b32 v22, 0
    v_mov_b32 v23, 0
    v_smfmac_f32_16x16x64_bf16 v[40:43], v[12:15], v[200:207], v3
    v_add_f32 v26, v24, v26
    v_add_f32 v27, v25, v27
    v_smfmac_f32_16x16x64_bf16 v[40:43], v[16:19], v[56:63], v3
    ds_read_b128 v[56:59], v10 offset:10240
    ds_read_b128 v[60:63], v10 offset:11264
    v_cvt_pk_bf16_f32 v24, v26, v27
    v_smfmac_f32_16x16x64_bf16 v[44:47], v[12:15], v[208:215], v3
    v_add_f32 v30, v28, v30
    v_add_f32 v31, v29, v31
    s_waitcnt lgkmcnt(2)
    v_smfmac_f32_16x16x64_bf16 v[44:47], v[16:19], v[48:55], v3
    ds_read_b128 v[48:51], v10 offset:12288
    ds_read_b128 v[52:55], v10 offset:13312
    v_cvt_pk_bf16_f32 v25, v30, v31
    v_mov_b32 v28, 0
    v_smfmac_f32_16x16x64_bf16 v[68:71], v[12:15], v[216:223], v3
    v_mov_b32 v29, 0
    v_mov_b32 v30, 0
    s_waitcnt lgkmcnt(2)
    v_smfmac_f32_16x16x64_bf16 v[68:71], v[16:19], v[56:63], v3
    ds_read_b128 v[56:59], v10 offset:14336
    ds_read_b128 v[60:63], v10 offset:15360
    v_mov_b32 v31, 0
    v_add_f32 v42, v40, v42
    v_smfmac_f32_16x16x64_bf16 v[32:35], v[12:15], v[224:231], v3
    v_add_f32 v43, v41, v43
    v_cvt_pk_bf16_f32 v26, v42, v43
    s_waitcnt lgkmcnt(2)
    v_smfmac_f32_16x16x64_bf16 v[32:35], v[16:19], v[48:55], v3
    ds_read_b128 v[48:51], v10 offset:16384
    ds_read_b128 v[52:55], v10 offset:17408
    v_add_f32 v46, v44, v46
    v_add_f32 v47, v45, v47
    v_smfmac_f32_16x16x64_bf16 v[36:39], v[12:15], v[232:239], v3
    v_cvt_pk_bf16_f32 v27, v46, v47
    buffer_store_dwordx4 v[24:27], v8, s[8:11], s20 offen
    s_waitcnt lgkmcnt(2)
    v_smfmac_f32_16x16x64_bf16 v[36:39], v[16:19], v[56:63], v3
    ds_read_b128 v[56:59], v10 offset:4096
    ds_read_b128 v[60:63], v10 offset:5120
    v_lshrrev_b32 v40, 2, v1
    v_add_f32 v70, v68, v70
    v_smfmac_f32_16x16x64_bf16 v[20:23], v[12:15], v[240:247], v3
    v_add_f32 v71, v69, v71
    v_cvt_pk_bf16_f32 v68, v70, v71
    s_waitcnt lgkmcnt(2)
    v_smfmac_f32_16x16x64_bf16 v[20:23], v[16:19], v[48:55], v3
    v_add_f32 v34, v32, v34
    v_add_f32 v35, v33, v35
    v_smfmac_f32_16x16x64_bf16 v[28:31], v[12:15], v[248:255], v3
    v_cvt_pk_bf16_f32 v69, v34, v35
    v_add_f32 v38, v36, v38
    s_waitcnt lgkmcnt(0)
    v_smfmac_f32_16x16x64_bf16 v[28:31], v[16:19], v[56:63], v3
    v_add_f32 v39, v37, v39
    v_cvt_pk_bf16_f32 v70, v38, v39
    v_add_f32 v22, v20, v22
    v_add_f32 v23, v21, v23
    v_cvt_pk_bf16_f32 v71, v22, v23
    buffer_store_dwordx4 v[68:71], v8, s[8:11], s20 offen offset:1024
    ds_read_b128 v[12:15], v1 offset:23552
    s_nop 0
    v_add_f32 v30, v28, v30
    v_add_f32 v31, v29, v31
    v_cvt_pk_bf16_f32 v28, v30, v31
    buffer_store_dword v28, v40, s[8:11], s61 offen
    s_add_u32 s24, s24, 262144
    s_add_u32 s25, s25, 262144
    s_xor_b32 s20, s20, 524288
    s_xor_b32 s61, s61, 524288
    v_mov_b32 v24, 0
    v_mov_b32 v25, 0
    v_mov_b32 v26, 0
    v_mov_b32 v27, 0
    v_mov_b32 v28, 0
    v_mov_b32 v29, 0
    v_mov_b32 v30, 0
    v_mov_b32 v31, 0
    v_mov_b32 v32, 0
    v_mov_b32 v33, 0
    v_mov_b32 v34, 0
    v_mov_b32 v35, 0
    v_mov_b32 v36, 0
    v_mov_b32 v37, 0
    v_mov_b32 v38, 0
    v_mov_b32 v39, 0
    s_mov_b32 s38, s39
    s_add_u32 s39, s39, 9216
    s_add_u32 s18, s18, 1
    s_branch L_rfr_top
L_rfr_e2:
    buffer_load_dwordx4 v[12:15], v11, s[8:11], s22 offen offset:0 sc1
    buffer_load_dwordx4 v[16:19], v11, s[8:11], s22 offen offset:1024 sc1
    buffer_load_dwordx4 v[20:23], v11, s[8:11], s22 offen offset:2048 sc1
    s_add_u32 s29, s29, 1
    s_cmp_ge_u32 s29, 4194304
    s_cbranch_scc1 L_abort
    s_waitcnt vmcnt(2)
    v_max3_u32 v66, v12, v13, v14
    s_waitcnt vmcnt(1)
    v_max3_u32 v66, v66, v15, v16
    v_max3_u32 v66, v66, v17, v18
    s_waitcnt vmcnt(0)
    v_max3_u32 v66, v66, v19, v20
    v_max3_u32 v66, v66, v21, v22
    v_max_u32 v66, v66, v23
    v_cmp_eq_u32 vcc, -1, v66
    s_nop 0
    s_cbranch_vccnz L_rfr_e2
    s_branch L_rfr_e2ok
L_rfr_e1x:
    s_waitcnt vmcnt(0)
L_rfr_e1y:
    buffer_load_dwordx4 v[40:43], v6, s[8:11], s44 offen sc1
    buffer_load_dwordx4 v[44:47], v6, s[8:11], s45 offen sc1
    buffer_load_dwordx4 v[48:51], v6, s[8:11], s46 offen sc1
    buffer_load_dwordx4 v[52:55], v6, s[8:11], s47 offen sc1
    s_add_u32 s29, s29, 1
    s_cmp_ge_u32 s29, 4194304
    s_cbranch_scc1 L_abort
    s_waitcnt vmcnt(3) lgkmcnt(0)
    v_mfma_f32_16x16x32_bf16 v[16:19], v[12:15], v[40:43], 0
    s_waitcnt vmcnt(2) lgkmcnt(0)
    v_mfma_f32_16x16x32_bf16 v[16:19], v[12:15], v[44:47], v[16:19]
    s_waitcnt vmcnt(1) lgkmcnt(0)
    v_mfma_f32_16x16x32_bf16 v[16:19], v[12:15], v[48:51], v[16:19]
    s_waitcnt vmcnt(0) lgkmcnt(0)
    v_mfma_f32_16x16x32_bf16 v[16:19], v[12:15], v[52:55], v[16:19]
    v_max3_u32 v22, v40, v41, v42
    v_max3_u32 v22, v22, v43, v44
    v_max3_u32 v22, v22, v45, v46
    v_max3_u32 v22, v22, v47, v48
    v_max3_u32 v22, v22, v49, v50
    v_max3_u32 v22, v22, v51, v52
    v_max3_u32 v22, v22, v53, v54
    v_max_u32 v22, v22, v55
    v_cmp_eq_u32 vcc, -1, v22
    s_nop 0
    s_cbranch_vccnz L_rfr_e1y
    s_mov_b32 exec_hi, 0
    s_branch L_rfr_e1ok
L_rfr_last:
    s_endpgm
L_rfg_entry:
    v_mov_b32 v24, 0
    v_mov_b32 v25, 0
    v_mov_b32 v26, 0
    v_mov_b32 v27, 0
    v_mov_b32 v28, 0
    v_mov_b32 v29, 0
    v_mov_b32 v30, 0
    v_mov_b32 v31, 0
    v_mov_b32 v32, 0
    v_mov_b32 v33, 0
    v_mov_b32 v34, 0
    v_mov_b32 v35, 0
    v_mov_b32 v36, 0
    v_mov_b32 v37, 0
    v_mov_b32 v38, 0
    v_mov_b32 v39, 0
    s_add_u32 m0, s65, 9216
    s_add_u32 s30, s24, s65
    buffer_load_dwordx4 v1, s[8:11], s30 offen lds
    buffer_load_dwordx4 v1, s[8:11], s30 offen offset:3072 lds
    s_add_u32 m0, s69, 9216
    s_add_u32 s30, s24, s69
    buffer_load_dwordx4 v1, s[8:11], s30 offen lds
    s_add_u32 s24, s24, 262144
    s_branch L_rfg_gather
L_rfg_top:
    s_cmp_ge_u32 s18, 63
    s_cbranch_scc1 L_rfg_last
L_rfg_gather:
    s_barrier
    s_mov_b32 s30, s22
    s_mov_b32 s22, s35
    s_mov_b32 s35, s23
    s_mov_b32 s23, s30
    s_nop 7
    s_nop 7
    s_mov_b32 s29, 1
    ds_read_b128 v[40:43], v10 offset:32768
    ds_read_b128 v[44:47], v10 offset:33792
    ds_read_b128 v[48:51], v10 offset:24576
    ds_read_b128 v[52:55], v10 offset:25600
    ds_read_b128 v[56:59], v10 offset:30720
    ds_read_b128 v[60:63], v10 offset:31744
    s_nop 7
    s_nop 7
    buffer_load_dwordx4 v[12:15], v11, s[8:11], s22 offen offset:0 sc1
    buffer_load_dwordx4 v[16:19], v11, s[8:11], s22 offen offset:1024 sc1
    buffer_load_dwordx4 v[20:23], v11, s[8:11], s22 offen offset:2048 sc1
    s_waitcnt vmcnt(2)
    v_max3_u32 v66, v12, v13, v14
    s_waitcnt vmcnt(1)
    v_max3_u32 v66, v66, v15, v16
    v_max3_u32 v66, v66, v17, v18
    s_waitcnt vmcnt(0)
    v_max3_u32 v66, v66, v19, v20
    v_max3_u32 v66, v66, v21, v22
    v_max_u32 v66, v66, v23
    v_cmp_eq_u32 vcc, -1, v66
    s_nop 0
    s_cbranch_vccnz L_rfg_e2
L_rfg_e2ok:
    ds_write_b128 v11, v[12:15] offset:0
    ds_write_b128 v11, v[16:19] offset:1024
    ds_write_b128 v11, v[20:23] offset:2048
    s_waitcnt lgkmcnt(7)
    v_smfmac_f32_16x16x64_bf16 v[36:39], v[12:15], v[40:47], v3
    ds_read_b128 v[40:43], v10 offset:20480
    v_smfmac_f32_16x16x64_bf16 v[24:27], v[12:15], a[0:7], v3
    ds_read_b128 v[44:47], v10 offset:21504
    v_smfmac_f32_16x16x64_bf16 v[32:35], v[12:15], a[144:151], v3
    v_smfmac_f32_16x16x64_bf16 v[28:31], v[12:15], a[8:15], v3
    s_waitcnt lgkmcnt(7)
    v_smfmac_f32_16x16x64_bf16 v[36:39], v[16:19], v[48:55], v3
    ds_read_b128 v[48:51], v10 offset:26624
    v_smfmac_f32_16x16x64_bf16 v[24:27], v[16:19], a[16:23], v3
    s_waitcnt lgkmcnt(3)
    s_barrier
    ds_read_b128 v[12:15], v2 offset:0
    v_smfmac_f32_16x16x64_bf16 v[32:35], v[16:19], a[152:159], v3
    ds_read_b128 v[52:55], v10 offset:27648
    v_smfmac_f32_16x16x64_bf16 v[28:31], v[16:19], a[24:31], v3
    v_smfmac_f32_16x16x64_bf16 v[36:39], v[20:23], v[56:63], v3
    ds_read_b128 v[16:19], v2 offset:1024
    v_smfmac_f32_16x16x64_bf16 v[24:27], v[20:23], a[32:39], v3
    ds_read_b128 v[56:59], v10 offset:0
    v_smfmac_f32_16x16x64_bf16 v[32:35], v[20:23], a[160:167], v3
    ds_read_b128 v[60:63], v10 offset:1024
    v_smfmac_f32_16x16x64_bf16 v[28:31], v[20:23], a[40:47], v3
    s_waitcnt lgkmcnt(4)
    v_smfmac_f32_16x16x64_bf16 v[36:39], v[12:15], v[40:47], v3
    ds_read_b128 v[40:43], v10 offset:22528
    v_smfmac_f32_16x16x64_bf16 v[24:27], v[12:15], a[48:55], v3
    ds_read_b128 v[44:47], v10 offset:23552
    v_smfmac_f32_16x16x64_bf16 v[32:35], v[12:15], a[168:175], v3
    ds_read_b128 v[20:23], v2 offset:2048
    v_smfmac_f32_16x16x64_bf16 v[28:31], v[12:15], a[56:63], v3
    s_waitcnt lgkmcnt(5)
    v_smfmac_f32_16x16x64_bf16 v[36:39], v[16:19], v[48:55], v3
    ds_read_b128 v[48:51], v10 offset:28672
    v_smfmac_f32_16x16x64_bf16 v[24:27], v[16:19], a[64:71], v3
    ds_read_b128 v[52:55], v10 offset:29696
    v_smfmac_f32_16x16x64_bf16 v[32:35], v[16:19], a[176:183], v3
    ds_read_b128 v[12:15], v9 offset:0
    v_smfmac_f32_16x16x64_bf16 v[28:31], v[16:19], a[72:79], v3
    s_waitcnt lgkmcnt(3)
    v_smfmac_f32_16x16x64_bf16 v[36:39], v[20:23], v[56:63], v3
    ds_read_b128 v[56:59], v10 offset:2048
    v_smfmac_f32_16x16x64_bf16 v[24:27], v[20:23], a[80:87], v3
    ds_read_b128 v[60:63], v10 offset:3072
    v_smfmac_f32_16x16x64_bf16 v[32:35], v[20:23], a[184:191], v3
    ds_read_b128 v[16:19], v9 offset:1024
    v_smfmac_f32_16x16x64_bf16 v[28:31], v[20:23], a[88:95], v3
    s_waitcnt lgkmcnt(3)
    v_smfmac_f32_16x16x64_bf16 v[36:39], v[12:15], v[40:47], v3
    ds_read_b128 v[64:67], v1 offset:9216
    v_smfmac_f32_16x16x64_bf16 v[24:27], v[12:15], a[96:103], v3
    ds_read_b128 v[68:71], v1 offset:10240
    v_smfmac_f32_16x16x64_bf16 v[32:35], v[12:15], a[192:199], v3
    ds_read_b128 v[20:23], v9 offset:2048
    v_smfmac_f32_16x16x64_bf16 v[28:31], v[12:15], a[104:111], v3
    s_waitcnt lgkmcnt(3)
    v_smfmac_f32_16x16x64_bf16 v[36:39], v[16:19], v[48:55], v3
    v_mov_b32 v40, 0
    v_smfmac_f32_16x16x64_bf16 v[24:27], v[16:19], a[112:119], v3
    v_mov_b32 v41, 0
    v_smfmac_f32_16x16x64_bf16 v[32:35], v[16:19], a[200:207], v3
    ds_read_b128 v[12:15], v11 offset:0
    v_smfmac_f32_16x16x64_bf16 v[28:31], v[16:19], a[120:127], v3
    v_mov_b32 v42, 0
    v_mov_b32 v43, 0
    s_waitcnt lgkmcnt(1)
    v_smfmac_f32_16x16x64_bf16 v[32:35], v[20:23], a[208:215], v3
    v_mov_b32 v44, 0
    v_smfmac_f32_16x16x64_bf16 v[24:27], v[20:23], a[128:135], v3
    v_mov_b32 v45, 0
    v_smfmac_f32_16x16x64_bf16 v[36:39], v[20:23], v[56:63], v3
    ds_read_b128 v[16:19], v11 offset:1024
    v_smfmac_f32_16x16x64_bf16 v[28:31], v[20:23], a[136:143], v3
    v_mov_b32 v46, 0
    v_mov_b32 v47, 0
    ds_read_b128 v[20:23], v11 offset:2048
    s_waitcnt lgkmcnt(2)
    v_smfmac_f32_16x16x64_bf16 v[40:43], v[12:15], a[216:223], v3
    v_add_f32 v32, v32, v34
    v_add_f32 v33, v33, v35
    v_add_f32 v24, v24, v26
    v_add_f32 v25, v25, v27
    v_cvt_pk_bf16_f32 v32, v32, v33
    v_cvt_pk_bf16_f32 v33, v24, v25
    ds_write_b64 v4, v[32:33] offset:0
    v_add_f32 v36, v36, v38
    v_add_f32 v37, v37, v39
    v_add_f32 v28, v28, v30
    v_add_f32 v29, v29, v31
    v_cvt_pk_bf16_f32 v36, v36, v37
    v_cvt_pk_bf16_f32 v37, v28, v29
    ds_write_b64 v4, v[36:37] offset:256
    v_lshrrev_b32 v35, 1, v1
    ds_read_b128 v[24:27], v1 offset:11264
    ds_read_b128 v[28:31], v1 offset:12288
    v_smfmac_f32_16x16x64_bf16 v[44:47], v[12:15], a[224:231], v3
    ds_read_b128 v[12:15], v2 offset:0
    s_waitcnt lgkmcnt(6)
    v_smfmac_f32_16x16x64_bf16 v[40:43], v[16:19], a[232:239], v3
    v_smfmac_f32_16x16x64_bf16 v[44:47], v[16:19], a[240:247], v3
    ds_read_b128 v[16:19], v2 offset:1024
    s_waitcnt lgkmcnt(4)
    s_barrier
    ds_read_b64_tr_b16 v[48:49], v35 offset:17408
    ds_read_b64_tr_b16 v[50:51], v35 offset:17920
    ds_read_b64_tr_b16 v[52:53], v35 offset:18432
    ds_read_b64_tr_b16 v[54:55], v35 offset:18944
    ds_read_b64_tr_b16 v[56:57], v35 offset:19456
    ds_read_b64_tr_b16 v[58:59], v35 offset:19968
    ds_read_b64_tr_b16 v[60:61], v35 offset:20480
    ds_read_b64_tr_b16 v[62:63], v35 offset:20992
    v_smfmac_f32_16x16x64_bf16 v[40:43], v[20:23], a[248:255], v3
    v_smfmac_f32_16x16x64_bf16 v[44:47], v[20:23], v[72:79], v3
    s_waitcnt lgkmcnt(6)
    v_mfma_f32_16x16x32_bf16 v[32:35], v[48:51], v[48:51], 0
    v_mfma_f32_16x16x32_bf16 v[36:39], v[64:67], v[48:51], 0
    ds_read_b128 v[64:67], v1 offset:13312
    v_mfma_f32_16x16x32_bf16 v[20:23], v[68:71], v[48:51], 0
    ds_read_b128 v[68:71], v1 offset:14336
    s_waitcnt lgkmcnt(6)
    v_mfma_f32_16x16x32_bf16 v[32:35], v[52:55], v[52:55], v[32:35]
    v_mfma_f32_16x16x32_bf16 v[36:39], v[24:27], v[52:55], v[36:39]
    ds_read_b128 v[24:27], v1 offset:15360
    v_mfma_f32_16x16x32_bf16 v[20:23], v[28:31], v[52:55], v[20:23]
    ds_read_b128 v[28:31], v1 offset:16384
    v_smfmac_f32_16x16x64_bf16 v[40:43], v[12:15], v[80:87], v3
    s_waitcnt lgkmcnt(2)
    v_mfma_f32_16x16x32_bf16 v[32:35], v[56:59], v[56:59], v[32:35]
    v_mfma_f32_16x16x32_bf16 v[36:39], v[64:67], v[56:59], v[36:39]
    v_mfma_f32_16x16x32_bf16 v[20:23], v[68:71], v[56:59], v[20:23]
    ds_read_b128 v[56:59], v2 offset:2048
    s_waitcnt lgkmcnt(1)
    v_mfma_f32_16x16x32_bf16 v[32:35], v[60:63], v[60:63], v[32:35]
    v_mfma_f32_16x16x32_bf16 v[36:39], v[24:27], v[60:63], v[36:39]
    v_mov_b32 v48, 0x3f803f80
    v_mov_b32 v49, 0x3f803f80
    v_mfma_f32_16x16x32_bf16 v[20:23], v[28:31], v[60:63], v[20:23]
    v_mov_b32 v50, 0x3f803f80
    v_mov_b32 v51, 0x3f803f80
    ds_read_b128 v[60:63], v9 offset:0
    v_smfmac_f32_16x16x64_bf16 v[44:47], v[12:15], v[88:95], v3
    ds_read_b128 v[12:15], v9 offset:1024
    buffer_load_dwordx4 v[64:67], v1, s[8:11], s25 offen offset:0
    v_smfmac_f32_16x16x64_bf16 v[40:43], v[16:19], v[96:103], v3
    buffer_load_dwordx4 v[68:71], v1, s[8:11], s25 offen offset:1024
    v_max3_f32 v30, v32, v33, v36
    v_max3_f32 v31, v37, v38, v39
    v_max3_f32 v30, v30, v20, v21
    v_max3_f32 v31, v31, v22, v23
    v_max_f32 v30, v30, v31
    v_max_f32 v31, v30, v31
    v_smfmac_f32_16x16x64_bf16 v[44:47], v[16:19], v[104:111], v3
    ds_read_b128 v[16:19], v9 offset:2048
    v_mov_b32 v52, 0x3f003f00
    v_permlane16_swap_b32 v30, v31
    v_max_f32 v30, v30, v31
    v_max_f32 v31, v30, v31
    s_waitcnt lgkmcnt(3)
    v_smfmac_f32_16x16x64_bf16 v[40:43], v[56:59], v[112:119], v3
    v_mov_b32 v53, 0x3f003f00
    v_permlane32_swap_b32 v30, v31
    v_max_f32 v30, v30, v31
    v_mul_f32 v30, 0xbe0293ee, v30
    v_fma_f32 v36, v36, s68, v30
    v_exp_f32 v36, v36
    v_smfmac_f32_16x16x64_bf16 v[44:47], v[56:59], v[120:127], v3
    v_fma_f32 v37, v37, s68, v30
    v_exp_f32 v37, v37
    s_waitcnt lgkmcnt(2)
    v_smfmac_f32_16x16x64_bf16 v[40:43], v[60:63], v[128:135], v3
    v_fma_f32 v38, v38, s68, v30
    v_cvt_pk_bf16_f32 v24, v36, v37
    v_exp_f32 v38, v38
    v_smfmac_f32_16x16x64_bf16 v[44:47], v[60:63], v[136:143], v3
    v_fma_f32 v39, v39, s68, v30
    v_exp_f32 v39, v39
    s_waitcnt lgkmcnt(1)
    v_smfmac_f32_16x16x64_bf16 v[40:43], v[12:15], v[144:151], v3
    v_fma_f32 v20, v20, s68, v30
    v_cvt_pk_bf16_f32 v25, v38, v39
    v_exp_f32 v20, v20
    v_smfmac_f32_16x16x64_bf16 v[44:47], v[12:15], v[152:159], v3
    v_fma_f32 v21, v21, s68, v30
    v_exp_f32 v21, v21
    s_waitcnt lgkmcnt(0)
    v_smfmac_f32_16x16x64_bf16 v[40:43], v[16:19], v[160:167], v3
    v_fma_f32 v22, v22, s68, v30
    v_cvt_pk_bf16_f32 v26, v20, v21
    v_exp_f32 v22, v22
    v_smfmac_f32_16x16x64_bf16 v[44:47], v[16:19], v[168:175], v3
    v_fma_f32 v23, v23, s68, v30
    v_exp_f32 v23, v23
    v_fma_f32 v32, v32, s68, v30
    v_cvt_pk_bf16_f32 v27, v22, v23
    v_exp_f32 v32, v32
    v_fma_f32 v33, v33, s68, v30
    v_exp_f32 v33, v33
    s_waitcnt vmcnt(0)
    v_cvt_pk_bf16_f32 v28, v32, v33
    v_cvt_pk_bf16_f32 v29, v32, v33
    v_mfma_f32_16x16x32_bf16 v[56:59], v[48:51], v[24:27], 0
    v_mfma_f32_16x16x32_bf16 v[32:35], v[64:67], v[24:27], 0
    v_cvt_pk_bf16_f32 v64, v40, v41
    v_cvt_pk_bf16_f32 v65, v42, v43
    v_mfma_f32_16x16x32_bf16 v[36:39], v[68:71], v[24:27], 0
    v_cvt_pk_bf16_f32 v66, v44, v45
    v_cvt_pk_bf16_f32 v67, v46, v47
    v_mfma_f32_16x16x16_bf16 v[56:59], v[52:53], v[28:29], v[56:59]
    v_mfma_f32_16x16x16_bf16 v[32:35], v[64:65], v[28:29], v[32:35]
    ds_read_b128 v[48:51], v10 offset:18432
    ds_read_b128 v[52:55], v10 offset:19456
    v_mfma_f32_16x16x16_bf16 v[36:39], v[66:67], v[28:29], v[36:39]
    v_mov_b32 v24, 0
    v_mov_b32 v25, 0
    v_mov_b32 v26, 0
    v_mov_b32 v27, 0
    v_rcp_f32 v30, v56
    s_mov_b32 exec_lo, 0xcccccccc
    s_mov_b32 exec_hi, 0xcccccccc
    v_mul_f32 v32, v32, v30
    v_mul_f32 v33, v33, v30
    v_mul_f32 v34, v34, v30
    v_mul_f32 v35, v35, v30
    v_cvt_pk_bf16_f32 v20, v32, v33
    v_cvt_pk_bf16_f32 v21, v34, v35
    v_mul_f32 v36, v36, v30
    v_mul_f32 v37, v37, v30
    v_mul_f32 v38, v38, v30
    v_mul_f32 v39, v39, v30
    v_cvt_pk_bf16_f32 v22, v36, v37
    v_cvt_pk_bf16_f32 v23, v38, v39
    ds_write_b128 v5, v[20:23]
    s_mov_b64 exec, -1
    ds_read_b128 v[56:59], v10 offset:6144
    ds_read_b128 v[60:63], v10 offset:7168
    v_mov_b32 v28, 0
    v_mov_b32 v29, 0
    v_mov_b32 v30, 0
    v_mov_b32 v31, 0
    v_mov_b32 v40, 0
    v_mov_b32 v41, 0
    v_mov_b32 v42, 0
    v_mov_b32 v43, 0
    v_mov_b32 v44, 0
    v_mov_b32 v45, 0
    v_mov_b32 v46, 0
    v_mov_b32 v47, 0
    v_mov_b32 v68, 0
    v_mov_b32 v69, 0
    v_mov_b32 v70, 0
    v_mov_b32 v71, 0
    s_waitcnt lgkmcnt(2)
    s_barrier
    ds_read_b128 v[12:15], v1 offset:21504
    ds_read_b128 v[16:19], v1 offset:22528
    s_add_u32 m0, s65, 9216
    s_add_u32 s30, s24, s65
    buffer_load_dwordx4 v1, s[8:11], s30 offen lds
    buffer_load_dwordx4 v1, s[8:11], s30 offen offset:3072 lds
    s_add_u32 m0, s69, 9216
    s_add_u32 s30, s24, s69
    buffer_load_dwordx4 v1, s[8:11], s30 offen lds
    v_mov_b32 v32, 0
    v_mov_b32 v33, 0
    v_mov_b32 v34, 0
    v_mov_b32 v35, 0
    s_waitcnt lgkmcnt(1)
    v_smfmac_f32_16x16x64_bf16 v[24:27], v[12:15], v[176:183], v3
    v_mov_b32 v36, 0
    v_mov_b32 v37, 0
    s_waitcnt lgkmcnt(0)
    v_smfmac_f32_16x16x64_bf16 v[24:27], v[16:19], v[184:191], v3
    v_mov_b32 v38, 0
    v_mov_b32 v39, 0
    v_smfmac_f32_16x16x64_bf16 v[28:31], v[12:15], v[192:199], v3
    v_mov_b32 v20, 0
    v_mov_b32 v21, 0
    v_smfmac_f32_16x16x64_bf16 v[28:31], v[16:19], v[48:55], v3
    ds_read_b128 v[48:51], v10 offset:8192
    ds_read_b128 v[52:55], v10 offset:9216
    v_mov_b32 v22, 0
    v_mov_b32 v23, 0
    v_smfmac_f32_16x16x64_bf16 v[40:43], v[12:15], v[200:207], v3
    v_add_f32 v26, v24, v26
    v_add_f32 v27, v25, v27
    v_smfmac_f32_16x16x64_bf16 v[40:43], v[16:19], v[56:63], v3
    ds_read_b128 v[56:59], v10 offset:10240
    ds_read_b128 v[60:63], v10 offset:11264
    v_cvt_pk_bf16_f32 v24, v26, v27
    v_smfmac_f32_16x16x64_bf16 v[44:47], v[12:15], v[208:215], v3
    v_add_f32 v30, v28, v30
    v_add_f32 v31, v29, v31
    s_waitcnt lgkmcnt(2)
    v_smfmac_f32_16x16x64_bf16 v[44:47], v[16:19], v[48:55], v3
    ds_read_b128 v[48:51], v10 offset:12288
    ds_read_b128 v[52:55], v10 offset:13312
    v_cvt_pk_bf16_f32 v25, v30, v31
    v_mov_b32 v28, 0
    v_smfmac_f32_16x16x64_bf16 v[68:71], v[12:15], v[216:223], v3
    v_mov_b32 v29, 0
    v_mov_b32 v30, 0
    s_waitcnt lgkmcnt(2)
    v_smfmac_f32_16x16x64_bf16 v[68:71], v[16:19], v[56:63], v3
    ds_read_b128 v[56:59], v10 offset:14336
    ds_read_b128 v[60:63], v10 offset:15360
    v_mov_b32 v31, 0
    v_add_f32 v42, v40, v42
    v_smfmac_f32_16x16x64_bf16 v[32:35], v[12:15], v[224:231], v3
    v_add_f32 v43, v41, v43
    v_cvt_pk_bf16_f32 v26, v42, v43
    s_waitcnt lgkmcnt(2)
    v_smfmac_f32_16x16x64_bf16 v[32:35], v[16:19], v[48:55], v3
    ds_read_b128 v[48:51], v10 offset:16384
    ds_read_b128 v[52:55], v10 offset:17408
    v_add_f32 v46, v44, v46
    v_add_f32 v47, v45, v47
    v_smfmac_f32_16x16x64_bf16 v[36:39], v[12:15], v[232:239], v3
    v_cvt_pk_bf16_f32 v27, v46, v47
    buffer_store_dwordx4 v[24:27], v8, s[8:11], s20 offen
    s_waitcnt lgkmcnt(2)
    v_smfmac_f32_16x16x64_bf16 v[36:39], v[16:19], v[56:63], v3
    ds_read_b128 v[56:59], v10 offset:4096
    ds_read_b128 v[60:63], v10 offset:5120
    v_lshrrev_b32 v40, 2, v1
    v_add_f32 v70, v68, v70
    v_smfmac_f32_16x16x64_bf16 v[20:23], v[12:15], v[240:247], v3
    v_add_f32 v71, v69, v71
    v_cvt_pk_bf16_f32 v68, v70, v71
    s_waitcnt lgkmcnt(2)
    v_smfmac_f32_16x16x64_bf16 v[20:23], v[16:19], v[48:55], v3
    v_add_f32 v34, v32, v34
    v_add_f32 v35, v33, v35
    v_smfmac_f32_16x16x64_bf16 v[28:31], v[12:15], v[248:255], v3
    v_cvt_pk_bf16_f32 v69, v34, v35
    v_add_f32 v38, v36, v38
    s_waitcnt lgkmcnt(0)
    v_smfmac_f32_16x16x64_bf16 v[28:31], v[16:19], v[56:63], v3
    v_add_f32 v39, v37, v39
    v_cvt_pk_bf16_f32 v70, v38, v39
    v_add_f32 v22, v20, v22
    v_add_f32 v23, v21, v23
    v_cvt_pk_bf16_f32 v71, v22, v23
    buffer_store_dwordx4 v[68:71], v8, s[8:11], s20 offen offset:1024
    s_nop 1
    v_add_f32 v30, v28, v30
    v_add_f32 v31, v29, v31
    v_cvt_pk_bf16_f32 v28, v30, v31
    buffer_store_dword v28, v40, s[8:11], s61 offen
    s_add_u32 s24, s24, 262144
    s_add_u32 s25, s25, 262144
    s_xor_b32 s20, s20, 524288
    s_xor_b32 s61, s61, 524288
    v_mov_b32 v24, 0
    v_mov_b32 v25, 0
    v_mov_b32 v26, 0
    v_mov_b32 v27, 0
    v_mov_b32 v28, 0
    v_mov_b32 v29, 0
    v_mov_b32 v30, 0
    v_mov_b32 v31, 0
    v_mov_b32 v32, 0
    v_mov_b32 v33, 0
    v_mov_b32 v34, 0
    v_mov_b32 v35, 0
    v_mov_b32 v36, 0
    v_mov_b32 v37, 0
    v_mov_b32 v38, 0
    v_mov_b32 v39, 0
    s_mov_b32 s38, s39
    s_add_u32 s39, s39, 9216
    s_add_u32 s18, s18, 1
    s_branch L_rfg_top
L_rfg_e2:
    buffer_load_dwordx4 v[12:15], v11, s[8:11], s22 offen offset:0 sc1
    buffer_load_dwordx4 v[16:19], v11, s[8:11], s22 offen offset:1024 sc1
    buffer_load_dwordx4 v[20:23], v11, s[8:11], s22 offen offset:2048 sc1
    s_add_u32 s29, s29, 1
    s_cmp_ge_u32 s29, 4194304
    s_cbranch_scc1 L_abort
    s_waitcnt vmcnt(2)
    v_max3_u32 v66, v12, v13, v14
    s_waitcnt vmcnt(1)
    v_max3_u32 v66, v66, v15, v16
    v_max3_u32 v66, v66, v17, v18
    s_waitcnt vmcnt(0)
    v_max3_u32 v66, v66, v19, v20
    v_max3_u32 v66, v66, v21, v22
    v_max_u32 v66, v66, v23
    v_cmp_eq_u32 vcc, -1, v66
    s_nop 0
    s_cbranch_vccnz L_rfg_e2
    s_branch L_rfg_e2ok
L_rfg_last:
    s_endpgm
L_rfi_entry:
    v_mov_b32 v24, 0
    v_mov_b32 v25, 0
    v_mov_b32 v26, 0
    v_mov_b32 v27, 0
    v_mov_b32 v28, 0
    v_mov_b32 v29, 0
    v_mov_b32 v30, 0
    v_mov_b32 v31, 0
    v_mov_b32 v32, 0
    v_mov_b32 v33, 0
    v_mov_b32 v34, 0
    v_mov_b32 v35, 0
    v_mov_b32 v36, 0
    v_mov_b32 v37, 0
    v_mov_b32 v38, 0
    v_mov_b32 v39, 0
    v_lshlrev_b32 v64, 3, v1
    buffer_load_dword v0, v64, s[8:11], s24 offen
    s_add_u32 s30, s24, 16777216
    buffer_load_dword v0, v64, s[8:11], s30 offen
    s_add_u32 s24, s24, 262144
    buffer_load_dword v0, v64, s[8:11], s24 offen
    s_add_u32 s30, s24, 16777216
    buffer_load_dword v0, v64, s[8:11], s30 offen
    s_add_u32 s24, s24, 262144
    v_and_b32 v6, 0x3ff, v21
    s_add_u32 s36, s36, 3072
    s_nop 0
    s_branch L_rfi_gather
L_rfi_top:
    s_cmp_ge_u32 s18, 63
    s_cbranch_scc1 L_rfi_last
L_rfi_gather:
    s_barrier
    s_mov_b32 s30, s22
    s_mov_b32 s22, s35
    s_mov_b32 s35, s23
    s_mov_b32 s23, s30
    s_nop 7
    s_nop 7
    v_lshlrev_b32 v64, 3, v1
    s_add_u32 s31, s24, 16777216
    s_mov_b32 s29, 1
    ds_read_b128 v[40:43], v10 offset:32768
    ds_read_b128 v[44:47], v10 offset:33792
    ds_read_b128 v[48:51], v10 offset:24576
    ds_read_b128 v[52:55], v10 offset:25600
    ds_read_b128 v[56:59], v10 offset:30720
    ds_read_b128 v[60:63], v10 offset:31744
    s_nop 7
    s_nop 7
    buffer_load_dwordx4 v[12:15], v11, s[8:11], s22 offen offset:0 sc1
    buffer_load_dwordx4 v[16:19], v11, s[8:11], s22 offen offset:1024 sc1
    buffer_load_dwordx4 v[20:23], v11, s[8:11], s22 offen offset:2048 sc1
    s_waitcnt vmcnt(2)
    v_max3_u32 v66, v12, v13, v14
    s_waitcnt vmcnt(1)
    v_max3_u32 v66, v66, v15, v16
    v_max3_u32 v66, v66, v17, v18
    s_waitcnt vmcnt(0)
    v_max3_u32 v66, v66, v19, v20
    v_max3_u32 v66, v66, v21, v22
    v_max_u32 v66, v66, v23
    v_cmp_eq_u32 vcc, -1, v66
    s_nop 0
    s_cbranch_vccnz L_rfi_e2
L_rfi_e2ok:
    s_mov_b64 exec, s[42:43]
    buffer_store_dwordx4 v[12:15], v11, s[8:11], s38 offen offset:0 sc1
    buffer_store_dwordx4 v[16:19], v11, s[8:11], s38 offen offset:1024 sc1
    buffer_store_dwordx4 v[20:23], v11, s[8:11], s38 offen offset:2048 sc1
    s_mov_b64 exec, -1
    s_waitcnt lgkmcnt(4)
    v_smfmac_f32_16x16x64_bf16 v[36:39], v[12:15], v[40:47], v3
    ds_read_b128 v[40:43], v10 offset:20480
    v_smfmac_f32_16x16x64_bf16 v[24:27], v[12:15], a[0:7], v3
    ds_read_b128 v[44:47], v10 offset:21504
    v_smfmac_f32_16x16x64_bf16 v[32:35], v[12:15], a[144:151], v3
    buffer_load_dword v0, v64, s[8:11], s24 offen
    v_smfmac_f32_16x16x64_bf16 v[28:31], v[12:15], a[8:15], v3
    buffer_load_dword v0, v64, s[8:11], s31 offen
    s_waitcnt lgkmcnt(4)
    v_smfmac_f32_16x16x64_bf16 v[36:39], v[16:19], v[48:55], v3
    ds_read_b128 v[48:51], v10 offset:26624
    v_smfmac_f32_16x16x64_bf16 v[24:27], v[16:19], a[16:23], v3
    s_barrier
    ds_read_b128 v[12:15], v2 offset:0
    v_smfmac_f32_16x16x64_bf16 v[32:35], v[16:19], a[152:159], v3
    ds_read_b128 v[52:55], v10 offset:27648
    v_smfmac_f32_16x16x64_bf16 v[28:31], v[16:19], a[24:31], v3
    buffer_load_dword v7, v6, s[8:11], s36 offen sc1
    s_waitcnt lgkmcnt(5)
    v_smfmac_f32_16x16x64_bf16 v[36:39], v[20:23], v[56:63], v3
    ds_read_b128 v[16:19], v2 offset:1024
    v_smfmac_f32_16x16x64_bf16 v[24:27], v[20:23], a[32:39], v3
    ds_read_b128 v[56:59], v10 offset:0
    v_smfmac_f32_16x16x64_bf16 v[32:35], v[20:23], a[160:167], v3
    ds_read_b128 v[60:63], v10 offset:1024
    v_smfmac_f32_16x16x64_bf16 v[28:31], v[20:23], a[40:47], v3
    s_waitcnt lgkmcnt(4)
    v_smfmac_f32_16x16x64_bf16 v[36:39], v[12:15], v[40:47], v3
    ds_read_b128 v[40:43], v10 offset:22528
    v_smfmac_f32_16x16x64_bf16 v[24:27], v[12:15], a[48:55], v3
    ds_read_b128 v[44:47], v10 offset:23552
    v_smfmac_f32_16x16x64_bf16 v[32:35], v[12:15], a[168:175], v3
    ds_read_b128 v[20:23], v2 offset:2048
    v_smfmac_f32_16x16x64_bf16 v[28:31], v[12:15], a[56:63], v3
    s_waitcnt lgkmcnt(5)
    v_smfmac_f32_16x16x64_bf16 v[36:39], v[16:19], v[48:55], v3
    ds_read_b128 v[48:51], v10 offset:28672
    v_smfmac_f32_16x16x64_bf16 v[24:27], v[16:19], a[64:71], v3
    ds_read_b128 v[52:55], v10 offset:29696
    v_smfmac_f32_16x16x64_bf16 v[32:35], v[16:19], a[176:183], v3
    ds_read_b128 v[12:15], v9 offset:0
    v_smfmac_f32_16x16x64_bf16 v[28:31], v[16:19], a[72:79], v3
    s_waitcnt lgkmcnt(3)
    v_smfmac_f32_16x16x64_bf16 v[36:39], v[20:23], v[56:63], v3
    ds_read_b128 v[56:59], v10 offset:2048
    v_smfmac_f32_16x16x64_bf16 v[24:27], v[20:23], a[80:87], v3
    ds_read_b128 v[60:63], v10 offset:3072
    v_smfmac_f32_16x16x64_bf16 v[32:35], v[20:23], a[184:191], v3
    ds_read_b128 v[16:19], v9 offset:1024
    v_smfmac_f32_16x16x64_bf16 v[28:31], v[20:23], a[88:95], v3
    s_waitcnt lgkmcnt(3)
    v_smfmac_f32_16x16x64_bf16 v[36:39], v[12:15], v[40:47], v3
    ds_read_b128 v[64:67], v1 offset:9216
    v_smfmac_f32_16x16x64_bf16 v[24:27], v[12:15], a[96:103], v3
    ds_read_b128 v[68:71], v1 offset:10240
    v_smfmac_f32_16x16x64_bf16 v[32:35], v[12:15], a[192:199], v3
    ds_read_b128 v[20:23], v9 offset:2048
    v_smfmac_f32_16x16x64_bf16 v[28:31], v[12:15], a[104:111], v3
    s_waitcnt lgkmcnt(3)
    v_smfmac_f32_16x16x64_bf16 v[36:39], v[16:19], v[48:55], v3
    v_mov_b32 v40, 0
    v_smfmac_f32_16x16x64_bf16 v[24:27], v[16:19], a[112:119], v3
    v_mov_b32 v41, 0
    v_smfmac_f32_16x16x64_bf16 v[32:35], v[16:19], a[200:207], v3
    ds_read_b128 v[12:15], v11 offset:0
    v_smfmac_f32_16x16x64_bf16 v[28:31], v[16:19], a[120:127], v3
    v_mov_b32 v42, 0
    v_mov_b32 v43, 0
    s_waitcnt lgkmcnt(1)
    v_smfmac_f32_16x16x64_bf16 v[32:35], v[20:23], a[208:215], v3
    v_mov_b32 v44, 0
    v_smfmac_f32_16x16x64_bf16 v[24:27], v[20:23], a[128:135], v3
    v_mov_b32 v45, 0
    v_smfmac_f32_16x16x64_bf16 v[36:39], v[20:23], v[56:63], v3
    ds_read_b128 v[16:19], v11 offset:1024
    v_smfmac_f32_16x16x64_bf16 v[28:31], v[20:23], a[136:143], v3
    v_mov_b32 v46, 0
    v_mov_b32 v47, 0
    ds_read_b128 v[20:23], v11 offset:2048
    s_waitcnt lgkmcnt(2)
    v_smfmac_f32_16x16x64_bf16 v[40:43], v[12:15], a[216:223], v3
    v_add_f32 v32, v32, v34
    v_add_f32 v33, v33, v35
    v_add_f32 v24, v24, v26
    v_add_f32 v25, v25, v27
    v_cvt_pk_bf16_f32 v32, v32, v33
    v_cvt_pk_bf16_f32 v33, v24, v25
    ds_write_b64 v4, v[32:33] offset:0
    v_add_f32 v36, v36, v38
    v_add_f32 v37, v37, v39
    v_add_f32 v28, v28, v30
    v_add_f32 v29, v29, v31
    v_cvt_pk_bf16_f32 v36, v36, v37
    v_cvt_pk_bf16_f32 v37, v28, v29
    ds_write_b64 v4, v[36:37] offset:256
    v_lshrrev_b32 v35, 1, v1
    ds_read_b128 v[24:27], v1 offset:11264
    ds_read_b128 v[28:31], v1 offset:12288
    v_smfmac_f32_16x16x64_bf16 v[44:47], v[12:15], a[224:231], v3
    ds_read_b128 v[12:15], v2 offset:0
    s_waitcnt lgkmcnt(6)
    v_smfmac_f32_16x16x64_bf16 v[40:43], v[16:19], a[232:239], v3
    v_smfmac_f32_16x16x64_bf16 v[44:47], v[16:19], a[240:247], v3
    ds_read_b128 v[16:19], v2 offset:1024
    s_waitcnt lgkmcnt(4)
    s_barrier
    ds_read_b64_tr_b16 v[48:49], v35 offset:17408
    ds_read_b64_tr_b16 v[50:51], v35 offset:17920
    ds_read_b64_tr_b16 v[52:53], v35 offset:18432
    ds_read_b64_tr_b16 v[54:55], v35 offset:18944
    ds_read_b64_tr_b16 v[56:57], v35 offset:19456
    ds_read_b64_tr_b16 v[58:59], v35 offset:19968
    ds_read_b64_tr_b16 v[60:61], v35 offset:20480
    ds_read_b64_tr_b16 v[62:63], v35 offset:20992
    v_smfmac_f32_16x16x64_bf16 v[40:43], v[20:23], a[248:255], v3
    v_smfmac_f32_16x16x64_bf16 v[44:47], v[20:23], v[72:79], v3
    s_waitcnt lgkmcnt(6)
    v_mfma_f32_16x16x32_bf16 v[32:35], v[48:51], v[48:51], 0
    v_mfma_f32_16x16x32_bf16 v[36:39], v[64:67], v[48:51], 0
    ds_read_b128 v[64:67], v1 offset:13312
    v_mfma_f32_16x16x32_bf16 v[20:23], v[68:71], v[48:51], 0
    ds_read_b128 v[68:71], v1 offset:14336
    s_waitcnt lgkmcnt(6)
    v_mfma_f32_16x16x32_bf16 v[32:35], v[52:55], v[52:55], v[32:35]
    v_mfma_f32_16x16x32_bf16 v[36:39], v[24:27], v[52:55], v[36:39]
    ds_read_b128 v[24:27], v1 offset:15360
    v_mfma_f32_16x16x32_bf16 v[20:23], v[28:31], v[52:55], v[20:23]
    ds_read_b128 v[28:31], v1 offset:16384
    v_smfmac_f32_16x16x64_bf16 v[40:43], v[12:15], v[80:87], v3
    s_waitcnt lgkmcnt(2)
    v_mfma_f32_16x16x32_bf16 v[32:35], v[56:59], v[56:59], v[32:35]
    v_mfma_f32_16x16x32_bf16 v[36:39], v[64:67], v[56:59], v[36:39]
    v_mfma_f32_16x16x32_bf16 v[20:23], v[68:71], v[56:59], v[20:23]
    ds_read_b128 v[56:59], v2 offset:2048
    s_waitcnt lgkmcnt(1)
    v_mfma_f32_16x16x32_bf16 v[32:35], v[60:63], v[60:63], v[32:35]
    v_mfma_f32_16x16x32_bf16 v[36:39], v[24:27], v[60:63], v[36:39]
    v_mov_b32 v48, 0x3f803f80
    v_mov_b32 v49, 0x3f803f80
    v_mfma_f32_16x16x32_bf16 v[20:23], v[28:31], v[60:63], v[20:23]
    v_mov_b32 v50, 0x3f803f80
    v_mov_b32 v51, 0x3f803f80
    ds_read_b128 v[60:63], v9 offset:0
    v_smfmac_f32_16x16x64_bf16 v[44:47], v[12:15], v[88:95], v3
    ds_read_b128 v[12:15], v9 offset:1024
    buffer_load_dwordx4 v[64:67], v1, s[8:11], s25 offen offset:0
    v_smfmac_f32_16x16x64_bf16 v[40:43], v[16:19], v[96:103], v3
    buffer_load_dwordx4 v[68:71], v1, s[8:11], s25 offen offset:1024
    v_max3_f32 v30, v32, v33, v36
    v_max3_f32 v31, v37, v38, v39
    v_max3_f32 v30, v30, v20, v21
    v_max3_f32 v31, v31, v22, v23
    v_max_f32 v30, v30, v31
    v_max_f32 v31, v30, v31
    v_smfmac_f32_16x16x64_bf16 v[44:47], v[16:19], v[104:111], v3
    ds_read_b128 v[16:19], v9 offset:2048
    v_mov_b32 v52, 0x3f003f00
    v_permlane16_swap_b32 v30, v31
    v_max_f32 v30, v30, v31
    v_max_f32 v31, v30, v31
    s_waitcnt lgkmcnt(3)
    v_smfmac_f32_16x16x64_bf16 v[40:43], v[56:59], v[112:119], v3
    v_mov_b32 v53, 0x3f003f00
    v_permlane32_swap_b32 v30, v31
    v_max_f32 v30, v30, v31
    v_mul_f32 v30, 0xbe0293ee, v30
    v_fma_f32 v36, v36, s68, v30
    v_exp_f32 v36, v36
    v_smfmac_f32_16x16x64_bf16 v[44:47], v[56:59], v[120:127], v3
    v_fma_f32 v37, v37, s68, v30
    v_exp_f32 v37, v37
    s_waitcnt lgkmcnt(2)
    v_smfmac_f32_16x16x64_bf16 v[40:43], v[60:63], v[128:135], v3
    v_fma_f32 v38, v38, s68, v30
    v_cvt_pk_bf16_f32 v24, v36, v37
    v_exp_f32 v38, v38
    v_smfmac_f32_16x16x64_bf16 v[44:47], v[60:63], v[136:143], v3
    v_fma_f32 v39, v39, s68, v30
    v_exp_f32 v39, v39
    s_waitcnt lgkmcnt(1)
    v_smfmac_f32_16x16x64_bf16 v[40:43], v[12:15], v[144:151], v3
    v_fma_f32 v20, v20, s68, v30
    v_cvt_pk_bf16_f32 v25, v38, v39
    v_exp_f32 v20, v20
    v_smfmac_f32_16x16x64_bf16 v[44:47], v[12:15], v[152:159], v3
    v_fma_f32 v21, v21, s68, v30
    v_exp_f32 v21, v21
    s_waitcnt lgkmcnt(0)
    v_smfmac_f32_16x16x64_bf16 v[40:43], v[16:19], v[160:167], v3
    v_fma_f32 v22, v22, s68, v30
    v_cvt_pk_bf16_f32 v26, v20, v21
    v_exp_f32 v22, v22
    v_smfmac_f32_16x16x64_bf16 v[44:47], v[16:19], v[168:175], v3
    v_fma_f32 v23, v23, s68, v30
    v_exp_f32 v23, v23
    v_fma_f32 v32, v32, s68, v30
    v_cvt_pk_bf16_f32 v27, v22, v23
    v_exp_f32 v32, v32
    v_fma_f32 v33, v33, s68, v30
    v_exp_f32 v33, v33
    s_waitcnt vmcnt(0)
    v_cvt_pk_bf16_f32 v28, v32, v33
    v_cvt_pk_bf16_f32 v29, v32, v33
    v_mfma_f32_16x16x32_bf16 v[56:59], v[48:51], v[24:27], 0
    v_mfma_f32_16x16x32_bf16 v[32:35], v[64:67], v[24:27], 0
    v_cvt_pk_bf16_f32 v64, v40, v41
    v_cvt_pk_bf16_f32 v65, v42, v43
    v_mfma_f32_16x16x32_bf16 v[36:39], v[68:71], v[24:27], 0
    v_cvt_pk_bf16_f32 v66, v44, v45
    v_cvt_pk_bf16_f32 v67, v46, v47
    v_mfma_f32_16x16x16_bf16 v[56:59], v[52:53], v[28:29], v[56:59]
    v_mfma_f32_16x16x16_bf16 v[32:35], v[64:65], v[28:29], v[32:35]
    ds_read_b128 v[48:51], v10 offset:18432
    ds_read_b128 v[52:55], v10 offset:19456
    v_mfma_f32_16x16x16_bf16 v[36:39], v[66:67], v[28:29], v[36:39]
    v_mov_b32 v24, 0
    v_mov_b32 v25, 0
    v_mov_b32 v26, 0
    v_mov_b32 v27, 0
    v_rcp_f32 v30, v56
    s_mov_b32 exec_lo, 0xcccccccc
    s_mov_b32 exec_hi, 0xcccccccc
    v_mul_f32 v32, v32, v30
    v_mul_f32 v33, v33, v30
    v_mul_f32 v34, v34, v30
    v_mul_f32 v35, v35, v30
    v_cvt_pk_bf16_f32 v20, v32, v33
    v_cvt_pk_bf16_f32 v21, v34, v35
    v_mul_f32 v36, v36, v30
    v_mul_f32 v37, v37, v30
    v_mul_f32 v38, v38, v30
    v_mul_f32 v39, v39, v30
    v_cvt_pk_bf16_f32 v22, v36, v37
    v_cvt_pk_bf16_f32 v23, v38, v39
    ds_write_b128 v5, v[20:23]
    s_mov_b64 exec, -1
    ds_read_b128 v[56:59], v10 offset:6144
    ds_read_b128 v[60:63], v10 offset:7168
    v_mov_b32 v28, 0
    v_mov_b32 v29, 0
    v_mov_b32 v30, 0
    v_mov_b32 v31, 0
    v_mov_b32 v40, 0
    v_mov_b32 v41, 0
    v_mov_b32 v42, 0
    v_mov_b32 v43, 0
    v_mov_b32 v44, 0
    v_mov_b32 v45, 0
    v_mov_b32 v46, 0
    v_mov_b32 v47, 0
    v_mov_b32 v68, 0
    v_mov_b32 v69, 0
    v_mov_b32 v70, 0
    v_mov_b32 v71, 0
    s_waitcnt lgkmcnt(2)
    s_barrier
    ds_read_b128 v[12:15], v1 offset:21504
    ds_read_b128 v[16:19], v1 offset:22528
    v_mov_b32 v32, 0
    v_mov_b32 v33, 0
    v_mov_b32 v34, 0
    v_mov_b32 v35, 0
    v_mov_b32 v36, 0
    v_mov_b32 v37, 0
    v_mov_b32 v38, 0
    v_mov_b32 v39, 0
    s_waitcnt lgkmcnt(1)
    v_smfmac_f32_16x16x64_bf16 v[24:27], v[12:15], v[176:183], v3
    v_mov_b32 v20, 0
    v_mov_b32 v21, 0
    s_waitcnt lgkmcnt(0)
    v_smfmac_f32_16x16x64_bf16 v[24:27], v[16:19], v[184:191], v3
    v_mov_b32 v22, 0
    v_mov_b32 v23, 0
    v_smfmac_f32_16x16x64_bf16 v[28:31], v[12:15], v[192:199], v3
    v_smfmac_f32_16x16x64_bf16 v[28:31], v[16:19], v[48:55], v3
    ds_read_b128 v[48:51], v10 offset:8192
    ds_read_b128 v[52:55], v10 offset:9216
    v_smfmac_f32_16x16x64_bf16 v[40:43], v[12:15], v[200:207], v3
    s_nop 0
    v_add_f32 v26, v24, v26
    v_add_f32 v27, v25, v27
    v_smfmac_f32_16x16x64_bf16 v[40:43], v[16:19], v[56:63], v3
    ds_read_b128 v[56:59], v10 offset:10240
    ds_read_b128 v[60:63], v10 offset:11264
    v_cvt_pk_bf16_f32 v24, v26, v27
    v_smfmac_f32_16x16x64_bf16 v[44:47], v[12:15], v[208:215], v3
    v_add_f32 v30, v28, v30
    v_add_f32 v31, v29, v31
    s_waitcnt lgkmcnt(2)
    v_smfmac_f32_16x16x64_bf16 v[44:47], v[16:19], v[48:55], v3
    ds_read_b128 v[48:51], v10 offset:12288
    ds_read_b128 v[52:55], v10 offset:13312
    v_cvt_pk_bf16_f32 v25, v30, v31
    v_mov_b32 v28, 0
    v_smfmac_f32_16x16x64_bf16 v[68:71], v[12:15], v[216:223], v3
    v_mov_b32 v29, 0
    v_mov_b32 v30, 0
    s_waitcnt lgkmcnt(2)
    v_smfmac_f32_16x16x64_bf16 v[68:71], v[16:19], v[56:63], v3
    ds_read_b128 v[56:59], v10 offset:14336
    ds_read_b128 v[60:63], v10 offset:15360
    v_mov_b32 v31, 0
    v_add_f32 v42, v40, v42
    v_smfmac_f32_16x16x64_bf16 v[32:35], v[12:15], v[224:231], v3
    v_add_f32 v43, v41, v43
    v_cvt_pk_bf16_f32 v26, v42, v43
    s_waitcnt lgkmcnt(2)
    v_smfmac_f32_16x16x64_bf16 v[32:35], v[16:19], v[48:55], v3
    ds_read_b128 v[48:51], v10 offset:16384
    ds_read_b128 v[52:55], v10 offset:17408
    v_add_f32 v46, v44, v46
    v_add_f32 v47, v45, v47
    v_smfmac_f32_16x16x64_bf16 v[36:39], v[12:15], v[232:239], v3
    v_cvt_pk_bf16_f32 v27, v46, v47
    buffer_store_dwordx4 v[24:27], v8, s[8:11], s20 offen
    s_waitcnt lgkmcnt(2)
    v_smfmac_f32_16x16x64_bf16 v[36:39], v[16:19], v[56:63], v3
    ds_read_b128 v[56:59], v10 offset:4096
    ds_read_b128 v[60:63], v10 offset:5120
    v_lshrrev_b32 v40, 2, v1
    v_add_f32 v70, v68, v70
    v_smfmac_f32_16x16x64_bf16 v[20:23], v[12:15], v[240:247], v3
    v_add_f32 v71, v69, v71
    v_cvt_pk_bf16_f32 v68, v70, v71
    s_waitcnt lgkmcnt(2)
    v_smfmac_f32_16x16x64_bf16 v[20:23], v[16:19], v[48:55], v3
    v_add_f32 v34, v32, v34
    v_add_f32 v35, v33, v35
    v_smfmac_f32_16x16x64_bf16 v[28:31], v[12:15], v[248:255], v3
    v_cvt_pk_bf16_f32 v69, v34, v35
    v_add_f32 v38, v36, v38
    s_waitcnt lgkmcnt(0)
    v_smfmac_f32_16x16x64_bf16 v[28:31], v[16:19], v[56:63], v3
    v_add_f32 v39, v37, v39
    v_cvt_pk_bf16_f32 v70, v38, v39
    v_add_f32 v22, v20, v22
    v_add_f32 v23, v21, v23
    v_cvt_pk_bf16_f32 v71, v22, v23
    buffer_store_dwordx4 v[68:71], v8, s[8:11], s20 offen offset:1024
    s_nop 1
    v_add_f32 v30, v28, v30
    v_add_f32 v31, v29, v31
    v_cvt_pk_bf16_f32 v28, v30, v31
    buffer_store_dword v28, v40, s[8:11], s61 offen
    v_cmp_eq_u32 vcc, 0, v7
    s_cbranch_vccnz L_rfi_fwait
L_rfi_fok:
    s_add_u32 s36, s36, 1024
    s_min_u32 s36, s36, 119733504
    s_add_u32 s24, s24, 262144
    s_add_u32 s25, s25, 262144
    s_xor_b32 s20, s20, 524288
    s_xor_b32 s61, s61, 524288
    v_mov_b32 v24, 0
    v_mov_b32 v25, 0
    v_mov_b32 v26, 0
    v_mov_b32 v27, 0
    v_mov_b32 v28, 0
    v_mov_b32 v29, 0
    v_mov_b32 v30, 0
    v_mov_b32 v31, 0
    v_mov_b32 v32, 0
    v_mov_b32 v33, 0
    v_mov_b32 v34, 0
    v_mov_b32 v35, 0
    v_mov_b32 v36, 0
    v_mov_b32 v37, 0
    v_mov_b32 v38, 0
    v_mov_b32 v39, 0
    s_mov_b32 s38, s39
    s_add_u32 s39, s39, 9216
    s_add_u32 s18, s18, 1
    s_branch L_rfi_top
L_rfi_fwait:
    buffer_load_dword v7, v6, s[8:11], s36 offen sc1
    s_add_u32 s29, s29, 1
    s_cmp_ge_u32 s29, 4194304
    s_cbranch_scc1 L_abort
    s_waitcnt vmcnt(0)
    v_cmp_eq_u32 vcc, 0, v7
    s_cbranch_vccz L_rfi_fok
    s_sleep 4
    s_branch L_rfi_fwait
L_rfi_e2:
    buffer_load_dwordx4 v[12:15], v11, s[8:11], s22 offen offset:0 sc1
    buffer_load_dwordx4 v[16:19], v11, s[8:11], s22 offen offset:1024 sc1
    buffer_load_dwordx4 v[20:23], v11, s[8:11], s22 offen offset:2048 sc1
    s_add_u32 s29, s29, 1
    s_cmp_ge_u32 s29, 4194304
    s_cbranch_scc1 L_abort
    s_waitcnt vmcnt(2)
    v_max3_u32 v66, v12, v13, v14
    s_waitcnt vmcnt(1)
    v_max3_u32 v66, v66, v15, v16
    v_max3_u32 v66, v66, v17, v18
    s_waitcnt vmcnt(0)
    v_max3_u32 v66, v66, v19, v20
    v_max3_u32 v66, v66, v21, v22
    v_max_u32 v66, v66, v23
    v_cmp_eq_u32 vcc, -1, v66
    s_nop 0
    s_cbranch_vccnz L_rfi_e2
    s_branch L_rfi_e2ok
L_rfi_last:
    s_cmp_ge_u32 s66, 3
    s_cbranch_scc1 L_rfi_end
    s_mov_b32 s29, 0
L_rfi_l2:
    buffer_load_dwordx4 v[12:15], v11, s[8:11], s35 offen offset:0 sc1
    buffer_load_dwordx4 v[16:19], v11, s[8:11], s35 offen offset:1024 sc1
    buffer_load_dwordx4 v[20:23], v11, s[8:11], s35 offen offset:2048 sc1
    s_add_u32 s29, s29, 1
    s_cmp_ge_u32 s29, 4194304
    s_cbranch_scc1 L_abort
    s_waitcnt vmcnt(2)
    v_max3_u32 v66, v12, v13, v14
    s_waitcnt vmcnt(1)
    v_max3_u32 v66, v66, v15, v16
    v_max3_u32 v66, v66, v17, v18
    s_waitcnt vmcnt(0)
    v_max3_u32 v66, v66, v19, v20
    v_max3_u32 v66, v66, v21, v22
    v_max_u32 v66, v66, v23
    v_cmp_eq_u32 vcc, -1, v66
    s_nop 0
    s_cbranch_vccnz L_rfi_l2
    s_mov_b64 exec, s[42:43]
    buffer_store_dwordx4 v[12:15], v11, s[8:11], s38 offen offset:0 sc1
    buffer_store_dwordx4 v[16:19], v11, s[8:11], s38 offen offset:1024 sc1
    buffer_store_dwordx4 v[20:23], v11, s[8:11], s38 offen offset:2048 sc1
    s_mov_b64 exec, -1
    s_nop 0
L_rfi_end:
    s_endpgm
L_r_slow:
    s_cmp_eq_u32 s17, 3
    s_cbranch_scc1 L_rsi_entry
    s_cmp_eq_u32 s28, 0
    s_cbranch_scc1 L_rsg_entry
L_rsr_entry:
    v_mov_b32 v24, 0
    v_mov_b32 v25, 0
    v_mov_b32 v26, 0
    v_mov_b32 v27, 0
    v_mov_b32 v28, 0
    v_mov_b32 v29, 0
    v_mov_b32 v30, 0
    v_mov_b32 v31, 0
    v_mov_b32 v32, 0
    v_mov_b32 v33, 0
    v_mov_b32 v34, 0
    v_mov_b32 v35, 0
    v_mov_b32 v36, 0
    v_mov_b32 v37, 0
    v_mov_b32 v38, 0
    v_mov_b32 v39, 0
    s_add_u32 m0, s65, 9216
    s_add_u32 s30, s24, s65
    buffer_load_dwordx4 v1, s[8:11], s30 offen lds
    buffer_load_dwordx4 v1, s[8:11], s30 offen offset:3072 lds
    s_add_u32 m0, s69, 9216
    s_add_u32 s30, s24, s69
    buffer_load_dwordx4 v1, s[8:11], s30 offen lds
    s_add_u32 s24, s24, 262144
    s_branch L_rsr_gather
L_rsr_top:
    s_mov_b32 s29, 0
    s_nop 7
    s_nop 7
    buffer_load_dwordx4 v[40:43], v6, s[8:11], s44 offen sc1
    buffer_load_dwordx4 v[44:47], v6, s[8:11], s45 offen sc1
    buffer_load_dwordx4 v[48:51], v6, s[8:11], s46 offen sc1
    buffer_load_dwordx4 v[52:55], v6, s[8:11], s47 offen sc1
    s_nop 7
    s_nop 7
    s_nop 7
    s_nop 7
    s_nop 7
    s_nop 7
L_rsr_e1:
    buffer_load_dwordx4 v[56:59], v6, s[8:11], s44 offen sc1
    buffer_load_dwordx4 v[60:63], v6, s[8:11], s45 offen sc1
    buffer_load_dwordx4 v[68:71], v6, s[8:11], s46 offen sc1
    buffer_load_dwordx4 v[20:23], v6, s[8:11], s47 offen sc1
    s_waitcnt vmcnt(7) lgkmcnt(0)
    v_mfma_f32_16x16x32_bf16 v[16:19], v[12:15], v[40:43], 0
    s_waitcnt vmcnt(6) lgkmcnt(0)
    v_mfma_f32_16x16x32_bf16 v[16:19], v[12:15], v[44:47], v[16:19]
    s_waitcnt vmcnt(5) lgkmcnt(0)
    v_mfma_f32_16x16x32_bf16 v[16:19], v[12:15], v[48:51], v[16:19]
    s_waitcnt vmcnt(4) lgkmcnt(0)
    v_mfma_f32_16x16x32_bf16 v[16:19], v[12:15], v[52:55], v[16:19]
    s_add_u32 s29, s29, 1
    s_mov_b32 exec_hi, 0
    s_nop 5
    v_cmp_u_f32 vcc, v16, v16
    s_cbranch_vccz L_rsr_e1ok
    s_mov_b32 exec_hi, -1
    buffer_load_dwordx4 v[40:43], v6, s[8:11], s44 offen sc1
    buffer_load_dwordx4 v[44:47], v6, s[8:11], s45 offen sc1
    buffer_load_dwordx4 v[48:51], v6, s[8:11], s46 offen sc1
    buffer_load_dwordx4 v[52:55], v6, s[8:11], s47 offen sc1
    s_waitcnt vmcnt(7) lgkmcnt(0)
    v_mfma_f32_16x16x32_bf16 v[16:19], v[12:15], v[56:59], 0
    s_waitcnt vmcnt(6) lgkmcnt(0)
    v_mfma_f32_16x16x32_bf16 v[16:19], v[12:15], v[60:63], v[16:19]
    s_waitcnt vmcnt(5) lgkmcnt(0)
    v_mfma_f32_16x16x32_bf16 v[16:19], v[12:15], v[68:71], v[16:19]
    s_waitcnt vmcnt(4) lgkmcnt(0)
    v_mfma_f32_16x16x32_bf16 v[16:19], v[12:15], v[20:23], v[16:19]
    s_add_u32 s29, s29, 1
    s_mov_b32 exec_hi, 0
    s_nop 5
    v_cmp_u_f32 vcc, v16, v16
    s_cbranch_vccz L_rsr_e1ok
    s_mov_b32 exec_hi, -1
    s_cmp_lt_u32 s29, 4096
    s_cbranch_scc1 L_rsr_e1
    s_branch L_rsr_e1x
L_rsr_e1ok:
    v_add_f32_dpp v16, v16, v16 row_ror:8 row_mask:0xf bank_mask:0xf
    v_add_f32_dpp v17, v17, v17 row_ror:8 row_mask:0xf bank_mask:0xf
    v_add_f32_dpp v18, v18, v18 row_ror:8 row_mask:0xf bank_mask:0xf
    v_add_f32_dpp v19, v19, v19 row_ror:8 row_mask:0xf bank_mask:0xf
    v_cvt_pk_bf16_f32 v64, v16, v17
    v_cvt_pk_bf16_f32 v65, v18, v19
    s_mov_b32 exec_lo, 0x00ff00ff
    buffer_store_dwordx2 v[64:65], v7, s[8:11], s35 offen sc1
    s_mov_b64 exec, -1
    s_cmp_ge_u32 s18, 63
    s_cbranch_scc1 L_rsr_last
L_rsr_gather:
    s_barrier
    s_mov_b32 s30, s22
    s_mov_b32 s22, s35
    s_mov_b32 s35, s23
    s_mov_b32 s23, s30
    s_mov_b32 s56, s44
    s_xor_b32 s44, s44, 524288
    s_mov_b32 s57, s45
    s_xor_b32 s45, s45, 524288
    s_mov_b32 s58, s46
    s_xor_b32 s46, s46, 524288
    s_mov_b32 s59, s47
    s_xor_b32 s47, s47, 524288
    s_waitcnt vmcnt(1)
    v_mov_b32 v68, -1
    v_mov_b32 v69, -1
    v_mov_b32 v70, -1
    v_mov_b32 v71, -1
    s_mov_b32 s29, 1
    ds_read_b128 v[40:43], v10 offset:32768
    ds_read_b128 v[44:47], v10 offset:33792
    ds_read_b128 v[48:51], v10 offset:24576
    ds_read_b128 v[52:55], v10 offset:25600
    ds_read_b128 v[56:59], v10 offset:30720
    ds_read_b128 v[60:63], v10 offset:31744
    s_nop 7
    s_nop 7
    buffer_load_dwordx4 v[12:15], v11, s[8:11], s22 offen offset:0 sc1
    buffer_load_dwordx4 v[16:19], v11, s[8:11], s22 offen offset:1024 sc1
    buffer_load_dwordx4 v[20:23], v11, s[8:11], s22 offen offset:2048 sc1
    s_waitcnt vmcnt(2)
    v_max3_u32 v66, v12, v13, v14
    s_waitcnt vmcnt(1)
    v_max3_u32 v66, v66, v15, v16
    v_max3_u32 v66, v66, v17, v18
    s_waitcnt vmcnt(0)
    v_max3_u32 v66, v66, v19, v20
    v_max3_u32 v66, v66, v21, v22
    v_max_u32 v66, v66, v23
    v_cmp_eq_u32 vcc, -1, v66
    s_nop 0
    s_cbranch_vccnz L_rsr_e2
L_rsr_e2ok:
    ds_write_b128 v11, v[12:15] offset:0
    ds_write_b128 v11, v[16:19] offset:1024
    ds_write_b128 v11, v[20:23] offset:2048
    s_waitcnt lgkmcnt(7)
    v_smfmac_f32_16x16x64_bf16 v[36:39], v[12:15], v[40:47], v3
    ds_read_b128 v[40:43], v10 offset:20480
    v_smfmac_f32_16x16x64_bf16 v[24:27], v[12:15], a[0:7], v3
    ds_read_b128 v[44:47], v10 offset:21504
    v_smfmac_f32_16x16x64_bf16 v[32:35], v[12:15], a[144:151], v3
    buffer_store_dwordx4 v[68:71], v6, s[8:11], s56 offen sc1
    v_smfmac_f32_16x16x64_bf16 v[28:31], v[12:15], a[8:15], v3
    buffer_store_dwordx4 v[68:71], v6, s[8:11], s57 offen sc1
    s_waitcnt lgkmcnt(7)
    v_smfmac_f32_16x16x64_bf16 v[36:39], v[16:19], v[48:55], v3
    ds_read_b128 v[48:51], v10 offset:26624
    v_smfmac_f32_16x16x64_bf16 v[24:27], v[16:19], a[16:23], v3
    s_waitcnt lgkmcnt(3)
    s_barrier
    ds_read_b128 v[12:15], v2 offset:0
    v_smfmac_f32_16x16x64_bf16 v[32:35], v[16:19], a[152:159], v3
    ds_read_b128 v[52:55], v10 offset:27648
    v_smfmac_f32_16x16x64_bf16 v[28:31], v[16:19], a[24:31], v3
    buffer_store_dwordx4 v[68:71], v6, s[8:11], s58 offen sc1
    buffer_store_dwordx4 v[68:71], v6, s[8:11], s59 offen sc1
    v_smfmac_f32_16x16x64_bf16 v[36:39], v[20:23], v[56:63], v3
    ds_read_b128 v[16:19], v2 offset:1024
    v_smfmac_f32_16x16x64_bf16 v[24:27], v[20:23], a[32:39], v3
    ds_read_b128 v[56:59], v10 offset:0
    v_smfmac_f32_16x16x64_bf16 v[32:35], v[20:23], a[160:167], v3
    ds_read_b128 v[60:63], v10 offset:1024
    v_smfmac_f32_16x16x64_bf16 v[28:31], v[20:23], a[40:47], v3
    s_waitcnt lgkmcnt(4)
    v_smfmac_f32_16x16x64_bf16 v[36:39], v[12:15], v[40:47], v3
    ds_read_b128 v[40:43], v10 offset:22528
    v_smfmac_f32_16x16x64_bf16 v[24:27], v[12:15], a[48:55], v3
    ds_read_b128 v[44:47], v10 offset:23552
    v_smfmac_f32_16x16x64_bf16 v[32:35], v[12:15], a[168:175], v3
    ds_read_b128 v[20:23], v2 offset:2048
    v_smfmac_f32_16x16x64_bf16 v[28:31], v[12:15], a[56:63], v3
    s_mov_b64 exec, s[40:41]
    buffer_store_dwordx2 v[68:69], v7, s[8:11], s23 offen sc1
    s_mov_b64 exec, -1
    s_waitcnt lgkmcnt(5)
    v_smfmac_f32_16x16x64_bf16 v[36:39], v[16:19], v[48:55], v3
    ds_read_b128 v[48:51], v10 offset:28672
    v_smfmac_f32_16x16x64_bf16 v[24:27], v[16:19], a[64:71], v3
    ds_read_b128 v[52:55], v10 offset:29696
    v_smfmac_f32_16x16x64_bf16 v[32:35], v[16:19], a[176:183], v3
    ds_read_b128 v[12:15], v9 offset:0
    v_smfmac_f32_16x16x64_bf16 v[28:31], v[16:19], a[72:79], v3
    s_waitcnt lgkmcnt(3)
    v_smfmac_f32_16x16x64_bf16 v[36:39], v[20:23], v[56:63], v3
    ds_read_b128 v[56:59], v10 offset:2048
    v_smfmac_f32_16x16x64_bf16 v[24:27], v[20:23], a[80:87], v3
    ds_read_b128 v[60:63], v10 offset:3072
    v_smfmac_f32_16x16x64_bf16 v[32:35], v[20:23], a[184:191], v3
    ds_read_b128 v[16:19], v9 offset:1024
    v_smfmac_f32_16x16x64_bf16 v[28:31], v[20:23], a[88:95], v3
    s_waitcnt lgkmcnt(3)
    v_smfmac_f32_16x16x64_bf16 v[36:39], v[12:15], v[40:47], v3
    ds_read_b128 v[64:67], v1 offset:9216
    v_smfmac_f32_16x16x64_bf16 v[24:27], v[12:15], a[96:103], v3
    ds_read_b128 v[68:71], v1 offset:10240
    v_smfmac_f32_16x16x64_bf16 v[32:35], v[12:15], a[192:199], v3
    ds_read_b128 v[20:23], v9 offset:2048
    v_smfmac_f32_16x16x64_bf16 v[28:31], v[12:15], a[104:111], v3
    s_waitcnt lgkmcnt(3)
    v_smfmac_f32_16x16x64_bf16 v[36:39], v[16:19], v[48:55], v3
    v_mov_b32 v40, 0
    v_smfmac_f32_16x16x64_bf16 v[24:27], v[16:19], a[112:119], v3
    v_mov_b32 v41, 0
    v_smfmac_f32_16x16x64_bf16 v[32:35], v[16:19], a[200:207], v3
    ds_read_b128 v[12:15], v11 offset:0
    v_smfmac_f32_16x16x64_bf16 v[28:31], v[16:19], a[120:127], v3
    v_mov_b32 v42, 0
    v_mov_b32 v43, 0
    s_waitcnt lgkmcnt(1)
    v_smfmac_f32_16x16x64_bf16 v[32:35], v[20:23], a[208:215], v3
    v_mov_b32 v44, 0
    v_smfmac_f32_16x16x64_bf16 v[24:27], v[20:23], a[128:135], v3
    v_mov_b32 v45, 0
    v_smfmac_f32_16x16x64_bf16 v[36:39], v[20:23], v[56:63], v3
    ds_read_b128 v[16:19], v11 offset:1024
    v_smfmac_f32_16x16x64_bf16 v[28:31], v[20:23], a[136:143], v3
    v_mov_b32 v46, 0
    v_mov_b32 v47, 0
    ds_read_b128 v[20:23], v11 offset:2048
    s_waitcnt lgkmcnt(2)
    v_smfmac_f32_16x16x64_bf16 v[40:43], v[12:15], a[216:223], v3
    v_add_f32 v32, v32, v34
    v_add_f32 v33, v33, v35
    v_add_f32 v24, v24, v26
    v_add_f32 v25, v25, v27
    v_cvt_pk_bf16_f32 v32, v32, v33
    v_cvt_pk_bf16_f32 v33, v24, v25
    ds_write_b64 v4, v[32:33] offset:0
    v_add_f32 v36, v36, v38
    v_add_f32 v37, v37, v39
    v_add_f32 v28, v28, v30
    v_add_f32 v29, v29, v31
    v_cvt_pk_bf16_f32 v36, v36, v37
    v_cvt_pk_bf16_f32 v37, v28, v29
    ds_write_b64 v4, v[36:37] offset:256
    v_lshrrev_b32 v35, 1, v1
    ds_read_b128 v[24:27], v1 offset:11264
    ds_read_b128 v[28:31], v1 offset:12288
    v_smfmac_f32_16x16x64_bf16 v[44:47], v[12:15], a[224:231], v3
    ds_read_b128 v[12:15], v2 offset:0
    s_waitcnt lgkmcnt(6)
    v_smfmac_f32_16x16x64_bf16 v[40:43], v[16:19], a[232:239], v3
    v_smfmac_f32_16x16x64_bf16 v[44:47], v[16:19], a[240:247], v3
    ds_read_b128 v[16:19], v2 offset:1024
    s_waitcnt lgkmcnt(4)
    s_barrier
    ds_read_b64_tr_b16 v[48:49], v35 offset:17408
    ds_read_b64_tr_b16 v[50:51], v35 offset:17920
    ds_read_b64_tr_b16 v[52:53], v35 offset:18432
    ds_read_b64_tr_b16 v[54:55], v35 offset:18944
    ds_read_b64_tr_b16 v[56:57], v35 offset:19456
    ds_read_b64_tr_b16 v[58:59], v35 offset:19968
    ds_read_b64_tr_b16 v[60:61], v35 offset:20480
    ds_read_b64_tr_b16 v[62:63], v35 offset:20992
    v_smfmac_f32_16x16x64_bf16 v[40:43], v[20:23], a[248:255], v3
    v_smfmac_f32_16x16x64_bf16 v[44:47], v[20:23], v[72:79], v3
    s_waitcnt lgkmcnt(6)
    v_mfma_f32_16x16x32_bf16 v[32:35], v[48:51], v[48:51], 0
    v_mfma_f32_16x16x32_bf16 v[36:39], v[64:67], v[48:51], 0
    ds_read_b128 v[64:67], v1 offset:13312
    v_mfma_f32_16x16x32_bf16 v[20:23], v[68:71], v[48:51], 0
    ds_read_b128 v[68:71], v1 offset:14336
    s_waitcnt lgkmcnt(6)
    v_mfma_f32_16x16x32_bf16 v[32:35], v[52:55], v[52:55], v[32:35]
    v_mfma_f32_16x16x32_bf16 v[36:39], v[24:27], v[52:55], v[36:39]
    ds_read_b128 v[24:27], v1 offset:15360
    v_mfma_f32_16x16x32_bf16 v[20:23], v[28:31], v[52:55], v[20:23]
    ds_read_b128 v[28:31], v1 offset:16384
    v_smfmac_f32_16x16x64_bf16 v[40:43], v[12:15], v[80:87], v3
    s_waitcnt lgkmcnt(2)
    v_mfma_f32_16x16x32_bf16 v[32:35], v[56:59], v[56:59], v[32:35]
    v_mfma_f32_16x16x32_bf16 v[36:39], v[64:67], v[56:59], v[36:39]
    v_mfma_f32_16x16x32_bf16 v[20:23], v[68:71], v[56:59], v[20:23]
    ds_read_b128 v[56:59], v2 offset:2048
    s_waitcnt lgkmcnt(1)
    v_mfma_f32_16x16x32_bf16 v[32:35], v[60:63], v[60:63], v[32:35]
    v_mfma_f32_16x16x32_bf16 v[36:39], v[24:27], v[60:63], v[36:39]
    v_mov_b32 v48, 0x3f803f80
    v_mov_b32 v49, 0x3f803f80
    v_mfma_f32_16x16x32_bf16 v[20:23], v[28:31], v[60:63], v[20:23]
    v_mov_b32 v50, 0x3f803f80
    v_mov_b32 v51, 0x3f803f80
    ds_read_b128 v[60:63], v9 offset:0
    v_smfmac_f32_16x16x64_bf16 v[44:47], v[12:15], v[88:95], v3
    ds_read_b128 v[12:15], v9 offset:1024
    buffer_load_dwordx4 v[64:67], v1, s[8:11], s25 offen offset:0
    v_smfmac_f32_16x16x64_bf16 v[40:43], v[16:19], v[96:103], v3
    buffer_load_dwordx4 v[68:71], v1, s[8:11], s25 offen offset:1024
    v_max3_f32 v30, v32, v33, v36
    v_max3_f32 v31, v37, v38, v39
    v_max3_f32 v30, v30, v20, v21
    v_max3_f32 v31, v31, v22, v23
    v_max_f32 v30, v30, v31
    v_max_f32 v31, v30, v31
    v_smfmac_f32_16x16x64_bf16 v[44:47], v[16:19], v[104:111], v3
    ds_read_b128 v[16:19], v9 offset:2048
    v_mov_b32 v52, 0x3f003f00
    v_permlane16_swap_b32 v30, v31
    v_max_f32 v30, v30, v31
    v_max_f32 v31, v30, v31
    s_waitcnt lgkmcnt(3)
    v_smfmac_f32_16x16x64_bf16 v[40:43], v[56:59], v[112:119], v3
    v_mov_b32 v53, 0x3f003f00
    v_permlane32_swap_b32 v30, v31
    v_max_f32 v30, v30, v31
    v_mul_f32 v30, 0xbe0293ee, v30
    v_fma_f32 v36, v36, s68, v30
    v_exp_f32 v36, v36
    v_smfmac_f32_16x16x64_bf16 v[44:47], v[56:59], v[120:127], v3
    v_fma_f32 v37, v37, s68, v30
    v_exp_f32 v37, v37
    s_waitcnt lgkmcnt(2)
    v_smfmac_f32_16x16x64_bf16 v[40:43], v[60:63], v[128:135], v3
    v_fma_f32 v38, v38, s68, v30
    v_cvt_pk_bf16_f32 v24, v36, v37
    v_exp_f32 v38, v38
    v_smfmac_f32_16x16x64_bf16 v[44:47], v[60:63], v[136:143], v3
    v_fma_f32 v39, v39, s68, v30
    v_exp_f32 v39, v39
    s_waitcnt lgkmcnt(1)
    v_smfmac_f32_16x16x64_bf16 v[40:43], v[12:15], v[144:151], v3
    v_fma_f32 v20, v20, s68, v30
    v_cvt_pk_bf16_f32 v25, v38, v39
    v_exp_f32 v20, v20
    v_smfmac_f32_16x16x64_bf16 v[44:47], v[12:15], v[152:159], v3
    v_fma_f32 v21, v21, s68, v30
    v_exp_f32 v21, v21
    s_waitcnt lgkmcnt(0)
    v_smfmac_f32_16x16x64_bf16 v[40:43], v[16:19], v[160:167], v3
    v_fma_f32 v22, v22, s68, v30
    v_cvt_pk_bf16_f32 v26, v20, v21
    v_exp_f32 v22, v22
    v_smfmac_f32_16x16x64_bf16 v[44:47], v[16:19], v[168:175], v3
    v_fma_f32 v23, v23, s68, v30
    v_exp_f32 v23, v23
    v_fma_f32 v32, v32, s68, v30
    v_cvt_pk_bf16_f32 v27, v22, v23
    v_exp_f32 v32, v32
    v_fma_f32 v33, v33, s68, v30
    v_exp_f32 v33, v33
    s_waitcnt vmcnt(0)
    v_cvt_pk_bf16_f32 v28, v32, v33
    v_cvt_pk_bf16_f32 v29, v32, v33
    v_mfma_f32_16x16x32_bf16 v[56:59], v[48:51], v[24:27], 0
    v_mfma_f32_16x16x32_bf16 v[32:35], v[64:67], v[24:27], 0
    v_cvt_pk_bf16_f32 v64, v40, v41
    v_cvt_pk_bf16_f32 v65, v42, v43
    v_mfma_f32_16x16x32_bf16 v[36:39], v[68:71], v[24:27], 0
    v_cvt_pk_bf16_f32 v66, v44, v45
    v_cvt_pk_bf16_f32 v67, v46, v47
    v_mfma_f32_16x16x16_bf16 v[56:59], v[52:53], v[28:29], v[56:59]
    v_mfma_f32_16x16x16_bf16 v[32:35], v[64:65], v[28:29], v[32:35]
    ds_read_b128 v[48:51], v10 offset:18432
    ds_read_b128 v[52:55], v10 offset:19456
    v_mfma_f32_16x16x16_bf16 v[36:39], v[66:67], v[28:29], v[36:39]
    v_mov_b32 v24, 0
    v_mov_b32 v25, 0
    v_mov_b32 v26, 0
    v_mov_b32 v27, 0
    v_rcp_f32 v30, v56
    s_mov_b32 exec_lo, 0xcccccccc
    s_mov_b32 exec_hi, 0xcccccccc
    v_mul_f32 v32, v32, v30
    v_mul_f32 v33, v33, v30
    v_mul_f32 v34, v34, v30
    v_mul_f32 v35, v35, v30
    v_cvt_pk_bf16_f32 v20, v32, v33
    v_cvt_pk_bf16_f32 v21, v34, v35
    v_mul_f32 v36, v36, v30
    v_mul_f32 v37, v37, v30
    v_mul_f32 v38, v38, v30
    v_mul_f32 v39, v39, v30
    v_cvt_pk_bf16_f32 v22, v36, v37
    v_cvt_pk_bf16_f32 v23, v38, v39
    ds_write_b128 v5, v[20:23]
    s_mov_b64 exec, -1
    ds_read_b128 v[56:59], v10 offset:6144
    ds_read_b128 v[60:63], v10 offset:7168
    v_mov_b32 v28, 0
    v_mov_b32 v29, 0
    v_mov_b32 v30, 0
    v_mov_b32 v31, 0
    v_mov_b32 v40, 0
    v_mov_b32 v41, 0
    v_mov_b32 v42, 0
    v_mov_b32 v43, 0
    v_mov_b32 v44, 0
    v_mov_b32 v45, 0
    v_mov_b32 v46, 0
    v_mov_b32 v47, 0
    v_mov_b32 v68, 0
    v_mov_b32 v69, 0
    v_mov_b32 v70, 0
    v_mov_b32 v71, 0
    s_waitcnt lgkmcnt(2)
    s_barrier
    ds_read_b128 v[12:15], v1 offset:21504
    ds_read_b128 v[16:19], v1 offset:22528
    s_add_u32 m0, s65, 9216
    s_add_u32 s30, s24, s65
    buffer_load_dwordx4 v1, s[8:11], s30 offen lds
    buffer_load_dwordx4 v1, s[8:11], s30 offen offset:3072 lds
    s_add_u32 m0, s69, 9216
    s_add_u32 s30, s24, s69
    buffer_load_dwordx4 v1, s[8:11], s30 offen lds
    v_mov_b32 v32, 0
    v_mov_b32 v33, 0
    v_mov_b32 v34, 0
    v_mov_b32 v35, 0
    s_waitcnt lgkmcnt(1)
    v_smfmac_f32_16x16x64_bf16 v[24:27], v[12:15], v[176:183], v3
    v_mov_b32 v36, 0
    v_mov_b32 v37, 0
    s_waitcnt lgkmcnt(0)
    v_smfmac_f32_16x16x64_bf16 v[24:27], v[16:19], v[184:191], v3
    v_mov_b32 v38, 0
    v_mov_b32 v39, 0
    v_smfmac_f32_16x16x64_bf16 v[28:31], v[12:15], v[192:199], v3
    v_mov_b32 v20, 0
    v_mov_b32 v21, 0
    v_smfmac_f32_16x16x64_bf16 v[28:31], v[16:19], v[48:55], v3
    ds_read_b128 v[48:51], v10 offset:8192
    ds_read_b128 v[52:55], v10 offset:9216
    v_mov_b32 v22, 0
    v_mov_b32 v23, 0
    v_smfmac_f32_16x16x64_bf16 v[40:43], v[12:15], v[200:207], v3
    v_add_f32 v26, v24, v26
    v_add_f32 v27, v25, v27
    v_smfmac_f32_16x16x64_bf16 v[40:43], v[16:19], v[56:63], v3
    ds_read_b128 v[56:59], v10 offset:10240
    ds_read_b128 v[60:63], v10 offset:11264
    v_cvt_pk_bf16_f32 v24, v26, v27
    v_smfmac_f32_16x16x64_bf16 v[44:47], v[12:15], v[208:215], v3
    v_add_f32 v30, v28, v30
    v_add_f32 v31, v29, v31
    s_waitcnt lgkmcnt(2)
    v_smfmac_f32_16x16x64_bf16 v[44:47], v[16:19], v[48:55], v3
    ds_read_b128 v[48:51], v10 offset:12288
    ds_read_b128 v[52:55], v10 offset:13312
    v_cvt_pk_bf16_f32 v25, v30, v31
    v_mov_b32 v28, 0
    v_smfmac_f32_16x16x64_bf16 v[68:71], v[12:15], v[216:223], v3
    v_mov_b32 v29, 0
    v_mov_b32 v30, 0
    s_waitcnt lgkmcnt(2)
    v_smfmac_f32_16x16x64_bf16 v[68:71], v[16:19], v[56:63], v3
    ds_read_b128 v[56:59], v10 offset:14336
    ds_read_b128 v[60:63], v10 offset:15360
    v_mov_b32 v31, 0
    v_add_f32 v42, v40, v42
    v_smfmac_f32_16x16x64_bf16 v[32:35], v[12:15], v[224:231], v3
    v_add_f32 v43, v41, v43
    v_cvt_pk_bf16_f32 v26, v42, v43
    s_waitcnt lgkmcnt(2)
    v_smfmac_f32_16x16x64_bf16 v[32:35], v[16:19], v[48:55], v3
    ds_read_b128 v[48:51], v10 offset:16384
    ds_read_b128 v[52:55], v10 offset:17408
    v_add_f32 v46, v44, v46
    v_add_f32 v47, v45, v47
    v_smfmac_f32_16x16x64_bf16 v[36:39], v[12:15], v[232:239], v3
    v_cvt_pk_bf16_f32 v27, v46, v47
    buffer_store_dwordx4 v[24:27], v8, s[8:11], s20 offen sc1
    s_waitcnt lgkmcnt(2)
    v_smfmac_f32_16x16x64_bf16 v[36:39], v[16:19], v[56:63], v3
    ds_read_b128 v[56:59], v10 offset:4096
    ds_read_b128 v[60:63], v10 offset:5120
    v_lshrrev_b32 v40, 2, v1
    v_add_f32 v70, v68, v70
    v_smfmac_f32_16x16x64_bf16 v[20:23], v[12:15], v[240:247], v3
    v_add_f32 v71, v69, v71
    v_cvt_pk_bf16_f32 v68, v70, v71
    s_waitcnt lgkmcnt(2)
    v_smfmac_f32_16x16x64_bf16 v[20:23], v[16:19], v[48:55], v3
    v_add_f32 v34, v32, v34
    v_add_f32 v35, v33, v35
    v_smfmac_f32_16x16x64_bf16 v[28:31], v[12:15], v[248:255], v3
    v_cvt_pk_bf16_f32 v69, v34, v35
    v_add_f32 v38, v36, v38
    s_waitcnt lgkmcnt(0)
    v_smfmac_f32_16x16x64_bf16 v[28:31], v[16:19], v[56:63], v3
    v_add_f32 v39, v37, v39
    v_cvt_pk_bf16_f32 v70, v38, v39
    v_add_f32 v22, v20, v22
    v_add_f32 v23, v21, v23
    v_cvt_pk_bf16_f32 v71, v22, v23
    buffer_store_dwordx4 v[68:71], v8, s[8:11], s20 offen offset:1024 sc1
    ds_read_b128 v[12:15], v1 offset:23552
    s_nop 0
    v_add_f32 v30, v28, v30
    v_add_f32 v31, v29, v31
    v_cvt_pk_bf16_f32 v28, v30, v31
    buffer_store_dword v28, v40, s[8:11], s61 offen sc1
    s_add_u32 s24, s24, 262144
    s_add_u32 s25, s25, 262144
    s_xor_b32 s20, s20, 524288
    s_xor_b32 s61, s61, 524288
    v_mov_b32 v24, 0
    v_mov_b32 v25, 0
    v_mov_b32 v26, 0
    v_mov_b32 v27, 0
    v_mov_b32 v28, 0
    v_mov_b32 v29, 0
    v_mov_b32 v30, 0
    v_mov_b32 v31, 0
    v_mov_b32 v32, 0
    v_mov_b32 v33, 0
    v_mov_b32 v34, 0
    v_mov_b32 v35, 0
    v_mov_b32 v36, 0
    v_mov_b32 v37, 0
    v_mov_b32 v38, 0
    v_mov_b32 v39, 0
    s_mov_b32 s38, s39
    s_add_u32 s39, s39, 9216
    s_add_u32 s18, s18, 1
    s_branch L_rsr_top
L_rsr_e2:
    buffer_load_dwordx4 v[12:15], v11, s[8:11], s22 offen offset:0 sc1
    buffer_load_dwordx4 v[16:19], v11, s[8:11], s22 offen offset:1024 sc1
    buffer_load_dwordx4 v[20:23], v11, s[8:11], s22 offen offset:2048 sc1
    s_add_u32 s29, s29, 1
    s_cmp_ge_u32 s29, 4194304
    s_cbranch_scc1 L_abort
    s_waitcnt vmcnt(2)
    v_max3_u32 v66, v12, v13, v14
    s_waitcnt vmcnt(1)
    v_max3_u32 v66, v66, v15, v16
    v_max3_u32 v66, v66, v17, v18
    s_waitcnt vmcnt(0)
    v_max3_u32 v66, v66, v19, v20
    v_max3_u32 v66, v66, v21, v22
    v_max_u32 v66, v66, v23
    v_cmp_eq_u32 vcc, -1, v66
    s_nop 0
    s_cbranch_vccnz L_rsr_e2
    s_branch L_rsr_e2ok
L_rsr_e1x:
    s_waitcnt vmcnt(0)
L_rsr_e1y:
    buffer_load_dwordx4 v[40:43], v6, s[8:11], s44 offen sc1
    buffer_load_dwordx4 v[44:47], v6, s[8:11], s45 offen sc1
    buffer_load_dwordx4 v[48:51], v6, s[8:11], s46 offen sc1
    buffer_load_dwordx4 v[52:55], v6, s[8:11], s47 offen sc1
    s_add_u32 s29, s29, 1
    s_cmp_ge_u32 s29, 4194304
    s_cbranch_scc1 L_abort
    s_waitcnt vmcnt(3) lgkmcnt(0)
    v_mfma_f32_16x16x32_bf16 v[16:19], v[12:15], v[40:43], 0
    s_waitcnt vmcnt(2) lgkmcnt(0)
    v_mfma_f32_16x16x32_bf16 v[16:19], v[12:15], v[44:47], v[16:19]
    s_waitcnt vmcnt(1) lgkmcnt(0)
    v_mfma_f32_16x16x32_bf16 v[16:19], v[12:15], v[48:51], v[16:19]
    s_waitcnt vmcnt(0) lgkmcnt(0)
    v_mfma_f32_16x16x32_bf16 v[16:19], v[12:15], v[52:55], v[16:19]
    v_max3_u32 v22, v40, v41, v42
    v_max3_u32 v22, v22, v43, v44
    v_max3_u32 v22, v22, v45, v46
    v_max3_u32 v22, v22, v47, v48
    v_max3_u32 v22, v22, v49, v50
    v_max3_u32 v22, v22, v51, v52
    v_max3_u32 v22, v22, v53, v54
    v_max_u32 v22, v22, v55
    v_cmp_eq_u32 vcc, -1, v22
    s_nop 0
    s_cbranch_vccnz L_rsr_e1y
    s_mov_b32 exec_hi, 0
    s_branch L_rsr_e1ok
L_rsr_last:
    s_endpgm
L_rsg_entry:
    v_mov_b32 v24, 0
    v_mov_b32 v25, 0
    v_mov_b32 v26, 0
    v_mov_b32 v27, 0
    v_mov_b32 v28, 0
    v_mov_b32 v29, 0
    v_mov_b32 v30, 0
    v_mov_b32 v31, 0
    v_mov_b32 v32, 0
    v_mov_b32 v33, 0
    v_mov_b32 v34, 0
    v_mov_b32 v35, 0
    v_mov_b32 v36, 0
    v_mov_b32 v37, 0
    v_mov_b32 v38, 0
    v_mov_b32 v39, 0
    s_add_u32 m0, s65, 9216
    s_add_u32 s30, s24, s65
    buffer_load_dwordx4 v1, s[8:11], s30 offen lds
    buffer_load_dwordx4 v1, s[8:11], s30 offen offset:3072 lds
    s_add_u32 m0, s69, 9216
    s_add_u32 s30, s24, s69
    buffer_load_dwordx4 v1, s[8:11], s30 offen lds
    s_add_u32 s24, s24, 262144
    s_branch L_rsg_gather
L_rsg_top:
    s_cmp_ge_u32 s18, 63
    s_cbranch_scc1 L_rsg_last
L_rsg_gather:
    s_barrier
    s_mov_b32 s30, s22
    s_mov_b32 s22, s35
    s_mov_b32 s35, s23
    s_mov_b32 s23, s30
    s_nop 7
    s_nop 7
    s_mov_b32 s29, 1
    ds_read_b128 v[40:43], v10 offset:32768
    ds_read_b128 v[44:47], v10 offset:33792
    ds_read_b128 v[48:51], v10 offset:24576
    ds_read_b128 v[52:55], v10 offset:25600
    ds_read_b128 v[56:59], v10 offset:30720
    ds_read_b128 v[60:63], v10 offset:31744
    s_nop 7
    s_nop 7
    buffer_load_dwordx4 v[12:15], v11, s[8:11], s22 offen offset:0 sc1
    buffer_load_dwordx4 v[16:19], v11, s[8:11], s22 offen offset:1024 sc1
    buffer_load_dwordx4 v[20:23], v11, s[8:11], s22 offen offset:2048 sc1
    s_waitcnt vmcnt(2)
    v_max3_u32 v66, v12, v13, v14
    s_waitcnt vmcnt(1)
    v_max3_u32 v66, v66, v15, v16
    v_max3_u32 v66, v66, v17, v18
    s_waitcnt vmcnt(0)
    v_max3_u32 v66, v66, v19, v20
    v_max3_u32 v66, v66, v21, v22
    v_max_u32 v66, v66, v23
    v_cmp_eq_u32 vcc, -1, v66
    s_nop 0
    s_cbranch_vccnz L_rsg_e2
L_rsg_e2ok:
    ds_write_b128 v11, v[12:15] offset:0
    ds_write_b128 v11, v[16:19] offset:1024
    ds_write_b128 v11, v[20:23] offset:2048
    s_waitcnt lgkmcnt(7)
    v_smfmac_f32_16x16x64_bf16 v[36:39], v[12:15], v[40:47], v3
    ds_read_b128 v[40:43], v10 offset:20480
    v_smfmac_f32_16x16x64_bf16 v[24:27], v[12:15], a[0:7], v3
    ds_read_b128 v[44:47], v10 offset:21504
    v_smfmac_f32_16x16x64_bf16 v[32:35], v[12:15], a[144:151], v3
    v_smfmac_f32_16x16x64_bf16 v[28:31], v[12:15], a[8:15], v3
    s_waitcnt lgkmcnt(7)
    v_smfmac_f32_16x16x64_bf16 v[36:39], v[16:19], v[48:55], v3
    ds_read_b128 v[48:51], v10 offset:26624
    v_smfmac_f32_16x16x64_bf16 v[24:27], v[16:19], a[16:23], v3
    s_waitcnt lgkmcnt(3)
    s_barrier
    ds_read_b128 v[12:15], v2 offset:0
    v_smfmac_f32_16x16x64_bf16 v[32:35], v[16:19], a[152:159], v3
    ds_read_b128 v[52:55], v10 offset:27648
    v_smfmac_f32_16x16x64_bf16 v[28:31], v[16:19], a[24:31], v3
    v_smfmac_f32_16x16x64_bf16 v[36:39], v[20:23], v[56:63], v3
    ds_read_b128 v[16:19], v2 offset:1024
    v_smfmac_f32_16x16x64_bf16 v[24:27], v[20:23], a[32:39], v3
    ds_read_b128 v[56:59], v10 offset:0
    v_smfmac_f32_16x16x64_bf16 v[32:35], v[20:23], a[160:167], v3
    ds_read_b128 v[60:63], v10 offset:1024
    v_smfmac_f32_16x16x64_bf16 v[28:31], v[20:23], a[40:47], v3
    s_waitcnt lgkmcnt(4)
    v_smfmac_f32_16x16x64_bf16 v[36:39], v[12:15], v[40:47], v3
    ds_read_b128 v[40:43], v10 offset:22528
    v_smfmac_f32_16x16x64_bf16 v[24:27], v[12:15], a[48:55], v3
    ds_read_b128 v[44:47], v10 offset:23552
    v_smfmac_f32_16x16x64_bf16 v[32:35], v[12:15], a[168:175], v3
    ds_read_b128 v[20:23], v2 offset:2048
    v_smfmac_f32_16x16x64_bf16 v[28:31], v[12:15], a[56:63], v3
    s_waitcnt lgkmcnt(5)
    v_smfmac_f32_16x16x64_bf16 v[36:39], v[16:19], v[48:55], v3
    ds_read_b128 v[48:51], v10 offset:28672
    v_smfmac_f32_16x16x64_bf16 v[24:27], v[16:19], a[64:71], v3
    ds_read_b128 v[52:55], v10 offset:29696
    v_smfmac_f32_16x16x64_bf16 v[32:35], v[16:19], a[176:183], v3
    ds_read_b128 v[12:15], v9 offset:0
    v_smfmac_f32_16x16x64_bf16 v[28:31], v[16:19], a[72:79], v3
    s_waitcnt lgkmcnt(3)
    v_smfmac_f32_16x16x64_bf16 v[36:39], v[20:23], v[56:63], v3
    ds_read_b128 v[56:59], v10 offset:2048
    v_smfmac_f32_16x16x64_bf16 v[24:27], v[20:23], a[80:87], v3
    ds_read_b128 v[60:63], v10 offset:3072
    v_smfmac_f32_16x16x64_bf16 v[32:35], v[20:23], a[184:191], v3
    ds_read_b128 v[16:19], v9 offset:1024
    v_smfmac_f32_16x16x64_bf16 v[28:31], v[20:23], a[88:95], v3
    s_waitcnt lgkmcnt(3)
    v_smfmac_f32_16x16x64_bf16 v[36:39], v[12:15], v[40:47], v3
    ds_read_b128 v[64:67], v1 offset:9216
    v_smfmac_f32_16x16x64_bf16 v[24:27], v[12:15], a[96:103], v3
    ds_read_b128 v[68:71], v1 offset:10240
    v_smfmac_f32_16x16x64_bf16 v[32:35], v[12:15], a[192:199], v3
    ds_read_b128 v[20:23], v9 offset:2048
    v_smfmac_f32_16x16x64_bf16 v[28:31], v[12:15], a[104:111], v3
    s_waitcnt lgkmcnt(3)
    v_smfmac_f32_16x16x64_bf16 v[36:39], v[16:19], v[48:55], v3
    v_mov_b32 v40, 0
    v_smfmac_f32_16x16x64_bf16 v[24:27], v[16:19], a[112:119], v3
    v_mov_b32 v41, 0
    v_smfmac_f32_16x16x64_bf16 v[32:35], v[16:19], a[200:207], v3
    ds_read_b128 v[12:15], v11 offset:0
    v_smfmac_f32_16x16x64_bf16 v[28:31], v[16:19], a[120:127], v3
    v_mov_b32 v42, 0
    v_mov_b32 v43, 0
    s_waitcnt lgkmcnt(1)
    v_smfmac_f32_16x16x64_bf16 v[32:35], v[20:23], a[208:215], v3
    v_mov_b32 v44, 0
    v_smfmac_f32_16x16x64_bf16 v[24:27], v[20:23], a[128:135], v3
    v_mov_b32 v45, 0
    v_smfmac_f32_16x16x64_bf16 v[36:39], v[20:23], v[56:63], v3
    ds_read_b128 v[16:19], v11 offset:1024
    v_smfmac_f32_16x16x64_bf16 v[28:31], v[20:23], a[136:143], v3
    v_mov_b32 v46, 0
    v_mov_b32 v47, 0
    ds_read_b128 v[20:23], v11 offset:2048
    s_waitcnt lgkmcnt(2)
    v_smfmac_f32_16x16x64_bf16 v[40:43], v[12:15], a[216:223], v3
    v_add_f32 v32, v32, v34
    v_add_f32 v33, v33, v35
    v_add_f32 v24, v24, v26
    v_add_f32 v25, v25, v27
    v_cvt_pk_bf16_f32 v32, v32, v33
    v_cvt_pk_bf16_f32 v33, v24, v25
    ds_write_b64 v4, v[32:33] offset:0
    v_add_f32 v36, v36, v38
    v_add_f32 v37, v37, v39
    v_add_f32 v28, v28, v30
    v_add_f32 v29, v29, v31
    v_cvt_pk_bf16_f32 v36, v36, v37
    v_cvt_pk_bf16_f32 v37, v28, v29
    ds_write_b64 v4, v[36:37] offset:256
    v_lshrrev_b32 v35, 1, v1
    ds_read_b128 v[24:27], v1 offset:11264
    ds_read_b128 v[28:31], v1 offset:12288
    v_smfmac_f32_16x16x64_bf16 v[44:47], v[12:15], a[224:231], v3
    ds_read_b128 v[12:15], v2 offset:0
    s_waitcnt lgkmcnt(6)
    v_smfmac_f32_16x16x64_bf16 v[40:43], v[16:19], a[232:239], v3
    v_smfmac_f32_16x16x64_bf16 v[44:47], v[16:19], a[240:247], v3
    ds_read_b128 v[16:19], v2 offset:1024
    s_waitcnt lgkmcnt(4)
    s_barrier
    ds_read_b64_tr_b16 v[48:49], v35 offset:17408
    ds_read_b64_tr_b16 v[50:51], v35 offset:17920
    ds_read_b64_tr_b16 v[52:53], v35 offset:18432
    ds_read_b64_tr_b16 v[54:55], v35 offset:18944
    ds_read_b64_tr_b16 v[56:57], v35 offset:19456
    ds_read_b64_tr_b16 v[58:59], v35 offset:19968
    ds_read_b64_tr_b16 v[60:61], v35 offset:20480
    ds_read_b64_tr_b16 v[62:63], v35 offset:20992
    v_smfmac_f32_16x16x64_bf16 v[40:43], v[20:23], a[248:255], v3
    v_smfmac_f32_16x16x64_bf16 v[44:47], v[20:23], v[72:79], v3
    s_waitcnt lgkmcnt(6)
    v_mfma_f32_16x16x32_bf16 v[32:35], v[48:51], v[48:51], 0
    v_mfma_f32_16x16x32_bf16 v[36:39], v[64:67], v[48:51], 0
    ds_read_b128 v[64:67], v1 offset:13312
    v_mfma_f32_16x16x32_bf16 v[20:23], v[68:71], v[48:51], 0
    ds_read_b128 v[68:71], v1 offset:14336
    s_waitcnt lgkmcnt(6)
    v_mfma_f32_16x16x32_bf16 v[32:35], v[52:55], v[52:55], v[32:35]
    v_mfma_f32_16x16x32_bf16 v[36:39], v[24:27], v[52:55], v[36:39]
    ds_read_b128 v[24:27], v1 offset:15360
    v_mfma_f32_16x16x32_bf16 v[20:23], v[28:31], v[52:55], v[20:23]
    ds_read_b128 v[28:31], v1 offset:16384
    v_smfmac_f32_16x16x64_bf16 v[40:43], v[12:15], v[80:87], v3
    s_waitcnt lgkmcnt(2)
    v_mfma_f32_16x16x32_bf16 v[32:35], v[56:59], v[56:59], v[32:35]
    v_mfma_f32_16x16x32_bf16 v[36:39], v[64:67], v[56:59], v[36:39]
    v_mfma_f32_16x16x32_bf16 v[20:23], v[68:71], v[56:59], v[20:23]
    ds_read_b128 v[56:59], v2 offset:2048
    s_waitcnt lgkmcnt(1)
    v_mfma_f32_16x16x32_bf16 v[32:35], v[60:63], v[60:63], v[32:35]
    v_mfma_f32_16x16x32_bf16 v[36:39], v[24:27], v[60:63], v[36:39]
    v_mov_b32 v48, 0x3f803f80
    v_mov_b32 v49, 0x3f803f80
    v_mfma_f32_16x16x32_bf16 v[20:23], v[28:31], v[60:63], v[20:23]
    v_mov_b32 v50, 0x3f803f80
    v_mov_b32 v51, 0x3f803f80
    ds_read_b128 v[60:63], v9 offset:0
    v_smfmac_f32_16x16x64_bf16 v[44:47], v[12:15], v[88:95], v3
    ds_read_b128 v[12:15], v9 offset:1024
    buffer_load_dwordx4 v[64:67], v1, s[8:11], s25 offen offset:0
    v_smfmac_f32_16x16x64_bf16 v[40:43], v[16:19], v[96:103], v3
    buffer_load_dwordx4 v[68:71], v1, s[8:11], s25 offen offset:1024
    v_max3_f32 v30, v32, v33, v36
    v_max3_f32 v31, v37, v38, v39
    v_max3_f32 v30, v30, v20, v21
    v_max3_f32 v31, v31, v22, v23
    v_max_f32 v30, v30, v31
    v_max_f32 v31, v30, v31
    v_smfmac_f32_16x16x64_bf16 v[44:47], v[16:19], v[104:111], v3
    ds_read_b128 v[16:19], v9 offset:2048
    v_mov_b32 v52, 0x3f003f00
    v_permlane16_swap_b32 v30, v31
    v_max_f32 v30, v30, v31
    v_max_f32 v31, v30, v31
    s_waitcnt lgkmcnt(3)
    v_smfmac_f32_16x16x64_bf16 v[40:43], v[56:59], v[112:119], v3
    v_mov_b32 v53, 0x3f003f00
    v_permlane32_swap_b32 v30, v31
    v_max_f32 v30, v30, v31
    v_mul_f32 v30, 0xbe0293ee, v30
    v_fma_f32 v36, v36, s68, v30
    v_exp_f32 v36, v36
    v_smfmac_f32_16x16x64_bf16 v[44:47], v[56:59], v[120:127], v3
    v_fma_f32 v37, v37, s68, v30
    v_exp_f32 v37, v37
    s_waitcnt lgkmcnt(2)
    v_smfmac_f32_16x16x64_bf16 v[40:43], v[60:63], v[128:135], v3
    v_fma_f32 v38, v38, s68, v30
    v_cvt_pk_bf16_f32 v24, v36, v37
    v_exp_f32 v38, v38
    v_smfmac_f32_16x16x64_bf16 v[44:47], v[60:63], v[136:143], v3
    v_fma_f32 v39, v39, s68, v30
    v_exp_f32 v39, v39
    s_waitcnt lgkmcnt(1)
    v_smfmac_f32_16x16x64_bf16 v[40:43], v[12:15], v[144:151], v3
    v_fma_f32 v20, v20, s68, v30
    v_cvt_pk_bf16_f32 v25, v38, v39
    v_exp_f32 v20, v20
    v_smfmac_f32_16x16x64_bf16 v[44:47], v[12:15], v[152:159], v3
    v_fma_f32 v21, v21, s68, v30
    v_exp_f32 v21, v21
    s_waitcnt lgkmcnt(0)
    v_smfmac_f32_16x16x64_bf16 v[40:43], v[16:19], v[160:167], v3
    v_fma_f32 v22, v22, s68, v30
    v_cvt_pk_bf16_f32 v26, v20, v21
    v_exp_f32 v22, v22
    v_smfmac_f32_16x16x64_bf16 v[44:47], v[16:19], v[168:175], v3
    v_fma_f32 v23, v23, s68, v30
    v_exp_f32 v23, v23
    v_fma_f32 v32, v32, s68, v30
    v_cvt_pk_bf16_f32 v27, v22, v23
    v_exp_f32 v32, v32
    v_fma_f32 v33, v33, s68, v30
    v_exp_f32 v33, v33
    s_waitcnt vmcnt(0)
    v_cvt_pk_bf16_f32 v28, v32, v33
    v_cvt_pk_bf16_f32 v29, v32, v33
    v_mfma_f32_16x16x32_bf16 v[56:59], v[48:51], v[24:27], 0
    v_mfma_f32_16x16x32_bf16 v[32:35], v[64:67], v[24:27], 0
    v_cvt_pk_bf16_f32 v64, v40, v41
    v_cvt_pk_bf16_f32 v65, v42, v43
    v_mfma_f32_16x16x32_bf16 v[36:39], v[68:71], v[24:27], 0
    v_cvt_pk_bf16_f32 v66, v44, v45
    v_cvt_pk_bf16_f32 v67, v46, v47
    v_mfma_f32_16x16x16_bf16 v[56:59], v[52:53], v[28:29], v[56:59]
    v_mfma_f32_16x16x16_bf16 v[32:35], v[64:65], v[28:29], v[32:35]
    ds_read_b128 v[48:51], v10 offset:18432
    ds_read_b128 v[52:55], v10 offset:19456
    v_mfma_f32_16x16x16_bf16 v[36:39], v[66:67], v[28:29], v[36:39]
    v_mov_b32 v24, 0
    v_mov_b32 v25, 0
    v_mov_b32 v26, 0
    v_mov_b32 v27, 0
    v_rcp_f32 v30, v56
    s_mov_b32 exec_lo, 0xcccccccc
    s_mov_b32 exec_hi, 0xcccccccc
    v_mul_f32 v32, v32, v30
    v_mul_f32 v33, v33, v30
    v_mul_f32 v34, v34, v30
    v_mul_f32 v35, v35, v30
    v_cvt_pk_bf16_f32 v20, v32, v33
    v_cvt_pk_bf16_f32 v21, v34, v35
    v_mul_f32 v36, v36, v30
    v_mul_f32 v37, v37, v30
    v_mul_f32 v38, v38, v30
    v_mul_f32 v39, v39, v30
    v_cvt_pk_bf16_f32 v22, v36, v37
    v_cvt_pk_bf16_f32 v23, v38, v39
    ds_write_b128 v5, v[20:23]
    s_mov_b64 exec, -1
    ds_read_b128 v[56:59], v10 offset:6144
    ds_read_b128 v[60:63], v10 offset:7168
    v_mov_b32 v28, 0
    v_mov_b32 v29, 0
    v_mov_b32 v30, 0
    v_mov_b32 v31, 0
    v_mov_b32 v40, 0
    v_mov_b32 v41, 0
    v_mov_b32 v42, 0
    v_mov_b32 v43, 0
    v_mov_b32 v44, 0
    v_mov_b32 v45, 0
    v_mov_b32 v46, 0
    v_mov_b32 v47, 0
    v_mov_b32 v68, 0
    v_mov_b32 v69, 0
    v_mov_b32 v70, 0
    v_mov_b32 v71, 0
    s_waitcnt lgkmcnt(2)
    s_barrier
    ds_read_b128 v[12:15], v1 offset:21504
    ds_read_b128 v[16:19], v1 offset:22528
    s_add_u32 m0, s65, 9216
    s_add_u32 s30, s24, s65
    buffer_load_dwordx4 v1, s[8:11], s30 offen lds
    buffer_load_dwordx4 v1, s[8:11], s30 offen offset:3072 lds
    s_add_u32 m0, s69, 9216
    s_add_u32 s30, s24, s69
    buffer_load_dwordx4 v1, s[8:11], s30 offen lds
    v_mov_b32 v32, 0
    v_mov_b32 v33, 0
    v_mov_b32 v34, 0
    v_mov_b32 v35, 0
    s_waitcnt lgkmcnt(1)
    v_smfmac_f32_16x16x64_bf16 v[24:27], v[12:15], v[176:183], v3
    v_mov_b32 v36, 0
    v_mov_b32 v37, 0
    s_waitcnt lgkmcnt(0)
    v_smfmac_f32_16x16x64_bf16 v[24:27], v[16:19], v[184:191], v3
    v_mov_b32 v38, 0
    v_mov_b32 v39, 0
    v_smfmac_f32_16x16x64_bf16 v[28:31], v[12:15], v[192:199], v3
    v_mov_b32 v20, 0
    v_mov_b32 v21, 0
    v_smfmac_f32_16x16x64_bf16 v[28:31], v[16:19], v[48:55], v3
    ds_read_b128 v[48:51], v10 offset:8192
    ds_read_b128 v[52:55], v10 offset:9216
    v_mov_b32 v22, 0
    v_mov_b32 v23, 0
    v_smfmac_f32_16x16x64_bf16 v[40:43], v[12:15], v[200:207], v3
    v_add_f32 v26, v24, v26
    v_add_f32 v27, v25, v27
    v_smfmac_f32_16x16x64_bf16 v[40:43], v[16:19], v[56:63], v3
    ds_read_b128 v[56:59], v10 offset:10240
    ds_read_b128 v[60:63], v10 offset:11264
    v_cvt_pk_bf16_f32 v24, v26, v27
    v_smfmac_f32_16x16x64_bf16 v[44:47], v[12:15], v[208:215], v3
    v_add_f32 v30, v28, v30
    v_add_f32 v31, v29, v31
    s_waitcnt lgkmcnt(2)
    v_smfmac_f32_16x16x64_bf16 v[44:47], v[16:19], v[48:55], v3
    ds_read_b128 v[48:51], v10 offset:12288
    ds_read_b128 v[52:55], v10 offset:13312
    v_cvt_pk_bf16_f32 v25, v30, v31
    v_mov_b32 v28, 0
    v_smfmac_f32_16x16x64_bf16 v[68:71], v[12:15], v[216:223], v3
    v_mov_b32 v29, 0
    v_mov_b32 v30, 0
    s_waitcnt lgkmcnt(2)
    v_smfmac_f32_16x16x64_bf16 v[68:71], v[16:19], v[56:63], v3
    ds_read_b128 v[56:59], v10 offset:14336
    ds_read_b128 v[60:63], v10 offset:15360
    v_mov_b32 v31, 0
    v_add_f32 v42, v40, v42
    v_smfmac_f32_16x16x64_bf16 v[32:35], v[12:15], v[224:231], v3
    v_add_f32 v43, v41, v43
    v_cvt_pk_bf16_f32 v26, v42, v43
    s_waitcnt lgkmcnt(2)
    v_smfmac_f32_16x16x64_bf16 v[32:35], v[16:19], v[48:55], v3
    ds_read_b128 v[48:51], v10 offset:16384
    ds_read_b128 v[52:55], v10 offset:17408
    v_add_f32 v46, v44, v46
    v_add_f32 v47, v45, v47
    v_smfmac_f32_16x16x64_bf16 v[36:39], v[12:15], v[232:239], v3
    v_cvt_pk_bf16_f32 v27, v46, v47
    buffer_store_dwordx4 v[24:27], v8, s[8:11], s20 offen sc1
    s_waitcnt lgkmcnt(2)
    v_smfmac_f32_16x16x64_bf16 v[36:39], v[16:19], v[56:63], v3
    ds_read_b128 v[56:59], v10 offset:4096
    ds_read_b128 v[60:63], v10 offset:5120
    v_lshrrev_b32 v40, 2, v1
    v_add_f32 v70, v68, v70
    v_smfmac_f32_16x16x64_bf16 v[20:23], v[12:15], v[240:247], v3
    v_add_f32 v71, v69, v71
    v_cvt_pk_bf16_f32 v68, v70, v71
    s_waitcnt lgkmcnt(2)
    v_smfmac_f32_16x16x64_bf16 v[20:23], v[16:19], v[48:55], v3
    v_add_f32 v34, v32, v34
    v_add_f32 v35, v33, v35
    v_smfmac_f32_16x16x64_bf16 v[28:31], v[12:15], v[248:255], v3
    v_cvt_pk_bf16_f32 v69, v34, v35
    v_add_f32 v38, v36, v38
    s_waitcnt lgkmcnt(0)
    v_smfmac_f32_16x16x64_bf16 v[28:31], v[16:19], v[56:63], v3
    v_add_f32 v39, v37, v39
    v_cvt_pk_bf16_f32 v70, v38, v39
    v_add_f32 v22, v20, v22
    v_add_f32 v23, v21, v23
    v_cvt_pk_bf16_f32 v71, v22, v23
    buffer_store_dwordx4 v[68:71], v8, s[8:11], s20 offen offset:1024 sc1
    s_nop 1
    v_add_f32 v30, v28, v30
    v_add_f32 v31, v29, v31
    v_cvt_pk_bf16_f32 v28, v30, v31
    buffer_store_dword v28, v40, s[8:11], s61 offen sc1
    s_add_u32 s24, s24, 262144
    s_add_u32 s25, s25, 262144
    s_xor_b32 s20, s20, 524288
    s_xor_b32 s61, s61, 524288
    v_mov_b32 v24, 0
    v_mov_b32 v25, 0
    v_mov_b32 v26, 0
    v_mov_b32 v27, 0
    v_mov_b32 v28, 0
    v_mov_b32 v29, 0
    v_mov_b32 v30, 0
    v_mov_b32 v31, 0
    v_mov_b32 v32, 0
    v_mov_b32 v33, 0
    v_mov_b32 v34, 0
    v_mov_b32 v35, 0
    v_mov_b32 v36, 0
    v_mov_b32 v37, 0
    v_mov_b32 v38, 0
    v_mov_b32 v39, 0
    s_mov_b32 s38, s39
    s_add_u32 s39, s39, 9216
    s_add_u32 s18, s18, 1
    s_branch L_rsg_top
L_rsg_e2:
    buffer_load_dwordx4 v[12:15], v11, s[8:11], s22 offen offset:0 sc1
    buffer_load_dwordx4 v[16:19], v11, s[8:11], s22 offen offset:1024 sc1
    buffer_load_dwordx4 v[20:23], v11, s[8:11], s22 offen offset:2048 sc1
    s_add_u32 s29, s29, 1
    s_cmp_ge_u32 s29, 4194304
    s_cbranch_scc1 L_abort
    s_waitcnt vmcnt(2)
    v_max3_u32 v66, v12, v13, v14
    s_waitcnt vmcnt(1)
    v_max3_u32 v66, v66, v15, v16
    v_max3_u32 v66, v66, v17, v18
    s_waitcnt vmcnt(0)
    v_max3_u32 v66, v66, v19, v20
    v_max3_u32 v66, v66, v21, v22
    v_max_u32 v66, v66, v23
    v_cmp_eq_u32 vcc, -1, v66
    s_nop 0
    s_cbranch_vccnz L_rsg_e2
    s_branch L_rsg_e2ok
L_rsg_last:
    s_endpgm
L_rsi_entry:
    v_mov_b32 v24, 0
    v_mov_b32 v25, 0
    v_mov_b32 v26, 0
    v_mov_b32 v27, 0
    v_mov_b32 v28, 0
    v_mov_b32 v29, 0
    v_mov_b32 v30, 0
    v_mov_b32 v31, 0
    v_mov_b32 v32, 0
    v_mov_b32 v33, 0
    v_mov_b32 v34, 0
    v_mov_b32 v35, 0
    v_mov_b32 v36, 0
    v_mov_b32 v37, 0
    v_mov_b32 v38, 0
    v_mov_b32 v39, 0
    v_lshlrev_b32 v64, 3, v1
    buffer_load_dword v0, v64, s[8:11], s24 offen
    s_add_u32 s30, s24, 16777216
    buffer_load_dword v0, v64, s[8:11], s30 offen
    s_add_u32 s24, s24, 262144
    buffer_load_dword v0, v64, s[8:11], s24 offen
    s_add_u32 s30, s24, 16777216
    buffer_load_dword v0, v64, s[8:11], s30 offen
    s_add_u32 s24, s24, 262144
    v_and_b32 v6, 0x3ff, v21
    s_add_u32 s36, s36, 3072
    s_nop 0
    s_branch L_rsi_gather
L_rsi_top:
    s_cmp_ge_u32 s18, 63
    s_cbranch_scc1 L_rsi_last
L_rsi_gather:
    s_barrier
    s_mov_b32 s30, s22
    s_mov_b32 s22, s35
    s_mov_b32 s35, s23
    s_mov_b32 s23, s30
    s_nop 7
    s_nop 7
    v_lshlrev_b32 v64, 3, v1
    s_add_u32 s31, s24, 16777216
    s_mov_b32 s29, 1
    ds_read_b128 v[40:43], v10 offset:32768
    ds_read_b128 v[44:47], v10 offset:33792
    ds_read_b128 v[48:51], v10 offset:24576
    ds_read_b128 v[52:55], v10 offset:25600
    ds_read_b128 v[56:59], v10 offset:30720
    ds_read_b128 v[60:63], v10 offset:31744
    s_nop 7
    s_nop 7
    buffer_load_dwordx4 v[12:15], v11, s[8:11], s22 offen offset:0 sc1
    buffer_load_dwordx4 v[16:19], v11, s[8:11], s22 offen offset:1024 sc1
    buffer_load_dwordx4 v[20:23], v11, s[8:11], s22 offen offset:2048 sc1
    s_waitcnt vmcnt(2)
    v_max3_u32 v66, v12, v13, v14
    s_waitcnt vmcnt(1)
    v_max3_u32 v66, v66, v15, v16
    v_max3_u32 v66, v66, v17, v18
    s_waitcnt vmcnt(0)
    v_max3_u32 v66, v66, v19, v20
    v_max3_u32 v66, v66, v21, v22
    v_max_u32 v66, v66, v23
    v_cmp_eq_u32 vcc, -1, v66
    s_nop 0
    s_cbranch_vccnz L_rsi_e2
L_rsi_e2ok:
    s_mov_b64 exec, s[42:43]
    buffer_store_dwordx4 v[12:15], v11, s[8:11], s38 offen offset:0 sc1
    buffer_store_dwordx4 v[16:19], v11, s[8:11], s38 offen offset:1024 sc1
    buffer_store_dwordx4 v[20:23], v11, s[8:11], s38 offen offset:2048 sc1
    s_mov_b64 exec, -1
    s_waitcnt lgkmcnt(4)
    v_smfmac_f32_16x16x64_bf16 v[36:39], v[12:15], v[40:47], v3
    ds_read_b128 v[40:43], v10 offset:20480
    v_smfmac_f32_16x16x64_bf16 v[24:27], v[12:15], a[0:7], v3
    ds_read_b128 v[44:47], v10 offset:21504
    v_smfmac_f32_16x16x64_bf16 v[32:35], v[12:15], a[144:151], v3
    buffer_load_dword v0, v64, s[8:11], s24 offen
    v_smfmac_f32_16x16x64_bf16 v[28:31], v[12:15], a[8:15], v3
    buffer_load_dword v0, v64, s[8:11], s31 offen
    s_waitcnt lgkmcnt(4)
    v_smfmac_f32_16x16x64_bf16 v[36:39], v[16:19], v[48:55], v3
    ds_read_b128 v[48:51], v10 offset:26624
    v_smfmac_f32_16x16x64_bf16 v[24:27], v[16:19], a[16:23], v3
    s_barrier
    ds_read_b128 v[12:15], v2 offset:0
    v_smfmac_f32_16x16x64_bf16 v[32:35], v[16:19], a[152:159], v3
    ds_read_b128 v[52:55], v10 offset:27648
    v_smfmac_f32_16x16x64_bf16 v[28:31], v[16:19], a[24:31], v3
    buffer_load_dword v7, v6, s[8:11], s36 offen sc1
    s_waitcnt lgkmcnt(5)
    v_smfmac_f32_16x16x64_bf16 v[36:39], v[20:23], v[56:63], v3
    ds_read_b128 v[16:19], v2 offset:1024
    v_smfmac_f32_16x16x64_bf16 v[24:27], v[20:23], a[32:39], v3
    ds_read_b128 v[56:59], v10 offset:0
    v_smfmac_f32_16x16x64_bf16 v[32:35], v[20:23], a[160:167], v3
    ds_read_b128 v[60:63], v10 offset:1024
    v_smfmac_f32_16x16x64_bf16 v[28:31], v[20:23], a[40:47], v3
    s_waitcnt lgkmcnt(4)
    v_smfmac_f32_16x16x64_bf16 v[36:39], v[12:15], v[40:47], v3
    ds_read_b128 v[40:43], v10 offset:22528
    v_smfmac_f32_16x16x64_bf16 v[24:27], v[12:15], a[48:55], v3
    ds_read_b128 v[44:47], v10 offset:23552
    v_smfmac_f32_16x16x64_bf16 v[32:35], v[12:15], a[168:175], v3
    ds_read_b128 v[20:23], v2 offset:2048
    v_smfmac_f32_16x16x64_bf16 v[28:31], v[12:15], a[56:63], v3
    s_waitcnt lgkmcnt(5)
    v_smfmac_f32_16x16x64_bf16 v[36:39], v[16:19], v[48:55], v3
    ds_read_b128 v[48:51], v10 offset:28672
    v_smfmac_f32_16x16x64_bf16 v[24:27], v[16:19], a[64:71], v3
    ds_read_b128 v[52:55], v10 offset:29696
    v_smfmac_f32_16x16x64_bf16 v[32:35], v[16:19], a[176:183], v3
    ds_read_b128 v[12:15], v9 offset:0
    v_smfmac_f32_16x16x64_bf16 v[28:31], v[16:19], a[72:79], v3
    s_waitcnt lgkmcnt(3)
    v_smfmac_f32_16x16x64_bf16 v[36:39], v[20:23], v[56:63], v3
    ds_read_b128 v[56:59], v10 offset:2048
    v_smfmac_f32_16x16x64_bf16 v[24:27], v[20:23], a[80:87], v3
    ds_read_b128 v[60:63], v10 offset:3072
    v_smfmac_f32_16x16x64_bf16 v[32:35], v[20:23], a[184:191], v3
    ds_read_b128 v[16:19], v9 offset:1024
    v_smfmac_f32_16x16x64_bf16 v[28:31], v[20:23], a[88:95], v3
    s_waitcnt lgkmcnt(3)
    v_smfmac_f32_16x16x64_bf16 v[36:39], v[12:15], v[40:47], v3
    ds_read_b128 v[64:67], v1 offset:9216
    v_smfmac_f32_16x16x64_bf16 v[24:27], v[12:15], a[96:103], v3
    ds_read_b128 v[68:71], v1 offset:10240
    v_smfmac_f32_16x16x64_bf16 v[32:35], v[12:15], a[192:199], v3
    ds_read_b128 v[20:23], v9 offset:2048
    v_smfmac_f32_16x16x64_bf16 v[28:31], v[12:15], a[104:111], v3
    s_waitcnt lgkmcnt(3)
    v_smfmac_f32_16x16x64_bf16 v[36:39], v[16:19], v[48:55], v3
    v_mov_b32 v40, 0
    v_smfmac_f32_16x16x64_bf16 v[24:27], v[16:19], a[112:119], v3
    v_mov_b32 v41, 0
    v_smfmac_f32_16x16x64_bf16 v[32:35], v[16:19], a[200:207], v3
    ds_read_b128 v[12:15], v11 offset:0
    v_smfmac_f32_16x16x64_bf16 v[28:31], v[16:19], a[120:127], v3
    v_mov_b32 v42, 0
    v_mov_b32 v43, 0
    s_waitcnt lgkmcnt(1)
    v_smfmac_f32_16x16x64_bf16 v[32:35], v[20:23], a[208:215], v3
    v_mov_b32 v44, 0
    v_smfmac_f32_16x16x64_bf16 v[24:27], v[20:23], a[128:135], v3
    v_mov_b32 v45, 0
    v_smfmac_f32_16x16x64_bf16 v[36:39], v[20:23], v[56:63], v3
    ds_read_b128 v[16:19], v11 offset:1024
    v_smfmac_f32_16x16x64_bf16 v[28:31], v[20:23], a[136:143], v3
    v_mov_b32 v46, 0
    v_mov_b32 v47, 0
    ds_read_b128 v[20:23], v11 offset:2048
    s_waitcnt lgkmcnt(2)
    v_smfmac_f32_16x16x64_bf16 v[40:43], v[12:15], a[216:223], v3
    v_add_f32 v32, v32, v34
    v_add_f32 v33, v33, v35
    v_add_f32 v24, v24, v26
    v_add_f32 v25, v25, v27
    v_cvt_pk_bf16_f32 v32, v32, v33
    v_cvt_pk_bf16_f32 v33, v24, v25
    ds_write_b64 v4, v[32:33] offset:0
    v_add_f32 v36, v36, v38
    v_add_f32 v37, v37, v39
    v_add_f32 v28, v28, v30
    v_add_f32 v29, v29, v31
    v_cvt_pk_bf16_f32 v36, v36, v37
    v_cvt_pk_bf16_f32 v37, v28, v29
    ds_write_b64 v4, v[36:37] offset:256
    v_lshrrev_b32 v35, 1, v1
    ds_read_b128 v[24:27], v1 offset:11264
    ds_read_b128 v[28:31], v1 offset:12288
    v_smfmac_f32_16x16x64_bf16 v[44:47], v[12:15], a[224:231], v3
    ds_read_b128 v[12:15], v2 offset:0
    s_waitcnt lgkmcnt(6)
    v_smfmac_f32_16x16x64_bf16 v[40:43], v[16:19], a[232:239], v3
    v_smfmac_f32_16x16x64_bf16 v[44:47], v[16:19], a[240:247], v3
    ds_read_b128 v[16:19], v2 offset:1024
    s_waitcnt lgkmcnt(4)
    s_barrier
    ds_read_b64_tr_b16 v[48:49], v35 offset:17408
    ds_read_b64_tr_b16 v[50:51], v35 offset:17920
    ds_read_b64_tr_b16 v[52:53], v35 offset:18432
    ds_read_b64_tr_b16 v[54:55], v35 offset:18944
    ds_read_b64_tr_b16 v[56:57], v35 offset:19456
    ds_read_b64_tr_b16 v[58:59], v35 offset:19968
    ds_read_b64_tr_b16 v[60:61], v35 offset:20480
    ds_read_b64_tr_b16 v[62:63], v35 offset:20992
    v_smfmac_f32_16x16x64_bf16 v[40:43], v[20:23], a[248:255], v3
    v_smfmac_f32_16x16x64_bf16 v[44:47], v[20:23], v[72:79], v3
    s_waitcnt lgkmcnt(6)
    v_mfma_f32_16x16x32_bf16 v[32:35], v[48:51], v[48:51], 0
    v_mfma_f32_16x16x32_bf16 v[36:39], v[64:67], v[48:51], 0
    ds_read_b128 v[64:67], v1 offset:13312
    v_mfma_f32_16x16x32_bf16 v[20:23], v[68:71], v[48:51], 0
    ds_read_b128 v[68:71], v1 offset:14336
    s_waitcnt lgkmcnt(6)
    v_mfma_f32_16x16x32_bf16 v[32:35], v[52:55], v[52:55], v[32:35]
    v_mfma_f32_16x16x32_bf16 v[36:39], v[24:27], v[52:55], v[36:39]
    ds_read_b128 v[24:27], v1 offset:15360
    v_mfma_f32_16x16x32_bf16 v[20:23], v[28:31], v[52:55], v[20:23]
    ds_read_b128 v[28:31], v1 offset:16384
    v_smfmac_f32_16x16x64_bf16 v[40:43], v[12:15], v[80:87], v3
    s_waitcnt lgkmcnt(2)
    v_mfma_f32_16x16x32_bf16 v[32:35], v[56:59], v[56:59], v[32:35]
    v_mfma_f32_16x16x32_bf16 v[36:39], v[64:67], v[56:59], v[36:39]
    v_mfma_f32_16x16x32_bf16 v[20:23], v[68:71], v[56:59], v[20:23]
    ds_read_b128 v[56:59], v2 offset:2048
    s_waitcnt lgkmcnt(1)
    v_mfma_f32_16x16x32_bf16 v[32:35], v[60:63], v[60:63], v[32:35]
    v_mfma_f32_16x16x32_bf16 v[36:39], v[24:27], v[60:63], v[36:39]
    v_mov_b32 v48, 0x3f803f80
    v_mov_b32 v49, 0x3f803f80
    v_mfma_f32_16x16x32_bf16 v[20:23], v[28:31], v[60:63], v[20:23]
    v_mov_b32 v50, 0x3f803f80
    v_mov_b32 v51, 0x3f803f80
    ds_read_b128 v[60:63], v9 offset:0
    v_smfmac_f32_16x16x64_bf16 v[44:47], v[12:15], v[88:95], v3
    ds_read_b128 v[12:15], v9 offset:1024
    buffer_load_dwordx4 v[64:67], v1, s[8:11], s25 offen offset:0
    v_smfmac_f32_16x16x64_bf16 v[40:43], v[16:19], v[96:103], v3
    buffer_load_dwordx4 v[68:71], v1, s[8:11], s25 offen offset:1024
    v_max3_f32 v30, v32, v33, v36
    v_max3_f32 v31, v37, v38, v39
    v_max3_f32 v30, v30, v20, v21
    v_max3_f32 v31, v31, v22, v23
    v_max_f32 v30, v30, v31
    v_max_f32 v31, v30, v31
    v_smfmac_f32_16x16x64_bf16 v[44:47], v[16:19], v[104:111], v3
    ds_read_b128 v[16:19], v9 offset:2048
    v_mov_b32 v52, 0x3f003f00
    v_permlane16_swap_b32 v30, v31
    v_max_f32 v30, v30, v31
    v_max_f32 v31, v30, v31
    s_waitcnt lgkmcnt(3)
    v_smfmac_f32_16x16x64_bf16 v[40:43], v[56:59], v[112:119], v3
    v_mov_b32 v53, 0x3f003f00
    v_permlane32_swap_b32 v30, v31
    v_max_f32 v30, v30, v31
    v_mul_f32 v30, 0xbe0293ee, v30
    v_fma_f32 v36, v36, s68, v30
    v_exp_f32 v36, v36
    v_smfmac_f32_16x16x64_bf16 v[44:47], v[56:59], v[120:127], v3
    v_fma_f32 v37, v37, s68, v30
    v_exp_f32 v37, v37
    s_waitcnt lgkmcnt(2)
    v_smfmac_f32_16x16x64_bf16 v[40:43], v[60:63], v[128:135], v3
    v_fma_f32 v38, v38, s68, v30
    v_cvt_pk_bf16_f32 v24, v36, v37
    v_exp_f32 v38, v38
    v_smfmac_f32_16x16x64_bf16 v[44:47], v[60:63], v[136:143], v3
    v_fma_f32 v39, v39, s68, v30
    v_exp_f32 v39, v39
    s_waitcnt lgkmcnt(1)
    v_smfmac_f32_16x16x64_bf16 v[40:43], v[12:15], v[144:151], v3
    v_fma_f32 v20, v20, s68, v30
    v_cvt_pk_bf16_f32 v25, v38, v39
    v_exp_f32 v20, v20
    v_smfmac_f32_16x16x64_bf16 v[44:47], v[12:15], v[152:159], v3
    v_fma_f32 v21, v21, s68, v30
    v_exp_f32 v21, v21
    s_waitcnt lgkmcnt(0)
    v_smfmac_f32_16x16x64_bf16 v[40:43], v[16:19], v[160:167], v3
    v_fma_f32 v22, v22, s68, v30
    v_cvt_pk_bf16_f32 v26, v20, v21
    v_exp_f32 v22, v22
    v_smfmac_f32_16x16x64_bf16 v[44:47], v[16:19], v[168:175], v3
    v_fma_f32 v23, v23, s68, v30
    v_exp_f32 v23, v23
    v_fma_f32 v32, v32, s68, v30
    v_cvt_pk_bf16_f32 v27, v22, v23
    v_exp_f32 v32, v32
    v_fma_f32 v33, v33, s68, v30
    v_exp_f32 v33, v33
    s_waitcnt vmcnt(0)
    v_cvt_pk_bf16_f32 v28, v32, v33
    v_cvt_pk_bf16_f32 v29, v32, v33
    v_mfma_f32_16x16x32_bf16 v[56:59], v[48:51], v[24:27], 0
    v_mfma_f32_16x16x32_bf16 v[32:35], v[64:67], v[24:27], 0
    v_cvt_pk_bf16_f32 v64, v40, v41
    v_cvt_pk_bf16_f32 v65, v42, v43
    v_mfma_f32_16x16x32_bf16 v[36:39], v[68:71], v[24:27], 0
    v_cvt_pk_bf16_f32 v66, v44, v45
    v_cvt_pk_bf16_f32 v67, v46, v47
    v_mfma_f32_16x16x16_bf16 v[56:59], v[52:53], v[28:29], v[56:59]
    v_mfma_f32_16x16x16_bf16 v[32:35], v[64:65], v[28:29], v[32:35]
    ds_read_b128 v[48:51], v10 offset:18432
    ds_read_b128 v[52:55], v10 offset:19456
    v_mfma_f32_16x16x16_bf16 v[36:39], v[66:67], v[28:29], v[36:39]
    v_mov_b32 v24, 0
    v_mov_b32 v25, 0
    v_mov_b32 v26, 0
    v_mov_b32 v27, 0
    v_rcp_f32 v30, v56
    s_mov_b32 exec_lo, 0xcccccccc
    s_mov_b32 exec_hi, 0xcccccccc
    v_mul_f32 v32, v32, v30
    v_mul_f32 v33, v33, v30
    v_mul_f32 v34, v34, v30
    v_mul_f32 v35, v35, v30
    v_cvt_pk_bf16_f32 v20, v32, v33
    v_cvt_pk_bf16_f32 v21, v34, v35
    v_mul_f32 v36, v36, v30
    v_mul_f32 v37, v37, v30
    v_mul_f32 v38, v38, v30
    v_mul_f32 v39, v39, v30
    v_cvt_pk_bf16_f32 v22, v36, v37
    v_cvt_pk_bf16_f32 v23, v38, v39
    ds_write_b128 v5, v[20:23]
    s_mov_b64 exec, -1
    ds_read_b128 v[56:59], v10 offset:6144
    ds_read_b128 v[60:63], v10 offset:7168
    v_mov_b32 v28, 0
    v_mov_b32 v29, 0
    v_mov_b32 v30, 0
    v_mov_b32 v31, 0
    v_mov_b32 v40, 0
    v_mov_b32 v41, 0
    v_mov_b32 v42, 0
    v_mov_b32 v43, 0
    v_mov_b32 v44, 0
    v_mov_b32 v45, 0
    v_mov_b32 v46, 0
    v_mov_b32 v47, 0
    v_mov_b32 v68, 0
    v_mov_b32 v69, 0
    v_mov_b32 v70, 0
    v_mov_b32 v71, 0
    s_waitcnt lgkmcnt(2)
    s_barrier
    ds_read_b128 v[12:15], v1 offset:21504
    ds_read_b128 v[16:19], v1 offset:22528
    v_mov_b32 v32, 0
    v_mov_b32 v33, 0
    v_mov_b32 v34, 0
    v_mov_b32 v35, 0
    v_mov_b32 v36, 0
    v_mov_b32 v37, 0
    v_mov_b32 v38, 0
    v_mov_b32 v39, 0
    s_waitcnt lgkmcnt(1)
    v_smfmac_f32_16x16x64_bf16 v[24:27], v[12:15], v[176:183], v3
    v_mov_b32 v20, 0
    v_mov_b32 v21, 0
    s_waitcnt lgkmcnt(0)
    v_smfmac_f32_16x16x64_bf16 v[24:27], v[16:19], v[184:191], v3
    v_mov_b32 v22, 0
    v_mov_b32 v23, 0
    v_smfmac_f32_16x16x64_bf16 v[28:31], v[12:15], v[192:199], v3
    v_smfmac_f32_16x16x64_bf16 v[28:31], v[16:19], v[48:55], v3
    ds_read_b128 v[48:51], v10 offset:8192
    ds_read_b128 v[52:55], v10 offset:9216
    v_smfmac_f32_16x16x64_bf16 v[40:43], v[12:15], v[200:207], v3
    s_nop 0
    v_add_f32 v26, v24, v26
    v_add_f32 v27, v25, v27
    v_smfmac_f32_16x16x64_bf16 v[40:43], v[16:19], v[56:63], v3
    ds_read_b128 v[56:59], v10 offset:10240
    ds_read_b128 v[60:63], v10 offset:11264
    v_cvt_pk_bf16_f32 v24, v26, v27
    v_smfmac_f32_16x16x64_bf16 v[44:47], v[12:15], v[208:215], v3
    v_add_f32 v30, v28, v30
    v_add_f32 v31, v29, v31
    s_waitcnt lgkmcnt(2)
    v_smfmac_f32_16x16x64_bf16 v[44:47], v[16:19], v[48:55], v3
    ds_read_b128 v[48:51], v10 offset:12288
    ds_read_b128 v[52:55], v10 offset:13312
    v_cvt_pk_bf16_f32 v25, v30, v31
    v_mov_b32 v28, 0
    v_smfmac_f32_16x16x64_bf16 v[68:71], v[12:15], v[216:223], v3
    v_mov_b32 v29, 0
    v_mov_b32 v30, 0
    s_waitcnt lgkmcnt(2)
    v_smfmac_f32_16x16x64_bf16 v[68:71], v[16:19], v[56:63], v3
    ds_read_b128 v[56:59], v10 offset:14336
    ds_read_b128 v[60:63], v10 offset:15360
    v_mov_b32 v31, 0
    v_add_f32 v42, v40, v42
    v_smfmac_f32_16x16x64_bf16 v[32:35], v[12:15], v[224:231], v3
    v_add_f32 v43, v41, v43
    v_cvt_pk_bf16_f32 v26, v42, v43
    s_waitcnt lgkmcnt(2)
    v_smfmac_f32_16x16x64_bf16 v[32:35], v[16:19], v[48:55], v3
    ds_read_b128 v[48:51], v10 offset:16384
    ds_read_b128 v[52:55], v10 offset:17408
    v_add_f32 v46, v44, v46
    v_add_f32 v47, v45, v47
    v_smfmac_f32_16x16x64_bf16 v[36:39], v[12:15], v[232:239], v3
    v_cvt_pk_bf16_f32 v27, v46, v47
    buffer_store_dwordx4 v[24:27], v8, s[8:11], s20 offen sc1
    s_waitcnt lgkmcnt(2)
    v_smfmac_f32_16x16x64_bf16 v[36:39], v[16:19], v[56:63], v3
    ds_read_b128 v[56:59], v10 offset:4096
    ds_read_b128 v[60:63], v10 offset:5120
    v_lshrrev_b32 v40, 2, v1
    v_add_f32 v70, v68, v70
    v_smfmac_f32_16x16x64_bf16 v[20:23], v[12:15], v[240:247], v3
    v_add_f32 v71, v69, v71
    v_cvt_pk_bf16_f32 v68, v70, v71
    s_waitcnt lgkmcnt(2)
    v_smfmac_f32_16x16x64_bf16 v[20:23], v[16:19], v[48:55], v3
    v_add_f32 v34, v32, v34
    v_add_f32 v35, v33, v35
    v_smfmac_f32_16x16x64_bf16 v[28:31], v[12:15], v[248:255], v3
    v_cvt_pk_bf16_f32 v69, v34, v35
    v_add_f32 v38, v36, v38
    s_waitcnt lgkmcnt(0)
    v_smfmac_f32_16x16x64_bf16 v[28:31], v[16:19], v[56:63], v3
    v_add_f32 v39, v37, v39
    v_cvt_pk_bf16_f32 v70, v38, v39
    v_add_f32 v22, v20, v22
    v_add_f32 v23, v21, v23
    v_cvt_pk_bf16_f32 v71, v22, v23
    buffer_store_dwordx4 v[68:71], v8, s[8:11], s20 offen offset:1024 sc1
    s_nop 1
    v_add_f32 v30, v28, v30
    v_add_f32 v31, v29, v31
    v_cvt_pk_bf16_f32 v28, v30, v31
    buffer_store_dword v28, v40, s[8:11], s61 offen sc1
    v_cmp_eq_u32 vcc, 0, v7
    s_cbranch_vccnz L_rsi_fwait
L_rsi_fok:
    s_add_u32 s36, s36, 1024
    s_min_u32 s36, s36, 119733504
    s_add_u32 s24, s24, 262144
    s_add_u32 s25, s25, 262144
    s_xor_b32 s20, s20, 524288
    s_xor_b32 s61, s61, 524288
    v_mov_b32 v24, 0
    v_mov_b32 v25, 0
    v_mov_b32 v26, 0
    v_mov_b32 v27, 0
    v_mov_b32 v28, 0
    v_mov_b32 v29, 0
    v_mov_b32 v30, 0
    v_mov_b32 v31, 0
    v_mov_b32 v32, 0
    v_mov_b32 v33, 0
    v_mov_b32 v34, 0
    v_mov_b32 v35, 0
    v_mov_b32 v36, 0
    v_mov_b32 v37, 0
    v_mov_b32 v38, 0
    v_mov_b32 v39, 0
    s_mov_b32 s38, s39
    s_add_u32 s39, s39, 9216
    s_add_u32 s18, s18, 1
    s_branch L_rsi_top
L_rsi_fwait:
    buffer_load_dword v7, v6, s[8:11], s36 offen sc1
    s_add_u32 s29, s29, 1
    s_cmp_ge_u32 s29, 4194304
    s_cbranch_scc1 L_abort
    s_waitcnt vmcnt(0)
    v_cmp_eq_u32 vcc, 0, v7
    s_cbranch_vccz L_rsi_fok
    s_sleep 4
    s_branch L_rsi_fwait
L_rsi_e2:
    buffer_load_dwordx4 v[12:15], v11, s[8:11], s22 offen offset:0 sc1
    buffer_load_dwordx4 v[16:19], v11, s[8:11], s22 offen offset:1024 sc1
    buffer_load_dwordx4 v[20:23], v11, s[8:11], s22 offen offset:2048 sc1
    s_add_u32 s29, s29, 1
    s_cmp_ge_u32 s29, 4194304
    s_cbranch_scc1 L_abort
    s_waitcnt vmcnt(2)
    v_max3_u32 v66, v12, v13, v14
    s_waitcnt vmcnt(1)
    v_max3_u32 v66, v66, v15, v16
    v_max3_u32 v66, v66, v17, v18
    s_waitcnt vmcnt(0)
    v_max3_u32 v66, v66, v19, v20
    v_max3_u32 v66, v66, v21, v22
    v_max_u32 v66, v66, v23
    v_cmp_eq_u32 vcc, -1, v66
    s_nop 0
    s_cbranch_vccnz L_rsi_e2
    s_branch L_rsi_e2ok
L_rsi_last:
    s_cmp_ge_u32 s66, 3
    s_cbranch_scc1 L_rsi_end
    s_mov_b32 s29, 0
L_rsi_l2:
    buffer_load_dwordx4 v[12:15], v11, s[8:11], s35 offen offset:0 sc1
    buffer_load_dwordx4 v[16:19], v11, s[8:11], s35 offen offset:1024 sc1
    buffer_load_dwordx4 v[20:23], v11, s[8:11], s35 offen offset:2048 sc1
    s_add_u32 s29, s29, 1
    s_cmp_ge_u32 s29, 4194304
    s_cbranch_scc1 L_abort
    s_waitcnt vmcnt(2)
    v_max3_u32 v66, v12, v13, v14
    s_waitcnt vmcnt(1)
    v_max3_u32 v66, v66, v15, v16
    v_max3_u32 v66, v66, v17, v18
    s_waitcnt vmcnt(0)
    v_max3_u32 v66, v66, v19, v20
    v_max3_u32 v66, v66, v21, v22
    v_max_u32 v66, v66, v23
    v_cmp_eq_u32 vcc, -1, v66
    s_nop 0
    s_cbranch_vccnz L_rsi_l2
    s_mov_b64 exec, s[42:43]
    buffer_store_dwordx4 v[12:15], v11, s[8:11], s38 offen offset:0 sc1
    buffer_store_dwordx4 v[16:19], v11, s[8:11], s38 offen offset:1024 sc1
    buffer_store_dwordx4 v[20:23], v11, s[8:11], s38 offen offset:2048 sc1
    s_mov_b64 exec, -1
    s_nop 0
L_rsi_end:
    s_endpgm
.section .rodata,"a"
.p2align 6
.amdhsa_kernel sequential_preLN__memory_aug_recurrent_mem_tr__dense_activation_gelu__prompt_kernel
  .amdhsa_next_free_vgpr 512
  .amdhsa_next_free_sgpr 102
  .amdhsa_accum_offset 256
  .amdhsa_group_segment_fixed_size 0
  .amdhsa_kernarg_size 120
  .amdhsa_user_sgpr_count 2
  .amdhsa_user_sgpr_kernarg_segment_ptr 1
  .amdhsa_system_sgpr_workgroup_id_x 1
.end_amdhsa_kernel
```
